```python
import torch

def _softmax(x, axis=-1):
    return torch.softmax(x, dim=axis)

def _gelu(x):
    return torch.nn.functional.gelu(x, approximate='tanh')

def _silu(x):
    return torch.nn.functional.silu(x)

def _sigmoid(x):
    return torch.sigmoid(x)

def _layernorm(x, axis=-1, eps=1e-05):
    m = x.mean(dim=axis, keepdim=True)
    v = x.var(dim=axis, keepdim=True, unbiased=False)
    return (x - m) / torch.sqrt(v + eps)

def _scatter_add(tgt, idx, src, axis=0):
    return tgt.clone().index_add_(axis, idx, src)

def _segment_sum(src, seg, n):
    out = torch.zeros((n,) + src.shape[1:], dtype=src.dtype)
    return out.index_add_(0, seg, src)

def _pad(x, pw):
    flat = tuple((v for pair in reversed(pw) for v in pair))
    return torch.nn.functional.pad(x, flat)
kernel_name = 'interleave_layers__memory_aug_recurrent_mem_tr__glu_gated_geglu__prompt'

def setup_inputs():

    _w = lambda a: (lambda t: t.to(torch.bfloat16) if t.is_floating_point() else t)(torch.as_tensor(a))

    def _A_setup():
        B, S, Dm = (1, 2048, 1024)
        H, Dh = (32, 128)
        M, seg = (8, 32)
        seg = min(seg, S)
        S = S // seg * seg
        return {'x': _w((lambda *s: torch.randn(*s, dtype=torch.bfloat16) * 0.05)(B, S, Dm)), 'mem0': _w((lambda *s: torch.randn(*s, dtype=torch.bfloat16) * 0.2)(B, M, Dm)), 'Wq': _w((lambda *s: torch.randn(*s, dtype=torch.bfloat16) * 1.6)(Dm, H, Dh) * Dm ** (-0.5)), 'Wk': _w((lambda *s: torch.randn(*s, dtype=torch.bfloat16) * 1.6)(Dm, H, Dh) * Dm ** (-0.5)), 'Wv': _w((lambda *s: torch.randn(*s, dtype=torch.bfloat16) * 0.2)(Dm, H, Dh) * Dm ** (-0.5)), 'Wo': _w((lambda *s: torch.randn(*s, dtype=torch.bfloat16) * 0.2)(H, Dh, Dm) * (H * Dh) ** (-0.5)), 'seg_len': seg}
    _A_in = _A_setup()

    def _B_setup():
        B, S, Dm, Df = (1, 2048, 1024, 3584)
        return {'x': _w((lambda *s: torch.randn(*s, dtype=torch.bfloat16) * 0.05)(B, S, Dm)), 'w_gate': _w((lambda *s: torch.randn(*s, dtype=torch.bfloat16) * 0.4)(Dm, Df) * Dm ** (-0.5)), 'w_up': _w((lambda *s: torch.randn(*s, dtype=torch.bfloat16) * 0.4)(Dm, Df) * Dm ** (-0.5)), 'w_down': _w((lambda *s: torch.randn(*s, dtype=torch.bfloat16) * 0.4)(Df, Dm) * Df ** (-0.5))}
    _B_in = _B_setup()
    return {'A_x': _A_in['x'], 'A_mem0': _A_in['mem0'], 'A_Wq': _A_in['Wq'], 'A_Wk': _A_in['Wk'], 'A_Wv': _A_in['Wv'], 'A_Wo': _A_in['Wo'], 'A_seg_len': _A_in['seg_len'], 'B_x': _B_in['x'], 'B_w_gate': _B_in['w_gate'], 'B_w_up': _B_in['w_up'], 'B_w_down': _B_in['w_down']}

def reference(A_x, A_mem0, A_Wq, A_Wk, A_Wv, A_Wo, A_seg_len, B_x, B_w_gate, B_w_up, B_w_down):

    def _A_ref(x, mem0, Wq, Wk, Wv, Wo, seg_len):
        B, S, Dm = x.shape
        H, Dh = (Wq.shape[1], Wq.shape[2])
        M = mem0.shape[1]
        scale = Dh ** (-0.5)
        n_seg = S // seg_len
        L = M + seg_len
        idx = torch.arange(L)
        mask = (idx[:, None] < M) | (idx[:, None] >= idx[None, :])
        mem = mem0
        outs = []
        for s in range(n_seg):
            xs = x[:, s * seg_len:(s + 1) * seg_len, :].clone()
            h = torch.concatenate([mem, xs], axis=1)
            q = torch.einsum('btd,dhe->bhte', h, Wq)
            k = torch.einsum('btd,dhe->bhte', h, Wk)
            v = torch.einsum('btd,dhe->bhte', h, Wv)
            scores = torch.einsum('bhqe,bhke->bhqk', q, k) * scale
            scores = torch.where(mask[None, None], scores, -1000000000.0)
            p = _softmax(scores, axis=-1)
            o = torch.einsum('bhqk,bhke->bhqe', p, v)
            o = torch.einsum('bhte,hed->btd', o, Wo)
            mem = o[:, :M, :].clone()
            outs.append(o[:, M:, :])
        return torch.concatenate(outs, axis=1)

    def _B_ref(x, w_gate, w_up, w_down):
        g = torch.einsum('bsd,df->bsf', x, w_gate)
        u = torch.einsum('bsd,df->bsf', x, w_up)
        h = _gelu(g) * u
        return torch.einsum('bsf,fd->bsd', h, w_down)
    x = A_x
    x = x + _A_ref(_layernorm(x, axis=-1), A_mem0, A_Wq, A_Wk, A_Wv, A_Wo, A_seg_len)
    x = x + _B_ref(_layernorm(x, axis=-1), B_w_gate, B_w_up, B_w_down)
    x = x + _A_ref(_layernorm(x, axis=-1), A_mem0, A_Wq, A_Wk, A_Wv, A_Wo, A_seg_len)
    x = x + _B_ref(_layernorm(x, axis=-1), B_w_gate, B_w_up, B_w_down)
    return x
```

```asm
; @launch grid=(256,1,1) block=(256,1,1) lds=163840
.amdgcn_target "amdgcn-amd-amdhsa--gfx950"
.text
.globl interleave_layers__memory_aug_recurrent_mem_tr__glu_gated_geglu__prompt_kernel
.p2align 8
.type interleave_layers__memory_aug_recurrent_mem_tr__glu_gated_geglu__prompt_kernel,@function
interleave_layers__memory_aug_recurrent_mem_tr__glu_gated_geglu__prompt_kernel:
    s_cmp_ge_u32 s2, 256
    s_cbranch_scc1 L_exit
    s_load_dwordx16 s[64:79], s[0:1], 0
    s_load_dwordx8 s[80:87], s[0:1], 64
    s_load_dwordx4 s[88:91], s[0:1], 96
    s_getpc_b64 s[8:9]
L_pc_1:
    s_add_u32 s8, s8, L_code-L_pc_1
    s_addc_u32 s9, s9, 0
    s_mov_b32 s10, L_code_end-L_code
    s_mov_b32 s11, 0x20000
L_code:
    s_lshr_b32 s3, s2, 3
    s_lshl_b32 s3, s3, 12
    v_lshlrev_b32 v4, 4, v0
    buffer_load_dwordx4 v[216:219], v4, s[8:11], s3 offen
    s_getreg_b32 s16, hwreg(HW_REG_XCC_ID)
    s_and_b32 s16, s16, 15
    v_readfirstlane_b32 s18, v0
    s_nop 1
    s_lshr_b32 s18, s18, 6
    v_and_b32 v0, 63, v0
    s_waitcnt lgkmcnt(0)
    s_mov_b32 s4, s90
    s_mov_b32 s5, s91
    s_mov_b32 s6, 268435456
    s_mov_b32 s7, 0x20000
    s_mov_b32 s12, s88
    s_mov_b32 s13, s89
    s_mov_b32 s14, 256
    s_mov_b32 s15, 0x20000
    v_mov_b32 v2, 0
    s_lshl_b32 s3, s16, 6
    s_lshl_b32 s20, s16, 4
    s_add_u32 s20, s20, 96
    s_cmp_lt_u32 s16, 2
    s_cselect_b32 s3, s3, s20
    s_cmp_eq_u32 s18, 0
    s_cselect_b32 s3, s3, 0x1000
    s_mov_b32 s21, 1
    s_buffer_atomic_add s21, s[12:15], s3 glc
    s_waitcnt lgkmcnt(0)
    s_cmp_lg_u32 s18, 0
    s_cbranch_scc1 L_tk
    v_mov_b32 v1, s21
    ds_write_b32 v2, v1
    s_waitcnt lgkmcnt(0)
L_tk:
    s_barrier
    ds_read_b32 v1, v2
    s_waitcnt lgkmcnt(0)
    v_readfirstlane_b32 s17, v1
    s_barrier
    s_nop 0
    s_cmp_ge_u32 s17, 32
    s_cbranch_scc1 L_exit
    s_cmp_ge_u32 s16, 8
    s_cbranch_scc1 L_exit
    s_lshl_b32 s93, s16, 5
    s_add_u32 s93, s93, s17
    s_lshl_b32 s93, s93, 7
    s_add_u32 s93, s93, 163840
    buffer_store_dword v2, v2, s[4:7], s93 offen sc1
    s_mov_b32 s2, s16
    s_cmp_lt_u32 s16, 2
    s_cbranch_scc1 L_role_R
    s_sub_u32 s20, s16, 2
    s_lshl_b32 s21, s20, 3
    s_add_u32 s21, s21, s17
    s_sub_u32 s22, s17, 8
    s_mul_i32 s22, s22, 6
    s_add_u32 s22, s22, s20
    s_add_u32 s22, s22, 48
    s_cmp_lt_u32 s17, 8
    s_cselect_b32 s23, s21, s22
    s_mul_i32 s21, s23, 640
    s_add_u32 s21, s21, 1654784
    v_lshlrev_b32 v4, 3, v0
    v_mov_b32 v3, 0
    buffer_store_dwordx2 v[2:3], v4, s[4:7], s21 offen sc1
    s_mov_b32 s78, s23
    s_mov_b32 s79, 0
    s_sub_u32 s21, s23, 64
    s_cmp_lt_u32 s23, 48
    s_cselect_b32 s21, s23, s21
    s_cbranch_scc1 L_ln0
    s_cmp_lt_u32 s23, 112
    s_cbranch_scc1 L_disp
L_ln0:
    s_lshl_b32 s21, s21, 2
    s_add_u32 s21, s21, s18
    s_mov_b32 s8, s64
    s_mov_b32 s9, s65
    s_mov_b32 s10, 4194304
    s_mov_b32 s11, 0x20000
    v_and_b32 v2, 3, v0
    v_lshlrev_b32 v2, 11, v2
    v_lshrrev_b32 v3, 2, v0
    v_lshl_add_u32 v2, v3, 4, v2
    v_lshlrev_b32 v3, 4, v0
    s_lshl_b32 s92, s21, 13
    s_add_u32 s93, s92, 88080384
    s_add_u32 s94, s93, 4096
    buffer_load_dwordx4 v[192:195], v2, s[8:11], s92 offen offset:0
    buffer_load_dwordx4 v[196:199], v2, s[8:11], s92 offen offset:256
    buffer_load_dwordx4 v[200:203], v2, s[8:11], s92 offen offset:512
    buffer_load_dwordx4 v[204:207], v2, s[8:11], s92 offen offset:768
    buffer_load_dwordx4 v[208:211], v2, s[8:11], s92 offen offset:1024
    buffer_load_dwordx4 v[212:215], v2, s[8:11], s92 offen offset:1280
    buffer_load_dwordx4 v[216:219], v2, s[8:11], s92 offen offset:1536
    buffer_load_dwordx4 v[220:223], v2, s[8:11], s92 offen offset:1792
    s_waitcnt vmcnt(7)
    v_lshlrev_b32 v128, 16, v192
    v_and_b32 v129, 0xffff0000, v192
    v_lshlrev_b32 v130, 16, v193
    v_and_b32 v131, 0xffff0000, v193
    v_lshlrev_b32 v132, 16, v194
    v_and_b32 v133, 0xffff0000, v194
    v_lshlrev_b32 v134, 16, v195
    v_and_b32 v135, 0xffff0000, v195
    v_pk_add_f32 v[8:9], v[128:129], 0 op_sel_hi:[1,0]
    v_pk_mul_f32 v[10:11], v[128:129], v[128:129]
    v_pk_add_f32 v[8:9], v[8:9], v[130:131]
    v_pk_fma_f32 v[10:11], v[130:131], v[130:131], v[10:11]
    v_pk_add_f32 v[8:9], v[8:9], v[132:133]
    v_pk_fma_f32 v[10:11], v[132:133], v[132:133], v[10:11]
    v_pk_add_f32 v[8:9], v[8:9], v[134:135]
    v_pk_fma_f32 v[10:11], v[134:135], v[134:135], v[10:11]
    s_waitcnt vmcnt(6)
    v_lshlrev_b32 v136, 16, v196
    v_and_b32 v137, 0xffff0000, v196
    v_lshlrev_b32 v138, 16, v197
    v_and_b32 v139, 0xffff0000, v197
    v_lshlrev_b32 v140, 16, v198
    v_and_b32 v141, 0xffff0000, v198
    v_lshlrev_b32 v142, 16, v199
    v_and_b32 v143, 0xffff0000, v199
    v_pk_add_f32 v[8:9], v[8:9], v[136:137]
    v_pk_fma_f32 v[10:11], v[136:137], v[136:137], v[10:11]
    v_pk_add_f32 v[8:9], v[8:9], v[138:139]
    v_pk_fma_f32 v[10:11], v[138:139], v[138:139], v[10:11]
    v_pk_add_f32 v[8:9], v[8:9], v[140:141]
    v_pk_fma_f32 v[10:11], v[140:141], v[140:141], v[10:11]
    v_pk_add_f32 v[8:9], v[8:9], v[142:143]
    v_pk_fma_f32 v[10:11], v[142:143], v[142:143], v[10:11]
    s_waitcnt vmcnt(5)
    v_lshlrev_b32 v144, 16, v200
    v_and_b32 v145, 0xffff0000, v200
    v_lshlrev_b32 v146, 16, v201
    v_and_b32 v147, 0xffff0000, v201
    v_lshlrev_b32 v148, 16, v202
    v_and_b32 v149, 0xffff0000, v202
    v_lshlrev_b32 v150, 16, v203
    v_and_b32 v151, 0xffff0000, v203
    v_pk_add_f32 v[8:9], v[8:9], v[144:145]
    v_pk_fma_f32 v[10:11], v[144:145], v[144:145], v[10:11]
    v_pk_add_f32 v[8:9], v[8:9], v[146:147]
    v_pk_fma_f32 v[10:11], v[146:147], v[146:147], v[10:11]
    v_pk_add_f32 v[8:9], v[8:9], v[148:149]
    v_pk_fma_f32 v[10:11], v[148:149], v[148:149], v[10:11]
    v_pk_add_f32 v[8:9], v[8:9], v[150:151]
    v_pk_fma_f32 v[10:11], v[150:151], v[150:151], v[10:11]
    s_waitcnt vmcnt(4)
    v_lshlrev_b32 v152, 16, v204
    v_and_b32 v153, 0xffff0000, v204
    v_lshlrev_b32 v154, 16, v205
    v_and_b32 v155, 0xffff0000, v205
    v_lshlrev_b32 v156, 16, v206
    v_and_b32 v157, 0xffff0000, v206
    v_lshlrev_b32 v158, 16, v207
    v_and_b32 v159, 0xffff0000, v207
    v_pk_add_f32 v[8:9], v[8:9], v[152:153]
    v_pk_fma_f32 v[10:11], v[152:153], v[152:153], v[10:11]
    v_pk_add_f32 v[8:9], v[8:9], v[154:155]
    v_pk_fma_f32 v[10:11], v[154:155], v[154:155], v[10:11]
    v_pk_add_f32 v[8:9], v[8:9], v[156:157]
    v_pk_fma_f32 v[10:11], v[156:157], v[156:157], v[10:11]
    v_pk_add_f32 v[8:9], v[8:9], v[158:159]
    v_pk_fma_f32 v[10:11], v[158:159], v[158:159], v[10:11]
    s_waitcnt vmcnt(3)
    v_lshlrev_b32 v160, 16, v208
    v_and_b32 v161, 0xffff0000, v208
    v_lshlrev_b32 v162, 16, v209
    v_and_b32 v163, 0xffff0000, v209
    v_lshlrev_b32 v164, 16, v210
    v_and_b32 v165, 0xffff0000, v210
    v_lshlrev_b32 v166, 16, v211
    v_and_b32 v167, 0xffff0000, v211
    v_pk_add_f32 v[8:9], v[8:9], v[160:161]
    v_pk_fma_f32 v[10:11], v[160:161], v[160:161], v[10:11]
    v_pk_add_f32 v[8:9], v[8:9], v[162:163]
    v_pk_fma_f32 v[10:11], v[162:163], v[162:163], v[10:11]
    v_pk_add_f32 v[8:9], v[8:9], v[164:165]
    v_pk_fma_f32 v[10:11], v[164:165], v[164:165], v[10:11]
    v_pk_add_f32 v[8:9], v[8:9], v[166:167]
    v_pk_fma_f32 v[10:11], v[166:167], v[166:167], v[10:11]
    s_waitcnt vmcnt(2)
    v_lshlrev_b32 v168, 16, v212
    v_and_b32 v169, 0xffff0000, v212
    v_lshlrev_b32 v170, 16, v213
    v_and_b32 v171, 0xffff0000, v213
    v_lshlrev_b32 v172, 16, v214
    v_and_b32 v173, 0xffff0000, v214
    v_lshlrev_b32 v174, 16, v215
    v_and_b32 v175, 0xffff0000, v215
    v_pk_add_f32 v[8:9], v[8:9], v[168:169]
    v_pk_fma_f32 v[10:11], v[168:169], v[168:169], v[10:11]
    v_pk_add_f32 v[8:9], v[8:9], v[170:171]
    v_pk_fma_f32 v[10:11], v[170:171], v[170:171], v[10:11]
    v_pk_add_f32 v[8:9], v[8:9], v[172:173]
    v_pk_fma_f32 v[10:11], v[172:173], v[172:173], v[10:11]
    v_pk_add_f32 v[8:9], v[8:9], v[174:175]
    v_pk_fma_f32 v[10:11], v[174:175], v[174:175], v[10:11]
    s_waitcnt vmcnt(1)
    v_lshlrev_b32 v176, 16, v216
    v_and_b32 v177, 0xffff0000, v216
    v_lshlrev_b32 v178, 16, v217
    v_and_b32 v179, 0xffff0000, v217
    v_lshlrev_b32 v180, 16, v218
    v_and_b32 v181, 0xffff0000, v218
    v_lshlrev_b32 v182, 16, v219
    v_and_b32 v183, 0xffff0000, v219
    v_pk_add_f32 v[8:9], v[8:9], v[176:177]
    v_pk_fma_f32 v[10:11], v[176:177], v[176:177], v[10:11]
    v_pk_add_f32 v[8:9], v[8:9], v[178:179]
    v_pk_fma_f32 v[10:11], v[178:179], v[178:179], v[10:11]
    v_pk_add_f32 v[8:9], v[8:9], v[180:181]
    v_pk_fma_f32 v[10:11], v[180:181], v[180:181], v[10:11]
    v_pk_add_f32 v[8:9], v[8:9], v[182:183]
    v_pk_fma_f32 v[10:11], v[182:183], v[182:183], v[10:11]
    s_waitcnt vmcnt(0)
    v_lshlrev_b32 v184, 16, v220
    v_and_b32 v185, 0xffff0000, v220
    v_lshlrev_b32 v186, 16, v221
    v_and_b32 v187, 0xffff0000, v221
    v_lshlrev_b32 v188, 16, v222
    v_and_b32 v189, 0xffff0000, v222
    v_lshlrev_b32 v190, 16, v223
    v_and_b32 v191, 0xffff0000, v223
    v_pk_add_f32 v[8:9], v[8:9], v[184:185]
    v_pk_fma_f32 v[10:11], v[184:185], v[184:185], v[10:11]
    v_pk_add_f32 v[8:9], v[8:9], v[186:187]
    v_pk_fma_f32 v[10:11], v[186:187], v[186:187], v[10:11]
    v_pk_add_f32 v[8:9], v[8:9], v[188:189]
    v_pk_fma_f32 v[10:11], v[188:189], v[188:189], v[10:11]
    v_pk_add_f32 v[8:9], v[8:9], v[190:191]
    v_pk_fma_f32 v[10:11], v[190:191], v[190:191], v[10:11]
    v_add_f32 v8, v8, v9
    v_add_f32 v9, v10, v11
    s_nop 0
    v_add_f32_dpp v8, v8, v8 row_ror:4 row_mask:0xf bank_mask:0xf
    v_add_f32_dpp v9, v9, v9 row_ror:4 row_mask:0xf bank_mask:0xf
    s_nop 0
    v_add_f32_dpp v8, v8, v8 row_ror:8 row_mask:0xf bank_mask:0xf
    v_add_f32_dpp v9, v9, v9 row_ror:8 row_mask:0xf bank_mask:0xf
    v_mov_b32 v10, v8
    v_mov_b32 v11, v9
    s_nop 0
    v_permlane16_swap_b32 v8, v10
    v_permlane16_swap_b32 v9, v11
    v_add_f32 v8, v8, v10
    v_add_f32 v9, v9, v11
    v_mov_b32 v10, v8
    v_mov_b32 v11, v9
    s_nop 0
    v_permlane32_swap_b32 v8, v10
    v_permlane32_swap_b32 v9, v11
    v_add_f32 v8, v8, v10
    v_add_f32 v9, v9, v11
    v_mul_f32 v8, 0x3a800000, v8
    v_mul_f32 v9, 0x3a800000, v9
    v_fma_f32 v9, -v8, v8, v9
    v_max_f32 v9, 0, v9
    v_add_f32 v9, 0x3727c5ac, v9
    v_rsq_f32 v10, v9
    s_nop 0
    v_mul_f32 v8, v8, v10
    v_pk_fma_f32 v[128:129], v[128:129], v[10:11], v[8:9] op_sel_hi:[1,0,0] neg_lo:[0,0,1] neg_hi:[0,0,1]
    v_pk_fma_f32 v[130:131], v[130:131], v[10:11], v[8:9] op_sel_hi:[1,0,0] neg_lo:[0,0,1] neg_hi:[0,0,1]
    v_pk_fma_f32 v[132:133], v[132:133], v[10:11], v[8:9] op_sel_hi:[1,0,0] neg_lo:[0,0,1] neg_hi:[0,0,1]
    v_pk_fma_f32 v[134:135], v[134:135], v[10:11], v[8:9] op_sel_hi:[1,0,0] neg_lo:[0,0,1] neg_hi:[0,0,1]
    v_cvt_pk_bf16_f32 v224, v128, v129
    v_cvt_pk_bf16_f32 v225, v130, v131
    v_cvt_pk_bf16_f32 v226, v132, v133
    v_cvt_pk_bf16_f32 v227, v134, v135
    buffer_store_dwordx4 v[224:227], v3, s[4:7], s93 offen offset:0 sc1
    v_pk_fma_f32 v[136:137], v[136:137], v[10:11], v[8:9] op_sel_hi:[1,0,0] neg_lo:[0,0,1] neg_hi:[0,0,1]
    v_pk_fma_f32 v[138:139], v[138:139], v[10:11], v[8:9] op_sel_hi:[1,0,0] neg_lo:[0,0,1] neg_hi:[0,0,1]
    v_pk_fma_f32 v[140:141], v[140:141], v[10:11], v[8:9] op_sel_hi:[1,0,0] neg_lo:[0,0,1] neg_hi:[0,0,1]
    v_pk_fma_f32 v[142:143], v[142:143], v[10:11], v[8:9] op_sel_hi:[1,0,0] neg_lo:[0,0,1] neg_hi:[0,0,1]
    v_cvt_pk_bf16_f32 v228, v136, v137
    v_cvt_pk_bf16_f32 v229, v138, v139
    v_cvt_pk_bf16_f32 v230, v140, v141
    v_cvt_pk_bf16_f32 v231, v142, v143
    buffer_store_dwordx4 v[228:231], v3, s[4:7], s93 offen offset:1024 sc1
    v_pk_fma_f32 v[144:145], v[144:145], v[10:11], v[8:9] op_sel_hi:[1,0,0] neg_lo:[0,0,1] neg_hi:[0,0,1]
    v_pk_fma_f32 v[146:147], v[146:147], v[10:11], v[8:9] op_sel_hi:[1,0,0] neg_lo:[0,0,1] neg_hi:[0,0,1]
    v_pk_fma_f32 v[148:149], v[148:149], v[10:11], v[8:9] op_sel_hi:[1,0,0] neg_lo:[0,0,1] neg_hi:[0,0,1]
    v_pk_fma_f32 v[150:151], v[150:151], v[10:11], v[8:9] op_sel_hi:[1,0,0] neg_lo:[0,0,1] neg_hi:[0,0,1]
    v_cvt_pk_bf16_f32 v232, v144, v145
    v_cvt_pk_bf16_f32 v233, v146, v147
    v_cvt_pk_bf16_f32 v234, v148, v149
    v_cvt_pk_bf16_f32 v235, v150, v151
    buffer_store_dwordx4 v[232:235], v3, s[4:7], s93 offen offset:2048 sc1
    v_pk_fma_f32 v[152:153], v[152:153], v[10:11], v[8:9] op_sel_hi:[1,0,0] neg_lo:[0,0,1] neg_hi:[0,0,1]
    v_pk_fma_f32 v[154:155], v[154:155], v[10:11], v[8:9] op_sel_hi:[1,0,0] neg_lo:[0,0,1] neg_hi:[0,0,1]
    v_pk_fma_f32 v[156:157], v[156:157], v[10:11], v[8:9] op_sel_hi:[1,0,0] neg_lo:[0,0,1] neg_hi:[0,0,1]
    v_pk_fma_f32 v[158:159], v[158:159], v[10:11], v[8:9] op_sel_hi:[1,0,0] neg_lo:[0,0,1] neg_hi:[0,0,1]
    v_cvt_pk_bf16_f32 v236, v152, v153
    v_cvt_pk_bf16_f32 v237, v154, v155
    v_cvt_pk_bf16_f32 v238, v156, v157
    v_cvt_pk_bf16_f32 v239, v158, v159
    buffer_store_dwordx4 v[236:239], v3, s[4:7], s93 offen offset:3072 sc1
    v_pk_fma_f32 v[160:161], v[160:161], v[10:11], v[8:9] op_sel_hi:[1,0,0] neg_lo:[0,0,1] neg_hi:[0,0,1]
    v_pk_fma_f32 v[162:163], v[162:163], v[10:11], v[8:9] op_sel_hi:[1,0,0] neg_lo:[0,0,1] neg_hi:[0,0,1]
    v_pk_fma_f32 v[164:165], v[164:165], v[10:11], v[8:9] op_sel_hi:[1,0,0] neg_lo:[0,0,1] neg_hi:[0,0,1]
    v_pk_fma_f32 v[166:167], v[166:167], v[10:11], v[8:9] op_sel_hi:[1,0,0] neg_lo:[0,0,1] neg_hi:[0,0,1]
    v_cvt_pk_bf16_f32 v224, v160, v161
    v_cvt_pk_bf16_f32 v225, v162, v163
    v_cvt_pk_bf16_f32 v226, v164, v165
    v_cvt_pk_bf16_f32 v227, v166, v167
    buffer_store_dwordx4 v[224:227], v3, s[4:7], s94 offen offset:0 sc1
    v_pk_fma_f32 v[168:169], v[168:169], v[10:11], v[8:9] op_sel_hi:[1,0,0] neg_lo:[0,0,1] neg_hi:[0,0,1]
    v_pk_fma_f32 v[170:171], v[170:171], v[10:11], v[8:9] op_sel_hi:[1,0,0] neg_lo:[0,0,1] neg_hi:[0,0,1]
    v_pk_fma_f32 v[172:173], v[172:173], v[10:11], v[8:9] op_sel_hi:[1,0,0] neg_lo:[0,0,1] neg_hi:[0,0,1]
    v_pk_fma_f32 v[174:175], v[174:175], v[10:11], v[8:9] op_sel_hi:[1,0,0] neg_lo:[0,0,1] neg_hi:[0,0,1]
    v_cvt_pk_bf16_f32 v228, v168, v169
    v_cvt_pk_bf16_f32 v229, v170, v171
    v_cvt_pk_bf16_f32 v230, v172, v173
    v_cvt_pk_bf16_f32 v231, v174, v175
    buffer_store_dwordx4 v[228:231], v3, s[4:7], s94 offen offset:1024 sc1
    v_pk_fma_f32 v[176:177], v[176:177], v[10:11], v[8:9] op_sel_hi:[1,0,0] neg_lo:[0,0,1] neg_hi:[0,0,1]
    v_pk_fma_f32 v[178:179], v[178:179], v[10:11], v[8:9] op_sel_hi:[1,0,0] neg_lo:[0,0,1] neg_hi:[0,0,1]
    v_pk_fma_f32 v[180:181], v[180:181], v[10:11], v[8:9] op_sel_hi:[1,0,0] neg_lo:[0,0,1] neg_hi:[0,0,1]
    v_pk_fma_f32 v[182:183], v[182:183], v[10:11], v[8:9] op_sel_hi:[1,0,0] neg_lo:[0,0,1] neg_hi:[0,0,1]
    v_cvt_pk_bf16_f32 v232, v176, v177
    v_cvt_pk_bf16_f32 v233, v178, v179
    v_cvt_pk_bf16_f32 v234, v180, v181
    v_cvt_pk_bf16_f32 v235, v182, v183
    buffer_store_dwordx4 v[232:235], v3, s[4:7], s94 offen offset:2048 sc1
    v_pk_fma_f32 v[184:185], v[184:185], v[10:11], v[8:9] op_sel_hi:[1,0,0] neg_lo:[0,0,1] neg_hi:[0,0,1]
    v_pk_fma_f32 v[186:187], v[186:187], v[10:11], v[8:9] op_sel_hi:[1,0,0] neg_lo:[0,0,1] neg_hi:[0,0,1]
    v_pk_fma_f32 v[188:189], v[188:189], v[10:11], v[8:9] op_sel_hi:[1,0,0] neg_lo:[0,0,1] neg_hi:[0,0,1]
    v_pk_fma_f32 v[190:191], v[190:191], v[10:11], v[8:9] op_sel_hi:[1,0,0] neg_lo:[0,0,1] neg_hi:[0,0,1]
    v_cvt_pk_bf16_f32 v236, v184, v185
    v_cvt_pk_bf16_f32 v237, v186, v187
    v_cvt_pk_bf16_f32 v238, v188, v189
    v_cvt_pk_bf16_f32 v239, v190, v191
    buffer_store_dwordx4 v[236:239], v3, s[4:7], s94 offen offset:3072 sc1
L_disp:
    s_sub_u32 s19, s23, 0
    s_cmp_lt_u32 s19, 24
    s_cbranch_scc1 L_role_WO
    s_sub_u32 s19, s23, 24
    s_cmp_lt_u32 s19, 24
    s_cbranch_scc1 L_role_DN
    s_sub_u32 s19, s23, 48
    s_cmp_lt_u32 s19, 64
    s_cbranch_scc1 L_role_PJ
    s_sub_u32 s19, s23, 112
    s_cmp_lt_u32 s19, 16
    s_cbranch_scc1 L_role_AT
    s_sub_u32 s19, s23, 128
    s_cmp_lt_u32 s19, 56
    s_cbranch_scc1 L_role_GU
    s_sub_u32 s19, s23, 184
    s_branch L_role_LN
L_role_LN:
    v_mov_b32 v20, v0
    v_lshlrev_b32 v0, 4, v20
    v_mov_b32 v3, 0
    s_cmp_eq_u32 s18, 1
    s_cselect_b32 s92, 64, 56
    v_add_u32 v21, 0, v20
    v_mul_u32_u24 v21, 640, v21
    v_mov_b32 v22, 0x40000000
    v_cmp_gt_u32 vcc, s92, v20
    s_nop 1
    v_cndmask_b32 v2, v22, v21, vcc
    v_mov_b32 v5, 1
    s_and_b32 s92, s18, 1
    s_lshl_b32 s92, s92, 3
    s_add_u32 s92, s92, s19
    s_mul_i32 s60, s92, 640
    s_add_u32 s60, s60, 1726464
    v_and_b32 v21, 3, v20
    v_lshlrev_b32 v21, 11, v21
    v_lshrrev_b32 v22, 2, v20
    v_lshl_add_u32 v21, v22, 4, v21
    v_mov_b32 v6, v21
    v_and_b32 v22, 3, v20
    v_lshl_add_u32 v7, v22, 6, v21
    v_add_u32 v7, 1024, v7
    s_lshl_b32 s95, s19, 13
    s_lshl_b32 s94, s18, 22
    s_mov_b32 s8, s64
    s_mov_b32 s9, s65
    s_mov_b32 s10, 4194304
    s_mov_b32 s11, 0x20000
    s_add_u32 s23, s94, 100663296
    s_cmp_eq_u32 s18, 0
    s_cselect_b32 s23, 0, s23
    s_add_u32 s23, s23, s95
    s_mov_b32 s52, s86
    s_mov_b32 s53, s87
    s_mov_b32 s54, 4194304
    s_mov_b32 s55, 0x20000
    s_bitcmp1_b32 s18, 0
    s_cselect_b32 s24, 63, 31
    s_add_u32 s25, s94, 104857600
    s_cmp_eq_u32 s18, 3
    s_cselect_b32 s25, 0, s25
    s_add_u32 s25, s25, s95
    s_add_u32 s27, s94, 92274688
    s_add_u32 s27, s27, s95
    s_cmp_eq_u32 s18, 1
    s_cselect_b32 s28, 0, 51200
    s_min_u32 s92, s18, 1
    s_lshl_b32 s92, s92, 8
    s_add_u32 s28, s28, s92
    s_add_u32 s28, s28, 1685504
    s_and_b32 s92, s18, 1
    s_lshr_b32 s93, s18, 1
    s_mul_i32 s22, s92, 25165824
    s_mul_i32 s33, s93, 12582912
    s_add_u32 s22, s22, s33
    s_add_u32 s22, s22, 184549376
    s_add_u32 s22, s22, s95
    s_lshl_b32 s93, s93, 8
    s_add_u32 s33, s60, s93
    v_mov_b32 v240, 0
    v_mov_b32 v241, 0
    v_mov_b32 v242, 0
    v_mov_b32 v243, 0
    v_mov_b32 v244, 0
    v_mov_b32 v245, 0
    s_mov_b32 s92, 0x3f80
    s_mov_b32 s93, 0x3f800000
    v_writelane_b32 v242, s92, 0
    v_writelane_b32 v242, s93, 1
    v_writelane_b32 v243, s92, 2
    v_writelane_b32 v243, s93, 3
    v_writelane_b32 v242, s92, 20
    v_writelane_b32 v242, s93, 21
    v_writelane_b32 v243, s92, 22
    v_writelane_b32 v243, s93, 23
    v_writelane_b32 v242, s92, 40
    v_writelane_b32 v242, s93, 41
    v_writelane_b32 v243, s92, 42
    v_writelane_b32 v243, s93, 43
    v_writelane_b32 v242, s92, 60
    v_writelane_b32 v242, s93, 61
    v_writelane_b32 v243, s92, 62
    v_writelane_b32 v243, s93, 63
    v_mov_b32 v232, 0x3f803f80
    v_mov_b32 v236, 0
    v_mov_b32 v233, 0x3f803f80
    v_mov_b32 v237, 0
    v_mov_b32 v234, 0x3f803f80
    v_mov_b32 v238, 0
    v_mov_b32 v235, 0x3f803f80
    v_mov_b32 v239, 0
    v_writelane_b32 v236, s93, 0
    v_writelane_b32 v237, s93, 1
    v_writelane_b32 v238, s93, 2
    v_writelane_b32 v239, s93, 3
    v_writelane_b32 v236, s93, 20
    v_writelane_b32 v237, s93, 21
    v_writelane_b32 v238, s93, 22
    v_writelane_b32 v239, s93, 23
    v_writelane_b32 v236, s93, 40
    v_writelane_b32 v237, s93, 41
    v_writelane_b32 v238, s93, 42
    v_writelane_b32 v239, s93, 43
    v_writelane_b32 v236, s93, 60
    v_writelane_b32 v237, s93, 61
    v_writelane_b32 v238, s93, 62
    v_writelane_b32 v239, s93, 63
    s_lshl_b32 s92, s18, 2
    v_mov_b32 v4, s92
    v_add_u32 v1, 4, v4
    v_mov_b32 v8, 64
    ds_write_b32 v1, v3
    ds_write_b32 v3, v8
    s_waitcnt lgkmcnt(0)
    s_waitcnt vmcnt(0)
    s_barrier
    s_cmp_lg_u32 s18, 0
    s_cbranch_scc1 L_arr_2
    s_mov_b32 s3, 1
    s_buffer_atomic_add s3, s[12:15], 4 glc
    s_waitcnt lgkmcnt(0)
    s_add_u32 s3, s3, 1
    s_and_b32 s92, s3, 0xffff
    s_cmp_lg_u32 s92, 256
    s_cbranch_scc1 L_arr_2
    v_mov_b32 v20, s3
    v_lshlrev_b32 v21, 3, v0
    s_mov_b32 s92, 163840
    buffer_store_dword v20, v21, s[4:7], s92 offen sc1
    s_mov_b32 s92, 172032
    buffer_store_dword v20, v21, s[4:7], s92 offen sc1
    s_mov_b32 s92, 180224
    buffer_store_dword v20, v21, s[4:7], s92 offen sc1
    s_mov_b32 s92, 188416
    buffer_store_dword v20, v21, s[4:7], s92 offen sc1
    s_waitcnt vmcnt(0)
L_arr_2:
    s_lshl_b32 s93, s16, 5
    s_add_u32 s93, s93, s17
    s_lshl_b32 s93, s93, 7
    s_add_u32 s93, s93, 163840
    s_mov_b32 s3, 0
L_ws_3:
    s_buffer_load_dword s92, s[4:7], s93 glc
    s_waitcnt lgkmcnt(0)
    s_cmp_lg_u32 s92, 0
    s_cbranch_scc1 L_wsd_4
    s_add_u32 s3, s3, 1
    s_cmp_lt_u32 s3, 40000
    s_cbranch_scc1 L_ws_3
    s_mov_b32 s3, 21
    s_branch L_abort
L_wsd_4:
    s_mov_b32 s21, 0
L_LN_res:
    s_waitcnt vmcnt(0)
    v_mov_b32 v8, s21
    ds_write_b32 v1, v8
    s_add_u32 s32, s21, 1
    s_mov_b32 s3, 0
L_LN_rs:
    ds_read_b32 v8, v4
    s_waitcnt lgkmcnt(0)
    v_cmp_gt_u32 vcc, s32, v8
    s_cbranch_vccz L_LN_rg
    s_sleep 2
    s_add_u32 s3, s3, 1
    s_cmp_lt_u32 s3, 40000
    s_cbranch_scc1 L_LN_rs
    s_mov_b32 s3, 23
    s_branch L_abort
L_LN_rg:
    s_lshl_b32 s46, s21, 16
    s_add_u32 s46, s46, s23
    s_cmp_eq_u32 s18, 0
    s_cbranch_scc1 L_LN_r0a
    s_add_u32 s47, s46, 4096
    buffer_load_dwordx4 a[0:3], v0, s[4:7], s46 offen offset:0 sc1
    buffer_load_dwordx4 a[4:7], v0, s[4:7], s46 offen offset:1024 sc1
    buffer_load_dwordx4 a[8:11], v0, s[4:7], s46 offen offset:2048 sc1
    buffer_load_dwordx4 a[12:15], v0, s[4:7], s46 offen offset:3072 sc1
    buffer_load_dwordx4 a[16:19], v0, s[4:7], s47 offen offset:0 sc1
    buffer_load_dwordx4 a[20:23], v0, s[4:7], s47 offen offset:1024 sc1
    buffer_load_dwordx4 a[24:27], v0, s[4:7], s47 offen offset:2048 sc1
    buffer_load_dwordx4 a[28:31], v0, s[4:7], s47 offen offset:3072 sc1
    s_branch L_LN_r1a
L_LN_r0a:
    buffer_load_dwordx4 a[0:3], v6, s[8:11], s46 offen offset:0
    buffer_load_dwordx4 a[4:7], v6, s[8:11], s46 offen offset:256
    buffer_load_dwordx4 a[8:11], v6, s[8:11], s46 offen offset:512
    buffer_load_dwordx4 a[12:15], v6, s[8:11], s46 offen offset:768
    buffer_load_dwordx4 a[16:19], v6, s[8:11], s46 offen offset:1024
    buffer_load_dwordx4 a[20:23], v6, s[8:11], s46 offen offset:1280
    buffer_load_dwordx4 a[24:27], v6, s[8:11], s46 offen offset:1536
    buffer_load_dwordx4 a[28:31], v6, s[8:11], s46 offen offset:1792
L_LN_r1a:
    s_waitcnt vmcnt(0)
L_LN_loop:
    s_lshl2_add_u32 s30, s21, s33
    s_buffer_load_dword s62, s[4:7], s30 glc
    s_lshl2_add_u32 s37, s21, s28
    s_lshl_b32 s95, s21, 16
    s_and_b32 s93, s21, s24
    s_mul_i32 s93, s93, 196608
    s_add_u32 s93, s93, s22
    s_add_u32 s40, s93, 0
    s_add_u32 s41, s93, 4096
    s_add_u32 s42, s93, 65536
    s_add_u32 s43, s93, 69632
    s_add_u32 s44, s93, 131072
    s_add_u32 s45, s93, 135168
    s_add_u32 s92, s95, s25
    s_add_u32 s93, s95, s27
    s_add_u32 s94, s93, 4096
    s_mov_b32 s3, 0
    s_add_u32 s32, s21, 2
    s_add_u32 s31, s21, 1
    v_mfma_f32_16x16x32_bf16 v[16:19], v[242:245], a[0:3], 0
    v_mfma_f32_16x16x32_bf16 v[20:23], v[240:243], a[0:3], 0
    v_mfma_f32_16x16x32_bf16 v[24:27], v[242:245], a[4:7], 0
    v_mfma_f32_16x16x32_bf16 v[28:31], v[240:243], a[4:7], 0
    v_mfma_f32_16x16x32_bf16 v[32:35], v[242:245], a[8:11], 0
    v_mfma_f32_16x16x32_bf16 v[36:39], v[240:243], a[8:11], 0
    v_mfma_f32_16x16x32_bf16 v[40:43], v[242:245], a[12:15], 0
    v_mfma_f32_16x16x32_bf16 v[44:47], v[240:243], a[12:15], 0
    v_mfma_f32_16x16x32_bf16 v[48:51], v[242:245], a[16:19], 0
    v_mfma_f32_16x16x32_bf16 v[52:55], v[240:243], a[16:19], 0
    v_mfma_f32_16x16x32_bf16 v[56:59], v[242:245], a[20:23], 0
    v_mfma_f32_16x16x32_bf16 v[60:63], v[240:243], a[20:23], 0
    v_mfma_f32_16x16x32_bf16 v[64:67], v[242:245], a[24:27], 0
    v_mfma_f32_16x16x32_bf16 v[68:71], v[240:243], a[24:27], 0
    v_mfma_f32_16x16x32_bf16 v[72:75], v[242:245], a[28:31], 0
    v_mfma_f32_16x16x32_bf16 v[76:79], v[240:243], a[28:31], 0
    s_waitcnt lgkmcnt(0)
    s_cmp_ge_u32 s62, 24
    s_cbranch_scc1 L_LN_go
    s_waitcnt vmcnt(0)
    v_mov_b32 v8, s21
    ds_write_b32 v1, v8
L_LN_sp:
    s_buffer_load_dword s62, s[4:7], s30 glc
    s_waitcnt lgkmcnt(0)
    s_cmp_ge_u32 s62, 24
    s_cbranch_scc1 L_LN_go
    s_add_u32 s3, s3, 1
    s_cmp_lt_u32 s3, 40000
    s_cbranch_scc1 L_LN_sp
    s_mov_b32 s3, 22
    s_branch L_abort
L_LN_go:
    ds_read_b32 v9, v4
    buffer_load_dwordx4 v[112:115], v0, s[4:7], s40 offen offset:0 sc1
    buffer_load_dwordx4 v[116:119], v0, s[4:7], s42 offen offset:0 sc1
    buffer_load_dwordx4 v[120:123], v0, s[4:7], s44 offen offset:0 sc1
    buffer_load_dwordx4 v[124:127], v0, s[4:7], s40 offen offset:1024 sc1
    buffer_load_dwordx4 v[128:131], v0, s[4:7], s42 offen offset:1024 sc1
    buffer_load_dwordx4 v[132:135], v0, s[4:7], s44 offen offset:1024 sc1
    buffer_load_dwordx4 v[136:139], v0, s[4:7], s40 offen offset:2048 sc1
    buffer_load_dwordx4 v[140:143], v0, s[4:7], s42 offen offset:2048 sc1
    buffer_load_dwordx4 v[144:147], v0, s[4:7], s44 offen offset:2048 sc1
    buffer_load_dwordx4 v[148:151], v0, s[4:7], s40 offen offset:3072 sc1
    buffer_load_dwordx4 v[152:155], v0, s[4:7], s42 offen offset:3072 sc1
    buffer_load_dwordx4 v[156:159], v0, s[4:7], s44 offen offset:3072 sc1
    buffer_load_dwordx4 v[160:163], v0, s[4:7], s41 offen offset:0 sc1
    buffer_load_dwordx4 v[164:167], v0, s[4:7], s43 offen offset:0 sc1
    buffer_load_dwordx4 v[168:171], v0, s[4:7], s45 offen offset:0 sc1
    buffer_load_dwordx4 v[172:175], v0, s[4:7], s41 offen offset:1024 sc1
    buffer_load_dwordx4 v[176:179], v0, s[4:7], s43 offen offset:1024 sc1
    buffer_load_dwordx4 v[180:183], v0, s[4:7], s45 offen offset:1024 sc1
    buffer_load_dwordx4 v[184:187], v0, s[4:7], s41 offen offset:2048 sc1
    buffer_load_dwordx4 v[188:191], v0, s[4:7], s43 offen offset:2048 sc1
    buffer_load_dwordx4 v[192:195], v0, s[4:7], s45 offen offset:2048 sc1
    buffer_load_dwordx4 v[196:199], v0, s[4:7], s41 offen offset:3072 sc1
    buffer_load_dwordx4 v[200:203], v0, s[4:7], s43 offen offset:3072 sc1
    buffer_load_dwordx4 v[204:207], v0, s[4:7], s45 offen offset:3072 sc1
    s_waitcnt lgkmcnt(0)
    v_cmp_gt_u32 vcc, s32, v9
    s_nop 1
    s_cmp_eq_u64 vcc, 0
    s_cselect_b32 s29, 1, 0
    s_cselect_b32 s31, s31, 0x1000
    s_lshl_b32 s46, s31, 16
    s_add_u32 s46, s46, s23
    s_cmp_eq_u32 s18, 0
    s_cbranch_scc1 L_LN_r0b
    s_add_u32 s47, s46, 4096
    buffer_load_dwordx4 a[0:3], v0, s[4:7], s46 offen offset:0 sc1
    buffer_load_dwordx4 a[4:7], v0, s[4:7], s46 offen offset:1024 sc1
    buffer_load_dwordx4 a[8:11], v0, s[4:7], s46 offen offset:2048 sc1
    buffer_load_dwordx4 a[12:15], v0, s[4:7], s46 offen offset:3072 sc1
    buffer_load_dwordx4 a[16:19], v0, s[4:7], s47 offen offset:0 sc1
    buffer_load_dwordx4 a[20:23], v0, s[4:7], s47 offen offset:1024 sc1
    buffer_load_dwordx4 a[24:27], v0, s[4:7], s47 offen offset:2048 sc1
    buffer_load_dwordx4 a[28:31], v0, s[4:7], s47 offen offset:3072 sc1
    s_branch L_LN_r1b
L_LN_r0b:
    buffer_load_dwordx4 a[0:3], v6, s[8:11], s46 offen offset:0
    buffer_load_dwordx4 a[4:7], v6, s[8:11], s46 offen offset:256
    buffer_load_dwordx4 a[8:11], v6, s[8:11], s46 offen offset:512
    buffer_load_dwordx4 a[12:15], v6, s[8:11], s46 offen offset:768
    buffer_load_dwordx4 a[16:19], v6, s[8:11], s46 offen offset:1024
    buffer_load_dwordx4 a[20:23], v6, s[8:11], s46 offen offset:1280
    buffer_load_dwordx4 a[24:27], v6, s[8:11], s46 offen offset:1536
    buffer_load_dwordx4 a[28:31], v6, s[8:11], s46 offen offset:1792
L_LN_r1b:
    s_waitcnt vmcnt(31)
    v_mov_b32 v8, s21
    ds_write_b32 v1, v8
    s_waitcnt vmcnt(31)
    v_mfma_f32_16x16x32_bf16 v[16:19], v[242:245], v[112:115], v[16:19]
    v_mfma_f32_16x16x32_bf16 v[20:23], v[240:243], v[112:115], v[20:23]
    s_waitcnt vmcnt(30)
    v_mfma_f32_16x16x32_bf16 v[16:19], v[242:245], v[116:119], v[16:19]
    v_mfma_f32_16x16x32_bf16 v[20:23], v[240:243], v[116:119], v[20:23]
    s_waitcnt vmcnt(29)
    v_mfma_f32_16x16x32_bf16 v[16:19], v[242:245], v[120:123], v[16:19]
    v_mfma_f32_16x16x32_bf16 v[20:23], v[240:243], v[120:123], v[20:23]
    s_waitcnt vmcnt(28)
    v_mfma_f32_16x16x32_bf16 v[24:27], v[242:245], v[124:127], v[24:27]
    v_mfma_f32_16x16x32_bf16 v[28:31], v[240:243], v[124:127], v[28:31]
    s_waitcnt vmcnt(27)
    v_mfma_f32_16x16x32_bf16 v[24:27], v[242:245], v[128:131], v[24:27]
    v_mfma_f32_16x16x32_bf16 v[28:31], v[240:243], v[128:131], v[28:31]
    s_waitcnt vmcnt(26)
    v_mfma_f32_16x16x32_bf16 v[24:27], v[242:245], v[132:135], v[24:27]
    v_cvt_pk_bf16_f32 v80, v16, v17
    v_cvt_pk_bf16_f32 v81, v18, v19
    v_mfma_f32_16x16x32_bf16 v[28:31], v[240:243], v[132:135], v[28:31]
    v_cvt_pk_bf16_f32 v82, v20, v21
    v_cvt_pk_bf16_f32 v83, v22, v23
    s_waitcnt vmcnt(25)
    v_mfma_f32_16x16x32_bf16 v[32:35], v[242:245], v[136:139], v[32:35]
    v_mfma_f32_16x16x32_bf16 v[36:39], v[240:243], v[136:139], v[36:39]
    s_waitcnt vmcnt(24)
    v_mfma_f32_16x16x32_bf16 v[32:35], v[242:245], v[140:143], v[32:35]
    v_mfma_f32_16x16x32_bf16 v[36:39], v[240:243], v[140:143], v[36:39]
    s_waitcnt vmcnt(23)
    v_mfma_f32_16x16x32_bf16 v[32:35], v[242:245], v[144:147], v[32:35]
    v_cvt_pk_bf16_f32 v84, v24, v25
    v_cvt_pk_bf16_f32 v85, v26, v27
    v_mfma_f32_16x16x32_bf16 v[36:39], v[240:243], v[144:147], v[36:39]
    v_cvt_pk_bf16_f32 v86, v28, v29
    v_cvt_pk_bf16_f32 v87, v30, v31
    v_mfma_f32_16x16x32_bf16 v[224:227], v[232:235], v[80:83], 0
    v_mfma_f32_16x16x32_bf16 v[228:231], v[80:83], v[80:83], 0
    s_waitcnt vmcnt(22)
    v_mfma_f32_16x16x32_bf16 v[40:43], v[242:245], v[148:151], v[40:43]
    v_mfma_f32_16x16x32_bf16 v[44:47], v[240:243], v[148:151], v[44:47]
    s_waitcnt vmcnt(21)
    v_mfma_f32_16x16x32_bf16 v[40:43], v[242:245], v[152:155], v[40:43]
    v_mfma_f32_16x16x32_bf16 v[44:47], v[240:243], v[152:155], v[44:47]
    s_waitcnt vmcnt(20)
    v_mfma_f32_16x16x32_bf16 v[40:43], v[242:245], v[156:159], v[40:43]
    v_cvt_pk_bf16_f32 v88, v32, v33
    v_cvt_pk_bf16_f32 v89, v34, v35
    v_mfma_f32_16x16x32_bf16 v[44:47], v[240:243], v[156:159], v[44:47]
    v_cvt_pk_bf16_f32 v90, v36, v37
    v_cvt_pk_bf16_f32 v91, v38, v39
    v_mfma_f32_16x16x32_bf16 v[224:227], v[232:235], v[84:87], v[224:227]
    v_mfma_f32_16x16x32_bf16 v[228:231], v[84:87], v[84:87], v[228:231]
    s_waitcnt vmcnt(19)
    v_mfma_f32_16x16x32_bf16 v[48:51], v[242:245], v[160:163], v[48:51]
    v_mfma_f32_16x16x32_bf16 v[52:55], v[240:243], v[160:163], v[52:55]
    s_waitcnt vmcnt(18)
    v_mfma_f32_16x16x32_bf16 v[48:51], v[242:245], v[164:167], v[48:51]
    v_mfma_f32_16x16x32_bf16 v[52:55], v[240:243], v[164:167], v[52:55]
    s_waitcnt vmcnt(17)
    v_mfma_f32_16x16x32_bf16 v[48:51], v[242:245], v[168:171], v[48:51]
    v_cvt_pk_bf16_f32 v92, v40, v41
    v_cvt_pk_bf16_f32 v93, v42, v43
    v_mfma_f32_16x16x32_bf16 v[52:55], v[240:243], v[168:171], v[52:55]
    v_cvt_pk_bf16_f32 v94, v44, v45
    v_cvt_pk_bf16_f32 v95, v46, v47
    v_mfma_f32_16x16x32_bf16 v[224:227], v[232:235], v[88:91], v[224:227]
    v_mfma_f32_16x16x32_bf16 v[228:231], v[88:91], v[88:91], v[228:231]
    s_waitcnt vmcnt(16)
    v_mfma_f32_16x16x32_bf16 v[56:59], v[242:245], v[172:175], v[56:59]
    v_mfma_f32_16x16x32_bf16 v[60:63], v[240:243], v[172:175], v[60:63]
    s_waitcnt vmcnt(15)
    v_mfma_f32_16x16x32_bf16 v[56:59], v[242:245], v[176:179], v[56:59]
    v_mfma_f32_16x16x32_bf16 v[60:63], v[240:243], v[176:179], v[60:63]
    s_waitcnt vmcnt(14)
    v_mfma_f32_16x16x32_bf16 v[56:59], v[242:245], v[180:183], v[56:59]
    v_cvt_pk_bf16_f32 v96, v48, v49
    v_cvt_pk_bf16_f32 v97, v50, v51
    v_mfma_f32_16x16x32_bf16 v[60:63], v[240:243], v[180:183], v[60:63]
    v_cvt_pk_bf16_f32 v98, v52, v53
    v_cvt_pk_bf16_f32 v99, v54, v55
    v_mfma_f32_16x16x32_bf16 v[224:227], v[232:235], v[92:95], v[224:227]
    v_mfma_f32_16x16x32_bf16 v[228:231], v[92:95], v[92:95], v[228:231]
    s_waitcnt vmcnt(13)
    v_mfma_f32_16x16x32_bf16 v[64:67], v[242:245], v[184:187], v[64:67]
    v_mfma_f32_16x16x32_bf16 v[68:71], v[240:243], v[184:187], v[68:71]
    s_waitcnt vmcnt(12)
    v_mfma_f32_16x16x32_bf16 v[64:67], v[242:245], v[188:191], v[64:67]
    v_mfma_f32_16x16x32_bf16 v[68:71], v[240:243], v[188:191], v[68:71]
    s_waitcnt vmcnt(11)
    v_mfma_f32_16x16x32_bf16 v[64:67], v[242:245], v[192:195], v[64:67]
    v_cvt_pk_bf16_f32 v100, v56, v57
    v_cvt_pk_bf16_f32 v101, v58, v59
    v_mfma_f32_16x16x32_bf16 v[68:71], v[240:243], v[192:195], v[68:71]
    v_cvt_pk_bf16_f32 v102, v60, v61
    v_cvt_pk_bf16_f32 v103, v62, v63
    v_mfma_f32_16x16x32_bf16 v[224:227], v[232:235], v[96:99], v[224:227]
    v_mfma_f32_16x16x32_bf16 v[228:231], v[96:99], v[96:99], v[228:231]
    s_waitcnt vmcnt(10)
    v_mfma_f32_16x16x32_bf16 v[72:75], v[242:245], v[196:199], v[72:75]
    v_mfma_f32_16x16x32_bf16 v[76:79], v[240:243], v[196:199], v[76:79]
    s_waitcnt vmcnt(9)
    v_mfma_f32_16x16x32_bf16 v[72:75], v[242:245], v[200:203], v[72:75]
    v_mfma_f32_16x16x32_bf16 v[76:79], v[240:243], v[200:203], v[76:79]
    s_waitcnt vmcnt(8)
    v_mfma_f32_16x16x32_bf16 v[72:75], v[242:245], v[204:207], v[72:75]
    v_cvt_pk_bf16_f32 v104, v64, v65
    v_cvt_pk_bf16_f32 v105, v66, v67
    v_mfma_f32_16x16x32_bf16 v[76:79], v[240:243], v[204:207], v[76:79]
    v_cvt_pk_bf16_f32 v106, v68, v69
    v_cvt_pk_bf16_f32 v107, v70, v71
    v_mfma_f32_16x16x32_bf16 v[224:227], v[232:235], v[100:103], v[224:227]
    v_mfma_f32_16x16x32_bf16 v[228:231], v[100:103], v[100:103], v[228:231]
    v_mfma_f32_16x16x32_bf16 v[224:227], v[232:235], v[104:107], v[224:227]
    v_mfma_f32_16x16x32_bf16 v[228:231], v[104:107], v[104:107], v[228:231]
    v_cvt_pk_bf16_f32 v108, v72, v73
    v_cvt_pk_bf16_f32 v109, v74, v75
    v_cvt_pk_bf16_f32 v110, v76, v77
    v_cvt_pk_bf16_f32 v111, v78, v79
    s_add_u32 s21, s21, 1
    s_cmp_eq_u32 s18, 3
    s_cbranch_scc1 L_LN_out
    v_mfma_f32_16x16x32_bf16 v[224:227], v[232:235], v[108:111], v[224:227]
    v_mfma_f32_16x16x32_bf16 v[228:231], v[108:111], v[108:111], v[228:231]
    s_nop 6
    v_mul_f32 v8, 0x3e800000, v224
    v_mul_f32 v9, v236, v228
    v_fmac_f32 v9, v237, v229
    v_fmac_f32 v9, v238, v230
    v_fmac_f32 v9, v239, v231
    v_add_f32_dpp v8, v8, v8 row_ror:4 row_mask:0xf bank_mask:0xf
    s_nop 0
    v_add_f32_dpp v9, v9, v9 row_ror:4 row_mask:0xf bank_mask:0xf
    v_add_f32_dpp v8, v8, v8 row_ror:8 row_mask:0xf bank_mask:0xf
    s_nop 0
    v_add_f32_dpp v9, v9, v9 row_ror:8 row_mask:0xf bank_mask:0xf
    v_mov_b32 v10, v8
    v_mov_b32 v11, v9
    s_nop 0
    v_permlane16_swap_b32 v8, v10
    v_permlane16_swap_b32 v9, v11
    v_add_f32 v8, v8, v10
    v_add_f32 v9, v9, v11
    v_mov_b32 v10, v8
    v_mov_b32 v11, v9
    s_nop 0
    v_permlane32_swap_b32 v8, v10
    v_permlane32_swap_b32 v9, v11
    v_add_f32 v8, v8, v10
    v_add_f32 v9, v9, v11
    v_mul_f32 v8, 0x3a800000, v8
    v_mul_f32 v9, 0x3a800000, v9
    v_fma_f32 v9, -v8, v8, v9
    v_max_f32 v9, 0, v9
    v_add_f32 v9, 0x3727c5ac, v9
    v_rsq_f32 v10, v9
    s_nop 0
    v_mul_f32 v8, v8, v10
    v_pk_fma_f32 v[16:17], v[16:17], v[10:11], v[8:9] op_sel_hi:[1,0,0] neg_lo:[0,0,1] neg_hi:[0,0,1]
    v_pk_fma_f32 v[18:19], v[18:19], v[10:11], v[8:9] op_sel_hi:[1,0,0] neg_lo:[0,0,1] neg_hi:[0,0,1]
    v_pk_fma_f32 v[20:21], v[20:21], v[10:11], v[8:9] op_sel_hi:[1,0,0] neg_lo:[0,0,1] neg_hi:[0,0,1]
    v_pk_fma_f32 v[22:23], v[22:23], v[10:11], v[8:9] op_sel_hi:[1,0,0] neg_lo:[0,0,1] neg_hi:[0,0,1]
    v_cvt_pk_bf16_f32 v208, v16, v17
    v_cvt_pk_bf16_f32 v209, v18, v19
    v_cvt_pk_bf16_f32 v210, v20, v21
    v_cvt_pk_bf16_f32 v211, v22, v23
    buffer_store_dwordx4 v[208:211], v0, s[4:7], s93 offen offset:0 sc1
    v_pk_fma_f32 v[24:25], v[24:25], v[10:11], v[8:9] op_sel_hi:[1,0,0] neg_lo:[0,0,1] neg_hi:[0,0,1]
    v_pk_fma_f32 v[26:27], v[26:27], v[10:11], v[8:9] op_sel_hi:[1,0,0] neg_lo:[0,0,1] neg_hi:[0,0,1]
    v_pk_fma_f32 v[28:29], v[28:29], v[10:11], v[8:9] op_sel_hi:[1,0,0] neg_lo:[0,0,1] neg_hi:[0,0,1]
    v_pk_fma_f32 v[30:31], v[30:31], v[10:11], v[8:9] op_sel_hi:[1,0,0] neg_lo:[0,0,1] neg_hi:[0,0,1]
    v_cvt_pk_bf16_f32 v212, v24, v25
    v_cvt_pk_bf16_f32 v213, v26, v27
    v_cvt_pk_bf16_f32 v214, v28, v29
    v_cvt_pk_bf16_f32 v215, v30, v31
    buffer_store_dwordx4 v[212:215], v0, s[4:7], s93 offen offset:1024 sc1
    v_pk_fma_f32 v[32:33], v[32:33], v[10:11], v[8:9] op_sel_hi:[1,0,0] neg_lo:[0,0,1] neg_hi:[0,0,1]
    v_pk_fma_f32 v[34:35], v[34:35], v[10:11], v[8:9] op_sel_hi:[1,0,0] neg_lo:[0,0,1] neg_hi:[0,0,1]
    v_pk_fma_f32 v[36:37], v[36:37], v[10:11], v[8:9] op_sel_hi:[1,0,0] neg_lo:[0,0,1] neg_hi:[0,0,1]
    v_pk_fma_f32 v[38:39], v[38:39], v[10:11], v[8:9] op_sel_hi:[1,0,0] neg_lo:[0,0,1] neg_hi:[0,0,1]
    v_cvt_pk_bf16_f32 v216, v32, v33
    v_cvt_pk_bf16_f32 v217, v34, v35
    v_cvt_pk_bf16_f32 v218, v36, v37
    v_cvt_pk_bf16_f32 v219, v38, v39
    buffer_store_dwordx4 v[216:219], v0, s[4:7], s93 offen offset:2048 sc1
    v_pk_fma_f32 v[40:41], v[40:41], v[10:11], v[8:9] op_sel_hi:[1,0,0] neg_lo:[0,0,1] neg_hi:[0,0,1]
    v_pk_fma_f32 v[42:43], v[42:43], v[10:11], v[8:9] op_sel_hi:[1,0,0] neg_lo:[0,0,1] neg_hi:[0,0,1]
    v_pk_fma_f32 v[44:45], v[44:45], v[10:11], v[8:9] op_sel_hi:[1,0,0] neg_lo:[0,0,1] neg_hi:[0,0,1]
    v_pk_fma_f32 v[46:47], v[46:47], v[10:11], v[8:9] op_sel_hi:[1,0,0] neg_lo:[0,0,1] neg_hi:[0,0,1]
    v_cvt_pk_bf16_f32 v220, v40, v41
    v_cvt_pk_bf16_f32 v221, v42, v43
    v_cvt_pk_bf16_f32 v222, v44, v45
    v_cvt_pk_bf16_f32 v223, v46, v47
    buffer_store_dwordx4 v[220:223], v0, s[4:7], s93 offen offset:3072 sc1
    v_pk_fma_f32 v[48:49], v[48:49], v[10:11], v[8:9] op_sel_hi:[1,0,0] neg_lo:[0,0,1] neg_hi:[0,0,1]
    v_pk_fma_f32 v[50:51], v[50:51], v[10:11], v[8:9] op_sel_hi:[1,0,0] neg_lo:[0,0,1] neg_hi:[0,0,1]
    v_pk_fma_f32 v[52:53], v[52:53], v[10:11], v[8:9] op_sel_hi:[1,0,0] neg_lo:[0,0,1] neg_hi:[0,0,1]
    v_pk_fma_f32 v[54:55], v[54:55], v[10:11], v[8:9] op_sel_hi:[1,0,0] neg_lo:[0,0,1] neg_hi:[0,0,1]
    v_cvt_pk_bf16_f32 v208, v48, v49
    v_cvt_pk_bf16_f32 v209, v50, v51
    v_cvt_pk_bf16_f32 v210, v52, v53
    v_cvt_pk_bf16_f32 v211, v54, v55
    buffer_store_dwordx4 v[208:211], v0, s[4:7], s94 offen offset:0 sc1
    v_pk_fma_f32 v[56:57], v[56:57], v[10:11], v[8:9] op_sel_hi:[1,0,0] neg_lo:[0,0,1] neg_hi:[0,0,1]
    v_pk_fma_f32 v[58:59], v[58:59], v[10:11], v[8:9] op_sel_hi:[1,0,0] neg_lo:[0,0,1] neg_hi:[0,0,1]
    v_pk_fma_f32 v[60:61], v[60:61], v[10:11], v[8:9] op_sel_hi:[1,0,0] neg_lo:[0,0,1] neg_hi:[0,0,1]
    v_pk_fma_f32 v[62:63], v[62:63], v[10:11], v[8:9] op_sel_hi:[1,0,0] neg_lo:[0,0,1] neg_hi:[0,0,1]
    v_cvt_pk_bf16_f32 v212, v56, v57
    v_cvt_pk_bf16_f32 v213, v58, v59
    v_cvt_pk_bf16_f32 v214, v60, v61
    v_cvt_pk_bf16_f32 v215, v62, v63
    buffer_store_dwordx4 v[212:215], v0, s[4:7], s94 offen offset:1024 sc1
    v_pk_fma_f32 v[64:65], v[64:65], v[10:11], v[8:9] op_sel_hi:[1,0,0] neg_lo:[0,0,1] neg_hi:[0,0,1]
    v_pk_fma_f32 v[66:67], v[66:67], v[10:11], v[8:9] op_sel_hi:[1,0,0] neg_lo:[0,0,1] neg_hi:[0,0,1]
    v_pk_fma_f32 v[68:69], v[68:69], v[10:11], v[8:9] op_sel_hi:[1,0,0] neg_lo:[0,0,1] neg_hi:[0,0,1]
    v_pk_fma_f32 v[70:71], v[70:71], v[10:11], v[8:9] op_sel_hi:[1,0,0] neg_lo:[0,0,1] neg_hi:[0,0,1]
    v_cvt_pk_bf16_f32 v216, v64, v65
    v_cvt_pk_bf16_f32 v217, v66, v67
    v_cvt_pk_bf16_f32 v218, v68, v69
    v_cvt_pk_bf16_f32 v219, v70, v71
    buffer_store_dwordx4 v[216:219], v0, s[4:7], s94 offen offset:2048 sc1
    v_pk_fma_f32 v[72:73], v[72:73], v[10:11], v[8:9] op_sel_hi:[1,0,0] neg_lo:[0,0,1] neg_hi:[0,0,1]
    v_pk_fma_f32 v[74:75], v[74:75], v[10:11], v[8:9] op_sel_hi:[1,0,0] neg_lo:[0,0,1] neg_hi:[0,0,1]
    v_pk_fma_f32 v[76:77], v[76:77], v[10:11], v[8:9] op_sel_hi:[1,0,0] neg_lo:[0,0,1] neg_hi:[0,0,1]
    v_pk_fma_f32 v[78:79], v[78:79], v[10:11], v[8:9] op_sel_hi:[1,0,0] neg_lo:[0,0,1] neg_hi:[0,0,1]
    v_cvt_pk_bf16_f32 v220, v72, v73
    v_cvt_pk_bf16_f32 v221, v74, v75
    v_cvt_pk_bf16_f32 v222, v76, v77
    v_cvt_pk_bf16_f32 v223, v78, v79
    buffer_store_dwordx4 v[220:223], v0, s[4:7], s94 offen offset:3072 sc1
    buffer_store_dwordx4 v[80:83], v0, s[4:7], s92 offen offset:0 sc1
    buffer_store_dwordx4 v[84:87], v0, s[4:7], s92 offen offset:1024 sc1
    buffer_store_dwordx4 v[88:91], v0, s[4:7], s92 offen offset:2048 sc1
    buffer_store_dwordx4 v[92:95], v0, s[4:7], s92 offen offset:3072 sc1
    s_waitcnt vmcnt(4)
    buffer_atomic_add v5, v2, s[4:7], s37 offen
    s_add_u32 s92, s92, 4096
    buffer_store_dwordx4 v[96:99], v0, s[4:7], s92 offen offset:0 sc1
    buffer_store_dwordx4 v[100:103], v0, s[4:7], s92 offen offset:1024 sc1
    buffer_store_dwordx4 v[104:107], v0, s[4:7], s92 offen offset:2048 sc1
    buffer_store_dwordx4 v[108:111], v0, s[4:7], s92 offen offset:3072 sc1
    s_branch L_LN_nx
L_LN_out:
    ds_write_b128 v7, v[80:83] offset:0
    ds_write_b128 v7, v[84:87] offset:256
    ds_write_b128 v7, v[88:91] offset:512
    ds_write_b128 v7, v[92:95] offset:768
    ds_write_b128 v7, v[96:99] offset:1024
    ds_write_b128 v7, v[100:103] offset:1280
    ds_write_b128 v7, v[104:107] offset:1536
    ds_write_b128 v7, v[108:111] offset:1792
    ds_read_b128 v[112:115], v0 offset:1024
    ds_read_b128 v[116:119], v0 offset:2048
    ds_read_b128 v[120:123], v0 offset:3136
    ds_read_b128 v[124:127], v0 offset:4160
    ds_read_b128 v[128:131], v0 offset:5248
    ds_read_b128 v[132:135], v0 offset:6272
    ds_read_b128 v[136:139], v0 offset:7360
    ds_read_b128 v[140:143], v0 offset:8384
    s_waitcnt lgkmcnt(7)
    buffer_store_dwordx4 v[112:115], v0, s[52:55], s92 offen offset:0 sc1
    s_waitcnt lgkmcnt(6)
    buffer_store_dwordx4 v[116:119], v0, s[52:55], s92 offen offset:1024 sc1
    s_waitcnt lgkmcnt(5)
    buffer_store_dwordx4 v[120:123], v0, s[52:55], s92 offen offset:2048 sc1
    s_waitcnt lgkmcnt(4)
    buffer_store_dwordx4 v[124:127], v0, s[52:55], s92 offen offset:3072 sc1
    s_add_u32 s92, s92, 4096
    s_waitcnt lgkmcnt(3)
    buffer_store_dwordx4 v[128:131], v0, s[52:55], s92 offen offset:0 sc1
    s_waitcnt lgkmcnt(2)
    buffer_store_dwordx4 v[132:135], v0, s[52:55], s92 offen offset:1024 sc1
    s_waitcnt lgkmcnt(1)
    buffer_store_dwordx4 v[136:139], v0, s[52:55], s92 offen offset:2048 sc1
    s_waitcnt lgkmcnt(0)
    buffer_store_dwordx4 v[140:143], v0, s[52:55], s92 offen offset:3072 sc1
L_LN_nx:
    s_cmp_eq_u32 s21, 64
    s_cbranch_scc1 L_LN_fin
    s_cmp_eq_u32 s29, 0
    s_cbranch_scc1 L_LN_res
    s_waitcnt vmcnt(8)
    s_branch L_LN_loop
L_LN_fin:
    s_waitcnt vmcnt(0)
    v_mov_b32 v8, s21
    ds_write_b32 v1, v8
    s_waitcnt lgkmcnt(0)
    s_endpgm
L_role_PJ:
    v_mov_b32 v20, v0
    v_lshlrev_b32 v0, 4, v20
    v_mov_b32 v3, 0
    v_and_b32 v21, 15, v20
    v_lshlrev_b32 v21, 4, v21
    v_lshrrev_b32 v22, 4, v20
    v_lshl_add_u32 v19, v22, 9, v21
    s_and_b32 s92, s18, 1
    s_lshl_b32 s92, s92, 7
    v_xor_b32 v1, s92, v0
    v_bfe_u32 v21, v20, 2, 2
    v_lshlrev_b32 v23, 13, v21
    v_and_b32 v21, 1, v21
    v_lshlrev_b32 v21, 1, v21
    v_xor_b32 v22, v22, v21
    v_lshl_add_u32 v23, v22, 6, v23
    v_and_b32 v22, 3, v20
    v_lshl_add_u32 v6, v22, 4, v23
    v_add_u32 v7, 0x10000, v6
    v_add_u32 v8, 0x20000, v6
    s_mov_b32 s24, 0xb5540000
    s_mov_b32 s25, 0x6aad55aa
    s_mov_b32 s26, 0xd55aab55
    s_mov_b32 s27, 0xffb556aa
    s_mul_i32 s60, s19, 640
    s_add_u32 s60, s60, 1685504
    s_mov_b32 s61, 8
    s_and_b32 s48, s19, 31
    s_lshr_b32 s51, s19, 5
    s_lshl_b32 s56, s51, 2
    s_add_u32 s56, s56, s18
    s_mul_i32 s92, s48, 640
    s_lshl_b32 s93, s51, 2
    s_add_u32 s92, s92, s93
    s_add_u32 s43, s92, 1572864
    s_cmp_eq_u32 s79, 1
    s_cselect_b32 s27, 0, s27
    s_cselect_b32 s92, 8, 0
    s_add_u32 s43, s43, s92
    s_lshl_b32 s92, s48, 13
    s_lshl_b32 s93, s56, 10
    s_add_u32 s45, s92, s93
    s_add_u32 s45, s45, 37748736
    s_lshl_b32 s93, s18, 11
    s_add_u32 s44, s92, s93
    s_mul_i32 s93, s51, 230686720
    s_add_u32 s44, s44, s93
    s_add_u32 s44, s44, 4194304
    s_lshl_b32 s92, s18, 13
    s_add_u32 s42, s92, 88080384
    buffer_store_dword v3, v3, s[4:7], s43 offen sc1
    s_add_u32 s92, s43, 20480
    buffer_store_dword v3, v3, s[4:7], s92 offen sc1
    s_mov_b32 s93, 8192
    s_mul_i32 s94, s18, 65536
    s_and_b32 s95, s18, 1
    s_lshl_b32 s95, s95, 2
    v_lshrrev_b32 v24, 4, v20
    v_mul_lo_u32 v21, v24, s93
    v_and_b32 v22, 15, v20
    v_lshlrev_b32 v23, 2, v24
    v_xor_b32 v22, v22, v23
    v_lshl_add_u32 v21, v22, 4, v21
    v_add_u32 v31, s94, v21
    v_lshrrev_b32 v21, 3, v20
    v_mul_lo_u32 v21, v21, s93
    v_and_b32 v22, 7, v20
    v_and_b32 v23, 1, v24
    v_lshl_add_u32 v23, v23, 1, s95
    v_xor_b32 v22, v22, v23
    v_lshl_add_u32 v21, v22, 4, v21
    v_add_u32 v32, s94, v21
    v_bfe_u32 v25, v20, 2, 2
    v_and_b32 v22, 3, v20
    v_xor_b32 v26, s18, v25
    v_lshlrev_b32 v26, 6, v26
    v_lshl_add_u32 v26, v25, 8, v26
    v_add_u32 v26, 0, v26
    v_lshl_add_u32 v27, v24, 11, v26
    v_lshl_add_u32 v100, v22, 4, v27
    v_lshl_add_u32 v103, v22, 3, v27
    v_lshl_add_u32 v27, v24, 10, v26
    v_lshl_add_u32 v106, v22, 4, v27
    v_lshrrev_b32 v26, 1, v25
    v_and_b32 v27, 1, v24
    v_lshl_add_u32 v26, v27, 1, v26
    v_xor_b32 v26, s18, v26
    v_lshlrev_b32 v26, 5, v26
    v_lshl_add_u32 v26, v25, 7, v26
    v_lshl_add_u32 v26, v24, 10, v26
    v_lshl_add_u32 v26, v22, 3, v26
    v_add_u32 v109, 0, v26
    v_add_u32 v101, 0x10000, v100
    v_add_u32 v102, 0x20000, v100
    v_add_u32 v104, 0x10000, v103
    v_add_u32 v105, 0x20000, v103
    v_add_u32 v107, 0x10000, v106
    v_add_u32 v108, 0x20000, v106
    v_add_u32 v110, 0x10000, v109
    v_add_u32 v111, 0x20000, v109
    s_cmp_eq_u32 s51, 0
    s_cselect_b32 s8, s70, s68
    s_cselect_b32 s9, s71, s69
    s_mov_b32 s10, 8388608
    s_mov_b32 s11, 0x20000
    s_mov_b32 s52, s72
    s_mov_b32 s53, s73
    s_mov_b32 s54, 8388608
    s_mov_b32 s55, 0x20000
    s_lshl_b32 s49, s48, 8
    s_lshl_b32 s93, s51, 7
    s_add_u32 s50, s49, s93
    s_lshl_b32 s46, s18, 11
    s_lshl_b32 s47, s18, 10
    s_add_u32 s92, s49, 0
    s_add_u32 m0, s46, 0
    s_nop 0
    buffer_load_dwordx4 v31, s[8:11], s92 offen lds
    s_add_u32 s92, s49, 32768
    s_add_u32 m0, s46, 1024
    s_nop 0
    buffer_load_dwordx4 v31, s[8:11], s92 offen lds
    s_add_u32 s92, s49, 262144
    s_add_u32 m0, s46, 8192
    s_nop 0
    buffer_load_dwordx4 v31, s[8:11], s92 offen lds
    s_add_u32 s92, s49, 294912
    s_add_u32 m0, s46, 9216
    s_nop 0
    buffer_load_dwordx4 v31, s[8:11], s92 offen lds
    s_add_u32 s92, s49, 524288
    s_add_u32 m0, s46, 16384
    s_nop 0
    buffer_load_dwordx4 v31, s[8:11], s92 offen lds
    s_add_u32 s92, s49, 557056
    s_add_u32 m0, s46, 17408
    s_nop 0
    buffer_load_dwordx4 v31, s[8:11], s92 offen lds
    s_add_u32 s92, s49, 786432
    s_add_u32 m0, s46, 24576
    s_nop 0
    buffer_load_dwordx4 v31, s[8:11], s92 offen lds
    s_add_u32 s92, s49, 819200
    s_add_u32 m0, s46, 25600
    s_nop 0
    buffer_load_dwordx4 v31, s[8:11], s92 offen lds
    s_add_u32 s92, s49, 1048576
    s_add_u32 m0, s46, 32768
    s_nop 0
    buffer_load_dwordx4 v31, s[8:11], s92 offen lds
    s_add_u32 s92, s49, 1081344
    s_add_u32 m0, s46, 33792
    s_nop 0
    buffer_load_dwordx4 v31, s[8:11], s92 offen lds
    s_add_u32 s92, s49, 1310720
    s_add_u32 m0, s46, 40960
    s_nop 0
    buffer_load_dwordx4 v31, s[8:11], s92 offen lds
    s_add_u32 s92, s49, 1343488
    s_add_u32 m0, s46, 41984
    s_nop 0
    buffer_load_dwordx4 v31, s[8:11], s92 offen lds
    s_add_u32 s92, s49, 1572864
    s_add_u32 m0, s46, 49152
    s_nop 0
    buffer_load_dwordx4 v31, s[8:11], s92 offen lds
    s_add_u32 s92, s49, 1605632
    s_add_u32 m0, s46, 50176
    s_nop 0
    buffer_load_dwordx4 v31, s[8:11], s92 offen lds
    s_add_u32 s92, s49, 1835008
    s_add_u32 m0, s46, 57344
    s_nop 0
    buffer_load_dwordx4 v31, s[8:11], s92 offen lds
    s_add_u32 s92, s49, 1867776
    s_add_u32 m0, s46, 58368
    s_nop 0
    buffer_load_dwordx4 v31, s[8:11], s92 offen lds
    s_add_u32 s92, s49, 2097152
    s_add_u32 m0, s46, 65536
    s_nop 0
    buffer_load_dwordx4 v31, s[8:11], s92 offen lds
    s_add_u32 s92, s49, 2129920
    s_add_u32 m0, s46, 66560
    s_nop 0
    buffer_load_dwordx4 v31, s[8:11], s92 offen lds
    s_add_u32 s92, s49, 2359296
    s_add_u32 m0, s46, 73728
    s_nop 0
    buffer_load_dwordx4 v31, s[8:11], s92 offen lds
    s_add_u32 s92, s49, 2392064
    s_add_u32 m0, s46, 74752
    s_nop 0
    buffer_load_dwordx4 v31, s[8:11], s92 offen lds
    s_add_u32 s92, s49, 2621440
    s_add_u32 m0, s46, 81920
    s_nop 0
    buffer_load_dwordx4 v31, s[8:11], s92 offen lds
    s_add_u32 s92, s49, 2654208
    s_add_u32 m0, s46, 82944
    s_nop 0
    buffer_load_dwordx4 v31, s[8:11], s92 offen lds
    s_add_u32 s92, s49, 2883584
    s_add_u32 m0, s46, 90112
    s_nop 0
    buffer_load_dwordx4 v31, s[8:11], s92 offen lds
    s_add_u32 s92, s49, 2916352
    s_add_u32 m0, s46, 91136
    s_nop 0
    buffer_load_dwordx4 v31, s[8:11], s92 offen lds
    s_add_u32 s92, s49, 3145728
    s_add_u32 m0, s46, 98304
    s_nop 0
    buffer_load_dwordx4 v31, s[8:11], s92 offen lds
    s_add_u32 s92, s49, 3178496
    s_add_u32 m0, s46, 99328
    s_nop 0
    buffer_load_dwordx4 v31, s[8:11], s92 offen lds
    s_add_u32 s92, s49, 3407872
    s_add_u32 m0, s46, 106496
    s_nop 0
    buffer_load_dwordx4 v31, s[8:11], s92 offen lds
    s_add_u32 s92, s49, 3440640
    s_add_u32 m0, s46, 107520
    s_nop 0
    buffer_load_dwordx4 v31, s[8:11], s92 offen lds
    s_add_u32 s92, s49, 3670016
    s_add_u32 m0, s46, 114688
    s_nop 0
    buffer_load_dwordx4 v31, s[8:11], s92 offen lds
    s_add_u32 s92, s49, 3702784
    s_add_u32 m0, s46, 115712
    s_nop 0
    buffer_load_dwordx4 v31, s[8:11], s92 offen lds
    s_add_u32 s92, s49, 3932160
    s_add_u32 m0, s46, 122880
    s_nop 0
    buffer_load_dwordx4 v31, s[8:11], s92 offen lds
    s_add_u32 s92, s49, 3964928
    s_add_u32 m0, s46, 123904
    s_nop 0
    buffer_load_dwordx4 v31, s[8:11], s92 offen lds
    s_waitcnt vmcnt(24)
    s_barrier
    s_add_u32 s92, s49, 4194304
    s_add_u32 m0, s46, 131072
    s_nop 0
    buffer_load_dwordx4 v31, s[8:11], s92 offen lds
    s_add_u32 s92, s49, 4227072
    s_add_u32 m0, s46, 132096
    s_nop 0
    buffer_load_dwordx4 v31, s[8:11], s92 offen lds
    s_add_u32 s92, s49, 4456448
    s_add_u32 m0, s46, 139264
    s_nop 0
    buffer_load_dwordx4 v31, s[8:11], s92 offen lds
    s_add_u32 s92, s49, 4489216
    s_add_u32 m0, s46, 140288
    s_nop 0
    buffer_load_dwordx4 v31, s[8:11], s92 offen lds
    s_add_u32 s92, s49, 4718592
    s_add_u32 m0, s46, 147456
    s_nop 0
    buffer_load_dwordx4 v31, s[8:11], s92 offen lds
    s_add_u32 s92, s49, 4751360
    s_add_u32 m0, s46, 148480
    s_nop 0
    buffer_load_dwordx4 v31, s[8:11], s92 offen lds
    s_add_u32 s92, s49, 4980736
    s_add_u32 m0, s46, 155648
    s_nop 0
    buffer_load_dwordx4 v31, s[8:11], s92 offen lds
    s_add_u32 s92, s49, 5013504
    s_add_u32 m0, s46, 156672
    s_nop 0
    buffer_load_dwordx4 v31, s[8:11], s92 offen lds
    ds_read_b64_tr_b16 a[0:1], v100 offset:0
    ds_read_b64_tr_b16 a[2:3], v100 offset:1024
    ds_read_b64_tr_b16 a[4:5], v100 offset:8
    ds_read_b64_tr_b16 a[6:7], v100 offset:1032
    ds_read_b64_tr_b16 a[12:13], v100 offset:8192
    ds_read_b64_tr_b16 a[14:15], v100 offset:9216
    ds_read_b64_tr_b16 a[16:17], v100 offset:8200
    ds_read_b64_tr_b16 a[18:19], v100 offset:9224
    ds_read_b64_tr_b16 a[24:25], v100 offset:16384
    ds_read_b64_tr_b16 a[26:27], v100 offset:17408
    ds_read_b64_tr_b16 a[28:29], v100 offset:16392
    ds_read_b64_tr_b16 a[30:31], v100 offset:17416
    ds_read_b64_tr_b16 a[36:37], v100 offset:24576
    ds_read_b64_tr_b16 a[38:39], v100 offset:25600
    ds_read_b64_tr_b16 a[40:41], v100 offset:24584
    ds_read_b64_tr_b16 a[42:43], v100 offset:25608
    s_cmp_lg_u32 s18, 0
    s_cbranch_scc1 L_arr_5
    s_mov_b32 s3, 1
    s_buffer_atomic_add s3, s[12:15], 4 glc
    s_waitcnt lgkmcnt(0)
    s_add_u32 s3, s3, 1
    s_and_b32 s92, s3, 0xffff
    s_cmp_lg_u32 s92, 256
    s_cbranch_scc1 L_arr_5
    v_mov_b32 v20, s3
    v_lshlrev_b32 v21, 3, v0
    s_mov_b32 s92, 163840
    buffer_store_dword v20, v21, s[4:7], s92 offen sc1
    s_mov_b32 s92, 172032
    buffer_store_dword v20, v21, s[4:7], s92 offen sc1
    s_mov_b32 s92, 180224
    buffer_store_dword v20, v21, s[4:7], s92 offen sc1
    s_mov_b32 s92, 188416
    buffer_store_dword v20, v21, s[4:7], s92 offen sc1
    s_waitcnt vmcnt(0)
L_arr_5:
    s_waitcnt lgkmcnt(0)
    s_waitcnt vmcnt(24)
    s_barrier
    s_add_u32 s92, s49, 5242880
    s_add_u32 m0, s46, 0
    s_nop 0
    buffer_load_dwordx4 v31, s[8:11], s92 offen lds
    s_add_u32 s92, s49, 5275648
    s_add_u32 m0, s46, 1024
    s_nop 0
    buffer_load_dwordx4 v31, s[8:11], s92 offen lds
    s_add_u32 s92, s49, 5505024
    s_add_u32 m0, s46, 8192
    s_nop 0
    buffer_load_dwordx4 v31, s[8:11], s92 offen lds
    s_add_u32 s92, s49, 5537792
    s_add_u32 m0, s46, 9216
    s_nop 0
    buffer_load_dwordx4 v31, s[8:11], s92 offen lds
    s_add_u32 s92, s49, 5767168
    s_add_u32 m0, s46, 16384
    s_nop 0
    buffer_load_dwordx4 v31, s[8:11], s92 offen lds
    s_add_u32 s92, s49, 5799936
    s_add_u32 m0, s46, 17408
    s_nop 0
    buffer_load_dwordx4 v31, s[8:11], s92 offen lds
    s_add_u32 s92, s49, 6029312
    s_add_u32 m0, s46, 24576
    s_nop 0
    buffer_load_dwordx4 v31, s[8:11], s92 offen lds
    s_add_u32 s92, s49, 6062080
    s_add_u32 m0, s46, 25600
    s_nop 0
    buffer_load_dwordx4 v31, s[8:11], s92 offen lds
    ds_read_b64_tr_b16 a[48:49], v100 offset:32768
    ds_read_b64_tr_b16 a[50:51], v100 offset:33792
    ds_read_b64_tr_b16 a[52:53], v100 offset:32776
    ds_read_b64_tr_b16 a[54:55], v100 offset:33800
    ds_read_b64_tr_b16 a[60:61], v100 offset:40960
    ds_read_b64_tr_b16 a[62:63], v100 offset:41984
    ds_read_b64_tr_b16 a[64:65], v100 offset:40968
    ds_read_b64_tr_b16 a[66:67], v100 offset:41992
    ds_read_b64_tr_b16 a[72:73], v100 offset:49152
    ds_read_b64_tr_b16 a[74:75], v100 offset:50176
    ds_read_b64_tr_b16 a[76:77], v100 offset:49160
    ds_read_b64_tr_b16 a[78:79], v100 offset:50184
    ds_read_b64_tr_b16 a[84:85], v100 offset:57344
    ds_read_b64_tr_b16 a[86:87], v100 offset:58368
    ds_read_b64_tr_b16 a[88:89], v100 offset:57352
    ds_read_b64_tr_b16 a[90:91], v100 offset:58376
    s_waitcnt lgkmcnt(0)
    s_waitcnt vmcnt(24)
    s_barrier
    s_add_u32 s92, s49, 6291456
    s_add_u32 m0, s46, 32768
    s_nop 0
    buffer_load_dwordx4 v31, s[8:11], s92 offen lds
    s_add_u32 s92, s49, 6324224
    s_add_u32 m0, s46, 33792
    s_nop 0
    buffer_load_dwordx4 v31, s[8:11], s92 offen lds
    s_add_u32 s92, s49, 6553600
    s_add_u32 m0, s46, 40960
    s_nop 0
    buffer_load_dwordx4 v31, s[8:11], s92 offen lds
    s_add_u32 s92, s49, 6586368
    s_add_u32 m0, s46, 41984
    s_nop 0
    buffer_load_dwordx4 v31, s[8:11], s92 offen lds
    s_add_u32 s92, s49, 6815744
    s_add_u32 m0, s46, 49152
    s_nop 0
    buffer_load_dwordx4 v31, s[8:11], s92 offen lds
    s_add_u32 s92, s49, 6848512
    s_add_u32 m0, s46, 50176
    s_nop 0
    buffer_load_dwordx4 v31, s[8:11], s92 offen lds
    s_add_u32 s92, s49, 7077888
    s_add_u32 m0, s46, 57344
    s_nop 0
    buffer_load_dwordx4 v31, s[8:11], s92 offen lds
    s_add_u32 s92, s49, 7110656
    s_add_u32 m0, s46, 58368
    s_nop 0
    buffer_load_dwordx4 v31, s[8:11], s92 offen lds
    ds_read_b64_tr_b16 a[96:97], v101 offset:0
    ds_read_b64_tr_b16 a[98:99], v101 offset:1024
    ds_read_b64_tr_b16 a[100:101], v101 offset:8
    ds_read_b64_tr_b16 a[102:103], v101 offset:1032
    ds_read_b64_tr_b16 a[108:109], v101 offset:8192
    ds_read_b64_tr_b16 a[110:111], v101 offset:9216
    ds_read_b64_tr_b16 a[112:113], v101 offset:8200
    ds_read_b64_tr_b16 a[114:115], v101 offset:9224
    ds_read_b64_tr_b16 a[120:121], v101 offset:16384
    ds_read_b64_tr_b16 a[122:123], v101 offset:17408
    ds_read_b64_tr_b16 a[124:125], v101 offset:16392
    ds_read_b64_tr_b16 a[126:127], v101 offset:17416
    ds_read_b64_tr_b16 a[132:133], v101 offset:24576
    ds_read_b64_tr_b16 a[134:135], v101 offset:25600
    ds_read_b64_tr_b16 a[136:137], v101 offset:24584
    ds_read_b64_tr_b16 a[138:139], v101 offset:25608
    s_waitcnt lgkmcnt(0)
    s_waitcnt vmcnt(24)
    s_barrier
    s_add_u32 s92, s49, 7340032
    s_add_u32 m0, s46, 65536
    s_nop 0
    buffer_load_dwordx4 v31, s[8:11], s92 offen lds
    s_add_u32 s92, s49, 7372800
    s_add_u32 m0, s46, 66560
    s_nop 0
    buffer_load_dwordx4 v31, s[8:11], s92 offen lds
    s_add_u32 s92, s49, 7602176
    s_add_u32 m0, s46, 73728
    s_nop 0
    buffer_load_dwordx4 v31, s[8:11], s92 offen lds
    s_add_u32 s92, s49, 7634944
    s_add_u32 m0, s46, 74752
    s_nop 0
    buffer_load_dwordx4 v31, s[8:11], s92 offen lds
    s_add_u32 s92, s49, 7864320
    s_add_u32 m0, s46, 81920
    s_nop 0
    buffer_load_dwordx4 v31, s[8:11], s92 offen lds
    s_add_u32 s92, s49, 7897088
    s_add_u32 m0, s46, 82944
    s_nop 0
    buffer_load_dwordx4 v31, s[8:11], s92 offen lds
    s_add_u32 s92, s49, 8126464
    s_add_u32 m0, s46, 90112
    s_nop 0
    buffer_load_dwordx4 v31, s[8:11], s92 offen lds
    s_add_u32 s92, s49, 8159232
    s_add_u32 m0, s46, 91136
    s_nop 0
    buffer_load_dwordx4 v31, s[8:11], s92 offen lds
    ds_read_b64_tr_b16 a[144:145], v101 offset:32768
    ds_read_b64_tr_b16 a[146:147], v101 offset:33792
    ds_read_b64_tr_b16 a[148:149], v101 offset:32776
    ds_read_b64_tr_b16 a[150:151], v101 offset:33800
    ds_read_b64_tr_b16 a[156:157], v101 offset:40960
    ds_read_b64_tr_b16 a[158:159], v101 offset:41984
    ds_read_b64_tr_b16 a[160:161], v101 offset:40968
    ds_read_b64_tr_b16 a[162:163], v101 offset:41992
    ds_read_b64_tr_b16 a[168:169], v101 offset:49152
    ds_read_b64_tr_b16 a[170:171], v101 offset:50176
    ds_read_b64_tr_b16 a[172:173], v101 offset:49160
    ds_read_b64_tr_b16 a[174:175], v101 offset:50184
    ds_read_b64_tr_b16 a[180:181], v101 offset:57344
    ds_read_b64_tr_b16 a[182:183], v101 offset:58368
    ds_read_b64_tr_b16 a[184:185], v101 offset:57352
    ds_read_b64_tr_b16 a[186:187], v101 offset:58376
    s_waitcnt lgkmcnt(0)
    s_waitcnt vmcnt(24)
    s_barrier
    s_add_u32 s92, s50, 0
    s_add_u32 m0, s47, 98304
    s_nop 0
    buffer_load_dwordx4 v32, s[52:55], s92 offen lds
    s_add_u32 s92, s50, 262144
    s_add_u32 m0, s47, 102400
    s_nop 0
    buffer_load_dwordx4 v32, s[52:55], s92 offen lds
    s_add_u32 s92, s50, 524288
    s_add_u32 m0, s47, 106496
    s_nop 0
    buffer_load_dwordx4 v32, s[52:55], s92 offen lds
    s_add_u32 s92, s50, 786432
    s_add_u32 m0, s47, 110592
    s_nop 0
    buffer_load_dwordx4 v32, s[52:55], s92 offen lds
    s_add_u32 s92, s50, 1048576
    s_add_u32 m0, s47, 114688
    s_nop 0
    buffer_load_dwordx4 v32, s[52:55], s92 offen lds
    s_add_u32 s92, s50, 1310720
    s_add_u32 m0, s47, 118784
    s_nop 0
    buffer_load_dwordx4 v32, s[52:55], s92 offen lds
    s_add_u32 s92, s50, 1572864
    s_add_u32 m0, s47, 122880
    s_nop 0
    buffer_load_dwordx4 v32, s[52:55], s92 offen lds
    s_add_u32 s92, s50, 1835008
    s_add_u32 m0, s47, 126976
    s_nop 0
    buffer_load_dwordx4 v32, s[52:55], s92 offen lds
    ds_read_b64_tr_b16 a[192:193], v102 offset:0
    ds_read_b64_tr_b16 a[194:195], v102 offset:1024
    ds_read_b64_tr_b16 a[196:197], v102 offset:8
    ds_read_b64_tr_b16 a[198:199], v102 offset:1032
    ds_read_b64_tr_b16 a[204:205], v102 offset:8192
    ds_read_b64_tr_b16 a[206:207], v102 offset:9216
    ds_read_b64_tr_b16 a[208:209], v102 offset:8200
    ds_read_b64_tr_b16 a[210:211], v102 offset:9224
    ds_read_b64_tr_b16 a[216:217], v102 offset:16384
    ds_read_b64_tr_b16 a[218:219], v102 offset:17408
    ds_read_b64_tr_b16 a[220:221], v102 offset:16392
    ds_read_b64_tr_b16 a[222:223], v102 offset:17416
    ds_read_b64_tr_b16 a[228:229], v102 offset:24576
    ds_read_b64_tr_b16 a[230:231], v102 offset:25600
    ds_read_b64_tr_b16 a[232:233], v102 offset:24584
    ds_read_b64_tr_b16 a[234:235], v102 offset:25608
    s_waitcnt lgkmcnt(0)
    s_waitcnt vmcnt(24)
    s_barrier
    s_add_u32 s92, s50, 2097152
    s_add_u32 m0, s47, 131072
    s_nop 0
    buffer_load_dwordx4 v32, s[52:55], s92 offen lds
    s_add_u32 s92, s50, 2359296
    s_add_u32 m0, s47, 135168
    s_nop 0
    buffer_load_dwordx4 v32, s[52:55], s92 offen lds
    s_add_u32 s92, s50, 2621440
    s_add_u32 m0, s47, 139264
    s_nop 0
    buffer_load_dwordx4 v32, s[52:55], s92 offen lds
    s_add_u32 s92, s50, 2883584
    s_add_u32 m0, s47, 143360
    s_nop 0
    buffer_load_dwordx4 v32, s[52:55], s92 offen lds
    s_add_u32 s92, s50, 3145728
    s_add_u32 m0, s47, 147456
    s_nop 0
    buffer_load_dwordx4 v32, s[52:55], s92 offen lds
    s_add_u32 s92, s50, 3407872
    s_add_u32 m0, s47, 151552
    s_nop 0
    buffer_load_dwordx4 v32, s[52:55], s92 offen lds
    s_add_u32 s92, s50, 3670016
    s_add_u32 m0, s47, 155648
    s_nop 0
    buffer_load_dwordx4 v32, s[52:55], s92 offen lds
    s_add_u32 s92, s50, 3932160
    s_add_u32 m0, s47, 159744
    s_nop 0
    buffer_load_dwordx4 v32, s[52:55], s92 offen lds
    ds_read_b64_tr_b16 a[240:241], v100 offset:0
    ds_read_b64_tr_b16 a[242:243], v100 offset:1024
    ds_read_b64_tr_b16 a[244:245], v100 offset:8
    ds_read_b64_tr_b16 a[246:247], v100 offset:1032
    ds_read_b64_tr_b16 a[252:253], v100 offset:8192
    ds_read_b64_tr_b16 a[254:255], v100 offset:9216
    ds_read_b64_tr_b16 v[128:129], v100 offset:8200
    ds_read_b64_tr_b16 v[130:131], v100 offset:9224
    ds_read_b64_tr_b16 v[136:137], v100 offset:16384
    ds_read_b64_tr_b16 v[138:139], v100 offset:17408
    ds_read_b64_tr_b16 v[140:141], v100 offset:16392
    ds_read_b64_tr_b16 v[142:143], v100 offset:17416
    ds_read_b64_tr_b16 v[148:149], v100 offset:24576
    ds_read_b64_tr_b16 v[150:151], v100 offset:25600
    ds_read_b64_tr_b16 v[152:153], v100 offset:24584
    ds_read_b64_tr_b16 v[154:155], v100 offset:25608
    s_waitcnt lgkmcnt(0)
    s_waitcnt vmcnt(24)
    s_barrier
    s_add_u32 s92, s50, 4194304
    s_add_u32 m0, s47, 0
    s_nop 0
    buffer_load_dwordx4 v32, s[52:55], s92 offen lds
    s_add_u32 s92, s50, 4456448
    s_add_u32 m0, s47, 4096
    s_nop 0
    buffer_load_dwordx4 v32, s[52:55], s92 offen lds
    s_add_u32 s92, s50, 4718592
    s_add_u32 m0, s47, 8192
    s_nop 0
    buffer_load_dwordx4 v32, s[52:55], s92 offen lds
    s_add_u32 s92, s50, 4980736
    s_add_u32 m0, s47, 12288
    s_nop 0
    buffer_load_dwordx4 v32, s[52:55], s92 offen lds
    s_add_u32 s92, s50, 5242880
    s_add_u32 m0, s47, 16384
    s_nop 0
    buffer_load_dwordx4 v32, s[52:55], s92 offen lds
    s_add_u32 s92, s50, 5505024
    s_add_u32 m0, s47, 20480
    s_nop 0
    buffer_load_dwordx4 v32, s[52:55], s92 offen lds
    s_add_u32 s92, s50, 5767168
    s_add_u32 m0, s47, 24576
    s_nop 0
    buffer_load_dwordx4 v32, s[52:55], s92 offen lds
    s_add_u32 s92, s50, 6029312
    s_add_u32 m0, s47, 28672
    s_nop 0
    buffer_load_dwordx4 v32, s[52:55], s92 offen lds
    ds_read_b64_tr_b16 v[160:161], v100 offset:32768
    ds_read_b64_tr_b16 v[162:163], v100 offset:33792
    ds_read_b64_tr_b16 v[164:165], v100 offset:32776
    ds_read_b64_tr_b16 v[166:167], v100 offset:33800
    ds_read_b64_tr_b16 v[172:173], v100 offset:40960
    ds_read_b64_tr_b16 v[174:175], v100 offset:41984
    ds_read_b64_tr_b16 v[176:177], v100 offset:40968
    ds_read_b64_tr_b16 v[178:179], v100 offset:41992
    ds_read_b64_tr_b16 v[184:185], v100 offset:49152
    ds_read_b64_tr_b16 v[186:187], v100 offset:50176
    ds_read_b64_tr_b16 v[188:189], v100 offset:49160
    ds_read_b64_tr_b16 v[190:191], v100 offset:50184
    ds_read_b64_tr_b16 v[196:197], v100 offset:57344
    ds_read_b64_tr_b16 v[198:199], v100 offset:58368
    ds_read_b64_tr_b16 v[200:201], v100 offset:57352
    ds_read_b64_tr_b16 v[202:203], v100 offset:58376
    s_waitcnt lgkmcnt(0)
    s_waitcnt vmcnt(24)
    s_barrier
    s_add_u32 s92, s50, 6291456
    s_add_u32 m0, s47, 32768
    s_nop 0
    buffer_load_dwordx4 v32, s[52:55], s92 offen lds
    s_add_u32 s92, s50, 6553600
    s_add_u32 m0, s47, 36864
    s_nop 0
    buffer_load_dwordx4 v32, s[52:55], s92 offen lds
    s_add_u32 s92, s50, 6815744
    s_add_u32 m0, s47, 40960
    s_nop 0
    buffer_load_dwordx4 v32, s[52:55], s92 offen lds
    s_add_u32 s92, s50, 7077888
    s_add_u32 m0, s47, 45056
    s_nop 0
    buffer_load_dwordx4 v32, s[52:55], s92 offen lds
    s_add_u32 s92, s50, 7340032
    s_add_u32 m0, s47, 49152
    s_nop 0
    buffer_load_dwordx4 v32, s[52:55], s92 offen lds
    s_add_u32 s92, s50, 7602176
    s_add_u32 m0, s47, 53248
    s_nop 0
    buffer_load_dwordx4 v32, s[52:55], s92 offen lds
    s_add_u32 s92, s50, 7864320
    s_add_u32 m0, s47, 57344
    s_nop 0
    buffer_load_dwordx4 v32, s[52:55], s92 offen lds
    s_add_u32 s92, s50, 8126464
    s_add_u32 m0, s47, 61440
    s_nop 0
    buffer_load_dwordx4 v32, s[52:55], s92 offen lds
    ds_read_b64_tr_b16 v[208:209], v101 offset:0
    ds_read_b64_tr_b16 v[210:211], v101 offset:1024
    ds_read_b64_tr_b16 v[212:213], v101 offset:8
    ds_read_b64_tr_b16 v[214:215], v101 offset:1032
    ds_read_b64_tr_b16 v[220:221], v101 offset:8192
    ds_read_b64_tr_b16 v[222:223], v101 offset:9216
    ds_read_b64_tr_b16 v[224:225], v101 offset:8200
    ds_read_b64_tr_b16 v[226:227], v101 offset:9224
    ds_read_b64_tr_b16 v[232:233], v101 offset:16384
    ds_read_b64_tr_b16 v[234:235], v101 offset:17408
    ds_read_b64_tr_b16 v[236:237], v101 offset:16392
    ds_read_b64_tr_b16 v[238:239], v101 offset:17416
    ds_read_b64_tr_b16 v[244:245], v101 offset:24576
    ds_read_b64_tr_b16 v[246:247], v101 offset:25600
    ds_read_b64_tr_b16 v[248:249], v101 offset:24584
    ds_read_b64_tr_b16 v[250:251], v101 offset:25608
    s_waitcnt lgkmcnt(0)
    s_waitcnt vmcnt(24)
    s_barrier
    ds_read_b64_tr_b16 a[8:9], v110 offset:32768
    ds_read_b64_tr_b16 a[10:11], v110 offset:33280
    ds_read_b64_tr_b16 a[20:21], v110 offset:36864
    ds_read_b64_tr_b16 a[22:23], v110 offset:37376
    ds_read_b64_tr_b16 a[32:33], v110 offset:40960
    ds_read_b64_tr_b16 a[34:35], v110 offset:41472
    ds_read_b64_tr_b16 a[44:45], v110 offset:45056
    ds_read_b64_tr_b16 a[46:47], v110 offset:45568
    ds_read_b64_tr_b16 a[56:57], v110 offset:49152
    ds_read_b64_tr_b16 a[58:59], v110 offset:49664
    ds_read_b64_tr_b16 a[68:69], v110 offset:53248
    ds_read_b64_tr_b16 a[70:71], v110 offset:53760
    ds_read_b64_tr_b16 a[80:81], v110 offset:57344
    ds_read_b64_tr_b16 a[82:83], v110 offset:57856
    ds_read_b64_tr_b16 a[92:93], v110 offset:61440
    ds_read_b64_tr_b16 a[94:95], v110 offset:61952
    s_waitcnt lgkmcnt(0)
    s_waitcnt vmcnt(16)
    s_barrier
    ds_read_b64_tr_b16 a[104:105], v111 offset:0
    ds_read_b64_tr_b16 a[106:107], v111 offset:512
    ds_read_b64_tr_b16 a[116:117], v111 offset:4096
    ds_read_b64_tr_b16 a[118:119], v111 offset:4608
    ds_read_b64_tr_b16 a[128:129], v111 offset:8192
    ds_read_b64_tr_b16 a[130:131], v111 offset:8704
    ds_read_b64_tr_b16 a[140:141], v111 offset:12288
    ds_read_b64_tr_b16 a[142:143], v111 offset:12800
    ds_read_b64_tr_b16 a[152:153], v111 offset:16384
    ds_read_b64_tr_b16 a[154:155], v111 offset:16896
    ds_read_b64_tr_b16 a[164:165], v111 offset:20480
    ds_read_b64_tr_b16 a[166:167], v111 offset:20992
    ds_read_b64_tr_b16 a[176:177], v111 offset:24576
    ds_read_b64_tr_b16 a[178:179], v111 offset:25088
    ds_read_b64_tr_b16 a[188:189], v111 offset:28672
    ds_read_b64_tr_b16 a[190:191], v111 offset:29184
    s_waitcnt lgkmcnt(0)
    s_waitcnt vmcnt(8)
    s_barrier
    ds_read_b64_tr_b16 a[200:201], v109 offset:0
    ds_read_b64_tr_b16 a[202:203], v109 offset:512
    ds_read_b64_tr_b16 a[212:213], v109 offset:4096
    ds_read_b64_tr_b16 a[214:215], v109 offset:4608
    ds_read_b64_tr_b16 a[224:225], v109 offset:8192
    ds_read_b64_tr_b16 a[226:227], v109 offset:8704
    ds_read_b64_tr_b16 a[236:237], v109 offset:12288
    ds_read_b64_tr_b16 a[238:239], v109 offset:12800
    ds_read_b64_tr_b16 a[248:249], v109 offset:16384
    ds_read_b64_tr_b16 a[250:251], v109 offset:16896
    ds_read_b64_tr_b16 v[132:133], v109 offset:20480
    ds_read_b64_tr_b16 v[134:135], v109 offset:20992
    ds_read_b64_tr_b16 v[144:145], v109 offset:24576
    ds_read_b64_tr_b16 v[146:147], v109 offset:25088
    ds_read_b64_tr_b16 v[156:157], v109 offset:28672
    ds_read_b64_tr_b16 v[158:159], v109 offset:29184
    s_waitcnt lgkmcnt(0)
    s_waitcnt vmcnt(0)
    s_barrier
    ds_read_b64_tr_b16 v[168:169], v109 offset:32768
    ds_read_b64_tr_b16 v[170:171], v109 offset:33280
    ds_read_b64_tr_b16 v[180:181], v109 offset:36864
    ds_read_b64_tr_b16 v[182:183], v109 offset:37376
    ds_read_b64_tr_b16 v[192:193], v109 offset:40960
    ds_read_b64_tr_b16 v[194:195], v109 offset:41472
    ds_read_b64_tr_b16 v[204:205], v109 offset:45056
    ds_read_b64_tr_b16 v[206:207], v109 offset:45568
    ds_read_b64_tr_b16 v[216:217], v109 offset:49152
    ds_read_b64_tr_b16 v[218:219], v109 offset:49664
    ds_read_b64_tr_b16 v[228:229], v109 offset:53248
    ds_read_b64_tr_b16 v[230:231], v109 offset:53760
    ds_read_b64_tr_b16 v[240:241], v109 offset:57344
    ds_read_b64_tr_b16 v[242:243], v109 offset:57856
    ds_read_b64_tr_b16 v[252:253], v109 offset:61440
    ds_read_b64_tr_b16 v[254:255], v109 offset:61952
    s_waitcnt lgkmcnt(0)
    s_lshl_b32 s93, s16, 5
    s_add_u32 s93, s93, s17
    s_lshl_b32 s93, s93, 7
    s_add_u32 s93, s93, 163840
    s_mov_b32 s3, 0
L_ws_6:
    s_buffer_load_dword s92, s[4:7], s93 glc
    s_waitcnt lgkmcnt(0)
    s_cmp_lg_u32 s92, 0
    s_cbranch_scc1 L_wsd_7
    s_add_u32 s3, s3, 1
    s_cmp_lt_u32 s3, 40000
    s_cbranch_scc1 L_ws_6
    s_mov_b32 s3, 10
    s_branch L_abort
L_wsd_7:
    s_mul_i32 s46, s18, 8192
    s_mul_i32 s47, s18, 8192
    s_mul_i32 s96, s18, -3072
    s_lshl_b32 s97, s18, 10
    s_mov_b32 s20, 0
    s_mov_b32 s21, 0
    s_mov_b32 s22, 0
    s_mov_b32 s34, 0
    s_mov_b32 s35, 0
    s_mov_b32 s36, 0
    s_cmp_lt_u32 s20, 64
    s_cselect_b64 s[88:89], s[24:25], s[26:27]
    s_bitcmp1_b64 s[88:89], s20
    s_cselect_b32 s28, 1, 0
    s_cselect_b32 s29, s22, s21
    s_add_u32 s22, s22, s28
    s_xor_b32 s88, s28, 1
    s_add_u32 s21, s21, s88
    s_lshl_b32 s30, s28, 6
    s_add_u32 s30, s30, s29
    s_mul_i32 s88, s28, 8388608
    s_mul_i32 s89, s29, 65536
    s_add_u32 s31, s88, s89
    s_add_u32 s31, s31, s42
    s_lshl2_add_u32 s33, s30, s60
    s_cmp_lt_u32 s20, 128
    s_cselect_b32 s31, s31, 268435456
    s_cselect_b32 s32, s61, 0
    s_add_u32 s20, s20, 1
    s_mul_i32 s32, s32, s28
    s_barrier
    v_mov_b32 v9, 163824
    s_lshl_b32 s92, s18, 2
    v_add_u32 v11, s92, v9
    ds_write_b32 v11, v3
    s_mov_b32 s58, 268435456
    s_mov_b32 s59, -1
    s_cmp_eq_u32 s18, 0
    s_cselect_b32 s57, -1, 0
    s_cselect_b32 s43, s43, 268435456
    s_branch L_PJ_ss1
L_PJ_top0:
    s_waitcnt lgkmcnt(4)
    v_mfma_f32_16x16x32_bf16 v[16:19], a[0:3], v[64:67], 0
    ds_read_b128 v[88:91], v6 offset:768
    v_mfma_f32_16x16x32_bf16 v[28:31], a[0:3], v[68:71], 0
    ds_read_b128 v[92:95], v6 offset:33536
    v_mfma_f32_16x16x32_bf16 v[32:35], a[4:7], v[68:71], 0
    s_and_b32 s86, s36, 95
    s_mul_i32 s86, s86, 262144
    s_add_u32 s87, s86, s45
    v_mfma_f32_16x16x32_bf16 v[20:23], a[4:7], v[64:67], 0
    s_add_u32 s86, s86, s44
    v_cvt_pk_bf16_f32 v96, v40, v41
    v_cvt_pk_bf16_f32 v97, v42, v43
    v_mfma_f32_16x16x32_bf16 v[24:27], v[64:67], a[8:11], 0
    s_mul_i32 s37, s34, 20480
    v_cvt_pk_bf16_f32 v98, v44, v45
    v_cvt_pk_bf16_f32 v99, v46, v47
    v_mfma_f32_16x16x32_bf16 v[36:39], v[68:71], a[8:11], 0
    s_waitcnt lgkmcnt(4)
    s_add_u32 s37, s37, s43
    s_add_u32 s38, s35, 1
    v_mfma_f32_16x16x32_bf16 v[16:19], a[12:15], v[72:75], v[16:19]
    ds_read_b128 v[64:67], v6 offset:1024
    v_mov_b32 v5, s38
    v_mfma_f32_16x16x32_bf16 v[28:31], a[12:15], v[76:79], v[28:31]
    ds_read_b128 v[68:71], v6 offset:33792
    s_mov_b32 s34, s28
    v_mfma_f32_16x16x32_bf16 v[32:35], a[16:19], v[76:79], v[32:35]
    buffer_store_dwordx4 v[96:99], v0, s[4:7], s86 offen offset:0 sc1
    v_cvt_pk_bf16_f32 v100, v52, v53
    v_mfma_f32_16x16x32_bf16 v[20:23], a[16:19], v[72:75], v[20:23]
    s_mov_b32 s35, s29
    v_cvt_pk_bf16_f32 v101, v54, v55
    v_cvt_pk_bf16_f32 v102, v56, v57
    v_mfma_f32_16x16x32_bf16 v[24:27], v[72:75], a[20:23], v[24:27]
    s_mov_b32 s36, s30
    v_cvt_pk_bf16_f32 v103, v58, v59
    s_add_u32 s59, s59, 1
    v_mfma_f32_16x16x32_bf16 v[36:39], v[76:79], a[20:23], v[36:39]
    s_waitcnt lgkmcnt(2)
    s_cmp_lt_u32 s20, 64
    s_cselect_b64 s[88:89], s[24:25], s[26:27]
    v_mfma_f32_16x16x32_bf16 v[16:19], a[24:27], v[80:83], v[16:19]
    ds_read_b128 v[72:75], v6 offset:1280
    v_mfma_f32_16x16x32_bf16 v[28:31], a[24:27], v[84:87], v[28:31]
    ds_read_b128 v[76:79], v6 offset:34048
    v_mfma_f32_16x16x32_bf16 v[32:35], a[28:31], v[84:87], v[32:35]
    buffer_store_dwordx4 v[100:103], v0, s[4:7], s86 offen offset:1024 sc1
    v_cvt_pk_bf16_f32 v104, v48, v49
    v_mfma_f32_16x16x32_bf16 v[20:23], a[28:31], v[80:83], v[20:23]
    s_bitcmp1_b64 s[88:89], s20
    s_cselect_b32 s28, 1, 0
    s_cselect_b32 s29, s22, s21
    v_mfma_f32_16x16x32_bf16 v[24:27], v[80:83], a[32:35], v[24:27]
    s_add_u32 s22, s22, s28
    v_cvt_pk_bf16_f32 v105, v50, v51
    v_cvt_pk_bf16_f32 v106, v60, v61
    v_mfma_f32_16x16x32_bf16 v[36:39], v[84:87], a[32:35], v[36:39]
    s_xor_b32 s88, s28, 1
    v_cvt_pk_bf16_f32 v107, v62, v63
    s_add_u32 s21, s21, s88
    v_mfma_f32_16x16x32_bf16 v[16:19], a[36:39], v[88:91], v[16:19]
    ds_read_b128 v[80:83], v6 offset:1536
    s_lshl_b32 s30, s28, 6
    v_mfma_f32_16x16x32_bf16 v[28:31], a[36:39], v[92:95], v[28:31]
    ds_read_b128 v[84:87], v6 offset:34304
    s_add_u32 s30, s30, s29
    v_mfma_f32_16x16x32_bf16 v[32:35], a[40:43], v[92:95], v[32:35]
    buffer_store_dwordx4 v[104:107], v0, s[4:7], s87 offen sc1
    s_mul_i32 s88, s28, 8388608
    v_mfma_f32_16x16x32_bf16 v[20:23], a[40:43], v[88:91], v[20:23]
    s_mul_i32 s89, s29, 65536
    s_add_u32 s31, s88, s89
    s_add_u32 s31, s31, s42
    v_mfma_f32_16x16x32_bf16 v[24:27], v[88:91], a[44:47], v[24:27]
    s_lshl2_add_u32 s33, s30, s60
    v_mfma_f32_16x16x32_bf16 v[36:39], v[92:95], a[44:47], v[36:39]
    s_waitcnt lgkmcnt(2)
    v_mfma_f32_16x16x32_bf16 v[16:19], a[48:51], v[64:67], v[16:19]
    ds_read_b128 v[88:91], v6 offset:1792
    v_mfma_f32_16x16x32_bf16 v[28:31], a[48:51], v[68:71], v[28:31]
    ds_read_b128 v[92:95], v6 offset:34560
    v_mfma_f32_16x16x32_bf16 v[32:35], a[52:55], v[68:71], v[32:35]
    s_cmp_lt_u32 s20, 128
    s_cselect_b32 s31, s31, 268435456
    s_cselect_b32 s32, s61, 0
    v_mfma_f32_16x16x32_bf16 v[20:23], a[52:55], v[64:67], v[20:23]
    s_add_u32 s20, s20, 1
    s_mul_i32 s32, s32, s28
    s_andn2_b32 s23, s28, s34
    v_mfma_f32_16x16x32_bf16 v[24:27], v[64:67], a[56:59], v[24:27]
    v_mfma_f32_16x16x32_bf16 v[36:39], v[68:71], a[56:59], v[36:39]
    v_mfma_f32_16x16x32_bf16 v[16:19], a[60:63], v[72:75], v[16:19]
    ds_read_b128 v[64:67], v6 offset:2048
    v_mfma_f32_16x16x32_bf16 v[28:31], a[60:63], v[76:79], v[28:31]
    ds_read_b128 v[68:71], v6 offset:34816
    v_mfma_f32_16x16x32_bf16 v[32:35], a[64:67], v[76:79], v[32:35]
    v_mfma_f32_16x16x32_bf16 v[20:23], a[64:67], v[72:75], v[20:23]
    v_mfma_f32_16x16x32_bf16 v[24:27], v[72:75], a[68:71], v[24:27]
    v_mfma_f32_16x16x32_bf16 v[36:39], v[76:79], a[68:71], v[36:39]
    s_waitcnt lgkmcnt(2)
    v_mfma_f32_16x16x32_bf16 v[16:19], a[72:75], v[80:83], v[16:19]
    ds_read_b128 v[72:75], v6 offset:2304
    v_mfma_f32_16x16x32_bf16 v[28:31], a[72:75], v[84:87], v[28:31]
    ds_read_b128 v[76:79], v6 offset:35072
    v_mfma_f32_16x16x32_bf16 v[32:35], a[76:79], v[84:87], v[32:35]
    v_mfma_f32_16x16x32_bf16 v[20:23], a[76:79], v[80:83], v[20:23]
    v_mfma_f32_16x16x32_bf16 v[24:27], v[80:83], a[80:83], v[24:27]
    v_mfma_f32_16x16x32_bf16 v[36:39], v[84:87], a[80:83], v[36:39]
    v_mfma_f32_16x16x32_bf16 v[16:19], a[84:87], v[88:91], v[16:19]
    ds_read_b128 v[80:83], v6 offset:2560
    v_mfma_f32_16x16x32_bf16 v[28:31], a[84:87], v[92:95], v[28:31]
    ds_read_b128 v[84:87], v6 offset:35328
    v_mfma_f32_16x16x32_bf16 v[32:35], a[88:91], v[92:95], v[32:35]
    v_mfma_f32_16x16x32_bf16 v[20:23], a[88:91], v[88:91], v[20:23]
    v_mfma_f32_16x16x32_bf16 v[24:27], v[88:91], a[92:95], v[24:27]
    v_mfma_f32_16x16x32_bf16 v[36:39], v[92:95], a[92:95], v[36:39]
    s_waitcnt lgkmcnt(4)
    s_buffer_load_dword s62, s[4:7], s33 glc
    v_mfma_f32_16x16x32_bf16 v[16:19], a[96:99], v[64:67], v[16:19]
    ds_read_b128 v[88:91], v6 offset:2816
    v_mfma_f32_16x16x32_bf16 v[28:31], a[96:99], v[68:71], v[28:31]
    ds_read_b128 v[92:95], v6 offset:35584
    v_mfma_f32_16x16x32_bf16 v[32:35], a[100:103], v[68:71], v[32:35]
    v_mfma_f32_16x16x32_bf16 v[20:23], a[100:103], v[64:67], v[20:23]
    v_mfma_f32_16x16x32_bf16 v[24:27], v[64:67], a[104:107], v[24:27]
    v_mfma_f32_16x16x32_bf16 v[36:39], v[68:71], a[104:107], v[36:39]
    s_waitcnt lgkmcnt(4)
    v_mfma_f32_16x16x32_bf16 v[16:19], a[108:111], v[72:75], v[16:19]
    ds_read_b128 v[64:67], v6 offset:3072
    v_mfma_f32_16x16x32_bf16 v[28:31], a[108:111], v[76:79], v[28:31]
    ds_read_b128 v[68:71], v6 offset:35840
    v_mfma_f32_16x16x32_bf16 v[32:35], a[112:115], v[76:79], v[32:35]
    v_mfma_f32_16x16x32_bf16 v[20:23], a[112:115], v[72:75], v[20:23]
    v_mfma_f32_16x16x32_bf16 v[24:27], v[72:75], a[116:119], v[24:27]
    v_mfma_f32_16x16x32_bf16 v[36:39], v[76:79], a[116:119], v[36:39]
    s_waitcnt lgkmcnt(4)
    v_mfma_f32_16x16x32_bf16 v[16:19], a[120:123], v[80:83], v[16:19]
    ds_read_b128 v[72:75], v6 offset:3328
    v_mfma_f32_16x16x32_bf16 v[28:31], a[120:123], v[84:87], v[28:31]
    ds_read_b128 v[76:79], v6 offset:36096
    v_mfma_f32_16x16x32_bf16 v[32:35], a[124:127], v[84:87], v[32:35]
    v_mfma_f32_16x16x32_bf16 v[20:23], a[124:127], v[80:83], v[20:23]
    v_mfma_f32_16x16x32_bf16 v[24:27], v[80:83], a[128:131], v[24:27]
    v_mfma_f32_16x16x32_bf16 v[36:39], v[84:87], a[128:131], v[36:39]
    s_waitcnt lgkmcnt(4)
    v_mfma_f32_16x16x32_bf16 v[16:19], a[132:135], v[88:91], v[16:19]
    ds_read_b128 v[80:83], v6 offset:3584
    v_mfma_f32_16x16x32_bf16 v[28:31], a[132:135], v[92:95], v[28:31]
    ds_read_b128 v[84:87], v6 offset:36352
    v_mfma_f32_16x16x32_bf16 v[32:35], a[136:139], v[92:95], v[32:35]
    v_mfma_f32_16x16x32_bf16 v[20:23], a[136:139], v[88:91], v[20:23]
    v_mfma_f32_16x16x32_bf16 v[24:27], v[88:91], a[140:143], v[24:27]
    v_mfma_f32_16x16x32_bf16 v[36:39], v[92:95], a[140:143], v[36:39]
    s_waitcnt lgkmcnt(4)
    v_mfma_f32_16x16x32_bf16 v[16:19], a[144:147], v[64:67], v[16:19]
    ds_read_b128 v[88:91], v6 offset:3840
    v_mfma_f32_16x16x32_bf16 v[28:31], a[144:147], v[68:71], v[28:31]
    ds_read_b128 v[92:95], v6 offset:36608
    v_mfma_f32_16x16x32_bf16 v[32:35], a[148:151], v[68:71], v[32:35]
    v_mfma_f32_16x16x32_bf16 v[20:23], a[148:151], v[64:67], v[20:23]
    v_mfma_f32_16x16x32_bf16 v[24:27], v[64:67], a[152:155], v[24:27]
    v_mfma_f32_16x16x32_bf16 v[36:39], v[68:71], a[152:155], v[36:39]
    s_waitcnt vmcnt(0)
L_PJ_mid0:
    s_barrier
    s_waitcnt lgkmcnt(4)
    v_mfma_f32_16x16x32_bf16 v[16:19], a[156:159], v[72:75], v[16:19]
    s_max_u32 s37, s37, s58
    s_mov_b32 s58, 0
    v_mfma_f32_16x16x32_bf16 v[28:31], a[156:159], v[76:79], v[28:31]
    buffer_store_dword v5, v3, s[4:7], s37 offen sc1
    v_mfma_f32_16x16x32_bf16 v[32:35], a[160:163], v[76:79], v[32:35]
    v_mfma_f32_16x16x32_bf16 v[20:23], a[160:163], v[72:75], v[20:23]
    v_mfma_f32_16x16x32_bf16 v[24:27], v[72:75], a[164:167], v[24:27]
    v_mfma_f32_16x16x32_bf16 v[36:39], v[76:79], a[164:167], v[36:39]
    s_waitcnt lgkmcnt(0)
    s_cmp_ge_u32 s62, s32
    s_cbranch_scc0 L_PJ_nr0
L_PJ_rd0:
    s_mov_b32 s40, s31
L_PJ_go0:
    v_mfma_f32_16x16x32_bf16 v[16:19], a[168:171], v[80:83], v[16:19]
    ds_read_b128 v[64:67], v6 offset:4096
    s_add_u32 s94, s40, 0
    v_mfma_f32_16x16x32_bf16 v[28:31], a[168:171], v[84:87], v[28:31]
    ds_read_b128 v[68:71], v6 offset:36864
    s_add_u32 m0, s47, 65536
    v_mfma_f32_16x16x32_bf16 v[32:35], a[172:175], v[84:87], v[32:35]
    buffer_load_dwordx4 v1, s[4:7], s94 offen offset:0 sc1 lds
    v_mfma_f32_16x16x32_bf16 v[20:23], a[172:175], v[80:83], v[20:23]
    ds_read_b128 v[72:75], v6 offset:4352
    v_mfma_f32_16x16x32_bf16 v[24:27], v[80:83], a[176:179], v[24:27]
    buffer_load_dwordx4 v1, s[4:7], s94 offen offset:1024 sc1 lds
    v_mfma_f32_16x16x32_bf16 v[36:39], v[84:87], a[176:179], v[36:39]
    v_mfma_f32_16x16x32_bf16 v[16:19], a[180:183], v[88:91], v[16:19]
    ds_read_b128 v[76:79], v6 offset:37120
    v_mfma_f32_16x16x32_bf16 v[28:31], a[180:183], v[92:95], v[28:31]
    ds_read_b128 v[80:83], v6 offset:4608
    v_mfma_f32_16x16x32_bf16 v[32:35], a[184:187], v[92:95], v[32:35]
    v_mfma_f32_16x16x32_bf16 v[20:23], a[184:187], v[88:91], v[20:23]
    ds_read_b128 v[84:87], v6 offset:37376
    v_mfma_f32_16x16x32_bf16 v[24:27], v[88:91], a[188:191], v[24:27]
    buffer_load_dwordx4 v1, s[4:7], s94 offen offset:2048 sc1 lds
    v_mfma_f32_16x16x32_bf16 v[36:39], v[92:95], a[188:191], v[36:39]
    s_waitcnt lgkmcnt(4)
    v_mfma_f32_16x16x32_bf16 v[16:19], a[192:195], v[64:67], v[16:19]
    ds_read_b128 v[88:91], v6 offset:4864
    v_mfma_f32_16x16x32_bf16 v[28:31], a[192:195], v[68:71], v[28:31]
    ds_read_b128 v[92:95], v6 offset:37632
    v_mfma_f32_16x16x32_bf16 v[32:35], a[196:199], v[68:71], v[32:35]
    v_mfma_f32_16x16x32_bf16 v[20:23], a[196:199], v[64:67], v[20:23]
    buffer_load_dwordx4 v1, s[4:7], s94 offen offset:3072 sc1 lds
    v_mfma_f32_16x16x32_bf16 v[24:27], v[64:67], a[200:203], v[24:27]
    v_mfma_f32_16x16x32_bf16 v[36:39], v[68:71], a[200:203], v[36:39]
    s_waitcnt lgkmcnt(4)
    v_mfma_f32_16x16x32_bf16 v[16:19], a[204:207], v[72:75], v[16:19]
    ds_read_b128 v[64:67], v6 offset:5120
    v_mfma_f32_16x16x32_bf16 v[28:31], a[204:207], v[76:79], v[28:31]
    ds_read_b128 v[68:71], v6 offset:37888
    v_mfma_f32_16x16x32_bf16 v[32:35], a[208:211], v[76:79], v[32:35]
    v_mfma_f32_16x16x32_bf16 v[20:23], a[208:211], v[72:75], v[20:23]
    s_add_u32 s94, s40, 32768
    s_add_u32 m0, s47, 98304
    v_mfma_f32_16x16x32_bf16 v[24:27], v[72:75], a[212:215], v[24:27]
    buffer_load_dwordx4 v1, s[4:7], s94 offen offset:0 sc1 lds
    v_mfma_f32_16x16x32_bf16 v[36:39], v[76:79], a[212:215], v[36:39]
    s_waitcnt lgkmcnt(2)
    v_mfma_f32_16x16x32_bf16 v[16:19], a[216:219], v[80:83], v[16:19]
    ds_read_b128 v[72:75], v6 offset:5376
    v_mfma_f32_16x16x32_bf16 v[28:31], a[216:219], v[84:87], v[28:31]
    ds_read_b128 v[76:79], v6 offset:38144
    v_mfma_f32_16x16x32_bf16 v[32:35], a[220:223], v[84:87], v[32:35]
    v_mfma_f32_16x16x32_bf16 v[20:23], a[220:223], v[80:83], v[20:23]
    buffer_load_dwordx4 v1, s[4:7], s94 offen offset:1024 sc1 lds
    v_mfma_f32_16x16x32_bf16 v[24:27], v[80:83], a[224:227], v[24:27]
    v_mfma_f32_16x16x32_bf16 v[36:39], v[84:87], a[224:227], v[36:39]
    v_mfma_f32_16x16x32_bf16 v[16:19], a[228:231], v[88:91], v[16:19]
    ds_read_b128 v[80:83], v6 offset:5632
    v_mfma_f32_16x16x32_bf16 v[28:31], a[228:231], v[92:95], v[28:31]
    ds_read_b128 v[84:87], v6 offset:38400
    v_mfma_f32_16x16x32_bf16 v[32:35], a[232:235], v[92:95], v[32:35]
    buffer_load_dwordx4 v1, s[4:7], s94 offen offset:2048 sc1 lds
    v_mfma_f32_16x16x32_bf16 v[20:23], a[232:235], v[88:91], v[20:23]
    v_mfma_f32_16x16x32_bf16 v[24:27], v[88:91], a[236:239], v[24:27]
    v_mfma_f32_16x16x32_bf16 v[36:39], v[92:95], a[236:239], v[36:39]
    s_waitcnt lgkmcnt(2)
    v_mfma_f32_16x16x32_bf16 v[16:19], a[240:243], v[64:67], v[16:19]
    ds_read_b128 v[88:91], v6 offset:5888
    v_mfma_f32_16x16x32_bf16 v[28:31], a[240:243], v[68:71], v[28:31]
    ds_read_b128 v[92:95], v6 offset:38656
    v_mfma_f32_16x16x32_bf16 v[32:35], a[244:247], v[68:71], v[32:35]
    buffer_load_dwordx4 v1, s[4:7], s94 offen offset:3072 sc1 lds
    v_mfma_f32_16x16x32_bf16 v[20:23], a[244:247], v[64:67], v[20:23]
    v_mfma_f32_16x16x32_bf16 v[24:27], v[64:67], a[248:251], v[24:27]
    v_mfma_f32_16x16x32_bf16 v[36:39], v[68:71], a[248:251], v[36:39]
    v_mfma_f32_16x16x32_bf16 v[16:19], a[252:255], v[72:75], v[16:19]
    ds_read_b128 v[64:67], v6 offset:6144
    v_mfma_f32_16x16x32_bf16 v[28:31], a[252:255], v[76:79], v[28:31]
    ds_read_b128 v[68:71], v6 offset:38912
    v_mfma_f32_16x16x32_bf16 v[32:35], v[128:131], v[76:79], v[32:35]
    s_add_u32 s94, s40, 4096
    s_add_u32 m0, s47, 69632
    v_mfma_f32_16x16x32_bf16 v[20:23], v[128:131], v[72:75], v[20:23]
    buffer_load_dwordx4 v1, s[4:7], s94 offen offset:0 sc1 lds
    v_mfma_f32_16x16x32_bf16 v[24:27], v[72:75], v[132:135], v[24:27]
    v_mfma_f32_16x16x32_bf16 v[36:39], v[76:79], v[132:135], v[36:39]
    s_waitcnt lgkmcnt(2)
    v_mfma_f32_16x16x32_bf16 v[16:19], v[136:139], v[80:83], v[16:19]
    ds_read_b128 v[72:75], v6 offset:6400
    v_mfma_f32_16x16x32_bf16 v[28:31], v[136:139], v[84:87], v[28:31]
    ds_read_b128 v[76:79], v6 offset:39168
    v_mfma_f32_16x16x32_bf16 v[32:35], v[140:143], v[84:87], v[32:35]
    buffer_load_dwordx4 v1, s[4:7], s94 offen offset:1024 sc1 lds
    v_mfma_f32_16x16x32_bf16 v[20:23], v[140:143], v[80:83], v[20:23]
    v_mfma_f32_16x16x32_bf16 v[24:27], v[80:83], v[144:147], v[24:27]
    v_mfma_f32_16x16x32_bf16 v[36:39], v[84:87], v[144:147], v[36:39]
    v_mfma_f32_16x16x32_bf16 v[16:19], v[148:151], v[88:91], v[16:19]
    ds_read_b128 v[80:83], v6 offset:6656
    v_mfma_f32_16x16x32_bf16 v[28:31], v[148:151], v[92:95], v[28:31]
    ds_read_b128 v[84:87], v6 offset:39424
    v_mfma_f32_16x16x32_bf16 v[32:35], v[152:155], v[92:95], v[32:35]
    buffer_load_dwordx4 v1, s[4:7], s94 offen offset:2048 sc1 lds
    v_mfma_f32_16x16x32_bf16 v[20:23], v[152:155], v[88:91], v[20:23]
    v_mfma_f32_16x16x32_bf16 v[24:27], v[88:91], v[156:159], v[24:27]
    v_mfma_f32_16x16x32_bf16 v[36:39], v[92:95], v[156:159], v[36:39]
    s_waitcnt lgkmcnt(2)
    v_mfma_f32_16x16x32_bf16 v[16:19], v[160:163], v[64:67], v[16:19]
    ds_read_b128 v[88:91], v6 offset:6912
    v_mfma_f32_16x16x32_bf16 v[28:31], v[160:163], v[68:71], v[28:31]
    ds_read_b128 v[92:95], v6 offset:39680
    v_mfma_f32_16x16x32_bf16 v[32:35], v[164:167], v[68:71], v[32:35]
    buffer_load_dwordx4 v1, s[4:7], s94 offen offset:3072 sc1 lds
    v_mfma_f32_16x16x32_bf16 v[20:23], v[164:167], v[64:67], v[20:23]
    v_mfma_f32_16x16x32_bf16 v[24:27], v[64:67], v[168:171], v[24:27]
    v_mfma_f32_16x16x32_bf16 v[36:39], v[68:71], v[168:171], v[36:39]
    v_mfma_f32_16x16x32_bf16 v[16:19], v[172:175], v[72:75], v[16:19]
    ds_read_b128 v[64:67], v6 offset:7168
    s_add_u32 s94, s40, 36864
    v_mfma_f32_16x16x32_bf16 v[28:31], v[172:175], v[76:79], v[28:31]
    ds_read_b128 v[68:71], v6 offset:39936
    s_add_u32 m0, s47, 102400
    v_mfma_f32_16x16x32_bf16 v[32:35], v[176:179], v[76:79], v[32:35]
    buffer_load_dwordx4 v1, s[4:7], s94 offen offset:0 sc1 lds
    v_mfma_f32_16x16x32_bf16 v[20:23], v[176:179], v[72:75], v[20:23]
    v_mfma_f32_16x16x32_bf16 v[24:27], v[72:75], v[180:183], v[24:27]
    v_mfma_f32_16x16x32_bf16 v[36:39], v[76:79], v[180:183], v[36:39]
    s_waitcnt lgkmcnt(2)
    v_mfma_f32_16x16x32_bf16 v[16:19], v[184:187], v[80:83], v[16:19]
    ds_read_b128 v[72:75], v6 offset:7424
    v_mfma_f32_16x16x32_bf16 v[28:31], v[184:187], v[84:87], v[28:31]
    ds_read_b128 v[76:79], v6 offset:40192
    v_mfma_f32_16x16x32_bf16 v[32:35], v[188:191], v[84:87], v[32:35]
    buffer_load_dwordx4 v1, s[4:7], s94 offen offset:1024 sc1 lds
    v_mfma_f32_16x16x32_bf16 v[20:23], v[188:191], v[80:83], v[20:23]
    v_mfma_f32_16x16x32_bf16 v[24:27], v[80:83], v[192:195], v[24:27]
    v_mfma_f32_16x16x32_bf16 v[36:39], v[84:87], v[192:195], v[36:39]
    buffer_load_dwordx4 v1, s[4:7], s94 offen offset:2048 sc1 lds
    v_mfma_f32_16x16x32_bf16 v[16:19], v[196:199], v[88:91], v[16:19]
    ds_read_b128 v[80:83], v6 offset:7680
    v_mfma_f32_16x16x32_bf16 v[28:31], v[196:199], v[92:95], v[28:31]
    ds_read_b128 v[84:87], v6 offset:40448
    v_mfma_f32_16x16x32_bf16 v[32:35], v[200:203], v[92:95], v[32:35]
    v_mfma_f32_16x16x32_bf16 v[20:23], v[200:203], v[88:91], v[20:23]
    v_mfma_f32_16x16x32_bf16 v[24:27], v[88:91], v[204:207], v[24:27]
    v_mfma_f32_16x16x32_bf16 v[36:39], v[92:95], v[204:207], v[36:39]
    s_waitcnt lgkmcnt(2)
    v_mfma_f32_16x16x32_bf16 v[16:19], v[208:211], v[64:67], v[16:19]
    ds_read_b128 v[88:91], v6 offset:7936
    v_mfma_f32_16x16x32_bf16 v[28:31], v[208:211], v[68:71], v[28:31]
    ds_read_b128 v[92:95], v6 offset:40704
    v_mfma_f32_16x16x32_bf16 v[32:35], v[212:215], v[68:71], v[32:35]
    buffer_load_dwordx4 v1, s[4:7], s94 offen offset:3072 sc1 lds
    v_mfma_f32_16x16x32_bf16 v[20:23], v[212:215], v[64:67], v[20:23]
    v_mfma_f32_16x16x32_bf16 v[24:27], v[64:67], v[216:219], v[24:27]
    v_mfma_f32_16x16x32_bf16 v[36:39], v[68:71], v[216:219], v[36:39]
    s_cmp_ge_u32 s40, 268435456
    s_cbranch_scc1 L_PJ_slow0
    v_mfma_f32_16x16x32_bf16 v[16:19], v[220:223], v[72:75], v[16:19]
    v_mfma_f32_16x16x32_bf16 v[28:31], v[220:223], v[76:79], v[28:31]
    s_waitcnt vmcnt(8) lgkmcnt(0)
    s_barrier
    v_mfma_f32_16x16x32_bf16 v[32:35], v[224:227], v[76:79], v[32:35]
    ds_read_b128 v[64:67], v7 offset:0
    v_mfma_f32_16x16x32_bf16 v[20:23], v[224:227], v[72:75], v[20:23]
    ds_read_b128 v[68:71], v7 offset:32768
    v_mfma_f32_16x16x32_bf16 v[24:27], v[72:75], v[228:231], v[24:27]
    v_mfma_f32_16x16x32_bf16 v[36:39], v[76:79], v[228:231], v[36:39]
    v_mfma_f32_16x16x32_bf16 v[16:19], v[232:235], v[80:83], v[16:19]
    ds_read_b128 v[72:75], v7 offset:256
    v_mfma_f32_16x16x32_bf16 v[28:31], v[232:235], v[84:87], v[28:31]
    ds_read_b128 v[76:79], v7 offset:33024
    v_mfma_f32_16x16x32_bf16 v[32:35], v[236:239], v[84:87], v[32:35]
    v_mfma_f32_16x16x32_bf16 v[20:23], v[236:239], v[80:83], v[20:23]
    v_mfma_f32_16x16x32_bf16 v[24:27], v[80:83], v[240:243], v[24:27]
    v_mfma_f32_16x16x32_bf16 v[36:39], v[84:87], v[240:243], v[36:39]
    v_mfma_f32_16x16x32_bf16 v[16:19], v[244:247], v[88:91], v[16:19]
    ds_read_b128 v[80:83], v7 offset:512
    v_mfma_f32_16x16x32_bf16 v[28:31], v[244:247], v[92:95], v[28:31]
    ds_read_b128 v[84:87], v7 offset:33280
    v_mfma_f32_16x16x32_bf16 v[32:35], v[248:251], v[92:95], v[32:35]
    v_mfma_f32_16x16x32_bf16 v[20:23], v[248:251], v[88:91], v[20:23]
    v_mfma_f32_16x16x32_bf16 v[24:27], v[88:91], v[252:255], v[24:27]
    v_mfma_f32_16x16x32_bf16 v[36:39], v[92:95], v[252:255], v[36:39]
L_PJ_top1:
    s_waitcnt lgkmcnt(4)
    v_mfma_f32_16x16x32_bf16 v[40:43], a[0:3], v[64:67], 0
    ds_read_b128 v[88:91], v7 offset:768
    v_mfma_f32_16x16x32_bf16 v[52:55], a[0:3], v[68:71], 0
    ds_read_b128 v[92:95], v7 offset:33536
    v_mfma_f32_16x16x32_bf16 v[56:59], a[4:7], v[68:71], 0
    s_and_b32 s86, s36, 95
    s_mul_i32 s86, s86, 262144
    s_add_u32 s87, s86, s45
    v_mfma_f32_16x16x32_bf16 v[44:47], a[4:7], v[64:67], 0
    s_add_u32 s86, s86, s44
    v_cvt_pk_bf16_f32 v96, v16, v17
    v_cvt_pk_bf16_f32 v97, v18, v19
    v_mfma_f32_16x16x32_bf16 v[48:51], v[64:67], a[8:11], 0
    s_mul_i32 s37, s34, 20480
    v_cvt_pk_bf16_f32 v98, v20, v21
    v_cvt_pk_bf16_f32 v99, v22, v23
    v_mfma_f32_16x16x32_bf16 v[60:63], v[68:71], a[8:11], 0
    s_waitcnt lgkmcnt(4)
    s_add_u32 s37, s37, s43
    s_add_u32 s38, s35, 1
    v_mfma_f32_16x16x32_bf16 v[40:43], a[12:15], v[72:75], v[40:43]
    ds_read_b128 v[64:67], v7 offset:1024
    v_mov_b32 v5, s38
    v_mfma_f32_16x16x32_bf16 v[52:55], a[12:15], v[76:79], v[52:55]
    ds_read_b128 v[68:71], v7 offset:33792
    s_mov_b32 s34, s28
    v_mfma_f32_16x16x32_bf16 v[56:59], a[16:19], v[76:79], v[56:59]
    buffer_store_dwordx4 v[96:99], v0, s[4:7], s86 offen offset:0 sc1
    v_cvt_pk_bf16_f32 v100, v28, v29
    v_mfma_f32_16x16x32_bf16 v[44:47], a[16:19], v[72:75], v[44:47]
    s_mov_b32 s35, s29
    v_cvt_pk_bf16_f32 v101, v30, v31
    v_cvt_pk_bf16_f32 v102, v32, v33
    v_mfma_f32_16x16x32_bf16 v[48:51], v[72:75], a[20:23], v[48:51]
    s_mov_b32 s36, s30
    v_cvt_pk_bf16_f32 v103, v34, v35
    s_add_u32 s59, s59, 1
    v_mfma_f32_16x16x32_bf16 v[60:63], v[76:79], a[20:23], v[60:63]
    s_waitcnt lgkmcnt(2)
    s_cmp_lt_u32 s20, 64
    s_cselect_b64 s[88:89], s[24:25], s[26:27]
    v_mfma_f32_16x16x32_bf16 v[40:43], a[24:27], v[80:83], v[40:43]
    ds_read_b128 v[72:75], v7 offset:1280
    v_mfma_f32_16x16x32_bf16 v[52:55], a[24:27], v[84:87], v[52:55]
    ds_read_b128 v[76:79], v7 offset:34048
    v_mfma_f32_16x16x32_bf16 v[56:59], a[28:31], v[84:87], v[56:59]
    buffer_store_dwordx4 v[100:103], v0, s[4:7], s86 offen offset:1024 sc1
    v_cvt_pk_bf16_f32 v104, v24, v25
    v_mfma_f32_16x16x32_bf16 v[44:47], a[28:31], v[80:83], v[44:47]
    s_bitcmp1_b64 s[88:89], s20
    s_cselect_b32 s28, 1, 0
    s_cselect_b32 s29, s22, s21
    v_mfma_f32_16x16x32_bf16 v[48:51], v[80:83], a[32:35], v[48:51]
    s_add_u32 s22, s22, s28
    v_cvt_pk_bf16_f32 v105, v26, v27
    v_cvt_pk_bf16_f32 v106, v36, v37
    v_mfma_f32_16x16x32_bf16 v[60:63], v[84:87], a[32:35], v[60:63]
    s_xor_b32 s88, s28, 1
    v_cvt_pk_bf16_f32 v107, v38, v39
    s_add_u32 s21, s21, s88
    v_mfma_f32_16x16x32_bf16 v[40:43], a[36:39], v[88:91], v[40:43]
    ds_read_b128 v[80:83], v7 offset:1536
    s_lshl_b32 s30, s28, 6
    v_mfma_f32_16x16x32_bf16 v[52:55], a[36:39], v[92:95], v[52:55]
    ds_read_b128 v[84:87], v7 offset:34304
    s_add_u32 s30, s30, s29
    v_mfma_f32_16x16x32_bf16 v[56:59], a[40:43], v[92:95], v[56:59]
    buffer_store_dwordx4 v[104:107], v0, s[4:7], s87 offen sc1
    s_mul_i32 s88, s28, 8388608
    v_mfma_f32_16x16x32_bf16 v[44:47], a[40:43], v[88:91], v[44:47]
    s_mul_i32 s89, s29, 65536
    s_add_u32 s31, s88, s89
    s_add_u32 s31, s31, s42
    v_mfma_f32_16x16x32_bf16 v[48:51], v[88:91], a[44:47], v[48:51]
    s_lshl2_add_u32 s33, s30, s60
    v_mfma_f32_16x16x32_bf16 v[60:63], v[92:95], a[44:47], v[60:63]
    s_waitcnt lgkmcnt(2)
    v_mfma_f32_16x16x32_bf16 v[40:43], a[48:51], v[64:67], v[40:43]
    ds_read_b128 v[88:91], v7 offset:1792
    v_mfma_f32_16x16x32_bf16 v[52:55], a[48:51], v[68:71], v[52:55]
    ds_read_b128 v[92:95], v7 offset:34560
    v_mfma_f32_16x16x32_bf16 v[56:59], a[52:55], v[68:71], v[56:59]
    s_cmp_lt_u32 s20, 128
    s_cselect_b32 s31, s31, 268435456
    s_cselect_b32 s32, s61, 0
    v_mfma_f32_16x16x32_bf16 v[44:47], a[52:55], v[64:67], v[44:47]
    s_add_u32 s20, s20, 1
    s_mul_i32 s32, s32, s28
    s_andn2_b32 s23, s28, s34
    v_mfma_f32_16x16x32_bf16 v[48:51], v[64:67], a[56:59], v[48:51]
    v_mfma_f32_16x16x32_bf16 v[60:63], v[68:71], a[56:59], v[60:63]
    v_mfma_f32_16x16x32_bf16 v[40:43], a[60:63], v[72:75], v[40:43]
    ds_read_b128 v[64:67], v7 offset:2048
    v_mfma_f32_16x16x32_bf16 v[52:55], a[60:63], v[76:79], v[52:55]
    ds_read_b128 v[68:71], v7 offset:34816
    v_mfma_f32_16x16x32_bf16 v[56:59], a[64:67], v[76:79], v[56:59]
    v_mfma_f32_16x16x32_bf16 v[44:47], a[64:67], v[72:75], v[44:47]
    v_mfma_f32_16x16x32_bf16 v[48:51], v[72:75], a[68:71], v[48:51]
    v_mfma_f32_16x16x32_bf16 v[60:63], v[76:79], a[68:71], v[60:63]
    s_waitcnt lgkmcnt(2)
    v_mfma_f32_16x16x32_bf16 v[40:43], a[72:75], v[80:83], v[40:43]
    ds_read_b128 v[72:75], v7 offset:2304
    v_mfma_f32_16x16x32_bf16 v[52:55], a[72:75], v[84:87], v[52:55]
    ds_read_b128 v[76:79], v7 offset:35072
    v_mfma_f32_16x16x32_bf16 v[56:59], a[76:79], v[84:87], v[56:59]
    v_mfma_f32_16x16x32_bf16 v[44:47], a[76:79], v[80:83], v[44:47]
    v_mfma_f32_16x16x32_bf16 v[48:51], v[80:83], a[80:83], v[48:51]
    v_mfma_f32_16x16x32_bf16 v[60:63], v[84:87], a[80:83], v[60:63]
    v_mfma_f32_16x16x32_bf16 v[40:43], a[84:87], v[88:91], v[40:43]
    ds_read_b128 v[80:83], v7 offset:2560
    v_mfma_f32_16x16x32_bf16 v[52:55], a[84:87], v[92:95], v[52:55]
    ds_read_b128 v[84:87], v7 offset:35328
    v_mfma_f32_16x16x32_bf16 v[56:59], a[88:91], v[92:95], v[56:59]
    v_mfma_f32_16x16x32_bf16 v[44:47], a[88:91], v[88:91], v[44:47]
    v_mfma_f32_16x16x32_bf16 v[48:51], v[88:91], a[92:95], v[48:51]
    v_mfma_f32_16x16x32_bf16 v[60:63], v[92:95], a[92:95], v[60:63]
    s_waitcnt lgkmcnt(4)
    s_buffer_load_dword s62, s[4:7], s33 glc
    v_mfma_f32_16x16x32_bf16 v[40:43], a[96:99], v[64:67], v[40:43]
    ds_read_b128 v[88:91], v7 offset:2816
    v_mfma_f32_16x16x32_bf16 v[52:55], a[96:99], v[68:71], v[52:55]
    ds_read_b128 v[92:95], v7 offset:35584
    v_mfma_f32_16x16x32_bf16 v[56:59], a[100:103], v[68:71], v[56:59]
    v_mfma_f32_16x16x32_bf16 v[44:47], a[100:103], v[64:67], v[44:47]
    v_mfma_f32_16x16x32_bf16 v[48:51], v[64:67], a[104:107], v[48:51]
    v_mfma_f32_16x16x32_bf16 v[60:63], v[68:71], a[104:107], v[60:63]
    s_waitcnt lgkmcnt(4)
    v_mfma_f32_16x16x32_bf16 v[40:43], a[108:111], v[72:75], v[40:43]
    ds_read_b128 v[64:67], v7 offset:3072
    v_mfma_f32_16x16x32_bf16 v[52:55], a[108:111], v[76:79], v[52:55]
    ds_read_b128 v[68:71], v7 offset:35840
    v_mfma_f32_16x16x32_bf16 v[56:59], a[112:115], v[76:79], v[56:59]
    v_mfma_f32_16x16x32_bf16 v[44:47], a[112:115], v[72:75], v[44:47]
    v_mfma_f32_16x16x32_bf16 v[48:51], v[72:75], a[116:119], v[48:51]
    v_mfma_f32_16x16x32_bf16 v[60:63], v[76:79], a[116:119], v[60:63]
    s_waitcnt lgkmcnt(4)
    v_mfma_f32_16x16x32_bf16 v[40:43], a[120:123], v[80:83], v[40:43]
    ds_read_b128 v[72:75], v7 offset:3328
    v_mfma_f32_16x16x32_bf16 v[52:55], a[120:123], v[84:87], v[52:55]
    ds_read_b128 v[76:79], v7 offset:36096
    v_mfma_f32_16x16x32_bf16 v[56:59], a[124:127], v[84:87], v[56:59]
    v_mfma_f32_16x16x32_bf16 v[44:47], a[124:127], v[80:83], v[44:47]
    v_mfma_f32_16x16x32_bf16 v[48:51], v[80:83], a[128:131], v[48:51]
    v_mfma_f32_16x16x32_bf16 v[60:63], v[84:87], a[128:131], v[60:63]
    s_waitcnt lgkmcnt(4)
    v_mfma_f32_16x16x32_bf16 v[40:43], a[132:135], v[88:91], v[40:43]
    ds_read_b128 v[80:83], v7 offset:3584
    v_mfma_f32_16x16x32_bf16 v[52:55], a[132:135], v[92:95], v[52:55]
    ds_read_b128 v[84:87], v7 offset:36352
    v_mfma_f32_16x16x32_bf16 v[56:59], a[136:139], v[92:95], v[56:59]
    v_mfma_f32_16x16x32_bf16 v[44:47], a[136:139], v[88:91], v[44:47]
    v_mfma_f32_16x16x32_bf16 v[48:51], v[88:91], a[140:143], v[48:51]
    v_mfma_f32_16x16x32_bf16 v[60:63], v[92:95], a[140:143], v[60:63]
    s_waitcnt lgkmcnt(4)
    v_mfma_f32_16x16x32_bf16 v[40:43], a[144:147], v[64:67], v[40:43]
    ds_read_b128 v[88:91], v7 offset:3840
    v_mfma_f32_16x16x32_bf16 v[52:55], a[144:147], v[68:71], v[52:55]
    ds_read_b128 v[92:95], v7 offset:36608
    v_mfma_f32_16x16x32_bf16 v[56:59], a[148:151], v[68:71], v[56:59]
    v_mfma_f32_16x16x32_bf16 v[44:47], a[148:151], v[64:67], v[44:47]
    v_mfma_f32_16x16x32_bf16 v[48:51], v[64:67], a[152:155], v[48:51]
    v_mfma_f32_16x16x32_bf16 v[60:63], v[68:71], a[152:155], v[60:63]
    s_waitcnt vmcnt(0)
L_PJ_mid1:
    s_barrier
    s_waitcnt lgkmcnt(4)
    v_mfma_f32_16x16x32_bf16 v[40:43], a[156:159], v[72:75], v[40:43]
    s_max_u32 s37, s37, s58
    s_mov_b32 s58, 0
    v_mfma_f32_16x16x32_bf16 v[52:55], a[156:159], v[76:79], v[52:55]
    buffer_store_dword v5, v3, s[4:7], s37 offen sc1
    v_mfma_f32_16x16x32_bf16 v[56:59], a[160:163], v[76:79], v[56:59]
    v_mfma_f32_16x16x32_bf16 v[44:47], a[160:163], v[72:75], v[44:47]
    v_mfma_f32_16x16x32_bf16 v[48:51], v[72:75], a[164:167], v[48:51]
    v_mfma_f32_16x16x32_bf16 v[60:63], v[76:79], a[164:167], v[60:63]
    s_waitcnt lgkmcnt(0)
    s_cmp_ge_u32 s62, s32
    s_cbranch_scc0 L_PJ_nr1
L_PJ_rd1:
    s_mov_b32 s40, s31
L_PJ_go1:
    v_mfma_f32_16x16x32_bf16 v[40:43], a[168:171], v[80:83], v[40:43]
    ds_read_b128 v[64:67], v7 offset:4096
    s_add_u32 s94, s40, 0
    v_mfma_f32_16x16x32_bf16 v[52:55], a[168:171], v[84:87], v[52:55]
    ds_read_b128 v[68:71], v7 offset:36864
    s_add_u32 m0, s46, 0
    v_mfma_f32_16x16x32_bf16 v[56:59], a[172:175], v[84:87], v[56:59]
    buffer_load_dwordx4 v1, s[4:7], s94 offen offset:0 sc1 lds
    v_mfma_f32_16x16x32_bf16 v[44:47], a[172:175], v[80:83], v[44:47]
    ds_read_b128 v[72:75], v7 offset:4352
    v_mfma_f32_16x16x32_bf16 v[48:51], v[80:83], a[176:179], v[48:51]
    buffer_load_dwordx4 v1, s[4:7], s94 offen offset:1024 sc1 lds
    v_mfma_f32_16x16x32_bf16 v[60:63], v[84:87], a[176:179], v[60:63]
    v_mfma_f32_16x16x32_bf16 v[40:43], a[180:183], v[88:91], v[40:43]
    ds_read_b128 v[76:79], v7 offset:37120
    v_mfma_f32_16x16x32_bf16 v[52:55], a[180:183], v[92:95], v[52:55]
    ds_read_b128 v[80:83], v7 offset:4608
    v_mfma_f32_16x16x32_bf16 v[56:59], a[184:187], v[92:95], v[56:59]
    v_mfma_f32_16x16x32_bf16 v[44:47], a[184:187], v[88:91], v[44:47]
    ds_read_b128 v[84:87], v7 offset:37376
    v_mfma_f32_16x16x32_bf16 v[48:51], v[88:91], a[188:191], v[48:51]
    buffer_load_dwordx4 v1, s[4:7], s94 offen offset:2048 sc1 lds
    v_mfma_f32_16x16x32_bf16 v[60:63], v[92:95], a[188:191], v[60:63]
    s_waitcnt lgkmcnt(4)
    v_mfma_f32_16x16x32_bf16 v[40:43], a[192:195], v[64:67], v[40:43]
    ds_read_b128 v[88:91], v7 offset:4864
    v_mfma_f32_16x16x32_bf16 v[52:55], a[192:195], v[68:71], v[52:55]
    ds_read_b128 v[92:95], v7 offset:37632
    v_mfma_f32_16x16x32_bf16 v[56:59], a[196:199], v[68:71], v[56:59]
    v_mfma_f32_16x16x32_bf16 v[44:47], a[196:199], v[64:67], v[44:47]
    buffer_load_dwordx4 v1, s[4:7], s94 offen offset:3072 sc1 lds
    v_mfma_f32_16x16x32_bf16 v[48:51], v[64:67], a[200:203], v[48:51]
    v_mfma_f32_16x16x32_bf16 v[60:63], v[68:71], a[200:203], v[60:63]
    s_waitcnt lgkmcnt(4)
    v_mfma_f32_16x16x32_bf16 v[40:43], a[204:207], v[72:75], v[40:43]
    ds_read_b128 v[64:67], v7 offset:5120
    v_mfma_f32_16x16x32_bf16 v[52:55], a[204:207], v[76:79], v[52:55]
    ds_read_b128 v[68:71], v7 offset:37888
    v_mfma_f32_16x16x32_bf16 v[56:59], a[208:211], v[76:79], v[56:59]
    v_mfma_f32_16x16x32_bf16 v[44:47], a[208:211], v[72:75], v[44:47]
    s_add_u32 s94, s40, 32768
    s_add_u32 m0, s46, 32768
    v_mfma_f32_16x16x32_bf16 v[48:51], v[72:75], a[212:215], v[48:51]
    buffer_load_dwordx4 v1, s[4:7], s94 offen offset:0 sc1 lds
    v_mfma_f32_16x16x32_bf16 v[60:63], v[76:79], a[212:215], v[60:63]
    s_waitcnt lgkmcnt(2)
    v_mfma_f32_16x16x32_bf16 v[40:43], a[216:219], v[80:83], v[40:43]
    ds_read_b128 v[72:75], v7 offset:5376
    v_mfma_f32_16x16x32_bf16 v[52:55], a[216:219], v[84:87], v[52:55]
    ds_read_b128 v[76:79], v7 offset:38144
    v_mfma_f32_16x16x32_bf16 v[56:59], a[220:223], v[84:87], v[56:59]
    v_mfma_f32_16x16x32_bf16 v[44:47], a[220:223], v[80:83], v[44:47]
    buffer_load_dwordx4 v1, s[4:7], s94 offen offset:1024 sc1 lds
    v_mfma_f32_16x16x32_bf16 v[48:51], v[80:83], a[224:227], v[48:51]
    v_mfma_f32_16x16x32_bf16 v[60:63], v[84:87], a[224:227], v[60:63]
    v_mfma_f32_16x16x32_bf16 v[40:43], a[228:231], v[88:91], v[40:43]
    ds_read_b128 v[80:83], v7 offset:5632
    v_mfma_f32_16x16x32_bf16 v[52:55], a[228:231], v[92:95], v[52:55]
    ds_read_b128 v[84:87], v7 offset:38400
    v_mfma_f32_16x16x32_bf16 v[56:59], a[232:235], v[92:95], v[56:59]
    buffer_load_dwordx4 v1, s[4:7], s94 offen offset:2048 sc1 lds
    v_mfma_f32_16x16x32_bf16 v[44:47], a[232:235], v[88:91], v[44:47]
    v_mfma_f32_16x16x32_bf16 v[48:51], v[88:91], a[236:239], v[48:51]
    v_mfma_f32_16x16x32_bf16 v[60:63], v[92:95], a[236:239], v[60:63]
    s_waitcnt lgkmcnt(2)
    v_mfma_f32_16x16x32_bf16 v[40:43], a[240:243], v[64:67], v[40:43]
    ds_read_b128 v[88:91], v7 offset:5888
    v_mfma_f32_16x16x32_bf16 v[52:55], a[240:243], v[68:71], v[52:55]
    ds_read_b128 v[92:95], v7 offset:38656
    v_mfma_f32_16x16x32_bf16 v[56:59], a[244:247], v[68:71], v[56:59]
    buffer_load_dwordx4 v1, s[4:7], s94 offen offset:3072 sc1 lds
    v_mfma_f32_16x16x32_bf16 v[44:47], a[244:247], v[64:67], v[44:47]
    v_mfma_f32_16x16x32_bf16 v[48:51], v[64:67], a[248:251], v[48:51]
    v_mfma_f32_16x16x32_bf16 v[60:63], v[68:71], a[248:251], v[60:63]
    v_mfma_f32_16x16x32_bf16 v[40:43], a[252:255], v[72:75], v[40:43]
    ds_read_b128 v[64:67], v7 offset:6144
    v_mfma_f32_16x16x32_bf16 v[52:55], a[252:255], v[76:79], v[52:55]
    ds_read_b128 v[68:71], v7 offset:38912
    v_mfma_f32_16x16x32_bf16 v[56:59], v[128:131], v[76:79], v[56:59]
    s_add_u32 s94, s40, 4096
    s_add_u32 m0, s46, 4096
    v_mfma_f32_16x16x32_bf16 v[44:47], v[128:131], v[72:75], v[44:47]
    buffer_load_dwordx4 v1, s[4:7], s94 offen offset:0 sc1 lds
    v_mfma_f32_16x16x32_bf16 v[48:51], v[72:75], v[132:135], v[48:51]
    v_mfma_f32_16x16x32_bf16 v[60:63], v[76:79], v[132:135], v[60:63]
    s_waitcnt lgkmcnt(2)
    v_mfma_f32_16x16x32_bf16 v[40:43], v[136:139], v[80:83], v[40:43]
    ds_read_b128 v[72:75], v7 offset:6400
    v_mfma_f32_16x16x32_bf16 v[52:55], v[136:139], v[84:87], v[52:55]
    ds_read_b128 v[76:79], v7 offset:39168
    v_mfma_f32_16x16x32_bf16 v[56:59], v[140:143], v[84:87], v[56:59]
    buffer_load_dwordx4 v1, s[4:7], s94 offen offset:1024 sc1 lds
    v_mfma_f32_16x16x32_bf16 v[44:47], v[140:143], v[80:83], v[44:47]
    v_mfma_f32_16x16x32_bf16 v[48:51], v[80:83], v[144:147], v[48:51]
    v_mfma_f32_16x16x32_bf16 v[60:63], v[84:87], v[144:147], v[60:63]
    v_mfma_f32_16x16x32_bf16 v[40:43], v[148:151], v[88:91], v[40:43]
    ds_read_b128 v[80:83], v7 offset:6656
    v_mfma_f32_16x16x32_bf16 v[52:55], v[148:151], v[92:95], v[52:55]
    ds_read_b128 v[84:87], v7 offset:39424
    v_mfma_f32_16x16x32_bf16 v[56:59], v[152:155], v[92:95], v[56:59]
    buffer_load_dwordx4 v1, s[4:7], s94 offen offset:2048 sc1 lds
    v_mfma_f32_16x16x32_bf16 v[44:47], v[152:155], v[88:91], v[44:47]
    v_mfma_f32_16x16x32_bf16 v[48:51], v[88:91], v[156:159], v[48:51]
    v_mfma_f32_16x16x32_bf16 v[60:63], v[92:95], v[156:159], v[60:63]
    s_waitcnt lgkmcnt(2)
    v_mfma_f32_16x16x32_bf16 v[40:43], v[160:163], v[64:67], v[40:43]
    ds_read_b128 v[88:91], v7 offset:6912
    v_mfma_f32_16x16x32_bf16 v[52:55], v[160:163], v[68:71], v[52:55]
    ds_read_b128 v[92:95], v7 offset:39680
    v_mfma_f32_16x16x32_bf16 v[56:59], v[164:167], v[68:71], v[56:59]
    buffer_load_dwordx4 v1, s[4:7], s94 offen offset:3072 sc1 lds
    v_mfma_f32_16x16x32_bf16 v[44:47], v[164:167], v[64:67], v[44:47]
    v_mfma_f32_16x16x32_bf16 v[48:51], v[64:67], v[168:171], v[48:51]
    v_mfma_f32_16x16x32_bf16 v[60:63], v[68:71], v[168:171], v[60:63]
    v_mfma_f32_16x16x32_bf16 v[40:43], v[172:175], v[72:75], v[40:43]
    ds_read_b128 v[64:67], v7 offset:7168
    s_add_u32 s94, s40, 36864
    v_mfma_f32_16x16x32_bf16 v[52:55], v[172:175], v[76:79], v[52:55]
    ds_read_b128 v[68:71], v7 offset:39936
    s_add_u32 m0, s46, 36864
    v_mfma_f32_16x16x32_bf16 v[56:59], v[176:179], v[76:79], v[56:59]
    buffer_load_dwordx4 v1, s[4:7], s94 offen offset:0 sc1 lds
    v_mfma_f32_16x16x32_bf16 v[44:47], v[176:179], v[72:75], v[44:47]
    v_mfma_f32_16x16x32_bf16 v[48:51], v[72:75], v[180:183], v[48:51]
    v_mfma_f32_16x16x32_bf16 v[60:63], v[76:79], v[180:183], v[60:63]
    s_waitcnt lgkmcnt(2)
    v_mfma_f32_16x16x32_bf16 v[40:43], v[184:187], v[80:83], v[40:43]
    ds_read_b128 v[72:75], v7 offset:7424
    v_mfma_f32_16x16x32_bf16 v[52:55], v[184:187], v[84:87], v[52:55]
    ds_read_b128 v[76:79], v7 offset:40192
    v_mfma_f32_16x16x32_bf16 v[56:59], v[188:191], v[84:87], v[56:59]
    buffer_load_dwordx4 v1, s[4:7], s94 offen offset:1024 sc1 lds
    v_mfma_f32_16x16x32_bf16 v[44:47], v[188:191], v[80:83], v[44:47]
    v_mfma_f32_16x16x32_bf16 v[48:51], v[80:83], v[192:195], v[48:51]
    v_mfma_f32_16x16x32_bf16 v[60:63], v[84:87], v[192:195], v[60:63]
    buffer_load_dwordx4 v1, s[4:7], s94 offen offset:2048 sc1 lds
    v_mfma_f32_16x16x32_bf16 v[40:43], v[196:199], v[88:91], v[40:43]
    ds_read_b128 v[80:83], v7 offset:7680
    v_mfma_f32_16x16x32_bf16 v[52:55], v[196:199], v[92:95], v[52:55]
    ds_read_b128 v[84:87], v7 offset:40448
    v_mfma_f32_16x16x32_bf16 v[56:59], v[200:203], v[92:95], v[56:59]
    v_mfma_f32_16x16x32_bf16 v[44:47], v[200:203], v[88:91], v[44:47]
    v_mfma_f32_16x16x32_bf16 v[48:51], v[88:91], v[204:207], v[48:51]
    v_mfma_f32_16x16x32_bf16 v[60:63], v[92:95], v[204:207], v[60:63]
    s_waitcnt lgkmcnt(2)
    v_mfma_f32_16x16x32_bf16 v[40:43], v[208:211], v[64:67], v[40:43]
    ds_read_b128 v[88:91], v7 offset:7936
    v_mfma_f32_16x16x32_bf16 v[52:55], v[208:211], v[68:71], v[52:55]
    ds_read_b128 v[92:95], v7 offset:40704
    v_mfma_f32_16x16x32_bf16 v[56:59], v[212:215], v[68:71], v[56:59]
    buffer_load_dwordx4 v1, s[4:7], s94 offen offset:3072 sc1 lds
    v_mfma_f32_16x16x32_bf16 v[44:47], v[212:215], v[64:67], v[44:47]
    v_mfma_f32_16x16x32_bf16 v[48:51], v[64:67], v[216:219], v[48:51]
    v_mfma_f32_16x16x32_bf16 v[60:63], v[68:71], v[216:219], v[60:63]
    s_cmp_ge_u32 s40, 268435456
    s_cbranch_scc1 L_PJ_slow1
    v_mfma_f32_16x16x32_bf16 v[40:43], v[220:223], v[72:75], v[40:43]
    v_mfma_f32_16x16x32_bf16 v[52:55], v[220:223], v[76:79], v[52:55]
    s_waitcnt vmcnt(8) lgkmcnt(0)
    s_barrier
    v_mfma_f32_16x16x32_bf16 v[56:59], v[224:227], v[76:79], v[56:59]
    ds_read_b128 v[64:67], v6 offset:0
    v_mfma_f32_16x16x32_bf16 v[44:47], v[224:227], v[72:75], v[44:47]
    ds_read_b128 v[68:71], v6 offset:32768
    v_mfma_f32_16x16x32_bf16 v[48:51], v[72:75], v[228:231], v[48:51]
    v_mfma_f32_16x16x32_bf16 v[60:63], v[76:79], v[228:231], v[60:63]
    v_mfma_f32_16x16x32_bf16 v[40:43], v[232:235], v[80:83], v[40:43]
    ds_read_b128 v[72:75], v6 offset:256
    v_mfma_f32_16x16x32_bf16 v[52:55], v[232:235], v[84:87], v[52:55]
    ds_read_b128 v[76:79], v6 offset:33024
    v_mfma_f32_16x16x32_bf16 v[56:59], v[236:239], v[84:87], v[56:59]
    v_mfma_f32_16x16x32_bf16 v[44:47], v[236:239], v[80:83], v[44:47]
    v_mfma_f32_16x16x32_bf16 v[48:51], v[80:83], v[240:243], v[48:51]
    v_mfma_f32_16x16x32_bf16 v[60:63], v[84:87], v[240:243], v[60:63]
    v_mfma_f32_16x16x32_bf16 v[40:43], v[244:247], v[88:91], v[40:43]
    ds_read_b128 v[80:83], v6 offset:512
    v_mfma_f32_16x16x32_bf16 v[52:55], v[244:247], v[92:95], v[52:55]
    ds_read_b128 v[84:87], v6 offset:33280
    v_mfma_f32_16x16x32_bf16 v[56:59], v[248:251], v[92:95], v[56:59]
    v_mfma_f32_16x16x32_bf16 v[44:47], v[248:251], v[88:91], v[44:47]
    v_mfma_f32_16x16x32_bf16 v[48:51], v[88:91], v[252:255], v[48:51]
    v_mfma_f32_16x16x32_bf16 v[60:63], v[92:95], v[252:255], v[60:63]
    s_branch L_PJ_top0
L_PJ_nr0:
    s_mov_b32 s40, 268435456
    s_cmp_eq_u32 s23, 0
    s_cbranch_scc1 L_PJ_go0
    s_mov_b32 s3, 0
L_PJ_hl0:
    s_buffer_load_dword s62, s[4:7], s33 glc
    s_waitcnt lgkmcnt(0)
    s_cmp_ge_u32 s62, s32
    s_cbranch_scc1 L_PJ_hd0
    s_add_u32 s3, s3, 1
    s_cmp_lt_u32 s3, 40000
    s_cbranch_scc1 L_PJ_hl0
    s_mov_b32 s3, 31
    s_branch L_abort
L_PJ_hd0:
    s_branch L_PJ_rd0
L_PJ_slow0:
    v_mfma_f32_16x16x32_bf16 v[16:19], v[220:223], v[72:75], v[16:19]
    v_mfma_f32_16x16x32_bf16 v[28:31], v[220:223], v[76:79], v[28:31]
    v_mfma_f32_16x16x32_bf16 v[32:35], v[224:227], v[76:79], v[32:35]
    v_mfma_f32_16x16x32_bf16 v[20:23], v[224:227], v[72:75], v[20:23]
    v_mfma_f32_16x16x32_bf16 v[24:27], v[72:75], v[228:231], v[24:27]
    v_mfma_f32_16x16x32_bf16 v[36:39], v[76:79], v[228:231], v[36:39]
    s_waitcnt lgkmcnt(3)
    v_mfma_f32_16x16x32_bf16 v[16:19], v[232:235], v[80:83], v[16:19]
    s_waitcnt lgkmcnt(2)
    v_mfma_f32_16x16x32_bf16 v[28:31], v[232:235], v[84:87], v[28:31]
    v_mfma_f32_16x16x32_bf16 v[32:35], v[236:239], v[84:87], v[32:35]
    v_mfma_f32_16x16x32_bf16 v[20:23], v[236:239], v[80:83], v[20:23]
    v_mfma_f32_16x16x32_bf16 v[24:27], v[80:83], v[240:243], v[24:27]
    v_mfma_f32_16x16x32_bf16 v[36:39], v[84:87], v[240:243], v[36:39]
    s_waitcnt lgkmcnt(1)
    v_mfma_f32_16x16x32_bf16 v[16:19], v[244:247], v[88:91], v[16:19]
    s_waitcnt lgkmcnt(0)
    v_mfma_f32_16x16x32_bf16 v[28:31], v[244:247], v[92:95], v[28:31]
    v_mfma_f32_16x16x32_bf16 v[32:35], v[248:251], v[92:95], v[32:35]
    v_mfma_f32_16x16x32_bf16 v[20:23], v[248:251], v[88:91], v[20:23]
    v_mfma_f32_16x16x32_bf16 v[24:27], v[88:91], v[252:255], v[24:27]
    v_mfma_f32_16x16x32_bf16 v[36:39], v[92:95], v[252:255], v[36:39]
    s_and_b32 s86, s36, 95
    s_mul_i32 s86, s86, 262144
    s_add_u32 s87, s86, s45
    s_add_u32 s86, s86, s44
    s_mul_i32 s37, s34, 20480
    s_add_u32 s37, s37, s43
    s_add_u32 s38, s35, 1
    v_cvt_pk_bf16_f32 v96, v16, v17
    v_cvt_pk_bf16_f32 v97, v18, v19
    v_cvt_pk_bf16_f32 v98, v20, v21
    v_cvt_pk_bf16_f32 v99, v22, v23
    buffer_store_dwordx4 v[96:99], v0, s[4:7], s86 offen offset:0 sc1
    v_cvt_pk_bf16_f32 v100, v28, v29
    v_cvt_pk_bf16_f32 v101, v30, v31
    v_cvt_pk_bf16_f32 v102, v32, v33
    v_cvt_pk_bf16_f32 v103, v34, v35
    buffer_store_dwordx4 v[100:103], v0, s[4:7], s86 offen offset:1024 sc1
    v_cvt_pk_bf16_f32 v104, v24, v25
    v_cvt_pk_bf16_f32 v105, v26, v27
    v_cvt_pk_bf16_f32 v106, v36, v37
    v_cvt_pk_bf16_f32 v107, v38, v39
    buffer_store_dwordx4 v[104:107], v0, s[4:7], s87 offen sc1
    s_buffer_load_dword s62, s[4:7], s33 glc
    s_waitcnt vmcnt(0)
    s_add_u32 s92, s59, 1
    v_mov_b32 v12, s92
    s_and_b32 s95, s92, s57
    ds_write_b32 v11, v12
    s_cmp_lg_u32 s58, 0
    s_cbranch_scc1 L_pd_8
    ds_read_b128 v[116:119], v9
    s_waitcnt lgkmcnt(0)
    v_min3_u32 v116, v116, v117, v118
    v_min_u32 v116, v116, v119
    v_cmp_gt_u32 vcc, s95, v116
    s_cbranch_vccnz L_pd_8
    v_mov_b32 v5, s38
    buffer_store_dword v5, v3, s[4:7], s37 offen sc1
    s_mov_b32 s58, 268435456
L_pd_8:
    s_cmp_lg_u32 s58, 0
    s_cbranch_scc1 L_pd_9
    ds_read_b128 v[116:119], v9
    s_waitcnt lgkmcnt(0)
    v_min3_u32 v116, v116, v117, v118
    v_min_u32 v116, v116, v119
    v_cmp_gt_u32 vcc, s95, v116
    s_cbranch_vccnz L_pd_9
    v_mov_b32 v5, s38
    buffer_store_dword v5, v3, s[4:7], s37 offen sc1
    s_mov_b32 s58, 268435456
L_pd_9:
    s_cmp_gt_u32 s20, 128
    s_cbranch_scc1 L_PJ_done
    s_waitcnt lgkmcnt(0)
    s_cmp_ge_u32 s62, s32
    s_cbranch_scc1 L_PJ_sd0
L_PJ_ss0:
    s_mov_b32 s3, 0
L_PJ_sl0:
    s_cmp_lg_u32 s58, 0
    s_cbranch_scc1 L_pd_10
    ds_read_b128 v[116:119], v9
    s_waitcnt lgkmcnt(0)
    v_min3_u32 v116, v116, v117, v118
    v_min_u32 v116, v116, v119
    v_cmp_gt_u32 vcc, s95, v116
    s_cbranch_vccnz L_pd_10
    v_mov_b32 v5, s38
    buffer_store_dword v5, v3, s[4:7], s37 offen sc1
    s_mov_b32 s58, 268435456
L_pd_10:
    s_buffer_load_dword s62, s[4:7], s33 glc
    s_waitcnt lgkmcnt(0)
    s_cmp_ge_u32 s62, s32
    s_cbranch_scc1 L_PJ_sd0
    s_add_u32 s3, s3, 1
    s_cmp_lt_u32 s3, 40000
    s_cbranch_scc1 L_PJ_sl0
    s_mov_b32 s3, 11
    s_branch L_abort
L_PJ_sd0:
    s_mov_b32 s40, s31
    s_add_u32 s94, s40, 0
    s_add_u32 m0, s47, 65536
    s_nop 0
    buffer_load_dwordx4 v1, s[4:7], s94 offen offset:0 sc1 lds
    buffer_load_dwordx4 v1, s[4:7], s94 offen offset:1024 sc1 lds
    buffer_load_dwordx4 v1, s[4:7], s94 offen offset:2048 sc1 lds
    buffer_load_dwordx4 v1, s[4:7], s94 offen offset:3072 sc1 lds
    s_add_u32 s94, s40, 32768
    s_add_u32 m0, s47, 98304
    s_nop 0
    buffer_load_dwordx4 v1, s[4:7], s94 offen offset:0 sc1 lds
    buffer_load_dwordx4 v1, s[4:7], s94 offen offset:1024 sc1 lds
    buffer_load_dwordx4 v1, s[4:7], s94 offen offset:2048 sc1 lds
    buffer_load_dwordx4 v1, s[4:7], s94 offen offset:3072 sc1 lds
    s_add_u32 s94, s40, 4096
    s_add_u32 m0, s47, 69632
    s_nop 0
    buffer_load_dwordx4 v1, s[4:7], s94 offen offset:0 sc1 lds
    buffer_load_dwordx4 v1, s[4:7], s94 offen offset:1024 sc1 lds
    buffer_load_dwordx4 v1, s[4:7], s94 offen offset:2048 sc1 lds
    buffer_load_dwordx4 v1, s[4:7], s94 offen offset:3072 sc1 lds
    s_waitcnt vmcnt(4)
    s_barrier
    ds_read_b128 v[64:67], v7 offset:0
    ds_read_b128 v[68:71], v7 offset:32768
    ds_read_b128 v[72:75], v7 offset:256
    ds_read_b128 v[76:79], v7 offset:33024
    ds_read_b128 v[80:83], v7 offset:512
    ds_read_b128 v[84:87], v7 offset:33280
    s_waitcnt lgkmcnt(4)
    v_mfma_f32_16x16x32_bf16 v[40:43], a[0:3], v[64:67], 0
    ds_read_b128 v[88:91], v7 offset:768
    s_add_u32 s94, s40, 36864
    v_mfma_f32_16x16x32_bf16 v[52:55], a[0:3], v[68:71], 0
    ds_read_b128 v[92:95], v7 offset:33536
    s_add_u32 m0, s47, 102400
    v_mfma_f32_16x16x32_bf16 v[56:59], a[4:7], v[68:71], 0
    buffer_load_dwordx4 v1, s[4:7], s94 offen offset:0 sc1 lds
    s_mul_i32 s37, s34, 20480
    v_mfma_f32_16x16x32_bf16 v[44:47], a[4:7], v[64:67], 0
    s_add_u32 s37, s37, s43
    s_add_u32 s38, s35, 1
    v_mov_b32 v5, s38
    v_mfma_f32_16x16x32_bf16 v[48:51], v[64:67], a[8:11], 0
    buffer_load_dwordx4 v1, s[4:7], s94 offen offset:1024 sc1 lds
    s_mov_b32 s34, s28
    v_mfma_f32_16x16x32_bf16 v[60:63], v[68:71], a[8:11], 0
    s_waitcnt lgkmcnt(4)
    s_mov_b32 s35, s29
    s_mov_b32 s36, s30
    v_mfma_f32_16x16x32_bf16 v[40:43], a[12:15], v[72:75], v[40:43]
    ds_read_b128 v[64:67], v7 offset:1024
    s_add_u32 s59, s59, 1
    v_mfma_f32_16x16x32_bf16 v[52:55], a[12:15], v[76:79], v[52:55]
    ds_read_b128 v[68:71], v7 offset:33792
    v_mfma_f32_16x16x32_bf16 v[56:59], a[16:19], v[76:79], v[56:59]
    buffer_load_dwordx4 v1, s[4:7], s94 offen offset:2048 sc1 lds
    v_mfma_f32_16x16x32_bf16 v[44:47], a[16:19], v[72:75], v[44:47]
    s_cmp_lt_u32 s20, 64
    s_cselect_b64 s[88:89], s[24:25], s[26:27]
    v_mfma_f32_16x16x32_bf16 v[48:51], v[72:75], a[20:23], v[48:51]
    s_bitcmp1_b64 s[88:89], s20
    s_cselect_b32 s28, 1, 0
    s_cselect_b32 s29, s22, s21
    v_mfma_f32_16x16x32_bf16 v[60:63], v[76:79], a[20:23], v[60:63]
    s_waitcnt lgkmcnt(2)
    s_add_u32 s22, s22, s28
    s_xor_b32 s88, s28, 1
    v_mfma_f32_16x16x32_bf16 v[40:43], a[24:27], v[80:83], v[40:43]
    ds_read_b128 v[72:75], v7 offset:1280
    s_add_u32 s21, s21, s88
    v_mfma_f32_16x16x32_bf16 v[52:55], a[24:27], v[84:87], v[52:55]
    ds_read_b128 v[76:79], v7 offset:34048
    s_lshl_b32 s30, s28, 6
    v_mfma_f32_16x16x32_bf16 v[56:59], a[28:31], v[84:87], v[56:59]
    buffer_load_dwordx4 v1, s[4:7], s94 offen offset:3072 sc1 lds
    s_add_u32 s30, s30, s29
    v_mfma_f32_16x16x32_bf16 v[44:47], a[28:31], v[80:83], v[44:47]
    s_mul_i32 s88, s28, 8388608
    s_mul_i32 s89, s29, 65536
    s_add_u32 s31, s88, s89
    v_mfma_f32_16x16x32_bf16 v[48:51], v[80:83], a[32:35], v[48:51]
    s_add_u32 s31, s31, s42
    s_lshl2_add_u32 s33, s30, s60
    v_mfma_f32_16x16x32_bf16 v[60:63], v[84:87], a[32:35], v[60:63]
    s_cmp_lt_u32 s20, 128
    s_cselect_b32 s31, s31, 268435456
    s_cselect_b32 s32, s61, 0
    v_mfma_f32_16x16x32_bf16 v[40:43], a[36:39], v[88:91], v[40:43]
    ds_read_b128 v[80:83], v7 offset:1536
    s_add_u32 s20, s20, 1
    v_mfma_f32_16x16x32_bf16 v[52:55], a[36:39], v[92:95], v[52:55]
    ds_read_b128 v[84:87], v7 offset:34304
    s_mul_i32 s32, s32, s28
    v_mfma_f32_16x16x32_bf16 v[56:59], a[40:43], v[92:95], v[56:59]
    s_andn2_b32 s23, s28, s34
    v_mfma_f32_16x16x32_bf16 v[44:47], a[40:43], v[88:91], v[44:47]
    v_mfma_f32_16x16x32_bf16 v[48:51], v[88:91], a[44:47], v[48:51]
    v_mfma_f32_16x16x32_bf16 v[60:63], v[92:95], a[44:47], v[60:63]
    s_waitcnt lgkmcnt(2)
    v_mfma_f32_16x16x32_bf16 v[40:43], a[48:51], v[64:67], v[40:43]
    ds_read_b128 v[88:91], v7 offset:1792
    v_mfma_f32_16x16x32_bf16 v[52:55], a[48:51], v[68:71], v[52:55]
    ds_read_b128 v[92:95], v7 offset:34560
    v_mfma_f32_16x16x32_bf16 v[56:59], a[52:55], v[68:71], v[56:59]
    v_mfma_f32_16x16x32_bf16 v[44:47], a[52:55], v[64:67], v[44:47]
    v_mfma_f32_16x16x32_bf16 v[48:51], v[64:67], a[56:59], v[48:51]
    v_mfma_f32_16x16x32_bf16 v[60:63], v[68:71], a[56:59], v[60:63]
    v_mfma_f32_16x16x32_bf16 v[40:43], a[60:63], v[72:75], v[40:43]
    ds_read_b128 v[64:67], v7 offset:2048
    v_mfma_f32_16x16x32_bf16 v[52:55], a[60:63], v[76:79], v[52:55]
    ds_read_b128 v[68:71], v7 offset:34816
    v_mfma_f32_16x16x32_bf16 v[56:59], a[64:67], v[76:79], v[56:59]
    v_mfma_f32_16x16x32_bf16 v[44:47], a[64:67], v[72:75], v[44:47]
    v_mfma_f32_16x16x32_bf16 v[48:51], v[72:75], a[68:71], v[48:51]
    v_mfma_f32_16x16x32_bf16 v[60:63], v[76:79], a[68:71], v[60:63]
    s_waitcnt lgkmcnt(2)
    v_mfma_f32_16x16x32_bf16 v[40:43], a[72:75], v[80:83], v[40:43]
    ds_read_b128 v[72:75], v7 offset:2304
    v_mfma_f32_16x16x32_bf16 v[52:55], a[72:75], v[84:87], v[52:55]
    ds_read_b128 v[76:79], v7 offset:35072
    v_mfma_f32_16x16x32_bf16 v[56:59], a[76:79], v[84:87], v[56:59]
    v_mfma_f32_16x16x32_bf16 v[44:47], a[76:79], v[80:83], v[44:47]
    v_mfma_f32_16x16x32_bf16 v[48:51], v[80:83], a[80:83], v[48:51]
    v_mfma_f32_16x16x32_bf16 v[60:63], v[84:87], a[80:83], v[60:63]
    v_mfma_f32_16x16x32_bf16 v[40:43], a[84:87], v[88:91], v[40:43]
    ds_read_b128 v[80:83], v7 offset:2560
    v_mfma_f32_16x16x32_bf16 v[52:55], a[84:87], v[92:95], v[52:55]
    ds_read_b128 v[84:87], v7 offset:35328
    v_mfma_f32_16x16x32_bf16 v[56:59], a[88:91], v[92:95], v[56:59]
    v_mfma_f32_16x16x32_bf16 v[44:47], a[88:91], v[88:91], v[44:47]
    v_mfma_f32_16x16x32_bf16 v[48:51], v[88:91], a[92:95], v[48:51]
    v_mfma_f32_16x16x32_bf16 v[60:63], v[92:95], a[92:95], v[60:63]
    s_waitcnt lgkmcnt(4)
    s_buffer_load_dword s62, s[4:7], s33 glc
    v_mfma_f32_16x16x32_bf16 v[40:43], a[96:99], v[64:67], v[40:43]
    ds_read_b128 v[88:91], v7 offset:2816
    v_mfma_f32_16x16x32_bf16 v[52:55], a[96:99], v[68:71], v[52:55]
    ds_read_b128 v[92:95], v7 offset:35584
    v_mfma_f32_16x16x32_bf16 v[56:59], a[100:103], v[68:71], v[56:59]
    v_mfma_f32_16x16x32_bf16 v[44:47], a[100:103], v[64:67], v[44:47]
    v_mfma_f32_16x16x32_bf16 v[48:51], v[64:67], a[104:107], v[48:51]
    v_mfma_f32_16x16x32_bf16 v[60:63], v[68:71], a[104:107], v[60:63]
    s_waitcnt lgkmcnt(4)
    v_mfma_f32_16x16x32_bf16 v[40:43], a[108:111], v[72:75], v[40:43]
    ds_read_b128 v[64:67], v7 offset:3072
    v_mfma_f32_16x16x32_bf16 v[52:55], a[108:111], v[76:79], v[52:55]
    ds_read_b128 v[68:71], v7 offset:35840
    v_mfma_f32_16x16x32_bf16 v[56:59], a[112:115], v[76:79], v[56:59]
    v_mfma_f32_16x16x32_bf16 v[44:47], a[112:115], v[72:75], v[44:47]
    v_mfma_f32_16x16x32_bf16 v[48:51], v[72:75], a[116:119], v[48:51]
    v_mfma_f32_16x16x32_bf16 v[60:63], v[76:79], a[116:119], v[60:63]
    s_waitcnt lgkmcnt(4)
    v_mfma_f32_16x16x32_bf16 v[40:43], a[120:123], v[80:83], v[40:43]
    ds_read_b128 v[72:75], v7 offset:3328
    v_mfma_f32_16x16x32_bf16 v[52:55], a[120:123], v[84:87], v[52:55]
    ds_read_b128 v[76:79], v7 offset:36096
    v_mfma_f32_16x16x32_bf16 v[56:59], a[124:127], v[84:87], v[56:59]
    v_mfma_f32_16x16x32_bf16 v[44:47], a[124:127], v[80:83], v[44:47]
    v_mfma_f32_16x16x32_bf16 v[48:51], v[80:83], a[128:131], v[48:51]
    v_mfma_f32_16x16x32_bf16 v[60:63], v[84:87], a[128:131], v[60:63]
    s_waitcnt lgkmcnt(4)
    v_mfma_f32_16x16x32_bf16 v[40:43], a[132:135], v[88:91], v[40:43]
    ds_read_b128 v[80:83], v7 offset:3584
    v_mfma_f32_16x16x32_bf16 v[52:55], a[132:135], v[92:95], v[52:55]
    ds_read_b128 v[84:87], v7 offset:36352
    v_mfma_f32_16x16x32_bf16 v[56:59], a[136:139], v[92:95], v[56:59]
    v_mfma_f32_16x16x32_bf16 v[44:47], a[136:139], v[88:91], v[44:47]
    v_mfma_f32_16x16x32_bf16 v[48:51], v[88:91], a[140:143], v[48:51]
    v_mfma_f32_16x16x32_bf16 v[60:63], v[92:95], a[140:143], v[60:63]
    s_waitcnt lgkmcnt(4)
    v_mfma_f32_16x16x32_bf16 v[40:43], a[144:147], v[64:67], v[40:43]
    ds_read_b128 v[88:91], v7 offset:3840
    v_mfma_f32_16x16x32_bf16 v[52:55], a[144:147], v[68:71], v[52:55]
    ds_read_b128 v[92:95], v7 offset:36608
    v_mfma_f32_16x16x32_bf16 v[56:59], a[148:151], v[68:71], v[56:59]
    v_mfma_f32_16x16x32_bf16 v[44:47], a[148:151], v[64:67], v[44:47]
    v_mfma_f32_16x16x32_bf16 v[48:51], v[64:67], a[152:155], v[48:51]
    v_mfma_f32_16x16x32_bf16 v[60:63], v[68:71], a[152:155], v[60:63]
    s_waitcnt vmcnt(0)
    s_branch L_PJ_mid1
L_PJ_nr1:
    s_mov_b32 s40, 268435456
    s_cmp_eq_u32 s23, 0
    s_cbranch_scc1 L_PJ_go1
    s_mov_b32 s3, 0
L_PJ_hl1:
    s_buffer_load_dword s62, s[4:7], s33 glc
    s_waitcnt lgkmcnt(0)
    s_cmp_ge_u32 s62, s32
    s_cbranch_scc1 L_PJ_hd1
    s_add_u32 s3, s3, 1
    s_cmp_lt_u32 s3, 40000
    s_cbranch_scc1 L_PJ_hl1
    s_mov_b32 s3, 31
    s_branch L_abort
L_PJ_hd1:
    s_branch L_PJ_rd1
L_PJ_slow1:
    v_mfma_f32_16x16x32_bf16 v[40:43], v[220:223], v[72:75], v[40:43]
    v_mfma_f32_16x16x32_bf16 v[52:55], v[220:223], v[76:79], v[52:55]
    v_mfma_f32_16x16x32_bf16 v[56:59], v[224:227], v[76:79], v[56:59]
    v_mfma_f32_16x16x32_bf16 v[44:47], v[224:227], v[72:75], v[44:47]
    v_mfma_f32_16x16x32_bf16 v[48:51], v[72:75], v[228:231], v[48:51]
    v_mfma_f32_16x16x32_bf16 v[60:63], v[76:79], v[228:231], v[60:63]
    s_waitcnt lgkmcnt(3)
    v_mfma_f32_16x16x32_bf16 v[40:43], v[232:235], v[80:83], v[40:43]
    s_waitcnt lgkmcnt(2)
    v_mfma_f32_16x16x32_bf16 v[52:55], v[232:235], v[84:87], v[52:55]
    v_mfma_f32_16x16x32_bf16 v[56:59], v[236:239], v[84:87], v[56:59]
    v_mfma_f32_16x16x32_bf16 v[44:47], v[236:239], v[80:83], v[44:47]
    v_mfma_f32_16x16x32_bf16 v[48:51], v[80:83], v[240:243], v[48:51]
    v_mfma_f32_16x16x32_bf16 v[60:63], v[84:87], v[240:243], v[60:63]
    s_waitcnt lgkmcnt(1)
    v_mfma_f32_16x16x32_bf16 v[40:43], v[244:247], v[88:91], v[40:43]
    s_waitcnt lgkmcnt(0)
    v_mfma_f32_16x16x32_bf16 v[52:55], v[244:247], v[92:95], v[52:55]
    v_mfma_f32_16x16x32_bf16 v[56:59], v[248:251], v[92:95], v[56:59]
    v_mfma_f32_16x16x32_bf16 v[44:47], v[248:251], v[88:91], v[44:47]
    v_mfma_f32_16x16x32_bf16 v[48:51], v[88:91], v[252:255], v[48:51]
    v_mfma_f32_16x16x32_bf16 v[60:63], v[92:95], v[252:255], v[60:63]
    s_and_b32 s86, s36, 95
    s_mul_i32 s86, s86, 262144
    s_add_u32 s87, s86, s45
    s_add_u32 s86, s86, s44
    s_mul_i32 s37, s34, 20480
    s_add_u32 s37, s37, s43
    s_add_u32 s38, s35, 1
    v_cvt_pk_bf16_f32 v96, v40, v41
    v_cvt_pk_bf16_f32 v97, v42, v43
    v_cvt_pk_bf16_f32 v98, v44, v45
    v_cvt_pk_bf16_f32 v99, v46, v47
    buffer_store_dwordx4 v[96:99], v0, s[4:7], s86 offen offset:0 sc1
    v_cvt_pk_bf16_f32 v100, v52, v53
    v_cvt_pk_bf16_f32 v101, v54, v55
    v_cvt_pk_bf16_f32 v102, v56, v57
    v_cvt_pk_bf16_f32 v103, v58, v59
    buffer_store_dwordx4 v[100:103], v0, s[4:7], s86 offen offset:1024 sc1
    v_cvt_pk_bf16_f32 v104, v48, v49
    v_cvt_pk_bf16_f32 v105, v50, v51
    v_cvt_pk_bf16_f32 v106, v60, v61
    v_cvt_pk_bf16_f32 v107, v62, v63
    buffer_store_dwordx4 v[104:107], v0, s[4:7], s87 offen sc1
    s_buffer_load_dword s62, s[4:7], s33 glc
    s_waitcnt vmcnt(0)
    s_add_u32 s92, s59, 1
    v_mov_b32 v12, s92
    s_and_b32 s95, s92, s57
    ds_write_b32 v11, v12
    s_cmp_lg_u32 s58, 0
    s_cbranch_scc1 L_pd_11
    ds_read_b128 v[116:119], v9
    s_waitcnt lgkmcnt(0)
    v_min3_u32 v116, v116, v117, v118
    v_min_u32 v116, v116, v119
    v_cmp_gt_u32 vcc, s95, v116
    s_cbranch_vccnz L_pd_11
    v_mov_b32 v5, s38
    buffer_store_dword v5, v3, s[4:7], s37 offen sc1
    s_mov_b32 s58, 268435456
L_pd_11:
    s_cmp_lg_u32 s58, 0
    s_cbranch_scc1 L_pd_12
    ds_read_b128 v[116:119], v9
    s_waitcnt lgkmcnt(0)
    v_min3_u32 v116, v116, v117, v118
    v_min_u32 v116, v116, v119
    v_cmp_gt_u32 vcc, s95, v116
    s_cbranch_vccnz L_pd_12
    v_mov_b32 v5, s38
    buffer_store_dword v5, v3, s[4:7], s37 offen sc1
    s_mov_b32 s58, 268435456
L_pd_12:
    s_cmp_gt_u32 s20, 128
    s_cbranch_scc1 L_PJ_done
    s_waitcnt lgkmcnt(0)
    s_cmp_ge_u32 s62, s32
    s_cbranch_scc1 L_PJ_sd1
L_PJ_ss1:
    s_mov_b32 s3, 0
L_PJ_sl1:
    s_cmp_lg_u32 s58, 0
    s_cbranch_scc1 L_pd_13
    ds_read_b128 v[116:119], v9
    s_waitcnt lgkmcnt(0)
    v_min3_u32 v116, v116, v117, v118
    v_min_u32 v116, v116, v119
    v_cmp_gt_u32 vcc, s95, v116
    s_cbranch_vccnz L_pd_13
    v_mov_b32 v5, s38
    buffer_store_dword v5, v3, s[4:7], s37 offen sc1
    s_mov_b32 s58, 268435456
L_pd_13:
    s_buffer_load_dword s62, s[4:7], s33 glc
    s_waitcnt lgkmcnt(0)
    s_cmp_ge_u32 s62, s32
    s_cbranch_scc1 L_PJ_sd1
    s_add_u32 s3, s3, 1
    s_cmp_lt_u32 s3, 40000
    s_cbranch_scc1 L_PJ_sl1
    s_mov_b32 s3, 11
    s_branch L_abort
L_PJ_sd1:
    s_mov_b32 s40, s31
    s_add_u32 s94, s40, 0
    s_add_u32 m0, s46, 0
    s_nop 0
    buffer_load_dwordx4 v1, s[4:7], s94 offen offset:0 sc1 lds
    buffer_load_dwordx4 v1, s[4:7], s94 offen offset:1024 sc1 lds
    buffer_load_dwordx4 v1, s[4:7], s94 offen offset:2048 sc1 lds
    buffer_load_dwordx4 v1, s[4:7], s94 offen offset:3072 sc1 lds
    s_add_u32 s94, s40, 32768
    s_add_u32 m0, s46, 32768
    s_nop 0
    buffer_load_dwordx4 v1, s[4:7], s94 offen offset:0 sc1 lds
    buffer_load_dwordx4 v1, s[4:7], s94 offen offset:1024 sc1 lds
    buffer_load_dwordx4 v1, s[4:7], s94 offen offset:2048 sc1 lds
    buffer_load_dwordx4 v1, s[4:7], s94 offen offset:3072 sc1 lds
    s_add_u32 s94, s40, 4096
    s_add_u32 m0, s46, 4096
    s_nop 0
    buffer_load_dwordx4 v1, s[4:7], s94 offen offset:0 sc1 lds
    buffer_load_dwordx4 v1, s[4:7], s94 offen offset:1024 sc1 lds
    buffer_load_dwordx4 v1, s[4:7], s94 offen offset:2048 sc1 lds
    buffer_load_dwordx4 v1, s[4:7], s94 offen offset:3072 sc1 lds
    s_waitcnt vmcnt(4)
    s_barrier
    ds_read_b128 v[64:67], v6 offset:0
    ds_read_b128 v[68:71], v6 offset:32768
    ds_read_b128 v[72:75], v6 offset:256
    ds_read_b128 v[76:79], v6 offset:33024
    ds_read_b128 v[80:83], v6 offset:512
    ds_read_b128 v[84:87], v6 offset:33280
    s_waitcnt lgkmcnt(4)
    v_mfma_f32_16x16x32_bf16 v[16:19], a[0:3], v[64:67], 0
    ds_read_b128 v[88:91], v6 offset:768
    s_add_u32 s94, s40, 36864
    v_mfma_f32_16x16x32_bf16 v[28:31], a[0:3], v[68:71], 0
    ds_read_b128 v[92:95], v6 offset:33536
    s_add_u32 m0, s46, 36864
    v_mfma_f32_16x16x32_bf16 v[32:35], a[4:7], v[68:71], 0
    buffer_load_dwordx4 v1, s[4:7], s94 offen offset:0 sc1 lds
    s_mul_i32 s37, s34, 20480
    v_mfma_f32_16x16x32_bf16 v[20:23], a[4:7], v[64:67], 0
    s_add_u32 s37, s37, s43
    s_add_u32 s38, s35, 1
    v_mov_b32 v5, s38
    v_mfma_f32_16x16x32_bf16 v[24:27], v[64:67], a[8:11], 0
    buffer_load_dwordx4 v1, s[4:7], s94 offen offset:1024 sc1 lds
    s_mov_b32 s34, s28
    v_mfma_f32_16x16x32_bf16 v[36:39], v[68:71], a[8:11], 0
    s_waitcnt lgkmcnt(4)
    s_mov_b32 s35, s29
    s_mov_b32 s36, s30
    v_mfma_f32_16x16x32_bf16 v[16:19], a[12:15], v[72:75], v[16:19]
    ds_read_b128 v[64:67], v6 offset:1024
    s_add_u32 s59, s59, 1
    v_mfma_f32_16x16x32_bf16 v[28:31], a[12:15], v[76:79], v[28:31]
    ds_read_b128 v[68:71], v6 offset:33792
    v_mfma_f32_16x16x32_bf16 v[32:35], a[16:19], v[76:79], v[32:35]
    buffer_load_dwordx4 v1, s[4:7], s94 offen offset:2048 sc1 lds
    v_mfma_f32_16x16x32_bf16 v[20:23], a[16:19], v[72:75], v[20:23]
    s_cmp_lt_u32 s20, 64
    s_cselect_b64 s[88:89], s[24:25], s[26:27]
    v_mfma_f32_16x16x32_bf16 v[24:27], v[72:75], a[20:23], v[24:27]
    s_bitcmp1_b64 s[88:89], s20
    s_cselect_b32 s28, 1, 0
    s_cselect_b32 s29, s22, s21
    v_mfma_f32_16x16x32_bf16 v[36:39], v[76:79], a[20:23], v[36:39]
    s_waitcnt lgkmcnt(2)
    s_add_u32 s22, s22, s28
    s_xor_b32 s88, s28, 1
    v_mfma_f32_16x16x32_bf16 v[16:19], a[24:27], v[80:83], v[16:19]
    ds_read_b128 v[72:75], v6 offset:1280
    s_add_u32 s21, s21, s88
    v_mfma_f32_16x16x32_bf16 v[28:31], a[24:27], v[84:87], v[28:31]
    ds_read_b128 v[76:79], v6 offset:34048
    s_lshl_b32 s30, s28, 6
    v_mfma_f32_16x16x32_bf16 v[32:35], a[28:31], v[84:87], v[32:35]
    buffer_load_dwordx4 v1, s[4:7], s94 offen offset:3072 sc1 lds
    s_add_u32 s30, s30, s29
    v_mfma_f32_16x16x32_bf16 v[20:23], a[28:31], v[80:83], v[20:23]
    s_mul_i32 s88, s28, 8388608
    s_mul_i32 s89, s29, 65536
    s_add_u32 s31, s88, s89
    v_mfma_f32_16x16x32_bf16 v[24:27], v[80:83], a[32:35], v[24:27]
    s_add_u32 s31, s31, s42
    s_lshl2_add_u32 s33, s30, s60
    v_mfma_f32_16x16x32_bf16 v[36:39], v[84:87], a[32:35], v[36:39]
    s_cmp_lt_u32 s20, 128
    s_cselect_b32 s31, s31, 268435456
    s_cselect_b32 s32, s61, 0
    v_mfma_f32_16x16x32_bf16 v[16:19], a[36:39], v[88:91], v[16:19]
    ds_read_b128 v[80:83], v6 offset:1536
    s_add_u32 s20, s20, 1
    v_mfma_f32_16x16x32_bf16 v[28:31], a[36:39], v[92:95], v[28:31]
    ds_read_b128 v[84:87], v6 offset:34304
    s_mul_i32 s32, s32, s28
    v_mfma_f32_16x16x32_bf16 v[32:35], a[40:43], v[92:95], v[32:35]
    s_andn2_b32 s23, s28, s34
    v_mfma_f32_16x16x32_bf16 v[20:23], a[40:43], v[88:91], v[20:23]
    v_mfma_f32_16x16x32_bf16 v[24:27], v[88:91], a[44:47], v[24:27]
    v_mfma_f32_16x16x32_bf16 v[36:39], v[92:95], a[44:47], v[36:39]
    s_waitcnt lgkmcnt(2)
    v_mfma_f32_16x16x32_bf16 v[16:19], a[48:51], v[64:67], v[16:19]
    ds_read_b128 v[88:91], v6 offset:1792
    v_mfma_f32_16x16x32_bf16 v[28:31], a[48:51], v[68:71], v[28:31]
    ds_read_b128 v[92:95], v6 offset:34560
    v_mfma_f32_16x16x32_bf16 v[32:35], a[52:55], v[68:71], v[32:35]
    v_mfma_f32_16x16x32_bf16 v[20:23], a[52:55], v[64:67], v[20:23]
    v_mfma_f32_16x16x32_bf16 v[24:27], v[64:67], a[56:59], v[24:27]
    v_mfma_f32_16x16x32_bf16 v[36:39], v[68:71], a[56:59], v[36:39]
    v_mfma_f32_16x16x32_bf16 v[16:19], a[60:63], v[72:75], v[16:19]
    ds_read_b128 v[64:67], v6 offset:2048
    v_mfma_f32_16x16x32_bf16 v[28:31], a[60:63], v[76:79], v[28:31]
    ds_read_b128 v[68:71], v6 offset:34816
    v_mfma_f32_16x16x32_bf16 v[32:35], a[64:67], v[76:79], v[32:35]
    v_mfma_f32_16x16x32_bf16 v[20:23], a[64:67], v[72:75], v[20:23]
    v_mfma_f32_16x16x32_bf16 v[24:27], v[72:75], a[68:71], v[24:27]
    v_mfma_f32_16x16x32_bf16 v[36:39], v[76:79], a[68:71], v[36:39]
    s_waitcnt lgkmcnt(2)
    v_mfma_f32_16x16x32_bf16 v[16:19], a[72:75], v[80:83], v[16:19]
    ds_read_b128 v[72:75], v6 offset:2304
    v_mfma_f32_16x16x32_bf16 v[28:31], a[72:75], v[84:87], v[28:31]
    ds_read_b128 v[76:79], v6 offset:35072
    v_mfma_f32_16x16x32_bf16 v[32:35], a[76:79], v[84:87], v[32:35]
    v_mfma_f32_16x16x32_bf16 v[20:23], a[76:79], v[80:83], v[20:23]
    v_mfma_f32_16x16x32_bf16 v[24:27], v[80:83], a[80:83], v[24:27]
    v_mfma_f32_16x16x32_bf16 v[36:39], v[84:87], a[80:83], v[36:39]
    v_mfma_f32_16x16x32_bf16 v[16:19], a[84:87], v[88:91], v[16:19]
    ds_read_b128 v[80:83], v6 offset:2560
    v_mfma_f32_16x16x32_bf16 v[28:31], a[84:87], v[92:95], v[28:31]
    ds_read_b128 v[84:87], v6 offset:35328
    v_mfma_f32_16x16x32_bf16 v[32:35], a[88:91], v[92:95], v[32:35]
    v_mfma_f32_16x16x32_bf16 v[20:23], a[88:91], v[88:91], v[20:23]
    v_mfma_f32_16x16x32_bf16 v[24:27], v[88:91], a[92:95], v[24:27]
    v_mfma_f32_16x16x32_bf16 v[36:39], v[92:95], a[92:95], v[36:39]
    s_waitcnt lgkmcnt(4)
    s_buffer_load_dword s62, s[4:7], s33 glc
    v_mfma_f32_16x16x32_bf16 v[16:19], a[96:99], v[64:67], v[16:19]
    ds_read_b128 v[88:91], v6 offset:2816
    v_mfma_f32_16x16x32_bf16 v[28:31], a[96:99], v[68:71], v[28:31]
    ds_read_b128 v[92:95], v6 offset:35584
    v_mfma_f32_16x16x32_bf16 v[32:35], a[100:103], v[68:71], v[32:35]
    v_mfma_f32_16x16x32_bf16 v[20:23], a[100:103], v[64:67], v[20:23]
    v_mfma_f32_16x16x32_bf16 v[24:27], v[64:67], a[104:107], v[24:27]
    v_mfma_f32_16x16x32_bf16 v[36:39], v[68:71], a[104:107], v[36:39]
    s_waitcnt lgkmcnt(4)
    v_mfma_f32_16x16x32_bf16 v[16:19], a[108:111], v[72:75], v[16:19]
    ds_read_b128 v[64:67], v6 offset:3072
    v_mfma_f32_16x16x32_bf16 v[28:31], a[108:111], v[76:79], v[28:31]
    ds_read_b128 v[68:71], v6 offset:35840
    v_mfma_f32_16x16x32_bf16 v[32:35], a[112:115], v[76:79], v[32:35]
    v_mfma_f32_16x16x32_bf16 v[20:23], a[112:115], v[72:75], v[20:23]
    v_mfma_f32_16x16x32_bf16 v[24:27], v[72:75], a[116:119], v[24:27]
    v_mfma_f32_16x16x32_bf16 v[36:39], v[76:79], a[116:119], v[36:39]
    s_waitcnt lgkmcnt(4)
    v_mfma_f32_16x16x32_bf16 v[16:19], a[120:123], v[80:83], v[16:19]
    ds_read_b128 v[72:75], v6 offset:3328
    v_mfma_f32_16x16x32_bf16 v[28:31], a[120:123], v[84:87], v[28:31]
    ds_read_b128 v[76:79], v6 offset:36096
    v_mfma_f32_16x16x32_bf16 v[32:35], a[124:127], v[84:87], v[32:35]
    v_mfma_f32_16x16x32_bf16 v[20:23], a[124:127], v[80:83], v[20:23]
    v_mfma_f32_16x16x32_bf16 v[24:27], v[80:83], a[128:131], v[24:27]
    v_mfma_f32_16x16x32_bf16 v[36:39], v[84:87], a[128:131], v[36:39]
    s_waitcnt lgkmcnt(4)
    v_mfma_f32_16x16x32_bf16 v[16:19], a[132:135], v[88:91], v[16:19]
    ds_read_b128 v[80:83], v6 offset:3584
    v_mfma_f32_16x16x32_bf16 v[28:31], a[132:135], v[92:95], v[28:31]
    ds_read_b128 v[84:87], v6 offset:36352
    v_mfma_f32_16x16x32_bf16 v[32:35], a[136:139], v[92:95], v[32:35]
    v_mfma_f32_16x16x32_bf16 v[20:23], a[136:139], v[88:91], v[20:23]
    v_mfma_f32_16x16x32_bf16 v[24:27], v[88:91], a[140:143], v[24:27]
    v_mfma_f32_16x16x32_bf16 v[36:39], v[92:95], a[140:143], v[36:39]
    s_waitcnt lgkmcnt(4)
    v_mfma_f32_16x16x32_bf16 v[16:19], a[144:147], v[64:67], v[16:19]
    ds_read_b128 v[88:91], v6 offset:3840
    v_mfma_f32_16x16x32_bf16 v[28:31], a[144:147], v[68:71], v[28:31]
    ds_read_b128 v[92:95], v6 offset:36608
    v_mfma_f32_16x16x32_bf16 v[32:35], a[148:151], v[68:71], v[32:35]
    v_mfma_f32_16x16x32_bf16 v[20:23], a[148:151], v[64:67], v[20:23]
    v_mfma_f32_16x16x32_bf16 v[24:27], v[64:67], a[152:155], v[24:27]
    v_mfma_f32_16x16x32_bf16 v[36:39], v[68:71], a[152:155], v[36:39]
    s_waitcnt vmcnt(0)
    s_branch L_PJ_mid0
L_PJ_done:
    s_mov_b32 s3, 0
L_PJ_dl:
    s_cmp_lg_u32 s58, 0
    s_cbranch_scc1 L_pd_14
    ds_read_b128 v[116:119], v9
    s_waitcnt lgkmcnt(0)
    v_min3_u32 v116, v116, v117, v118
    v_min_u32 v116, v116, v119
    v_cmp_gt_u32 vcc, s95, v116
    s_cbranch_vccnz L_pd_14
    v_mov_b32 v5, s38
    buffer_store_dword v5, v3, s[4:7], s37 offen sc1
    s_mov_b32 s58, 268435456
L_pd_14:
    s_cmp_lg_u32 s58, 0
    s_cbranch_scc1 L_PJ_dd
    s_add_u32 s3, s3, 1
    s_cmp_lt_u32 s3, 40000
    s_cbranch_scc1 L_PJ_dl
    s_mov_b32 s3, 51
    s_branch L_abort
L_PJ_dd:
    s_endpgm
L_role_AT:
    v_mov_b32 v20, v0
    v_lshlrev_b32 v0, 4, v20
    v_mov_b32 v3, 0
    v_and_b32 v21, 15, v20
    v_lshlrev_b32 v21, 4, v21
    v_lshrrev_b32 v22, 4, v20
    v_lshl_add_u32 v19, v22, 9, v21
    v_mov_b32 v1, v0
    v_mov_b32 v6, v19
    v_add_u32 v7, 0x10000, v6
    v_add_u32 v8, 0x20000, v6
    s_lshr_b32 s94, s18, 1
    s_lshl_b32 s48, s19, 1
    s_add_u32 s48, s48, s94
    s_and_b32 s49, s18, 1
    s_mul_i32 s95, s49, 20480
    s_mul_i32 s92, s48, 640
    s_add_u32 s92, s92, s95
    s_add_u32 s52, s92, 1572864
    s_add_u32 s67, s92, 1613824
    s_lshl_b32 s92, s48, 13
    s_lshl_b32 s93, s49, 24
    s_add_u32 s92, s92, s93
    s_add_u32 s50, s92, 4194304
    s_add_u32 s44, s92, 117440512
    s_lshl_b32 s92, s19, 14
    s_lshl_b32 s93, s94, 12
    s_add_u32 s92, s92, s93
    s_lshl_b32 s93, s49, 23
    s_add_u32 s92, s92, s93
    s_add_u32 s51, s92, 71303168
    v_mov_b32 v4, v19
    v_mov_b32 v22, 0x40000000
    v_lshrrev_b32 v23, 4, v20
    v_and_b32 v21, 15, v20
    v_lshlrev_b32 v18, 7, v23
    v_lshl_add_u32 v18, v21, 4, v18
    v_cmp_gt_u32 vcc, 8, v21
    s_nop 1
    v_cndmask_b32 v9, v22, v18, vcc
    v_add_u32 v18, 2048, v0
    v_cmp_gt_u32 vcc, 32, v20
    s_nop 1
    v_cndmask_b32 v10, v22, v18, vcc
    v_mov_b32 v22, 0xff800000
    v_cndmask_b32 v32, v22, v3, vcc
    v_mov_b32 v24, -1
    v_cndmask_b32 v33, v22, v3, vcc
    v_mov_b32 v25, -1
    v_cndmask_b32 v34, v22, v3, vcc
    v_mov_b32 v26, -1
    v_cndmask_b32 v35, v22, v3, vcc
    v_mov_b32 v27, -1
    v_lshlrev_b32 v23, 2, v23
    v_add_u32 v18, 0, v23
    v_cmp_le_u32 vcc, v18, v21
    s_nop 1
    v_cndmask_b32 v28, v22, v3, vcc
    v_add_u32 v18, 1, v23
    v_cmp_le_u32 vcc, v18, v21
    s_nop 1
    v_cndmask_b32 v29, v22, v3, vcc
    v_add_u32 v18, 2, v23
    v_cmp_le_u32 vcc, v18, v21
    s_nop 1
    v_cndmask_b32 v30, v22, v3, vcc
    v_add_u32 v18, 3, v23
    v_cmp_le_u32 vcc, v18, v21
    s_nop 1
    v_cndmask_b32 v31, v22, v3, vcc
    s_mov_b32 s54, 0x3e0293ee
    s_mov_b32 s53, 0xbe0293ee
    s_mov_b32 s21, 0
    s_cmp_gt_u32 s48, 10
    s_cselect_b32 s92, 8, 0
    s_cmp_gt_u32 s48, 21
    s_cselect_b32 s92, 16, s92
    s_cmp_eq_u32 s48, 10
    s_cselect_b32 s93, 16, 8
    s_cmp_eq_u32 s48, 21
    s_cselect_b32 s93, 16, s93
    v_add_u32 v21, s92, v20
    v_mul_u32_u24 v21, 640, v21
    v_mov_b32 v22, 0x40000000
    v_cmp_gt_u32 vcc, s93, v20
    s_nop 1
    v_cndmask_b32 v2, v22, v21, vcc
    v_mov_b32 v5, 1
    s_lshl_b32 s43, s49, 8
    s_add_u32 s43, s43, 1654784
    s_mov_b32 s37, 268435456
    buffer_store_dword v3, v3, s[4:7], s67 offen sc1
    s_waitcnt vmcnt(0)
    s_barrier
    s_cmp_lg_u32 s18, 0
    s_cbranch_scc1 L_arr_15
    s_mov_b32 s3, 1
    s_buffer_atomic_add s3, s[12:15], 4 glc
    s_waitcnt lgkmcnt(0)
    s_add_u32 s3, s3, 1
    s_and_b32 s92, s3, 0xffff
    s_cmp_lg_u32 s92, 256
    s_cbranch_scc1 L_arr_15
    v_mov_b32 v20, s3
    v_lshlrev_b32 v21, 3, v0
    s_mov_b32 s92, 163840
    buffer_store_dword v20, v21, s[4:7], s92 offen sc1
    s_mov_b32 s92, 172032
    buffer_store_dword v20, v21, s[4:7], s92 offen sc1
    s_mov_b32 s92, 180224
    buffer_store_dword v20, v21, s[4:7], s92 offen sc1
    s_mov_b32 s92, 188416
    buffer_store_dword v20, v21, s[4:7], s92 offen sc1
    s_waitcnt vmcnt(0)
L_arr_15:
    s_lshl_b32 s93, s16, 5
    s_add_u32 s93, s93, s17
    s_lshl_b32 s93, s93, 7
    s_add_u32 s93, s93, 163840
    s_mov_b32 s3, 0
L_ws_16:
    s_buffer_load_dword s92, s[4:7], s93 glc
    s_waitcnt lgkmcnt(0)
    s_cmp_lg_u32 s92, 0
    s_cbranch_scc1 L_wsd_17
    s_add_u32 s3, s3, 1
    s_cmp_lt_u32 s3, 40000
    s_cbranch_scc1 L_ws_16
    s_mov_b32 s3, 17
    s_branch L_abort
L_wsd_17:
    s_lshl_b32 s55, s49, 2
    s_add_u32 s55, s55, 4
    s_lshr_b32 s55, s92, s55
L_AT_slow:
    s_add_u32 s65, s21, 1
    s_mov_b32 s3, 0
L_AT_sp:
    s_buffer_load_dwordx2 s[68:69], s[4:7], s52 glc
    s_waitcnt lgkmcnt(0)
    s_min_u32 s68, s68, s69
    s_cmp_ge_u32 s68, s65
    s_cbranch_scc1 L_AT_fetch
    s_add_u32 s3, s3, 1
    s_cmp_lt_u32 s3, 40000
    s_cbranch_scc1 L_AT_sp
    s_mov_b32 s3, 20
    s_branch L_abort
L_AT_fetch:
    s_and_b32 s61, s21, 31
    s_lshl_b32 s61, s61, 18
    s_add_u32 s61, s61, s50
    s_and_b32 s66, s21, 31
    s_lshl_b32 s66, s66, 18
    s_add_u32 s62, s61, 230686720
    s_add_u32 s63, s61, 33554432
    s_add_u32 s66, s66, s44
    s_add_u32 s95, s66, 4096
    s_and_b32 s59, s21, 31
    s_lshl_b32 s59, s59, 18
    s_add_u32 s59, s59, s51
    s_bfe_u32 s92, s21, 0x20003
    s_lshr_b32 s92, s55, s92
    s_and_b32 s92, s92, 8192
    s_add_u32 s59, s59, s92
    s_mov_b32 s3, 0
    buffer_load_dwordx4 a[0:3], v0, s[4:7], s62 offen offset:0 sc1
    buffer_load_dwordx4 a[4:7], v0, s[4:7], s62 offen offset:1024 sc1
    buffer_load_dwordx4 a[8:11], v0, s[4:7], s62 offen offset:2048 sc1
    buffer_load_dwordx4 a[12:15], v0, s[4:7], s62 offen offset:3072 sc1
    s_add_u32 s62, s62, 4096
    buffer_load_dwordx4 a[16:19], v0, s[4:7], s62 offen offset:0 sc1
    buffer_load_dwordx4 a[20:23], v0, s[4:7], s62 offen offset:1024 sc1
    s_waitcnt vmcnt(6)
    buffer_atomic_add v5, v2, s[4:7], s37 offen
    s_mov_b32 s37, 268435456
    buffer_load_dwordx4 a[24:27], v0, s[4:7], s62 offen offset:2048 sc1
    buffer_load_dwordx4 a[28:31], v0, s[4:7], s62 offen offset:3072 sc1
    buffer_load_dwordx4 a[32:35], v0, s[4:7], s61 offen offset:0 sc1
    buffer_load_dwordx4 a[36:39], v0, s[4:7], s61 offen offset:1024 sc1
    buffer_load_dwordx4 a[40:43], v0, s[4:7], s61 offen offset:2048 sc1
    buffer_load_dwordx4 a[44:47], v0, s[4:7], s61 offen offset:3072 sc1
    s_add_u32 s61, s61, 4096
    buffer_load_dwordx4 a[48:51], v0, s[4:7], s61 offen offset:0 sc1
    buffer_load_dwordx4 a[52:55], v0, s[4:7], s61 offen offset:1024 sc1
    buffer_load_dwordx4 a[56:59], v0, s[4:7], s61 offen offset:2048 sc1
    buffer_load_dwordx4 a[60:63], v0, s[4:7], s61 offen offset:3072 sc1
    buffer_load_dwordx4 a[64:67], v0, s[4:7], s63 offen offset:0 sc1
    buffer_load_dwordx4 a[68:71], v0, s[4:7], s63 offen offset:1024 sc1
    buffer_load_dwordx4 a[72:75], v0, s[4:7], s63 offen offset:2048 sc1
    buffer_load_dwordx4 a[76:79], v0, s[4:7], s63 offen offset:3072 sc1
    s_add_u32 s63, s63, 4096
    buffer_load_dwordx4 a[80:83], v0, s[4:7], s63 offen offset:0 sc1
    buffer_load_dwordx4 a[84:87], v0, s[4:7], s63 offen offset:1024 sc1
    buffer_load_dwordx4 a[88:91], v0, s[4:7], s63 offen offset:2048 sc1
    buffer_load_dwordx4 a[92:95], v0, s[4:7], s63 offen offset:3072 sc1
L_AT_km:
    s_buffer_load_dword s70, s[4:7], s67 glc
    s_waitcnt lgkmcnt(0)
    s_lshr_b32 s70, s70, 2
    s_cmp_gt_u32 s70, s21
    s_cbranch_scc1 L_AT_go
    s_add_u32 s3, s3, 1
    s_cmp_lt_u32 s3, 40000
    s_cbranch_scc1 L_AT_km
    s_mov_b32 s3, 19
    s_branch L_abort
L_AT_go:
    buffer_load_dwordx4 v[36:39], v9, s[4:7], s59 offen offset:0 sc1
    buffer_load_dwordx4 v[40:43], v9, s[4:7], s59 offen offset:512 sc1
    buffer_load_dwordx4 v[44:47], v9, s[4:7], s59 offen offset:1024 sc1
    buffer_load_dwordx4 v[48:51], v9, s[4:7], s59 offen offset:1536 sc1
    buffer_load_dwordx4 v[52:55], v10, s[4:7], s59 offen offset:0 sc1
    buffer_load_dwordx4 v[56:59], v10, s[4:7], s59 offen offset:512 sc1
    buffer_load_dwordx4 v[60:63], v10, s[4:7], s59 offen offset:1024 sc1
    buffer_load_dwordx4 v[64:67], v10, s[4:7], s59 offen offset:1536 sc1
    s_waitcnt vmcnt(8)
    v_mfma_f32_16x16x32_bf16 v[68:71], a[32:35], a[0:3], v[28:31]
    s_buffer_load_dwordx2 s[68:69], s[4:7], s52 glc
    s_add_u32 s65, s21, 2
    v_mfma_f32_16x16x32_bf16 v[68:71], a[40:43], a[8:11], v[68:71]
    v_mfma_f32_16x16x32_bf16 v[68:71], a[48:51], a[16:19], v[68:71]
    v_mfma_f32_16x16x32_bf16 v[68:71], a[56:59], a[24:27], v[68:71]
    v_mfma_f32_16x16x32_bf16 v[76:79], a[32:35], a[4:7], 0
    v_mfma_f32_16x16x32_bf16 v[76:79], a[40:43], a[12:15], v[76:79]
    v_mfma_f32_16x16x32_bf16 v[76:79], a[48:51], a[20:23], v[76:79]
    v_mfma_f32_16x16x32_bf16 v[76:79], a[56:59], a[28:31], v[76:79]
    v_mfma_f32_16x16x32_bf16 v[80:83], a[36:39], a[4:7], v[28:31]
    v_mfma_f32_16x16x32_bf16 v[80:83], a[44:47], a[12:15], v[80:83]
    v_mfma_f32_16x16x32_bf16 v[80:83], a[52:55], a[20:23], v[80:83]
    v_mfma_f32_16x16x32_bf16 v[80:83], a[60:63], a[28:31], v[80:83]
    s_waitcnt vmcnt(7)
    v_mfma_f32_16x16x32_bf16 v[72:75], v[36:39], a[0:3], v[32:35]
    s_waitcnt vmcnt(6)
    v_mfma_f32_16x16x32_bf16 v[72:75], v[40:43], a[8:11], v[72:75]
    s_waitcnt vmcnt(5)
    v_mfma_f32_16x16x32_bf16 v[72:75], v[44:47], a[16:19], v[72:75]
    s_waitcnt vmcnt(4)
    v_mfma_f32_16x16x32_bf16 v[72:75], v[48:51], a[24:27], v[72:75]
    v_mfma_f32_16x16x32_bf16 v[84:87], v[36:39], a[4:7], v[32:35]
    v_mfma_f32_16x16x32_bf16 v[84:87], v[40:43], a[12:15], v[84:87]
    v_mfma_f32_16x16x32_bf16 v[84:87], v[44:47], a[20:23], v[84:87]
    v_mfma_f32_16x16x32_bf16 v[84:87], v[48:51], a[28:31], v[84:87]
    v_max3_f32 v100, v68, v69, v70
    s_nop 2
    v_max3_f32 v101, v71, v72, v73
    v_max3_f32 v102, v100, v74, v75
    v_max_f32 v100, v102, v101
    v_max_f32 v101, v102, v101
    v_max3_f32 v104, v76, v77, v78
    s_nop 0
    v_permlane16_swap_b32 v100, v101
    v_max_f32 v102, v100, v101
    v_max3_f32 v105, v79, v80, v81
    v_max_f32 v103, v100, v101
    s_nop 1
    v_permlane32_swap_b32 v102, v103
    v_max3_f32 v104, v104, v82, v83
    v_max_f32 v100, v102, v103
    v_mul_f32 v100, s53, v100
    v_max3_f32 v105, v105, v84, v85
    v_fma_f32 v68, v68, s54, v100
    v_fma_f32 v69, v69, s54, v100
    v_max3_f32 v106, v104, v86, v87
    v_fma_f32 v70, v70, s54, v100
    v_fma_f32 v71, v71, s54, v100
    v_max_f32 v104, v106, v105
    v_fma_f32 v72, v72, s54, v100
    v_fma_f32 v73, v73, s54, v100
    v_max_f32 v105, v106, v105
    v_fma_f32 v74, v74, s54, v100
    v_fma_f32 v75, v75, s54, v100
    v_permlane16_swap_b32 v104, v105
    v_exp_f32 v68, v68
    v_exp_f32 v69, v69
    v_max_f32 v106, v104, v105
    v_exp_f32 v70, v70
    v_exp_f32 v71, v71
    v_max_f32 v107, v104, v105
    v_exp_f32 v72, v72
    v_exp_f32 v73, v73
    v_permlane32_swap_b32 v106, v107
    v_exp_f32 v74, v74
    v_exp_f32 v75, v75
    v_max_f32 v104, v106, v107
    v_add_f32 v101, v68, v69
    v_add_f32 v102, v70, v71
    v_mul_f32 v104, s53, v104
    v_add_f32 v101, v101, v72
    v_add_f32 v102, v102, v73
    v_fma_f32 v76, v76, s54, v104
    v_add_f32 v101, v101, v74
    v_add_f32 v102, v102, v75
    v_fma_f32 v77, v77, s54, v104
    v_add_f32 v100, v102, v101
    v_add_f32 v101, v102, v101
    v_fma_f32 v78, v78, s54, v104
    s_nop 0
    v_permlane16_swap_b32 v100, v101
    v_add_f32 v102, v100, v101
    v_fma_f32 v79, v79, s54, v104
    v_add_f32 v103, v100, v101
    s_nop 1
    v_permlane32_swap_b32 v102, v103
    v_fma_f32 v80, v80, s54, v104
    v_add_f32 v100, v102, v103
    v_rcp_f32 v100, v100
    v_fma_f32 v81, v81, s54, v104
    v_mul_f32 v68, v68, v100
    v_mul_f32 v69, v69, v100
    v_fma_f32 v82, v82, s54, v104
    v_mul_f32 v70, v70, v100
    v_mul_f32 v71, v71, v100
    v_fma_f32 v83, v83, s54, v104
    v_mul_f32 v72, v72, v100
    v_mul_f32 v73, v73, v100
    v_fma_f32 v84, v84, s54, v104
    v_mul_f32 v74, v74, v100
    v_mul_f32 v75, v75, v100
    v_fma_f32 v85, v85, s54, v104
    v_cvt_pk_bf16_f32 v88, v68, v69
    v_cvt_pk_bf16_f32 v89, v70, v71
    v_fma_f32 v86, v86, s54, v104
    v_cvt_pk_bf16_f32 v90, v72, v73
    v_cvt_pk_bf16_f32 v91, v74, v75
    v_fma_f32 v87, v87, s54, v104
    s_waitcnt vmcnt(0)
    v_mfma_f32_16x16x16_bf16 v[108:111], a[64:65], v[88:89], 0
    v_exp_f32 v76, v76
    v_exp_f32 v77, v77
    v_mfma_f32_16x16x16_bf16 v[112:115], a[68:69], v[88:89], 0
    v_exp_f32 v78, v78
    v_exp_f32 v79, v79
    v_mfma_f32_16x16x16_bf16 v[116:119], a[72:73], v[88:89], 0
    v_exp_f32 v80, v80
    v_exp_f32 v81, v81
    v_mfma_f32_16x16x16_bf16 v[120:123], a[76:77], v[88:89], 0
    v_exp_f32 v82, v82
    v_exp_f32 v83, v83
    v_mfma_f32_16x16x16_bf16 v[124:127], a[80:81], v[88:89], 0
    v_exp_f32 v84, v84
    v_exp_f32 v85, v85
    v_mfma_f32_16x16x16_bf16 v[108:111], v[52:53], v[90:91], v[108:111]
    v_exp_f32 v86, v86
    v_exp_f32 v87, v87
    v_mfma_f32_16x16x16_bf16 v[128:131], a[84:85], v[88:89], 0
    v_add_f32 v105, v76, v77
    v_add_f32 v106, v78, v79
    v_add_f32 v105, v105, v80
    v_add_f32 v106, v106, v81
    v_mfma_f32_16x16x16_bf16 v[112:115], v[54:55], v[90:91], v[112:115]
    v_add_f32 v105, v105, v82
    v_add_f32 v106, v106, v83
    v_add_f32 v105, v105, v84
    v_add_f32 v106, v106, v85
    v_mfma_f32_16x16x16_bf16 v[132:135], a[88:89], v[88:89], 0
    v_add_f32 v105, v105, v86
    v_add_f32 v106, v106, v87
    v_add_f32 v104, v106, v105
    v_add_f32 v105, v106, v105
    v_mfma_f32_16x16x16_bf16 v[116:119], v[56:57], v[90:91], v[116:119]
    s_nop 0
    v_permlane16_swap_b32 v104, v105
    v_add_f32 v106, v104, v105
    v_add_f32 v107, v104, v105
    v_mfma_f32_16x16x16_bf16 v[136:139], a[92:93], v[88:89], 0
    s_nop 0
    v_permlane32_swap_b32 v106, v107
    v_add_f32 v104, v106, v107
    v_mfma_f32_16x16x16_bf16 v[120:123], v[58:59], v[90:91], v[120:123]
    v_rcp_f32 v104, v104
    s_nop 0
    v_mul_f32 v76, v76, v104
    v_mul_f32 v77, v77, v104
    v_mfma_f32_16x16x16_bf16 v[124:127], v[60:61], v[90:91], v[124:127]
    v_mul_f32 v78, v78, v104
    v_mul_f32 v79, v79, v104
    v_mul_f32 v80, v80, v104
    v_mul_f32 v81, v81, v104
    v_mfma_f32_16x16x16_bf16 v[128:131], v[62:63], v[90:91], v[128:131]
    v_mul_f32 v82, v82, v104
    v_mul_f32 v83, v83, v104
    v_mul_f32 v84, v84, v104
    v_mul_f32 v85, v85, v104
    v_mfma_f32_16x16x16_bf16 v[132:135], v[64:65], v[90:91], v[132:135]
    v_mul_f32 v86, v86, v104
    v_mul_f32 v87, v87, v104
    v_cvt_pk_bf16_f32 v92, v76, v77
    v_cvt_pk_bf16_f32 v93, v78, v79
    v_mfma_f32_16x16x16_bf16 v[136:139], v[66:67], v[90:91], v[136:139]
    v_cvt_pk_bf16_f32 v94, v80, v81
    v_cvt_pk_bf16_f32 v95, v82, v83
    v_cvt_pk_bf16_f32 v96, v84, v85
    v_cvt_pk_bf16_f32 v97, v86, v87
    v_mfma_f32_16x16x32_bf16 v[140:143], a[64:67], v[92:95], 0
    v_cvt_pk_bf16_f32 v172, v108, v109
    v_cvt_pk_bf16_f32 v173, v110, v111
    v_cvt_pk_bf16_f32 v174, v112, v113
    v_mfma_f32_16x16x32_bf16 v[144:147], a[68:71], v[92:95], 0
    v_cvt_pk_bf16_f32 v175, v114, v115
    v_mfma_f32_16x16x32_bf16 v[148:151], a[72:75], v[92:95], 0
    buffer_store_dwordx4 v[172:175], v4, s[4:7], s66 offen offset:0 sc1
    v_cvt_pk_bf16_f32 v176, v116, v117
    v_cvt_pk_bf16_f32 v177, v118, v119
    v_mfma_f32_16x16x32_bf16 v[152:155], a[76:79], v[92:95], 0
    v_cvt_pk_bf16_f32 v178, v120, v121
    v_cvt_pk_bf16_f32 v179, v122, v123
    v_mfma_f32_16x16x32_bf16 v[156:159], a[80:83], v[92:95], 0
    buffer_store_dwordx4 v[176:179], v4, s[4:7], s66 offen offset:2048 sc1
    v_cvt_pk_bf16_f32 v180, v124, v125
    v_cvt_pk_bf16_f32 v181, v126, v127
    v_mfma_f32_16x16x16_bf16 v[140:143], v[52:53], v[96:97], v[140:143]
    v_cvt_pk_bf16_f32 v182, v128, v129
    v_cvt_pk_bf16_f32 v183, v130, v131
    v_mfma_f32_16x16x32_bf16 v[160:163], a[84:87], v[92:95], 0
    buffer_store_dwordx4 v[180:183], v4, s[4:7], s95 offen offset:0 sc1
    v_cvt_pk_bf16_f32 v184, v132, v133
    v_cvt_pk_bf16_f32 v185, v134, v135
    v_mfma_f32_16x16x16_bf16 v[144:147], v[54:55], v[96:97], v[144:147]
    v_cvt_pk_bf16_f32 v186, v136, v137
    v_cvt_pk_bf16_f32 v187, v138, v139
    v_mfma_f32_16x16x32_bf16 v[164:167], a[88:91], v[92:95], 0
    buffer_store_dwordx4 v[184:187], v4, s[4:7], s95 offen offset:2048 sc1
    v_mfma_f32_16x16x16_bf16 v[148:151], v[56:57], v[96:97], v[148:151]
    v_mfma_f32_16x16x32_bf16 v[168:171], a[92:95], v[92:95], 0
    v_mfma_f32_16x16x16_bf16 v[152:155], v[58:59], v[96:97], v[152:155]
    v_mfma_f32_16x16x16_bf16 v[156:159], v[60:61], v[96:97], v[156:159]
    v_mfma_f32_16x16x16_bf16 v[160:163], v[62:63], v[96:97], v[160:163]
    v_cvt_pk_bf16_f32 v188, v140, v141
    v_cvt_pk_bf16_f32 v189, v142, v143
    v_cvt_pk_bf16_f32 v190, v144, v145
    v_mfma_f32_16x16x16_bf16 v[164:167], v[64:65], v[96:97], v[164:167]
    v_cvt_pk_bf16_f32 v191, v146, v147
    v_mfma_f32_16x16x16_bf16 v[168:171], v[66:67], v[96:97], v[168:171]
    buffer_store_dwordx4 v[188:191], v4, s[4:7], s66 offen offset:256 sc1
    v_cvt_pk_bf16_f32 v192, v148, v149
    v_cvt_pk_bf16_f32 v193, v150, v151
    v_cvt_pk_bf16_f32 v194, v152, v153
    v_cvt_pk_bf16_f32 v195, v154, v155
    buffer_store_dwordx4 v[192:195], v4, s[4:7], s66 offen offset:2304 sc1
    v_cvt_pk_bf16_f32 v196, v156, v157
    v_cvt_pk_bf16_f32 v197, v158, v159
    v_cvt_pk_bf16_f32 v198, v160, v161
    v_cvt_pk_bf16_f32 v199, v162, v163
    buffer_store_dwordx4 v[196:199], v4, s[4:7], s95 offen offset:256 sc1
    v_cvt_pk_bf16_f32 v200, v164, v165
    v_cvt_pk_bf16_f32 v201, v166, v167
    v_cvt_pk_bf16_f32 v202, v168, v169
    v_cvt_pk_bf16_f32 v203, v170, v171
    buffer_store_dwordx4 v[200:203], v4, s[4:7], s95 offen offset:2304 sc1
    s_lshl2_add_u32 s37, s21, s43
    s_add_u32 s21, s21, 1
    s_cmp_eq_u32 s21, 64
    s_cbranch_scc1 L_AT_done
    s_waitcnt lgkmcnt(0)
    s_min_u32 s68, s68, s69
    s_cmp_ge_u32 s68, s65
    s_cbranch_scc1 L_AT_fetch
    s_waitcnt vmcnt(0)
    buffer_atomic_add v5, v2, s[4:7], s37 offen
    s_mov_b32 s37, 268435456
    s_branch L_AT_slow
L_AT_done:
    s_waitcnt vmcnt(0)
    buffer_atomic_add v5, v2, s[4:7], s37 offen
    s_mov_b32 s37, 268435456
    s_endpgm
L_abort:
    v_mov_b32 v1, s3
    v_mov_b32 v2, 8
    buffer_store_dword v1, v2, s[12:15], 0 offen sc1
L_exit:
    s_endpgm
L_role_WO:
    v_mov_b32 v20, v0
    v_lshlrev_b32 v0, 4, v20
    v_mov_b32 v3, 0
    v_and_b32 v21, 15, v20
    v_lshlrev_b32 v21, 4, v21
    v_lshrrev_b32 v22, 4, v20
    v_lshl_add_u32 v19, v22, 9, v21
    v_mov_b32 v1, v0
    v_mov_b32 v6, v19
    v_add_u32 v7, 0x10000, v6
    v_add_u32 v8, 0x20000, v6
    s_mov_b32 s24, 0x55555400
    s_mov_b32 s25, 0x55555555
    s_mov_b32 s26, 0xaaaaaa55
    s_mov_b32 s27, 0xffeaaaaa
    s_lshr_b32 s48, s19, 3
    s_and_b32 s49, s19, 7
    s_mul_i32 s50, s48, 43
    s_min_u32 s50, s50, 85
    s_mul_i32 s60, s19, 640
    s_add_u32 s60, s60, 1654784
    s_and_b32 s61, s48, 1
    s_add_u32 s61, s61, 11
    s_mov_b32 s43, 1726464
    v_add_u32 v21, 0, v20
    v_mul_u32_u24 v21, 640, v21
    v_mov_b32 v22, 0x40000000
    v_cmp_gt_u32 vcc, 8, v20
    s_nop 1
    v_cndmask_b32 v2, v22, v21, vcc
    v_mov_b32 v5, 1
    s_lshl_b32 s92, s50, 11
    s_lshl_b32 s93, s18, 12
    s_add_u32 s42, s92, s93
    s_add_u32 s42, s42, 117440512
    s_lshl_b32 s92, s48, 16
    s_lshl_b32 s93, s49, 10
    s_add_u32 s92, s92, s93
    s_lshl_b32 s93, s18, 8
    s_add_u32 s92, s92, s93
    s_add_u32 s44, s92, 184549376
    v_bfe_u32 v21, v20, 2, 2
    v_lshlrev_b32 v21, 13, v21
    v_lshrrev_b32 v22, 4, v20
    v_lshl_add_u32 v21, v22, 6, v21
    v_and_b32 v22, 3, v20
    v_lshl_add_u32 v4, v22, 4, v21
    s_mov_b32 s93, 2048
    s_mul_i32 s94, s18, 16384
    s_and_b32 s95, s18, 1
    s_lshl_b32 s95, s95, 2
    v_lshrrev_b32 v24, 4, v20
    v_mul_lo_u32 v21, v24, s93
    v_and_b32 v22, 15, v20
    v_lshlrev_b32 v23, 2, v24
    v_xor_b32 v22, v22, v23
    v_lshl_add_u32 v21, v22, 4, v21
    v_add_u32 v31, s94, v21
    v_lshrrev_b32 v21, 3, v20
    v_mul_lo_u32 v21, v21, s93
    v_and_b32 v22, 7, v20
    v_and_b32 v23, 1, v24
    v_lshl_add_u32 v23, v23, 1, s95
    v_xor_b32 v22, v22, v23
    v_lshl_add_u32 v21, v22, 4, v21
    v_add_u32 v32, s94, v21
    v_bfe_u32 v25, v20, 2, 2
    v_and_b32 v22, 3, v20
    v_xor_b32 v26, s18, v25
    v_lshlrev_b32 v26, 6, v26
    v_lshl_add_u32 v26, v25, 8, v26
    v_add_u32 v26, 0, v26
    v_lshl_add_u32 v27, v24, 11, v26
    v_lshl_add_u32 v100, v22, 4, v27
    v_lshl_add_u32 v103, v22, 3, v27
    v_lshl_add_u32 v27, v24, 10, v26
    v_lshl_add_u32 v106, v22, 4, v27
    v_lshrrev_b32 v26, 1, v25
    v_and_b32 v27, 1, v24
    v_lshl_add_u32 v26, v27, 1, v26
    v_xor_b32 v26, s18, v26
    v_lshlrev_b32 v26, 5, v26
    v_lshl_add_u32 v26, v25, 7, v26
    v_lshl_add_u32 v26, v24, 10, v26
    v_lshl_add_u32 v26, v22, 3, v26
    v_add_u32 v109, 0, v26
    v_add_u32 v101, 0x10000, v100
    v_add_u32 v102, 0x20000, v100
    v_add_u32 v104, 0x10000, v103
    v_add_u32 v105, 0x20000, v103
    v_add_u32 v107, 0x10000, v106
    v_add_u32 v108, 0x20000, v106
    v_add_u32 v110, 0x10000, v109
    v_add_u32 v111, 0x20000, v109
    s_cmp_eq_u32 s79, 2
    s_cbranch_scc1 L_fl_18
    s_waitcnt vmcnt(0)
    s_barrier
    s_cmp_lg_u32 s18, 0
    s_cbranch_scc1 L_arr_19
    s_mov_b32 s3, 1
    s_buffer_atomic_add s3, s[12:15], 4 glc
    s_waitcnt lgkmcnt(0)
    s_add_u32 s3, s3, 1
    s_and_b32 s92, s3, 0xffff
    s_cmp_lg_u32 s92, 256
    s_cbranch_scc1 L_arr_19
    v_mov_b32 v20, s3
    v_lshlrev_b32 v21, 3, v0
    s_mov_b32 s92, 163840
    buffer_store_dword v20, v21, s[4:7], s92 offen sc1
    s_mov_b32 s92, 172032
    buffer_store_dword v20, v21, s[4:7], s92 offen sc1
    s_mov_b32 s92, 180224
    buffer_store_dword v20, v21, s[4:7], s92 offen sc1
    s_mov_b32 s92, 188416
    buffer_store_dword v20, v21, s[4:7], s92 offen sc1
    s_waitcnt vmcnt(0)
L_arr_19:
L_fl_18:
    s_mov_b32 s8, s74
    s_mov_b32 s9, s75
    s_mov_b32 s10, 8388608
    s_mov_b32 s11, 0x20000
    s_lshl_b32 s92, s50, 16
    s_lshl_b32 s93, s49, 8
    s_add_u32 s51, s92, s93
    s_lshl_b32 s46, s18, 11
    s_lshl_b32 s47, s18, 10
    s_add_u32 s92, s51, 0
    s_add_u32 m0, s46, 0
    s_nop 0
    buffer_load_dwordx4 v31, s[8:11], s92 offen lds
    s_add_u32 s92, s51, 8192
    s_add_u32 m0, s46, 1024
    s_nop 0
    buffer_load_dwordx4 v31, s[8:11], s92 offen lds
    s_add_u32 s92, s51, 65536
    s_add_u32 m0, s46, 8192
    s_nop 0
    buffer_load_dwordx4 v31, s[8:11], s92 offen lds
    s_add_u32 s92, s51, 73728
    s_add_u32 m0, s46, 9216
    s_nop 0
    buffer_load_dwordx4 v31, s[8:11], s92 offen lds
    s_add_u32 s92, s51, 131072
    s_add_u32 m0, s46, 16384
    s_nop 0
    buffer_load_dwordx4 v31, s[8:11], s92 offen lds
    s_add_u32 s92, s51, 139264
    s_add_u32 m0, s46, 17408
    s_nop 0
    buffer_load_dwordx4 v31, s[8:11], s92 offen lds
    s_add_u32 s92, s51, 196608
    s_add_u32 m0, s46, 24576
    s_nop 0
    buffer_load_dwordx4 v31, s[8:11], s92 offen lds
    s_add_u32 s92, s51, 204800
    s_add_u32 m0, s46, 25600
    s_nop 0
    buffer_load_dwordx4 v31, s[8:11], s92 offen lds
    s_add_u32 s92, s51, 262144
    s_add_u32 m0, s46, 32768
    s_nop 0
    buffer_load_dwordx4 v31, s[8:11], s92 offen lds
    s_add_u32 s92, s51, 270336
    s_add_u32 m0, s46, 33792
    s_nop 0
    buffer_load_dwordx4 v31, s[8:11], s92 offen lds
    s_add_u32 s92, s51, 327680
    s_add_u32 m0, s46, 40960
    s_nop 0
    buffer_load_dwordx4 v31, s[8:11], s92 offen lds
    s_add_u32 s92, s51, 335872
    s_add_u32 m0, s46, 41984
    s_nop 0
    buffer_load_dwordx4 v31, s[8:11], s92 offen lds
    s_add_u32 s92, s51, 393216
    s_add_u32 m0, s46, 49152
    s_nop 0
    buffer_load_dwordx4 v31, s[8:11], s92 offen lds
    s_add_u32 s92, s51, 401408
    s_add_u32 m0, s46, 50176
    s_nop 0
    buffer_load_dwordx4 v31, s[8:11], s92 offen lds
    s_add_u32 s92, s51, 458752
    s_add_u32 m0, s46, 57344
    s_nop 0
    buffer_load_dwordx4 v31, s[8:11], s92 offen lds
    s_add_u32 s92, s51, 466944
    s_add_u32 m0, s46, 58368
    s_nop 0
    buffer_load_dwordx4 v31, s[8:11], s92 offen lds
    s_add_u32 s92, s51, 524288
    s_add_u32 m0, s46, 65536
    s_nop 0
    buffer_load_dwordx4 v31, s[8:11], s92 offen lds
    s_add_u32 s92, s51, 532480
    s_add_u32 m0, s46, 66560
    s_nop 0
    buffer_load_dwordx4 v31, s[8:11], s92 offen lds
    s_add_u32 s92, s51, 589824
    s_add_u32 m0, s46, 73728
    s_nop 0
    buffer_load_dwordx4 v31, s[8:11], s92 offen lds
    s_add_u32 s92, s51, 598016
    s_add_u32 m0, s46, 74752
    s_nop 0
    buffer_load_dwordx4 v31, s[8:11], s92 offen lds
    s_add_u32 s92, s51, 655360
    s_add_u32 m0, s46, 81920
    s_nop 0
    buffer_load_dwordx4 v31, s[8:11], s92 offen lds
    s_add_u32 s92, s51, 663552
    s_add_u32 m0, s46, 82944
    s_nop 0
    buffer_load_dwordx4 v31, s[8:11], s92 offen lds
    s_add_u32 s92, s51, 720896
    s_add_u32 m0, s46, 90112
    s_nop 0
    buffer_load_dwordx4 v31, s[8:11], s92 offen lds
    s_add_u32 s92, s51, 729088
    s_add_u32 m0, s46, 91136
    s_nop 0
    buffer_load_dwordx4 v31, s[8:11], s92 offen lds
    s_waitcnt vmcnt(16)
    s_barrier
    s_add_u32 s92, s51, 786432
    s_add_u32 m0, s46, 98304
    s_nop 0
    buffer_load_dwordx4 v31, s[8:11], s92 offen lds
    s_add_u32 s92, s51, 794624
    s_add_u32 m0, s46, 99328
    s_nop 0
    buffer_load_dwordx4 v31, s[8:11], s92 offen lds
    s_add_u32 s92, s51, 851968
    s_add_u32 m0, s46, 106496
    s_nop 0
    buffer_load_dwordx4 v31, s[8:11], s92 offen lds
    s_add_u32 s92, s51, 860160
    s_add_u32 m0, s46, 107520
    s_nop 0
    buffer_load_dwordx4 v31, s[8:11], s92 offen lds
    s_add_u32 s92, s51, 917504
    s_add_u32 m0, s46, 114688
    s_nop 0
    buffer_load_dwordx4 v31, s[8:11], s92 offen lds
    s_add_u32 s92, s51, 925696
    s_add_u32 m0, s46, 115712
    s_nop 0
    buffer_load_dwordx4 v31, s[8:11], s92 offen lds
    s_add_u32 s92, s51, 983040
    s_add_u32 m0, s46, 122880
    s_nop 0
    buffer_load_dwordx4 v31, s[8:11], s92 offen lds
    s_add_u32 s92, s51, 991232
    s_add_u32 m0, s46, 123904
    s_nop 0
    buffer_load_dwordx4 v31, s[8:11], s92 offen lds
    ds_read_b64_tr_b16 a[0:1], v106 offset:0
    ds_read_b64_tr_b16 a[2:3], v106 offset:4096
    ds_read_b64_tr_b16 a[4:5], v106 offset:8
    ds_read_b64_tr_b16 a[6:7], v106 offset:4104
    ds_read_b64_tr_b16 a[8:9], v106 offset:8192
    ds_read_b64_tr_b16 a[10:11], v106 offset:12288
    ds_read_b64_tr_b16 a[12:13], v106 offset:8200
    ds_read_b64_tr_b16 a[14:15], v106 offset:12296
    ds_read_b64_tr_b16 a[16:17], v106 offset:16384
    ds_read_b64_tr_b16 a[18:19], v106 offset:20480
    ds_read_b64_tr_b16 a[20:21], v106 offset:16392
    ds_read_b64_tr_b16 a[22:23], v106 offset:20488
    ds_read_b64_tr_b16 a[24:25], v106 offset:24576
    ds_read_b64_tr_b16 a[26:27], v106 offset:28672
    ds_read_b64_tr_b16 a[28:29], v106 offset:24584
    ds_read_b64_tr_b16 a[30:31], v106 offset:28680
    s_waitcnt lgkmcnt(0)
    s_waitcnt vmcnt(16)
    s_barrier
    s_add_u32 s92, s51, 1048576
    s_add_u32 m0, s46, 0
    s_nop 0
    buffer_load_dwordx4 v31, s[8:11], s92 offen lds
    s_add_u32 s92, s51, 1056768
    s_add_u32 m0, s46, 1024
    s_nop 0
    buffer_load_dwordx4 v31, s[8:11], s92 offen lds
    s_add_u32 s92, s51, 1114112
    s_add_u32 m0, s46, 8192
    s_nop 0
    buffer_load_dwordx4 v31, s[8:11], s92 offen lds
    s_add_u32 s92, s51, 1122304
    s_add_u32 m0, s46, 9216
    s_nop 0
    buffer_load_dwordx4 v31, s[8:11], s92 offen lds
    s_add_u32 s92, s51, 1179648
    s_add_u32 m0, s46, 16384
    s_nop 0
    buffer_load_dwordx4 v31, s[8:11], s92 offen lds
    s_add_u32 s92, s51, 1187840
    s_add_u32 m0, s46, 17408
    s_nop 0
    buffer_load_dwordx4 v31, s[8:11], s92 offen lds
    s_add_u32 s92, s51, 1245184
    s_add_u32 m0, s46, 24576
    s_nop 0
    buffer_load_dwordx4 v31, s[8:11], s92 offen lds
    s_add_u32 s92, s51, 1253376
    s_add_u32 m0, s46, 25600
    s_nop 0
    buffer_load_dwordx4 v31, s[8:11], s92 offen lds
    ds_read_b64_tr_b16 a[32:33], v106 offset:32768
    ds_read_b64_tr_b16 a[34:35], v106 offset:36864
    ds_read_b64_tr_b16 a[36:37], v106 offset:32776
    ds_read_b64_tr_b16 a[38:39], v106 offset:36872
    ds_read_b64_tr_b16 a[40:41], v106 offset:40960
    ds_read_b64_tr_b16 a[42:43], v106 offset:45056
    ds_read_b64_tr_b16 a[44:45], v106 offset:40968
    ds_read_b64_tr_b16 a[46:47], v106 offset:45064
    ds_read_b64_tr_b16 a[48:49], v106 offset:49152
    ds_read_b64_tr_b16 a[50:51], v106 offset:53248
    ds_read_b64_tr_b16 a[52:53], v106 offset:49160
    ds_read_b64_tr_b16 a[54:55], v106 offset:53256
    ds_read_b64_tr_b16 a[56:57], v106 offset:57344
    ds_read_b64_tr_b16 a[58:59], v106 offset:61440
    ds_read_b64_tr_b16 a[60:61], v106 offset:57352
    ds_read_b64_tr_b16 a[62:63], v106 offset:61448
    s_waitcnt lgkmcnt(0)
    s_waitcnt vmcnt(16)
    s_barrier
    s_add_u32 s92, s51, 1310720
    s_add_u32 m0, s46, 32768
    s_nop 0
    buffer_load_dwordx4 v31, s[8:11], s92 offen lds
    s_add_u32 s92, s51, 1318912
    s_add_u32 m0, s46, 33792
    s_nop 0
    buffer_load_dwordx4 v31, s[8:11], s92 offen lds
    s_add_u32 s92, s51, 1376256
    s_add_u32 m0, s46, 40960
    s_nop 0
    buffer_load_dwordx4 v31, s[8:11], s92 offen lds
    s_add_u32 s92, s51, 1384448
    s_add_u32 m0, s46, 41984
    s_nop 0
    buffer_load_dwordx4 v31, s[8:11], s92 offen lds
    s_add_u32 s92, s51, 1441792
    s_add_u32 m0, s46, 49152
    s_nop 0
    buffer_load_dwordx4 v31, s[8:11], s92 offen lds
    s_add_u32 s92, s51, 1449984
    s_add_u32 m0, s46, 50176
    s_nop 0
    buffer_load_dwordx4 v31, s[8:11], s92 offen lds
    s_add_u32 s92, s51, 1507328
    s_add_u32 m0, s46, 57344
    s_nop 0
    buffer_load_dwordx4 v31, s[8:11], s92 offen lds
    s_add_u32 s92, s51, 1515520
    s_add_u32 m0, s46, 58368
    s_nop 0
    buffer_load_dwordx4 v31, s[8:11], s92 offen lds
    ds_read_b64_tr_b16 a[64:65], v107 offset:0
    ds_read_b64_tr_b16 a[66:67], v107 offset:4096
    ds_read_b64_tr_b16 a[68:69], v107 offset:8
    ds_read_b64_tr_b16 a[70:71], v107 offset:4104
    ds_read_b64_tr_b16 a[72:73], v107 offset:8192
    ds_read_b64_tr_b16 a[74:75], v107 offset:12288
    ds_read_b64_tr_b16 a[76:77], v107 offset:8200
    ds_read_b64_tr_b16 a[78:79], v107 offset:12296
    ds_read_b64_tr_b16 a[80:81], v107 offset:16384
    ds_read_b64_tr_b16 a[82:83], v107 offset:20480
    ds_read_b64_tr_b16 a[84:85], v107 offset:16392
    ds_read_b64_tr_b16 a[86:87], v107 offset:20488
    ds_read_b64_tr_b16 a[88:89], v107 offset:24576
    ds_read_b64_tr_b16 a[90:91], v107 offset:28672
    ds_read_b64_tr_b16 a[92:93], v107 offset:24584
    ds_read_b64_tr_b16 a[94:95], v107 offset:28680
    s_waitcnt lgkmcnt(0)
    s_waitcnt vmcnt(16)
    s_barrier
    s_add_u32 s92, s51, 1572864
    s_add_u32 m0, s46, 65536
    s_nop 0
    buffer_load_dwordx4 v31, s[8:11], s92 offen lds
    s_add_u32 s92, s51, 1581056
    s_add_u32 m0, s46, 66560
    s_nop 0
    buffer_load_dwordx4 v31, s[8:11], s92 offen lds
    s_add_u32 s92, s51, 1638400
    s_add_u32 m0, s46, 73728
    s_nop 0
    buffer_load_dwordx4 v31, s[8:11], s92 offen lds
    s_add_u32 s92, s51, 1646592
    s_add_u32 m0, s46, 74752
    s_nop 0
    buffer_load_dwordx4 v31, s[8:11], s92 offen lds
    s_add_u32 s92, s51, 1703936
    s_add_u32 m0, s46, 81920
    s_nop 0
    buffer_load_dwordx4 v31, s[8:11], s92 offen lds
    s_add_u32 s92, s51, 1712128
    s_add_u32 m0, s46, 82944
    s_nop 0
    buffer_load_dwordx4 v31, s[8:11], s92 offen lds
    s_add_u32 s92, s51, 1769472
    s_add_u32 m0, s46, 90112
    s_nop 0
    buffer_load_dwordx4 v31, s[8:11], s92 offen lds
    s_add_u32 s92, s51, 1777664
    s_add_u32 m0, s46, 91136
    s_nop 0
    buffer_load_dwordx4 v31, s[8:11], s92 offen lds
    ds_read_b64_tr_b16 a[96:97], v107 offset:32768
    ds_read_b64_tr_b16 a[98:99], v107 offset:36864
    ds_read_b64_tr_b16 a[100:101], v107 offset:32776
    ds_read_b64_tr_b16 a[102:103], v107 offset:36872
    ds_read_b64_tr_b16 a[104:105], v107 offset:40960
    ds_read_b64_tr_b16 a[106:107], v107 offset:45056
    ds_read_b64_tr_b16 a[108:109], v107 offset:40968
    ds_read_b64_tr_b16 a[110:111], v107 offset:45064
    ds_read_b64_tr_b16 a[112:113], v107 offset:49152
    ds_read_b64_tr_b16 a[114:115], v107 offset:53248
    ds_read_b64_tr_b16 a[116:117], v107 offset:49160
    ds_read_b64_tr_b16 a[118:119], v107 offset:53256
    ds_read_b64_tr_b16 a[120:121], v107 offset:57344
    ds_read_b64_tr_b16 a[122:123], v107 offset:61440
    ds_read_b64_tr_b16 a[124:125], v107 offset:57352
    ds_read_b64_tr_b16 a[126:127], v107 offset:61448
    s_waitcnt lgkmcnt(0)
    s_waitcnt vmcnt(16)
    s_barrier
    s_add_u32 s92, s51, 1835008
    s_add_u32 m0, s46, 98304
    s_nop 0
    buffer_load_dwordx4 v31, s[8:11], s92 offen lds
    s_add_u32 s92, s51, 1843200
    s_add_u32 m0, s46, 99328
    s_nop 0
    buffer_load_dwordx4 v31, s[8:11], s92 offen lds
    s_add_u32 s92, s51, 1900544
    s_add_u32 m0, s46, 106496
    s_nop 0
    buffer_load_dwordx4 v31, s[8:11], s92 offen lds
    s_add_u32 s92, s51, 1908736
    s_add_u32 m0, s46, 107520
    s_nop 0
    buffer_load_dwordx4 v31, s[8:11], s92 offen lds
    s_add_u32 s92, s51, 1966080
    s_add_u32 m0, s46, 114688
    s_nop 0
    buffer_load_dwordx4 v31, s[8:11], s92 offen lds
    s_add_u32 s92, s51, 1974272
    s_add_u32 m0, s46, 115712
    s_nop 0
    buffer_load_dwordx4 v31, s[8:11], s92 offen lds
    s_add_u32 s92, s51, 2031616
    s_add_u32 m0, s46, 122880
    s_nop 0
    buffer_load_dwordx4 v31, s[8:11], s92 offen lds
    s_add_u32 s92, s51, 2039808
    s_add_u32 m0, s46, 123904
    s_nop 0
    buffer_load_dwordx4 v31, s[8:11], s92 offen lds
    ds_read_b64_tr_b16 a[128:129], v106 offset:0
    ds_read_b64_tr_b16 a[130:131], v106 offset:4096
    ds_read_b64_tr_b16 a[132:133], v106 offset:8
    ds_read_b64_tr_b16 a[134:135], v106 offset:4104
    ds_read_b64_tr_b16 a[136:137], v106 offset:8192
    ds_read_b64_tr_b16 a[138:139], v106 offset:12288
    ds_read_b64_tr_b16 a[140:141], v106 offset:8200
    ds_read_b64_tr_b16 a[142:143], v106 offset:12296
    ds_read_b64_tr_b16 a[144:145], v106 offset:16384
    ds_read_b64_tr_b16 a[146:147], v106 offset:20480
    ds_read_b64_tr_b16 a[148:149], v106 offset:16392
    ds_read_b64_tr_b16 a[150:151], v106 offset:20488
    ds_read_b64_tr_b16 a[152:153], v106 offset:24576
    ds_read_b64_tr_b16 a[154:155], v106 offset:28672
    ds_read_b64_tr_b16 a[156:157], v106 offset:24584
    ds_read_b64_tr_b16 a[158:159], v106 offset:28680
    s_waitcnt lgkmcnt(0)
    s_waitcnt vmcnt(16)
    s_barrier
    s_add_u32 s92, s51, 2097152
    s_add_u32 m0, s46, 0
    s_nop 0
    buffer_load_dwordx4 v31, s[8:11], s92 offen lds
    s_add_u32 s92, s51, 2105344
    s_add_u32 m0, s46, 1024
    s_nop 0
    buffer_load_dwordx4 v31, s[8:11], s92 offen lds
    s_add_u32 s92, s51, 2162688
    s_add_u32 m0, s46, 8192
    s_nop 0
    buffer_load_dwordx4 v31, s[8:11], s92 offen lds
    s_add_u32 s92, s51, 2170880
    s_add_u32 m0, s46, 9216
    s_nop 0
    buffer_load_dwordx4 v31, s[8:11], s92 offen lds
    s_add_u32 s92, s51, 2228224
    s_add_u32 m0, s46, 16384
    s_nop 0
    buffer_load_dwordx4 v31, s[8:11], s92 offen lds
    s_add_u32 s92, s51, 2236416
    s_add_u32 m0, s46, 17408
    s_nop 0
    buffer_load_dwordx4 v31, s[8:11], s92 offen lds
    s_add_u32 s92, s51, 2293760
    s_add_u32 m0, s46, 24576
    s_nop 0
    buffer_load_dwordx4 v31, s[8:11], s92 offen lds
    s_add_u32 s92, s51, 2301952
    s_add_u32 m0, s46, 25600
    s_nop 0
    buffer_load_dwordx4 v31, s[8:11], s92 offen lds
    ds_read_b64_tr_b16 a[160:161], v106 offset:32768
    ds_read_b64_tr_b16 a[162:163], v106 offset:36864
    ds_read_b64_tr_b16 a[164:165], v106 offset:32776
    ds_read_b64_tr_b16 a[166:167], v106 offset:36872
    ds_read_b64_tr_b16 a[168:169], v106 offset:40960
    ds_read_b64_tr_b16 a[170:171], v106 offset:45056
    ds_read_b64_tr_b16 a[172:173], v106 offset:40968
    ds_read_b64_tr_b16 a[174:175], v106 offset:45064
    ds_read_b64_tr_b16 a[176:177], v106 offset:49152
    ds_read_b64_tr_b16 a[178:179], v106 offset:53248
    ds_read_b64_tr_b16 a[180:181], v106 offset:49160
    ds_read_b64_tr_b16 a[182:183], v106 offset:53256
    ds_read_b64_tr_b16 a[184:185], v106 offset:57344
    ds_read_b64_tr_b16 a[186:187], v106 offset:61440
    ds_read_b64_tr_b16 a[188:189], v106 offset:57352
    ds_read_b64_tr_b16 a[190:191], v106 offset:61448
    s_waitcnt lgkmcnt(0)
    s_waitcnt vmcnt(16)
    s_barrier
    s_add_u32 s92, s51, 2359296
    s_add_u32 m0, s46, 32768
    s_nop 0
    buffer_load_dwordx4 v31, s[8:11], s92 offen lds
    s_add_u32 s92, s51, 2367488
    s_add_u32 m0, s46, 33792
    s_nop 0
    buffer_load_dwordx4 v31, s[8:11], s92 offen lds
    s_add_u32 s92, s51, 2424832
    s_add_u32 m0, s46, 40960
    s_nop 0
    buffer_load_dwordx4 v31, s[8:11], s92 offen lds
    s_add_u32 s92, s51, 2433024
    s_add_u32 m0, s46, 41984
    s_nop 0
    buffer_load_dwordx4 v31, s[8:11], s92 offen lds
    s_add_u32 s92, s51, 2490368
    s_add_u32 m0, s46, 49152
    s_nop 0
    buffer_load_dwordx4 v31, s[8:11], s92 offen lds
    s_add_u32 s92, s51, 2498560
    s_add_u32 m0, s46, 50176
    s_nop 0
    buffer_load_dwordx4 v31, s[8:11], s92 offen lds
    s_add_u32 s92, s51, 2555904
    s_add_u32 m0, s46, 57344
    s_nop 0
    buffer_load_dwordx4 v31, s[8:11], s92 offen lds
    s_add_u32 s92, s51, 2564096
    s_add_u32 m0, s46, 58368
    s_nop 0
    buffer_load_dwordx4 v31, s[8:11], s92 offen lds
    ds_read_b64_tr_b16 a[192:193], v107 offset:0
    ds_read_b64_tr_b16 a[194:195], v107 offset:4096
    ds_read_b64_tr_b16 a[196:197], v107 offset:8
    ds_read_b64_tr_b16 a[198:199], v107 offset:4104
    ds_read_b64_tr_b16 a[200:201], v107 offset:8192
    ds_read_b64_tr_b16 a[202:203], v107 offset:12288
    ds_read_b64_tr_b16 a[204:205], v107 offset:8200
    ds_read_b64_tr_b16 a[206:207], v107 offset:12296
    ds_read_b64_tr_b16 a[208:209], v107 offset:16384
    ds_read_b64_tr_b16 a[210:211], v107 offset:20480
    ds_read_b64_tr_b16 a[212:213], v107 offset:16392
    ds_read_b64_tr_b16 a[214:215], v107 offset:20488
    ds_read_b64_tr_b16 a[216:217], v107 offset:24576
    ds_read_b64_tr_b16 a[218:219], v107 offset:28672
    ds_read_b64_tr_b16 a[220:221], v107 offset:24584
    ds_read_b64_tr_b16 a[222:223], v107 offset:28680
    s_waitcnt lgkmcnt(0)
    s_waitcnt vmcnt(16)
    s_barrier
    s_add_u32 s92, s51, 2621440
    s_add_u32 m0, s46, 65536
    s_nop 0
    buffer_load_dwordx4 v31, s[8:11], s92 offen lds
    s_add_u32 s92, s51, 2629632
    s_add_u32 m0, s46, 66560
    s_nop 0
    buffer_load_dwordx4 v31, s[8:11], s92 offen lds
    s_add_u32 s92, s51, 2686976
    s_add_u32 m0, s46, 73728
    s_nop 0
    buffer_load_dwordx4 v31, s[8:11], s92 offen lds
    s_add_u32 s92, s51, 2695168
    s_add_u32 m0, s46, 74752
    s_nop 0
    buffer_load_dwordx4 v31, s[8:11], s92 offen lds
    s_add_u32 s92, s51, 2752512
    s_add_u32 m0, s46, 81920
    s_nop 0
    buffer_load_dwordx4 v31, s[8:11], s92 offen lds
    s_add_u32 s92, s51, 2760704
    s_add_u32 m0, s46, 82944
    s_nop 0
    buffer_load_dwordx4 v31, s[8:11], s92 offen lds
    ds_read_b64_tr_b16 a[224:225], v107 offset:32768
    ds_read_b64_tr_b16 a[226:227], v107 offset:36864
    ds_read_b64_tr_b16 a[228:229], v107 offset:32776
    ds_read_b64_tr_b16 a[230:231], v107 offset:36872
    ds_read_b64_tr_b16 a[232:233], v107 offset:40960
    ds_read_b64_tr_b16 a[234:235], v107 offset:45056
    ds_read_b64_tr_b16 a[236:237], v107 offset:40968
    ds_read_b64_tr_b16 a[238:239], v107 offset:45064
    ds_read_b64_tr_b16 a[240:241], v107 offset:49152
    ds_read_b64_tr_b16 a[242:243], v107 offset:53248
    ds_read_b64_tr_b16 a[244:245], v107 offset:49160
    ds_read_b64_tr_b16 a[246:247], v107 offset:53256
    ds_read_b64_tr_b16 a[248:249], v107 offset:57344
    ds_read_b64_tr_b16 a[250:251], v107 offset:61440
    ds_read_b64_tr_b16 a[252:253], v107 offset:57352
    ds_read_b64_tr_b16 a[254:255], v107 offset:61448
    s_waitcnt lgkmcnt(0)
    s_waitcnt vmcnt(14)
    s_barrier
    ds_read_b64_tr_b16 v[128:129], v106 offset:0
    ds_read_b64_tr_b16 v[130:131], v106 offset:4096
    ds_read_b64_tr_b16 v[132:133], v106 offset:8
    ds_read_b64_tr_b16 v[134:135], v106 offset:4104
    ds_read_b64_tr_b16 v[136:137], v106 offset:8192
    ds_read_b64_tr_b16 v[138:139], v106 offset:12288
    ds_read_b64_tr_b16 v[140:141], v106 offset:8200
    ds_read_b64_tr_b16 v[142:143], v106 offset:12296
    ds_read_b64_tr_b16 v[144:145], v106 offset:16384
    ds_read_b64_tr_b16 v[146:147], v106 offset:20480
    ds_read_b64_tr_b16 v[148:149], v106 offset:16392
    ds_read_b64_tr_b16 v[150:151], v106 offset:20488
    ds_read_b64_tr_b16 v[152:153], v106 offset:24576
    ds_read_b64_tr_b16 v[154:155], v106 offset:28672
    ds_read_b64_tr_b16 v[156:157], v106 offset:24584
    ds_read_b64_tr_b16 v[158:159], v106 offset:28680
    s_waitcnt lgkmcnt(0)
    s_waitcnt vmcnt(6)
    s_barrier
    ds_read_b64_tr_b16 v[160:161], v106 offset:32768
    ds_read_b64_tr_b16 v[162:163], v106 offset:36864
    ds_read_b64_tr_b16 v[164:165], v106 offset:32776
    ds_read_b64_tr_b16 v[166:167], v106 offset:36872
    ds_read_b64_tr_b16 v[168:169], v106 offset:40960
    ds_read_b64_tr_b16 v[170:171], v106 offset:45056
    ds_read_b64_tr_b16 v[172:173], v106 offset:40968
    ds_read_b64_tr_b16 v[174:175], v106 offset:45064
    ds_read_b64_tr_b16 v[176:177], v106 offset:49152
    ds_read_b64_tr_b16 v[178:179], v106 offset:53248
    ds_read_b64_tr_b16 v[180:181], v106 offset:49160
    ds_read_b64_tr_b16 v[182:183], v106 offset:53256
    ds_read_b64_tr_b16 v[184:185], v106 offset:57344
    ds_read_b64_tr_b16 v[186:187], v106 offset:61440
    ds_read_b64_tr_b16 v[188:189], v106 offset:57352
    ds_read_b64_tr_b16 v[190:191], v106 offset:61448
    s_waitcnt lgkmcnt(0)
    s_waitcnt vmcnt(0)
    s_barrier
    ds_read_b64_tr_b16 v[192:193], v107 offset:0
    ds_read_b64_tr_b16 v[194:195], v107 offset:4096
    ds_read_b64_tr_b16 v[196:197], v107 offset:8
    ds_read_b64_tr_b16 v[198:199], v107 offset:4104
    ds_read_b64_tr_b16 v[200:201], v107 offset:8192
    ds_read_b64_tr_b16 v[202:203], v107 offset:12288
    ds_read_b64_tr_b16 v[204:205], v107 offset:8200
    ds_read_b64_tr_b16 v[206:207], v107 offset:12296
    ds_read_b64_tr_b16 v[208:209], v107 offset:16384
    ds_read_b64_tr_b16 v[210:211], v107 offset:20480
    ds_read_b64_tr_b16 v[212:213], v107 offset:16392
    ds_read_b64_tr_b16 v[214:215], v107 offset:20488
    s_waitcnt lgkmcnt(0)
    s_cmp_lt_u32 s48, 2
    s_cbranch_scc1 L_z_20
    v_accvgpr_write_b32 a0, 0
    v_accvgpr_write_b32 a1, 0
    v_accvgpr_write_b32 a2, 0
    v_accvgpr_write_b32 a3, 0
    v_accvgpr_write_b32 a4, 0
    v_accvgpr_write_b32 a5, 0
    v_accvgpr_write_b32 a6, 0
    v_accvgpr_write_b32 a7, 0
L_z_20:
    s_lshl_b32 s93, s16, 5
    s_add_u32 s93, s93, s17
    s_lshl_b32 s93, s93, 7
    s_add_u32 s93, s93, 163840
    s_mov_b32 s3, 0
L_ws_21:
    s_buffer_load_dword s92, s[4:7], s93 glc
    s_waitcnt lgkmcnt(0)
    s_cmp_lg_u32 s92, 0
    s_cbranch_scc1 L_wsd_22
    s_add_u32 s3, s3, 1
    s_cmp_lt_u32 s3, 40000
    s_cbranch_scc1 L_ws_21
    s_mov_b32 s3, 14
    s_branch L_abort
L_wsd_22:
    s_add_u32 s45, s44, 32768
    s_mul_i32 s46, s18, -4096
    s_mul_i32 s47, s18, 4096
    s_mul_i32 s96, s18, -3072
    s_lshl_b32 s97, s18, 10
    s_mov_b32 s20, 0
    s_mov_b32 s21, 0
    s_mov_b32 s22, 0
    s_mov_b32 s34, 0
    s_mov_b32 s35, 0
    s_mov_b32 s36, 0
    s_cmp_lt_u32 s20, 64
    s_cselect_b64 s[88:89], s[24:25], s[26:27]
    s_bitcmp1_b64 s[88:89], s20
    s_cselect_b32 s28, 1, 0
    s_cselect_b32 s29, s22, s21
    s_add_u32 s22, s22, s28
    s_xor_b32 s88, s28, 1
    s_add_u32 s21, s21, s88
    s_lshl_b32 s30, s28, 6
    s_add_u32 s30, s30, s29
    s_and_b32 s31, s30, 95
    s_mul_i32 s31, s31, 262144
    s_add_u32 s31, s31, s42
    s_lshl2_add_u32 s33, s30, s60
    s_cmp_lt_u32 s20, 128
    s_cselect_b32 s31, s31, 268435456
    s_cselect_b32 s32, s61, 0
    s_add_u32 s20, s20, 1
    s_barrier
    v_mov_b32 v9, 2048
    s_lshl_b32 s92, s18, 2
    v_add_u32 v11, s92, v9
    ds_write_b32 v11, v3
    s_mov_b32 s58, 268435456
    s_mov_b32 s59, -1
    s_cmp_eq_u32 s18, 0
    s_cselect_b32 s57, -1, 0
    s_cselect_b32 s43, s43, 268435456
    s_branch L_WO_ss1
L_WO_top0:
    s_waitcnt lgkmcnt(4)
    v_mfma_f32_16x16x32_bf16 v[16:19], a[0:3], v[64:67], 0
    ds_read_b128 v[88:91], v7 offset:18432
    v_mfma_f32_16x16x32_bf16 v[24:27], a[0:3], v[68:71], 0
    ds_read_b128 v[92:95], v7 offset:18688
    v_mfma_f32_16x16x32_bf16 v[28:31], a[4:7], v[68:71], 0
    s_and_b32 s86, s36, 95
    s_mul_i32 s86, s86, 196608
    s_add_u32 s87, s86, s45
    v_mfma_f32_16x16x32_bf16 v[20:23], a[4:7], v[64:67], 0
    s_waitcnt lgkmcnt(4)
    s_add_u32 s86, s86, s44
    v_cvt_pk_bf16_f32 v96, v40, v41
    v_mfma_f32_16x16x32_bf16 v[16:19], a[8:11], v[72:75], v[16:19]
    ds_read_b128 v[216:219], v7 offset:12288
    v_cvt_pk_bf16_f32 v97, v42, v43
    v_mfma_f32_16x16x32_bf16 v[24:27], a[8:11], v[76:79], v[24:27]
    ds_read_b128 v[220:223], v7 offset:12544
    v_cvt_pk_bf16_f32 v98, v44, v45
    v_mfma_f32_16x16x32_bf16 v[28:31], a[12:15], v[76:79], v[28:31]
    s_lshl2_add_u32 s37, s36, s43
    v_cvt_pk_bf16_f32 v99, v46, v47
    s_mov_b32 s34, s28
    v_mfma_f32_16x16x32_bf16 v[20:23], a[12:15], v[72:75], v[20:23]
    s_waitcnt lgkmcnt(2)
    s_mov_b32 s35, s29
    s_mov_b32 s36, s30
    v_mfma_f32_16x16x32_bf16 v[16:19], a[16:19], v[80:83], v[16:19]
    ds_read_b128 v[64:67], v7 offset:14336
    s_add_u32 s59, s59, 1
    v_mfma_f32_16x16x32_bf16 v[24:27], a[16:19], v[84:87], v[24:27]
    ds_read_b128 v[68:71], v7 offset:14592
    v_mfma_f32_16x16x32_bf16 v[28:31], a[20:23], v[84:87], v[28:31]
    buffer_store_dwordx4 v[96:99], v4, s[4:7], s86 offen sc1
    v_cvt_pk_bf16_f32 v100, v48, v49
    v_mfma_f32_16x16x32_bf16 v[20:23], a[20:23], v[80:83], v[20:23]
    s_cmp_lt_u32 s20, 64
    s_cselect_b64 s[88:89], s[24:25], s[26:27]
    v_cvt_pk_bf16_f32 v101, v50, v51
    v_mfma_f32_16x16x32_bf16 v[16:19], a[24:27], v[88:91], v[16:19]
    ds_read_b128 v[72:75], v7 offset:8192
    v_cvt_pk_bf16_f32 v102, v52, v53
    v_mfma_f32_16x16x32_bf16 v[24:27], a[24:27], v[92:95], v[24:27]
    ds_read_b128 v[76:79], v7 offset:8448
    v_cvt_pk_bf16_f32 v103, v54, v55
    v_mfma_f32_16x16x32_bf16 v[28:31], a[28:31], v[92:95], v[28:31]
    buffer_store_dwordx4 v[100:103], v4, s[4:7], s87 offen sc1
    v_mfma_f32_16x16x32_bf16 v[20:23], a[28:31], v[88:91], v[20:23]
    s_waitcnt lgkmcnt(2)
    v_mfma_f32_16x16x32_bf16 v[16:19], a[32:35], v[216:219], v[16:19]
    ds_read_b128 v[80:83], v7 offset:10240
    v_mfma_f32_16x16x32_bf16 v[24:27], a[32:35], v[220:223], v[24:27]
    ds_read_b128 v[84:87], v7 offset:10496
    v_mfma_f32_16x16x32_bf16 v[28:31], a[36:39], v[220:223], v[28:31]
    s_bitcmp1_b64 s[88:89], s20
    s_cselect_b32 s28, 1, 0
    s_cselect_b32 s29, s22, s21
    v_mfma_f32_16x16x32_bf16 v[20:23], a[36:39], v[216:219], v[20:23]
    s_add_u32 s22, s22, s28
    s_xor_b32 s88, s28, 1
    s_add_u32 s21, s21, s88
    v_mfma_f32_16x16x32_bf16 v[16:19], a[40:43], v[64:67], v[16:19]
    ds_read_b128 v[88:91], v7 offset:4096
    s_lshl_b32 s30, s28, 6
    v_mfma_f32_16x16x32_bf16 v[24:27], a[40:43], v[68:71], v[24:27]
    ds_read_b128 v[92:95], v7 offset:4352
    s_add_u32 s30, s30, s29
    v_mfma_f32_16x16x32_bf16 v[28:31], a[44:47], v[68:71], v[28:31]
    s_and_b32 s31, s30, 95
    s_mul_i32 s31, s31, 262144
    s_add_u32 s31, s31, s42
    v_mfma_f32_16x16x32_bf16 v[20:23], a[44:47], v[64:67], v[20:23]
    s_waitcnt lgkmcnt(2)
    s_lshl2_add_u32 s33, s30, s60
    v_mfma_f32_16x16x32_bf16 v[16:19], a[48:51], v[72:75], v[16:19]
    ds_read_b128 v[216:219], v7 offset:6144
    v_mfma_f32_16x16x32_bf16 v[24:27], a[48:51], v[76:79], v[24:27]
    ds_read_b128 v[220:223], v7 offset:6400
    v_mfma_f32_16x16x32_bf16 v[28:31], a[52:55], v[76:79], v[28:31]
    s_cmp_lt_u32 s20, 128
    s_cselect_b32 s31, s31, 268435456
    s_cselect_b32 s32, s61, 0
    v_mfma_f32_16x16x32_bf16 v[20:23], a[52:55], v[72:75], v[20:23]
    s_add_u32 s20, s20, 1
    s_andn2_b32 s23, s34, s28
    v_mfma_f32_16x16x32_bf16 v[16:19], a[56:59], v[80:83], v[16:19]
    ds_read_b128 v[64:67], v7 offset:0
    v_mfma_f32_16x16x32_bf16 v[24:27], a[56:59], v[84:87], v[24:27]
    ds_read_b128 v[68:71], v7 offset:256
    v_mfma_f32_16x16x32_bf16 v[28:31], a[60:63], v[84:87], v[28:31]
    v_mfma_f32_16x16x32_bf16 v[20:23], a[60:63], v[80:83], v[20:23]
    s_waitcnt lgkmcnt(2)
    v_mfma_f32_16x16x32_bf16 v[16:19], a[64:67], v[88:91], v[16:19]
    ds_read_b128 v[72:75], v7 offset:2048
    v_mfma_f32_16x16x32_bf16 v[24:27], a[64:67], v[92:95], v[24:27]
    ds_read_b128 v[76:79], v7 offset:2304
    v_mfma_f32_16x16x32_bf16 v[28:31], a[68:71], v[92:95], v[28:31]
    v_mfma_f32_16x16x32_bf16 v[20:23], a[68:71], v[88:91], v[20:23]
    s_buffer_load_dword s62, s[4:7], s33 glc
    v_mfma_f32_16x16x32_bf16 v[16:19], a[72:75], v[216:219], v[16:19]
    ds_read_b128 v[80:83], v6 offset:61440
    v_mfma_f32_16x16x32_bf16 v[24:27], a[72:75], v[220:223], v[24:27]
    ds_read_b128 v[84:87], v6 offset:61696
    v_mfma_f32_16x16x32_bf16 v[28:31], a[76:79], v[220:223], v[28:31]
    v_mfma_f32_16x16x32_bf16 v[20:23], a[76:79], v[216:219], v[20:23]
    s_waitcnt lgkmcnt(4)
    v_mfma_f32_16x16x32_bf16 v[16:19], a[80:83], v[64:67], v[16:19]
    ds_read_b128 v[88:91], v6 offset:63488
    v_mfma_f32_16x16x32_bf16 v[24:27], a[80:83], v[68:71], v[24:27]
    ds_read_b128 v[92:95], v6 offset:63744
    v_mfma_f32_16x16x32_bf16 v[28:31], a[84:87], v[68:71], v[28:31]
    v_mfma_f32_16x16x32_bf16 v[20:23], a[84:87], v[64:67], v[20:23]
    s_waitcnt lgkmcnt(4)
    v_mfma_f32_16x16x32_bf16 v[16:19], a[88:91], v[72:75], v[16:19]
    ds_read_b128 v[64:67], v6 offset:57344
    v_mfma_f32_16x16x32_bf16 v[24:27], a[88:91], v[76:79], v[24:27]
    ds_read_b128 v[68:71], v6 offset:57600
    v_mfma_f32_16x16x32_bf16 v[28:31], a[92:95], v[76:79], v[28:31]
    v_mfma_f32_16x16x32_bf16 v[20:23], a[92:95], v[72:75], v[20:23]
    s_waitcnt lgkmcnt(4)
    v_mfma_f32_16x16x32_bf16 v[16:19], a[96:99], v[80:83], v[16:19]
    ds_read_b128 v[72:75], v6 offset:59392
    v_mfma_f32_16x16x32_bf16 v[24:27], a[96:99], v[84:87], v[24:27]
    ds_read_b128 v[76:79], v6 offset:59648
    v_mfma_f32_16x16x32_bf16 v[28:31], a[100:103], v[84:87], v[28:31]
    v_mfma_f32_16x16x32_bf16 v[20:23], a[100:103], v[80:83], v[20:23]
    s_waitcnt lgkmcnt(4)
    v_mfma_f32_16x16x32_bf16 v[16:19], a[104:107], v[88:91], v[16:19]
    ds_read_b128 v[80:83], v6 offset:53248
    v_mfma_f32_16x16x32_bf16 v[24:27], a[104:107], v[92:95], v[24:27]
    ds_read_b128 v[84:87], v6 offset:53504
    v_mfma_f32_16x16x32_bf16 v[28:31], a[108:111], v[92:95], v[28:31]
    v_mfma_f32_16x16x32_bf16 v[20:23], a[108:111], v[88:91], v[20:23]
    s_waitcnt lgkmcnt(4)
    v_mfma_f32_16x16x32_bf16 v[16:19], a[112:115], v[64:67], v[16:19]
    ds_read_b128 v[88:91], v6 offset:55296
    v_mfma_f32_16x16x32_bf16 v[24:27], a[112:115], v[68:71], v[24:27]
    ds_read_b128 v[92:95], v6 offset:55552
    v_mfma_f32_16x16x32_bf16 v[28:31], a[116:119], v[68:71], v[28:31]
    v_mfma_f32_16x16x32_bf16 v[20:23], a[116:119], v[64:67], v[20:23]
    s_waitcnt lgkmcnt(4)
    v_mfma_f32_16x16x32_bf16 v[16:19], a[120:123], v[72:75], v[16:19]
    ds_read_b128 v[64:67], v6 offset:49152
    v_mfma_f32_16x16x32_bf16 v[24:27], a[120:123], v[76:79], v[24:27]
    ds_read_b128 v[68:71], v6 offset:49408
    v_mfma_f32_16x16x32_bf16 v[28:31], a[124:127], v[76:79], v[28:31]
    v_mfma_f32_16x16x32_bf16 v[20:23], a[124:127], v[72:75], v[20:23]
    s_waitcnt lgkmcnt(4)
    v_mfma_f32_16x16x32_bf16 v[16:19], a[128:131], v[80:83], v[16:19]
    ds_read_b128 v[72:75], v6 offset:51200
    v_mfma_f32_16x16x32_bf16 v[24:27], a[128:131], v[84:87], v[24:27]
    ds_read_b128 v[76:79], v6 offset:51456
    v_mfma_f32_16x16x32_bf16 v[28:31], a[132:135], v[84:87], v[28:31]
    v_mfma_f32_16x16x32_bf16 v[20:23], a[132:135], v[80:83], v[20:23]
    s_waitcnt vmcnt(0)
L_WO_mid0:
    s_barrier
    s_waitcnt lgkmcnt(4)
    v_mfma_f32_16x16x32_bf16 v[16:19], a[136:139], v[88:91], v[16:19]
    s_max_u32 s37, s37, s58
    s_mov_b32 s58, 0
    v_mfma_f32_16x16x32_bf16 v[24:27], a[136:139], v[92:95], v[24:27]
    buffer_atomic_add v5, v2, s[4:7], s37 offen
    v_mfma_f32_16x16x32_bf16 v[28:31], a[140:143], v[92:95], v[28:31]
    v_mfma_f32_16x16x32_bf16 v[20:23], a[140:143], v[88:91], v[20:23]
    s_waitcnt lgkmcnt(0)
    s_cmp_ge_u32 s62, s32
    s_cbranch_scc0 L_WO_nr0
L_WO_rd0:
    s_mov_b32 s40, s31
L_WO_go0:
    v_mfma_f32_16x16x32_bf16 v[16:19], a[144:147], v[64:67], v[16:19]
    ds_read_b128 v[80:83], v6 offset:45056
    s_add_u32 s94, s40, 0
    v_mfma_f32_16x16x32_bf16 v[24:27], a[144:147], v[68:71], v[24:27]
    ds_read_b128 v[84:87], v6 offset:45312
    s_add_u32 m0, s47, 75776
    v_mfma_f32_16x16x32_bf16 v[28:31], a[148:151], v[68:71], v[28:31]
    buffer_load_dwordx4 v1, s[4:7], s94 offen offset:0 sc1 lds
    v_mfma_f32_16x16x32_bf16 v[20:23], a[148:151], v[64:67], v[20:23]
    ds_read_b128 v[88:91], v6 offset:47104
    v_mfma_f32_16x16x32_bf16 v[16:19], a[152:155], v[72:75], v[16:19]
    ds_read_b128 v[92:95], v6 offset:47360
    v_mfma_f32_16x16x32_bf16 v[24:27], a[152:155], v[76:79], v[24:27]
    ds_read_b128 v[64:67], v6 offset:40960
    v_mfma_f32_16x16x32_bf16 v[28:31], a[156:159], v[76:79], v[28:31]
    buffer_load_dwordx4 v1, s[4:7], s94 offen offset:1024 sc1 lds
    v_mfma_f32_16x16x32_bf16 v[20:23], a[156:159], v[72:75], v[20:23]
    ds_read_b128 v[68:71], v6 offset:41216
    s_waitcnt lgkmcnt(4)
    v_mfma_f32_16x16x32_bf16 v[16:19], a[160:163], v[80:83], v[16:19]
    ds_read_b128 v[72:75], v6 offset:43008
    v_mfma_f32_16x16x32_bf16 v[24:27], a[160:163], v[84:87], v[24:27]
    ds_read_b128 v[76:79], v6 offset:43264
    v_mfma_f32_16x16x32_bf16 v[28:31], a[164:167], v[84:87], v[28:31]
    buffer_load_dwordx4 v1, s[4:7], s94 offen offset:2048 sc1 lds
    v_mfma_f32_16x16x32_bf16 v[20:23], a[164:167], v[80:83], v[20:23]
    s_waitcnt lgkmcnt(4)
    v_mfma_f32_16x16x32_bf16 v[16:19], a[168:171], v[88:91], v[16:19]
    ds_read_b128 v[80:83], v6 offset:36864
    v_mfma_f32_16x16x32_bf16 v[24:27], a[168:171], v[92:95], v[24:27]
    ds_read_b128 v[84:87], v6 offset:37120
    v_mfma_f32_16x16x32_bf16 v[28:31], a[172:175], v[92:95], v[28:31]
    buffer_load_dwordx4 v1, s[4:7], s94 offen offset:3072 sc1 lds
    v_mfma_f32_16x16x32_bf16 v[20:23], a[172:175], v[88:91], v[20:23]
    s_waitcnt lgkmcnt(2)
    v_mfma_f32_16x16x32_bf16 v[16:19], a[176:179], v[64:67], v[16:19]
    ds_read_b128 v[88:91], v6 offset:38912
    s_add_u32 s94, s40, 16384
    v_mfma_f32_16x16x32_bf16 v[24:27], a[176:179], v[68:71], v[24:27]
    ds_read_b128 v[92:95], v6 offset:39168
    s_add_u32 m0, s47, 92160
    v_mfma_f32_16x16x32_bf16 v[28:31], a[180:183], v[68:71], v[28:31]
    buffer_load_dwordx4 v1, s[4:7], s94 offen offset:0 sc1 lds
    v_mfma_f32_16x16x32_bf16 v[20:23], a[180:183], v[64:67], v[20:23]
    v_mfma_f32_16x16x32_bf16 v[16:19], a[184:187], v[72:75], v[16:19]
    ds_read_b128 v[64:67], v6 offset:32768
    v_mfma_f32_16x16x32_bf16 v[24:27], a[184:187], v[76:79], v[24:27]
    ds_read_b128 v[68:71], v6 offset:33024
    v_mfma_f32_16x16x32_bf16 v[28:31], a[188:191], v[76:79], v[28:31]
    buffer_load_dwordx4 v1, s[4:7], s94 offen offset:1024 sc1 lds
    v_mfma_f32_16x16x32_bf16 v[20:23], a[188:191], v[72:75], v[20:23]
    s_waitcnt lgkmcnt(2)
    v_mfma_f32_16x16x32_bf16 v[16:19], a[192:195], v[80:83], v[16:19]
    ds_read_b128 v[72:75], v6 offset:34816
    v_mfma_f32_16x16x32_bf16 v[24:27], a[192:195], v[84:87], v[24:27]
    ds_read_b128 v[76:79], v6 offset:35072
    v_mfma_f32_16x16x32_bf16 v[28:31], a[196:199], v[84:87], v[28:31]
    buffer_load_dwordx4 v1, s[4:7], s94 offen offset:2048 sc1 lds
    v_mfma_f32_16x16x32_bf16 v[20:23], a[196:199], v[80:83], v[20:23]
    v_mfma_f32_16x16x32_bf16 v[16:19], a[200:203], v[88:91], v[16:19]
    ds_read_b128 v[80:83], v6 offset:28672
    v_mfma_f32_16x16x32_bf16 v[24:27], a[200:203], v[92:95], v[24:27]
    ds_read_b128 v[84:87], v6 offset:28928
    v_mfma_f32_16x16x32_bf16 v[28:31], a[204:207], v[92:95], v[28:31]
    buffer_load_dwordx4 v1, s[4:7], s94 offen offset:3072 sc1 lds
    v_mfma_f32_16x16x32_bf16 v[20:23], a[204:207], v[88:91], v[20:23]
    s_waitcnt lgkmcnt(2)
    v_mfma_f32_16x16x32_bf16 v[16:19], a[208:211], v[64:67], v[16:19]
    ds_read_b128 v[88:91], v6 offset:30720
    s_add_u32 s94, s40, 32768
    v_mfma_f32_16x16x32_bf16 v[24:27], a[208:211], v[68:71], v[24:27]
    ds_read_b128 v[92:95], v6 offset:30976
    s_add_u32 m0, s47, 108544
    v_mfma_f32_16x16x32_bf16 v[28:31], a[212:215], v[68:71], v[28:31]
    buffer_load_dwordx4 v1, s[4:7], s94 offen offset:0 sc1 lds
    v_mfma_f32_16x16x32_bf16 v[20:23], a[212:215], v[64:67], v[20:23]
    v_mfma_f32_16x16x32_bf16 v[16:19], a[216:219], v[72:75], v[16:19]
    ds_read_b128 v[64:67], v6 offset:24576
    v_mfma_f32_16x16x32_bf16 v[24:27], a[216:219], v[76:79], v[24:27]
    ds_read_b128 v[68:71], v6 offset:24832
    v_mfma_f32_16x16x32_bf16 v[28:31], a[220:223], v[76:79], v[28:31]
    buffer_load_dwordx4 v1, s[4:7], s94 offen offset:1024 sc1 lds
    v_mfma_f32_16x16x32_bf16 v[20:23], a[220:223], v[72:75], v[20:23]
    s_waitcnt lgkmcnt(2)
    v_mfma_f32_16x16x32_bf16 v[16:19], a[224:227], v[80:83], v[16:19]
    ds_read_b128 v[72:75], v6 offset:26624
    v_mfma_f32_16x16x32_bf16 v[24:27], a[224:227], v[84:87], v[24:27]
    ds_read_b128 v[76:79], v6 offset:26880
    v_mfma_f32_16x16x32_bf16 v[28:31], a[228:231], v[84:87], v[28:31]
    buffer_load_dwordx4 v1, s[4:7], s94 offen offset:2048 sc1 lds
    v_mfma_f32_16x16x32_bf16 v[20:23], a[228:231], v[80:83], v[20:23]
    v_mfma_f32_16x16x32_bf16 v[16:19], a[232:235], v[88:91], v[16:19]
    ds_read_b128 v[80:83], v6 offset:20480
    v_mfma_f32_16x16x32_bf16 v[24:27], a[232:235], v[92:95], v[24:27]
    ds_read_b128 v[84:87], v6 offset:20736
    v_mfma_f32_16x16x32_bf16 v[28:31], a[236:239], v[92:95], v[28:31]
    buffer_load_dwordx4 v1, s[4:7], s94 offen offset:3072 sc1 lds
    v_mfma_f32_16x16x32_bf16 v[20:23], a[236:239], v[88:91], v[20:23]
    s_waitcnt lgkmcnt(2)
    v_mfma_f32_16x16x32_bf16 v[16:19], a[240:243], v[64:67], v[16:19]
    ds_read_b128 v[88:91], v6 offset:22528
    s_add_u32 s94, s40, 49152
    v_mfma_f32_16x16x32_bf16 v[24:27], a[240:243], v[68:71], v[24:27]
    ds_read_b128 v[92:95], v6 offset:22784
    s_add_u32 m0, s47, 124928
    v_mfma_f32_16x16x32_bf16 v[28:31], a[244:247], v[68:71], v[28:31]
    buffer_load_dwordx4 v1, s[4:7], s94 offen offset:0 sc1 lds
    v_mfma_f32_16x16x32_bf16 v[20:23], a[244:247], v[64:67], v[20:23]
    v_mfma_f32_16x16x32_bf16 v[16:19], a[248:251], v[72:75], v[16:19]
    ds_read_b128 v[64:67], v6 offset:16384
    v_mfma_f32_16x16x32_bf16 v[24:27], a[248:251], v[76:79], v[24:27]
    ds_read_b128 v[68:71], v6 offset:16640
    v_mfma_f32_16x16x32_bf16 v[28:31], a[252:255], v[76:79], v[28:31]
    buffer_load_dwordx4 v1, s[4:7], s94 offen offset:1024 sc1 lds
    v_mfma_f32_16x16x32_bf16 v[20:23], a[252:255], v[72:75], v[20:23]
    s_waitcnt lgkmcnt(2)
    v_mfma_f32_16x16x32_bf16 v[16:19], v[128:131], v[80:83], v[16:19]
    ds_read_b128 v[72:75], v6 offset:18432
    v_mfma_f32_16x16x32_bf16 v[24:27], v[128:131], v[84:87], v[24:27]
    ds_read_b128 v[76:79], v6 offset:18688
    v_mfma_f32_16x16x32_bf16 v[28:31], v[132:135], v[84:87], v[28:31]
    buffer_load_dwordx4 v1, s[4:7], s94 offen offset:2048 sc1 lds
    v_mfma_f32_16x16x32_bf16 v[20:23], v[132:135], v[80:83], v[20:23]
    v_mfma_f32_16x16x32_bf16 v[16:19], v[136:139], v[88:91], v[16:19]
    ds_read_b128 v[80:83], v6 offset:12288
    v_mfma_f32_16x16x32_bf16 v[24:27], v[136:139], v[92:95], v[24:27]
    ds_read_b128 v[84:87], v6 offset:12544
    v_mfma_f32_16x16x32_bf16 v[28:31], v[140:143], v[92:95], v[28:31]
    buffer_load_dwordx4 v1, s[4:7], s94 offen offset:3072 sc1 lds
    v_mfma_f32_16x16x32_bf16 v[20:23], v[140:143], v[88:91], v[20:23]
    s_waitcnt lgkmcnt(2)
    v_mfma_f32_16x16x32_bf16 v[16:19], v[144:147], v[64:67], v[16:19]
    ds_read_b128 v[88:91], v6 offset:14336
    s_add_u32 s94, s40, 65536
    v_mfma_f32_16x16x32_bf16 v[24:27], v[144:147], v[68:71], v[24:27]
    ds_read_b128 v[92:95], v6 offset:14592
    s_add_u32 m0, s47, 141312
    v_mfma_f32_16x16x32_bf16 v[28:31], v[148:151], v[68:71], v[28:31]
    buffer_load_dwordx4 v1, s[4:7], s94 offen offset:0 sc1 lds
    v_mfma_f32_16x16x32_bf16 v[20:23], v[148:151], v[64:67], v[20:23]
    v_mfma_f32_16x16x32_bf16 v[16:19], v[152:155], v[72:75], v[16:19]
    ds_read_b128 v[64:67], v6 offset:8192
    v_mfma_f32_16x16x32_bf16 v[24:27], v[152:155], v[76:79], v[24:27]
    ds_read_b128 v[68:71], v6 offset:8448
    v_mfma_f32_16x16x32_bf16 v[28:31], v[156:159], v[76:79], v[28:31]
    buffer_load_dwordx4 v1, s[4:7], s94 offen offset:1024 sc1 lds
    v_mfma_f32_16x16x32_bf16 v[20:23], v[156:159], v[72:75], v[20:23]
    s_waitcnt lgkmcnt(2)
    v_mfma_f32_16x16x32_bf16 v[16:19], v[160:163], v[80:83], v[16:19]
    ds_read_b128 v[72:75], v6 offset:10240
    v_mfma_f32_16x16x32_bf16 v[24:27], v[160:163], v[84:87], v[24:27]
    ds_read_b128 v[76:79], v6 offset:10496
    v_mfma_f32_16x16x32_bf16 v[28:31], v[164:167], v[84:87], v[28:31]
    buffer_load_dwordx4 v1, s[4:7], s94 offen offset:2048 sc1 lds
    v_mfma_f32_16x16x32_bf16 v[20:23], v[164:167], v[80:83], v[20:23]
    v_mfma_f32_16x16x32_bf16 v[16:19], v[168:171], v[88:91], v[16:19]
    ds_read_b128 v[80:83], v6 offset:4096
    v_mfma_f32_16x16x32_bf16 v[24:27], v[168:171], v[92:95], v[24:27]
    ds_read_b128 v[84:87], v6 offset:4352
    v_mfma_f32_16x16x32_bf16 v[28:31], v[172:175], v[92:95], v[28:31]
    buffer_load_dwordx4 v1, s[4:7], s94 offen offset:3072 sc1 lds
    v_mfma_f32_16x16x32_bf16 v[20:23], v[172:175], v[88:91], v[20:23]
    s_waitcnt lgkmcnt(2)
    v_mfma_f32_16x16x32_bf16 v[16:19], v[176:179], v[64:67], v[16:19]
    ds_read_b128 v[88:91], v6 offset:6144
    s_add_u32 s94, s40, s96
    v_mfma_f32_16x16x32_bf16 v[24:27], v[176:179], v[68:71], v[24:27]
    ds_read_b128 v[92:95], v6 offset:6400
    s_add_u32 s94, s94, 81920
    v_mfma_f32_16x16x32_bf16 v[28:31], v[180:183], v[68:71], v[28:31]
    s_add_u32 m0, s97, 157696
    v_mfma_f32_16x16x32_bf16 v[20:23], v[180:183], v[64:67], v[20:23]
    buffer_load_dwordx4 v1, s[4:7], s94 offen offset:0 sc1 lds
    v_mfma_f32_16x16x32_bf16 v[16:19], v[184:187], v[72:75], v[16:19]
    ds_read_b128 v[64:67], v6 offset:0
    v_mfma_f32_16x16x32_bf16 v[24:27], v[184:187], v[76:79], v[24:27]
    ds_read_b128 v[68:71], v6 offset:256
    v_mfma_f32_16x16x32_bf16 v[28:31], v[188:191], v[76:79], v[28:31]
    s_cmp_lt_u32 s18, 2
    s_cbranch_scc0 L_sk_23
    s_add_u32 s94, s40, s96
    s_add_u32 s94, s94, 86016
    s_add_u32 m0, s97, 161792
    s_nop 0
    buffer_load_dwordx4 v1, s[4:7], s94 offen offset:0 sc1 lds
L_sk_23:
    v_mfma_f32_16x16x32_bf16 v[20:23], v[188:191], v[72:75], v[20:23]
    s_cmp_ge_u32 s40, 268435456
    s_cbranch_scc1 L_WO_slow0
    s_waitcnt lgkmcnt(4)
    v_mfma_f32_16x16x32_bf16 v[16:19], v[192:195], v[80:83], v[16:19]
    v_mfma_f32_16x16x32_bf16 v[24:27], v[192:195], v[84:87], v[24:27]
    s_waitcnt vmcnt(9) lgkmcnt(0)
    s_barrier
    v_mfma_f32_16x16x32_bf16 v[28:31], v[196:199], v[84:87], v[28:31]
    ds_read_b128 v[72:75], v7 offset:10240
    v_mfma_f32_16x16x32_bf16 v[20:23], v[196:199], v[80:83], v[20:23]
    ds_read_b128 v[76:79], v7 offset:10496
    v_mfma_f32_16x16x32_bf16 v[16:19], v[200:203], v[88:91], v[16:19]
    ds_read_b128 v[80:83], v7 offset:12288
    v_mfma_f32_16x16x32_bf16 v[24:27], v[200:203], v[92:95], v[24:27]
    ds_read_b128 v[84:87], v7 offset:12544
    v_mfma_f32_16x16x32_bf16 v[28:31], v[204:207], v[92:95], v[28:31]
    v_mfma_f32_16x16x32_bf16 v[20:23], v[204:207], v[88:91], v[20:23]
    v_mfma_f32_16x16x32_bf16 v[16:19], v[208:211], v[64:67], v[16:19]
    ds_read_b128 v[88:91], v7 offset:14336
    v_mfma_f32_16x16x32_bf16 v[24:27], v[208:211], v[68:71], v[24:27]
    ds_read_b128 v[92:95], v7 offset:14592
    v_mfma_f32_16x16x32_bf16 v[28:31], v[212:215], v[68:71], v[28:31]
    v_mfma_f32_16x16x32_bf16 v[20:23], v[212:215], v[64:67], v[20:23]
L_WO_top1:
    s_waitcnt lgkmcnt(4)
    v_mfma_f32_16x16x32_bf16 v[40:43], a[0:3], v[72:75], 0
    ds_read_b128 v[64:67], v7 offset:16384
    v_mfma_f32_16x16x32_bf16 v[48:51], a[0:3], v[76:79], 0
    ds_read_b128 v[68:71], v7 offset:16640
    v_mfma_f32_16x16x32_bf16 v[52:55], a[4:7], v[76:79], 0
    s_and_b32 s86, s36, 95
    s_mul_i32 s86, s86, 196608
    s_add_u32 s87, s86, s45
    v_mfma_f32_16x16x32_bf16 v[44:47], a[4:7], v[72:75], 0
    s_waitcnt lgkmcnt(4)
    s_add_u32 s86, s86, s44
    v_cvt_pk_bf16_f32 v96, v16, v17
    v_mfma_f32_16x16x32_bf16 v[40:43], a[8:11], v[80:83], v[40:43]
    ds_read_b128 v[72:75], v7 offset:18432
    v_cvt_pk_bf16_f32 v97, v18, v19
    v_mfma_f32_16x16x32_bf16 v[48:51], a[8:11], v[84:87], v[48:51]
    ds_read_b128 v[76:79], v7 offset:18688
    v_cvt_pk_bf16_f32 v98, v20, v21
    v_mfma_f32_16x16x32_bf16 v[52:55], a[12:15], v[84:87], v[52:55]
    s_lshl2_add_u32 s37, s36, s43
    v_cvt_pk_bf16_f32 v99, v22, v23
    s_mov_b32 s34, s28
    v_mfma_f32_16x16x32_bf16 v[44:47], a[12:15], v[80:83], v[44:47]
    s_waitcnt lgkmcnt(2)
    s_mov_b32 s35, s29
    s_mov_b32 s36, s30
    v_mfma_f32_16x16x32_bf16 v[40:43], a[16:19], v[88:91], v[40:43]
    ds_read_b128 v[80:83], v7 offset:20480
    s_add_u32 s59, s59, 1
    v_mfma_f32_16x16x32_bf16 v[48:51], a[16:19], v[92:95], v[48:51]
    ds_read_b128 v[84:87], v7 offset:20736
    v_mfma_f32_16x16x32_bf16 v[52:55], a[20:23], v[92:95], v[52:55]
    buffer_store_dwordx4 v[96:99], v4, s[4:7], s86 offen sc1
    v_cvt_pk_bf16_f32 v100, v24, v25
    v_mfma_f32_16x16x32_bf16 v[44:47], a[20:23], v[88:91], v[44:47]
    s_cmp_lt_u32 s20, 64
    s_cselect_b64 s[88:89], s[24:25], s[26:27]
    v_cvt_pk_bf16_f32 v101, v26, v27
    v_mfma_f32_16x16x32_bf16 v[40:43], a[24:27], v[64:67], v[40:43]
    ds_read_b128 v[88:91], v7 offset:22528
    v_cvt_pk_bf16_f32 v102, v28, v29
    v_mfma_f32_16x16x32_bf16 v[48:51], a[24:27], v[68:71], v[48:51]
    ds_read_b128 v[92:95], v7 offset:22784
    v_cvt_pk_bf16_f32 v103, v30, v31
    v_mfma_f32_16x16x32_bf16 v[52:55], a[28:31], v[68:71], v[52:55]
    buffer_store_dwordx4 v[100:103], v4, s[4:7], s87 offen sc1
    v_mfma_f32_16x16x32_bf16 v[44:47], a[28:31], v[64:67], v[44:47]
    s_waitcnt lgkmcnt(2)
    v_mfma_f32_16x16x32_bf16 v[40:43], a[32:35], v[72:75], v[40:43]
    ds_read_b128 v[64:67], v7 offset:24576
    v_mfma_f32_16x16x32_bf16 v[48:51], a[32:35], v[76:79], v[48:51]
    ds_read_b128 v[68:71], v7 offset:24832
    v_mfma_f32_16x16x32_bf16 v[52:55], a[36:39], v[76:79], v[52:55]
    s_bitcmp1_b64 s[88:89], s20
    s_cselect_b32 s28, 1, 0
    s_cselect_b32 s29, s22, s21
    v_mfma_f32_16x16x32_bf16 v[44:47], a[36:39], v[72:75], v[44:47]
    s_add_u32 s22, s22, s28
    s_xor_b32 s88, s28, 1
    s_add_u32 s21, s21, s88
    v_mfma_f32_16x16x32_bf16 v[40:43], a[40:43], v[80:83], v[40:43]
    ds_read_b128 v[72:75], v7 offset:26624
    s_lshl_b32 s30, s28, 6
    v_mfma_f32_16x16x32_bf16 v[48:51], a[40:43], v[84:87], v[48:51]
    ds_read_b128 v[76:79], v7 offset:26880
    s_add_u32 s30, s30, s29
    v_mfma_f32_16x16x32_bf16 v[52:55], a[44:47], v[84:87], v[52:55]
    s_and_b32 s31, s30, 95
    s_mul_i32 s31, s31, 262144
    s_add_u32 s31, s31, s42
    v_mfma_f32_16x16x32_bf16 v[44:47], a[44:47], v[80:83], v[44:47]
    s_waitcnt lgkmcnt(2)
    s_lshl2_add_u32 s33, s30, s60
    v_mfma_f32_16x16x32_bf16 v[40:43], a[48:51], v[88:91], v[40:43]
    ds_read_b128 v[80:83], v7 offset:28672
    v_mfma_f32_16x16x32_bf16 v[48:51], a[48:51], v[92:95], v[48:51]
    ds_read_b128 v[84:87], v7 offset:28928
    v_mfma_f32_16x16x32_bf16 v[52:55], a[52:55], v[92:95], v[52:55]
    s_cmp_lt_u32 s20, 128
    s_cselect_b32 s31, s31, 268435456
    s_cselect_b32 s32, s61, 0
    v_mfma_f32_16x16x32_bf16 v[44:47], a[52:55], v[88:91], v[44:47]
    s_add_u32 s20, s20, 1
    s_andn2_b32 s23, s34, s28
    v_mfma_f32_16x16x32_bf16 v[40:43], a[56:59], v[64:67], v[40:43]
    ds_read_b128 v[88:91], v7 offset:30720
    v_mfma_f32_16x16x32_bf16 v[48:51], a[56:59], v[68:71], v[48:51]
    ds_read_b128 v[92:95], v7 offset:30976
    v_mfma_f32_16x16x32_bf16 v[52:55], a[60:63], v[68:71], v[52:55]
    v_mfma_f32_16x16x32_bf16 v[44:47], a[60:63], v[64:67], v[44:47]
    s_waitcnt lgkmcnt(2)
    v_mfma_f32_16x16x32_bf16 v[40:43], a[64:67], v[72:75], v[40:43]
    ds_read_b128 v[64:67], v7 offset:32768
    v_mfma_f32_16x16x32_bf16 v[48:51], a[64:67], v[76:79], v[48:51]
    ds_read_b128 v[68:71], v7 offset:33024
    v_mfma_f32_16x16x32_bf16 v[52:55], a[68:71], v[76:79], v[52:55]
    v_mfma_f32_16x16x32_bf16 v[44:47], a[68:71], v[72:75], v[44:47]
    s_buffer_load_dword s62, s[4:7], s33 glc
    v_mfma_f32_16x16x32_bf16 v[40:43], a[72:75], v[80:83], v[40:43]
    ds_read_b128 v[72:75], v7 offset:34816
    v_mfma_f32_16x16x32_bf16 v[48:51], a[72:75], v[84:87], v[48:51]
    ds_read_b128 v[76:79], v7 offset:35072
    v_mfma_f32_16x16x32_bf16 v[52:55], a[76:79], v[84:87], v[52:55]
    v_mfma_f32_16x16x32_bf16 v[44:47], a[76:79], v[80:83], v[44:47]
    s_waitcnt lgkmcnt(4)
    v_mfma_f32_16x16x32_bf16 v[40:43], a[80:83], v[88:91], v[40:43]
    ds_read_b128 v[80:83], v7 offset:36864
    v_mfma_f32_16x16x32_bf16 v[48:51], a[80:83], v[92:95], v[48:51]
    ds_read_b128 v[84:87], v7 offset:37120
    v_mfma_f32_16x16x32_bf16 v[52:55], a[84:87], v[92:95], v[52:55]
    v_mfma_f32_16x16x32_bf16 v[44:47], a[84:87], v[88:91], v[44:47]
    s_waitcnt lgkmcnt(4)
    v_mfma_f32_16x16x32_bf16 v[40:43], a[88:91], v[64:67], v[40:43]
    ds_read_b128 v[88:91], v7 offset:38912
    v_mfma_f32_16x16x32_bf16 v[48:51], a[88:91], v[68:71], v[48:51]
    ds_read_b128 v[92:95], v7 offset:39168
    v_mfma_f32_16x16x32_bf16 v[52:55], a[92:95], v[68:71], v[52:55]
    v_mfma_f32_16x16x32_bf16 v[44:47], a[92:95], v[64:67], v[44:47]
    s_waitcnt lgkmcnt(4)
    v_mfma_f32_16x16x32_bf16 v[40:43], a[96:99], v[72:75], v[40:43]
    ds_read_b128 v[64:67], v7 offset:40960
    v_mfma_f32_16x16x32_bf16 v[48:51], a[96:99], v[76:79], v[48:51]
    ds_read_b128 v[68:71], v7 offset:41216
    v_mfma_f32_16x16x32_bf16 v[52:55], a[100:103], v[76:79], v[52:55]
    v_mfma_f32_16x16x32_bf16 v[44:47], a[100:103], v[72:75], v[44:47]
    s_waitcnt lgkmcnt(4)
    v_mfma_f32_16x16x32_bf16 v[40:43], a[104:107], v[80:83], v[40:43]
    ds_read_b128 v[72:75], v7 offset:43008
    v_mfma_f32_16x16x32_bf16 v[48:51], a[104:107], v[84:87], v[48:51]
    ds_read_b128 v[76:79], v7 offset:43264
    v_mfma_f32_16x16x32_bf16 v[52:55], a[108:111], v[84:87], v[52:55]
    v_mfma_f32_16x16x32_bf16 v[44:47], a[108:111], v[80:83], v[44:47]
    s_waitcnt lgkmcnt(4)
    v_mfma_f32_16x16x32_bf16 v[40:43], a[112:115], v[88:91], v[40:43]
    ds_read_b128 v[80:83], v7 offset:45056
    v_mfma_f32_16x16x32_bf16 v[48:51], a[112:115], v[92:95], v[48:51]
    ds_read_b128 v[84:87], v7 offset:45312
    v_mfma_f32_16x16x32_bf16 v[52:55], a[116:119], v[92:95], v[52:55]
    v_mfma_f32_16x16x32_bf16 v[44:47], a[116:119], v[88:91], v[44:47]
    s_waitcnt lgkmcnt(4)
    v_mfma_f32_16x16x32_bf16 v[40:43], a[120:123], v[64:67], v[40:43]
    ds_read_b128 v[88:91], v7 offset:47104
    v_mfma_f32_16x16x32_bf16 v[48:51], a[120:123], v[68:71], v[48:51]
    ds_read_b128 v[92:95], v7 offset:47360
    v_mfma_f32_16x16x32_bf16 v[52:55], a[124:127], v[68:71], v[52:55]
    v_mfma_f32_16x16x32_bf16 v[44:47], a[124:127], v[64:67], v[44:47]
    s_waitcnt lgkmcnt(4)
    v_mfma_f32_16x16x32_bf16 v[40:43], a[128:131], v[72:75], v[40:43]
    ds_read_b128 v[64:67], v7 offset:49152
    v_mfma_f32_16x16x32_bf16 v[48:51], a[128:131], v[76:79], v[48:51]
    ds_read_b128 v[68:71], v7 offset:49408
    v_mfma_f32_16x16x32_bf16 v[52:55], a[132:135], v[76:79], v[52:55]
    v_mfma_f32_16x16x32_bf16 v[44:47], a[132:135], v[72:75], v[44:47]
    s_waitcnt vmcnt(0)
L_WO_mid1:
    s_barrier
    s_waitcnt lgkmcnt(4)
    v_mfma_f32_16x16x32_bf16 v[40:43], a[136:139], v[80:83], v[40:43]
    s_max_u32 s37, s37, s58
    s_mov_b32 s58, 0
    v_mfma_f32_16x16x32_bf16 v[48:51], a[136:139], v[84:87], v[48:51]
    buffer_atomic_add v5, v2, s[4:7], s37 offen
    v_mfma_f32_16x16x32_bf16 v[52:55], a[140:143], v[84:87], v[52:55]
    v_mfma_f32_16x16x32_bf16 v[44:47], a[140:143], v[80:83], v[44:47]
    s_waitcnt lgkmcnt(0)
    s_cmp_ge_u32 s62, s32
    s_cbranch_scc0 L_WO_nr1
L_WO_rd1:
    s_mov_b32 s40, s31
L_WO_go1:
    v_mfma_f32_16x16x32_bf16 v[40:43], a[144:147], v[88:91], v[40:43]
    ds_read_b128 v[72:75], v7 offset:51200
    s_add_u32 s94, s40, 0
    v_mfma_f32_16x16x32_bf16 v[48:51], a[144:147], v[92:95], v[48:51]
    ds_read_b128 v[76:79], v7 offset:51456
    s_add_u32 m0, s46, 86016
    v_mfma_f32_16x16x32_bf16 v[52:55], a[148:151], v[92:95], v[52:55]
    buffer_load_dwordx4 v1, s[4:7], s94 offen offset:0 sc1 lds
    v_mfma_f32_16x16x32_bf16 v[44:47], a[148:151], v[88:91], v[44:47]
    ds_read_b128 v[80:83], v7 offset:53248
    v_mfma_f32_16x16x32_bf16 v[40:43], a[152:155], v[64:67], v[40:43]
    ds_read_b128 v[84:87], v7 offset:53504
    v_mfma_f32_16x16x32_bf16 v[48:51], a[152:155], v[68:71], v[48:51]
    ds_read_b128 v[88:91], v7 offset:55296
    v_mfma_f32_16x16x32_bf16 v[52:55], a[156:159], v[68:71], v[52:55]
    buffer_load_dwordx4 v1, s[4:7], s94 offen offset:1024 sc1 lds
    v_mfma_f32_16x16x32_bf16 v[44:47], a[156:159], v[64:67], v[44:47]
    ds_read_b128 v[92:95], v7 offset:55552
    s_waitcnt lgkmcnt(4)
    v_mfma_f32_16x16x32_bf16 v[40:43], a[160:163], v[72:75], v[40:43]
    ds_read_b128 v[64:67], v7 offset:57344
    v_mfma_f32_16x16x32_bf16 v[48:51], a[160:163], v[76:79], v[48:51]
    ds_read_b128 v[68:71], v7 offset:57600
    v_mfma_f32_16x16x32_bf16 v[52:55], a[164:167], v[76:79], v[52:55]
    buffer_load_dwordx4 v1, s[4:7], s94 offen offset:2048 sc1 lds
    v_mfma_f32_16x16x32_bf16 v[44:47], a[164:167], v[72:75], v[44:47]
    s_waitcnt lgkmcnt(4)
    v_mfma_f32_16x16x32_bf16 v[40:43], a[168:171], v[80:83], v[40:43]
    ds_read_b128 v[72:75], v7 offset:59392
    v_mfma_f32_16x16x32_bf16 v[48:51], a[168:171], v[84:87], v[48:51]
    ds_read_b128 v[76:79], v7 offset:59648
    v_mfma_f32_16x16x32_bf16 v[52:55], a[172:175], v[84:87], v[52:55]
    buffer_load_dwordx4 v1, s[4:7], s94 offen offset:3072 sc1 lds
    v_mfma_f32_16x16x32_bf16 v[44:47], a[172:175], v[80:83], v[44:47]
    s_waitcnt lgkmcnt(2)
    v_mfma_f32_16x16x32_bf16 v[40:43], a[176:179], v[88:91], v[40:43]
    ds_read_b128 v[80:83], v7 offset:61440
    s_add_u32 s94, s40, 16384
    v_mfma_f32_16x16x32_bf16 v[48:51], a[176:179], v[92:95], v[48:51]
    ds_read_b128 v[84:87], v7 offset:61696
    s_add_u32 m0, s46, 69632
    v_mfma_f32_16x16x32_bf16 v[52:55], a[180:183], v[92:95], v[52:55]
    buffer_load_dwordx4 v1, s[4:7], s94 offen offset:0 sc1 lds
    v_mfma_f32_16x16x32_bf16 v[44:47], a[180:183], v[88:91], v[44:47]
    v_mfma_f32_16x16x32_bf16 v[40:43], a[184:187], v[64:67], v[40:43]
    ds_read_b128 v[88:91], v7 offset:63488
    v_mfma_f32_16x16x32_bf16 v[48:51], a[184:187], v[68:71], v[48:51]
    ds_read_b128 v[92:95], v7 offset:63744
    v_mfma_f32_16x16x32_bf16 v[52:55], a[188:191], v[68:71], v[52:55]
    buffer_load_dwordx4 v1, s[4:7], s94 offen offset:1024 sc1 lds
    v_mfma_f32_16x16x32_bf16 v[44:47], a[188:191], v[64:67], v[44:47]
    s_waitcnt lgkmcnt(2)
    v_mfma_f32_16x16x32_bf16 v[40:43], a[192:195], v[72:75], v[40:43]
    ds_read_b128 v[64:67], v8 offset:0
    v_mfma_f32_16x16x32_bf16 v[48:51], a[192:195], v[76:79], v[48:51]
    ds_read_b128 v[68:71], v8 offset:256
    v_mfma_f32_16x16x32_bf16 v[52:55], a[196:199], v[76:79], v[52:55]
    buffer_load_dwordx4 v1, s[4:7], s94 offen offset:2048 sc1 lds
    v_mfma_f32_16x16x32_bf16 v[44:47], a[196:199], v[72:75], v[44:47]
    v_mfma_f32_16x16x32_bf16 v[40:43], a[200:203], v[80:83], v[40:43]
    ds_read_b128 v[72:75], v8 offset:2048
    v_mfma_f32_16x16x32_bf16 v[48:51], a[200:203], v[84:87], v[48:51]
    ds_read_b128 v[76:79], v8 offset:2304
    v_mfma_f32_16x16x32_bf16 v[52:55], a[204:207], v[84:87], v[52:55]
    buffer_load_dwordx4 v1, s[4:7], s94 offen offset:3072 sc1 lds
    v_mfma_f32_16x16x32_bf16 v[44:47], a[204:207], v[80:83], v[44:47]
    s_waitcnt lgkmcnt(2)
    v_mfma_f32_16x16x32_bf16 v[40:43], a[208:211], v[88:91], v[40:43]
    ds_read_b128 v[80:83], v8 offset:4096
    s_add_u32 s94, s40, 32768
    v_mfma_f32_16x16x32_bf16 v[48:51], a[208:211], v[92:95], v[48:51]
    ds_read_b128 v[84:87], v8 offset:4352
    s_add_u32 m0, s46, 53248
    v_mfma_f32_16x16x32_bf16 v[52:55], a[212:215], v[92:95], v[52:55]
    buffer_load_dwordx4 v1, s[4:7], s94 offen offset:0 sc1 lds
    v_mfma_f32_16x16x32_bf16 v[44:47], a[212:215], v[88:91], v[44:47]
    v_mfma_f32_16x16x32_bf16 v[40:43], a[216:219], v[64:67], v[40:43]
    ds_read_b128 v[88:91], v8 offset:6144
    v_mfma_f32_16x16x32_bf16 v[48:51], a[216:219], v[68:71], v[48:51]
    ds_read_b128 v[92:95], v8 offset:6400
    v_mfma_f32_16x16x32_bf16 v[52:55], a[220:223], v[68:71], v[52:55]
    buffer_load_dwordx4 v1, s[4:7], s94 offen offset:1024 sc1 lds
    v_mfma_f32_16x16x32_bf16 v[44:47], a[220:223], v[64:67], v[44:47]
    s_waitcnt lgkmcnt(2)
    v_mfma_f32_16x16x32_bf16 v[40:43], a[224:227], v[72:75], v[40:43]
    ds_read_b128 v[64:67], v8 offset:8192
    v_mfma_f32_16x16x32_bf16 v[48:51], a[224:227], v[76:79], v[48:51]
    ds_read_b128 v[68:71], v8 offset:8448
    v_mfma_f32_16x16x32_bf16 v[52:55], a[228:231], v[76:79], v[52:55]
    buffer_load_dwordx4 v1, s[4:7], s94 offen offset:2048 sc1 lds
    v_mfma_f32_16x16x32_bf16 v[44:47], a[228:231], v[72:75], v[44:47]
    v_mfma_f32_16x16x32_bf16 v[40:43], a[232:235], v[80:83], v[40:43]
    ds_read_b128 v[72:75], v8 offset:10240
    v_mfma_f32_16x16x32_bf16 v[48:51], a[232:235], v[84:87], v[48:51]
    ds_read_b128 v[76:79], v8 offset:10496
    v_mfma_f32_16x16x32_bf16 v[52:55], a[236:239], v[84:87], v[52:55]
    buffer_load_dwordx4 v1, s[4:7], s94 offen offset:3072 sc1 lds
    v_mfma_f32_16x16x32_bf16 v[44:47], a[236:239], v[80:83], v[44:47]
    s_waitcnt lgkmcnt(2)
    v_mfma_f32_16x16x32_bf16 v[40:43], a[240:243], v[88:91], v[40:43]
    ds_read_b128 v[80:83], v8 offset:12288
    s_add_u32 s94, s40, 49152
    v_mfma_f32_16x16x32_bf16 v[48:51], a[240:243], v[92:95], v[48:51]
    ds_read_b128 v[84:87], v8 offset:12544
    s_add_u32 m0, s46, 36864
    v_mfma_f32_16x16x32_bf16 v[52:55], a[244:247], v[92:95], v[52:55]
    buffer_load_dwordx4 v1, s[4:7], s94 offen offset:0 sc1 lds
    v_mfma_f32_16x16x32_bf16 v[44:47], a[244:247], v[88:91], v[44:47]
    v_mfma_f32_16x16x32_bf16 v[40:43], a[248:251], v[64:67], v[40:43]
    ds_read_b128 v[88:91], v8 offset:14336
    v_mfma_f32_16x16x32_bf16 v[48:51], a[248:251], v[68:71], v[48:51]
    ds_read_b128 v[92:95], v8 offset:14592
    v_mfma_f32_16x16x32_bf16 v[52:55], a[252:255], v[68:71], v[52:55]
    buffer_load_dwordx4 v1, s[4:7], s94 offen offset:1024 sc1 lds
    v_mfma_f32_16x16x32_bf16 v[44:47], a[252:255], v[64:67], v[44:47]
    s_waitcnt lgkmcnt(2)
    v_mfma_f32_16x16x32_bf16 v[40:43], v[128:131], v[72:75], v[40:43]
    ds_read_b128 v[64:67], v8 offset:16384
    v_mfma_f32_16x16x32_bf16 v[48:51], v[128:131], v[76:79], v[48:51]
    ds_read_b128 v[68:71], v8 offset:16640
    v_mfma_f32_16x16x32_bf16 v[52:55], v[132:135], v[76:79], v[52:55]
    buffer_load_dwordx4 v1, s[4:7], s94 offen offset:2048 sc1 lds
    v_mfma_f32_16x16x32_bf16 v[44:47], v[132:135], v[72:75], v[44:47]
    v_mfma_f32_16x16x32_bf16 v[40:43], v[136:139], v[80:83], v[40:43]
    ds_read_b128 v[72:75], v8 offset:18432
    v_mfma_f32_16x16x32_bf16 v[48:51], v[136:139], v[84:87], v[48:51]
    ds_read_b128 v[76:79], v8 offset:18688
    v_mfma_f32_16x16x32_bf16 v[52:55], v[140:143], v[84:87], v[52:55]
    buffer_load_dwordx4 v1, s[4:7], s94 offen offset:3072 sc1 lds
    v_mfma_f32_16x16x32_bf16 v[44:47], v[140:143], v[80:83], v[44:47]
    s_waitcnt lgkmcnt(2)
    v_mfma_f32_16x16x32_bf16 v[40:43], v[144:147], v[88:91], v[40:43]
    ds_read_b128 v[80:83], v8 offset:20480
    s_add_u32 s94, s40, 65536
    v_mfma_f32_16x16x32_bf16 v[48:51], v[144:147], v[92:95], v[48:51]
    ds_read_b128 v[84:87], v8 offset:20736
    s_add_u32 m0, s46, 20480
    v_mfma_f32_16x16x32_bf16 v[52:55], v[148:151], v[92:95], v[52:55]
    buffer_load_dwordx4 v1, s[4:7], s94 offen offset:0 sc1 lds
    v_mfma_f32_16x16x32_bf16 v[44:47], v[148:151], v[88:91], v[44:47]
    v_mfma_f32_16x16x32_bf16 v[40:43], v[152:155], v[64:67], v[40:43]
    ds_read_b128 v[88:91], v8 offset:22528
    v_mfma_f32_16x16x32_bf16 v[48:51], v[152:155], v[68:71], v[48:51]
    ds_read_b128 v[92:95], v8 offset:22784
    v_mfma_f32_16x16x32_bf16 v[52:55], v[156:159], v[68:71], v[52:55]
    buffer_load_dwordx4 v1, s[4:7], s94 offen offset:1024 sc1 lds
    v_mfma_f32_16x16x32_bf16 v[44:47], v[156:159], v[64:67], v[44:47]
    s_waitcnt lgkmcnt(2)
    v_mfma_f32_16x16x32_bf16 v[40:43], v[160:163], v[72:75], v[40:43]
    ds_read_b128 v[64:67], v8 offset:24576
    v_mfma_f32_16x16x32_bf16 v[48:51], v[160:163], v[76:79], v[48:51]
    ds_read_b128 v[68:71], v8 offset:24832
    v_mfma_f32_16x16x32_bf16 v[52:55], v[164:167], v[76:79], v[52:55]
    buffer_load_dwordx4 v1, s[4:7], s94 offen offset:2048 sc1 lds
    v_mfma_f32_16x16x32_bf16 v[44:47], v[164:167], v[72:75], v[44:47]
    v_mfma_f32_16x16x32_bf16 v[40:43], v[168:171], v[80:83], v[40:43]
    ds_read_b128 v[72:75], v8 offset:26624
    v_mfma_f32_16x16x32_bf16 v[48:51], v[168:171], v[84:87], v[48:51]
    ds_read_b128 v[76:79], v8 offset:26880
    v_mfma_f32_16x16x32_bf16 v[52:55], v[172:175], v[84:87], v[52:55]
    buffer_load_dwordx4 v1, s[4:7], s94 offen offset:3072 sc1 lds
    v_mfma_f32_16x16x32_bf16 v[44:47], v[172:175], v[80:83], v[44:47]
    s_waitcnt lgkmcnt(2)
    v_mfma_f32_16x16x32_bf16 v[40:43], v[176:179], v[88:91], v[40:43]
    ds_read_b128 v[80:83], v8 offset:28672
    s_add_u32 s94, s40, s96
    v_mfma_f32_16x16x32_bf16 v[48:51], v[176:179], v[92:95], v[48:51]
    ds_read_b128 v[84:87], v8 offset:28928
    s_add_u32 s94, s94, 81920
    v_mfma_f32_16x16x32_bf16 v[52:55], v[180:183], v[92:95], v[52:55]
    s_add_u32 m0, s97, 4096
    v_mfma_f32_16x16x32_bf16 v[44:47], v[180:183], v[88:91], v[44:47]
    buffer_load_dwordx4 v1, s[4:7], s94 offen offset:0 sc1 lds
    v_mfma_f32_16x16x32_bf16 v[40:43], v[184:187], v[64:67], v[40:43]
    ds_read_b128 v[88:91], v8 offset:30720
    v_mfma_f32_16x16x32_bf16 v[48:51], v[184:187], v[68:71], v[48:51]
    ds_read_b128 v[92:95], v8 offset:30976
    v_mfma_f32_16x16x32_bf16 v[52:55], v[188:191], v[68:71], v[52:55]
    s_cmp_lt_u32 s18, 2
    s_cbranch_scc0 L_sk_24
    s_add_u32 s94, s40, s96
    s_add_u32 s94, s94, 86016
    s_add_u32 m0, s97, 0
    s_nop 0
    buffer_load_dwordx4 v1, s[4:7], s94 offen offset:0 sc1 lds
L_sk_24:
    v_mfma_f32_16x16x32_bf16 v[44:47], v[188:191], v[64:67], v[44:47]
    s_cmp_ge_u32 s40, 268435456
    s_cbranch_scc1 L_WO_slow1
    s_waitcnt lgkmcnt(4)
    v_mfma_f32_16x16x32_bf16 v[40:43], v[192:195], v[72:75], v[40:43]
    v_mfma_f32_16x16x32_bf16 v[48:51], v[192:195], v[76:79], v[48:51]
    s_waitcnt vmcnt(9) lgkmcnt(0)
    s_barrier
    v_mfma_f32_16x16x32_bf16 v[52:55], v[196:199], v[76:79], v[52:55]
    ds_read_b128 v[64:67], v7 offset:20480
    v_mfma_f32_16x16x32_bf16 v[44:47], v[196:199], v[72:75], v[44:47]
    ds_read_b128 v[68:71], v7 offset:20736
    v_mfma_f32_16x16x32_bf16 v[40:43], v[200:203], v[80:83], v[40:43]
    ds_read_b128 v[72:75], v7 offset:22528
    v_mfma_f32_16x16x32_bf16 v[48:51], v[200:203], v[84:87], v[48:51]
    ds_read_b128 v[76:79], v7 offset:22784
    v_mfma_f32_16x16x32_bf16 v[52:55], v[204:207], v[84:87], v[52:55]
    v_mfma_f32_16x16x32_bf16 v[44:47], v[204:207], v[80:83], v[44:47]
    v_mfma_f32_16x16x32_bf16 v[40:43], v[208:211], v[88:91], v[40:43]
    ds_read_b128 v[80:83], v7 offset:16384
    v_mfma_f32_16x16x32_bf16 v[48:51], v[208:211], v[92:95], v[48:51]
    ds_read_b128 v[84:87], v7 offset:16640
    v_mfma_f32_16x16x32_bf16 v[52:55], v[212:215], v[92:95], v[52:55]
    v_mfma_f32_16x16x32_bf16 v[44:47], v[212:215], v[88:91], v[44:47]
    s_branch L_WO_top0
L_WO_nr0:
    s_mov_b32 s40, 268435456
    s_cmp_eq_u32 s23, 0
    s_cbranch_scc1 L_WO_go0
    s_mov_b32 s3, 0
L_WO_hl0:
    s_buffer_load_dword s62, s[4:7], s33 glc
    s_waitcnt lgkmcnt(0)
    s_cmp_ge_u32 s62, s32
    s_cbranch_scc1 L_WO_hd0
    s_add_u32 s3, s3, 1
    s_cmp_lt_u32 s3, 40000
    s_cbranch_scc1 L_WO_hl0
    s_mov_b32 s3, 35
    s_branch L_abort
L_WO_hd0:
    s_branch L_WO_rd0
L_WO_slow0:
    s_waitcnt lgkmcnt(5)
    v_mfma_f32_16x16x32_bf16 v[16:19], v[192:195], v[80:83], v[16:19]
    s_waitcnt lgkmcnt(4)
    v_mfma_f32_16x16x32_bf16 v[24:27], v[192:195], v[84:87], v[24:27]
    v_mfma_f32_16x16x32_bf16 v[28:31], v[196:199], v[84:87], v[28:31]
    v_mfma_f32_16x16x32_bf16 v[20:23], v[196:199], v[80:83], v[20:23]
    s_waitcnt lgkmcnt(3)
    v_mfma_f32_16x16x32_bf16 v[16:19], v[200:203], v[88:91], v[16:19]
    s_waitcnt lgkmcnt(2)
    v_mfma_f32_16x16x32_bf16 v[24:27], v[200:203], v[92:95], v[24:27]
    v_mfma_f32_16x16x32_bf16 v[28:31], v[204:207], v[92:95], v[28:31]
    v_mfma_f32_16x16x32_bf16 v[20:23], v[204:207], v[88:91], v[20:23]
    s_waitcnt lgkmcnt(1)
    v_mfma_f32_16x16x32_bf16 v[16:19], v[208:211], v[64:67], v[16:19]
    s_waitcnt lgkmcnt(0)
    v_mfma_f32_16x16x32_bf16 v[24:27], v[208:211], v[68:71], v[24:27]
    v_mfma_f32_16x16x32_bf16 v[28:31], v[212:215], v[68:71], v[28:31]
    v_mfma_f32_16x16x32_bf16 v[20:23], v[212:215], v[64:67], v[20:23]
    s_and_b32 s86, s36, 95
    s_mul_i32 s86, s86, 196608
    s_add_u32 s87, s86, s45
    s_add_u32 s86, s86, s44
    s_lshl2_add_u32 s37, s36, s43
    v_cvt_pk_bf16_f32 v96, v16, v17
    v_cvt_pk_bf16_f32 v97, v18, v19
    s_nop 0
    v_cvt_pk_bf16_f32 v98, v20, v21
    v_cvt_pk_bf16_f32 v99, v22, v23
    buffer_store_dwordx4 v[96:99], v4, s[4:7], s86 offen sc1
    v_cvt_pk_bf16_f32 v100, v24, v25
    v_cvt_pk_bf16_f32 v101, v26, v27
    v_cvt_pk_bf16_f32 v102, v28, v29
    v_cvt_pk_bf16_f32 v103, v30, v31
    buffer_store_dwordx4 v[100:103], v4, s[4:7], s87 offen sc1
    s_buffer_load_dword s62, s[4:7], s33 glc
    s_waitcnt vmcnt(0)
    s_add_u32 s92, s59, 1
    v_mov_b32 v12, s92
    s_and_b32 s95, s92, s57
    ds_write_b32 v11, v12
    s_cmp_lg_u32 s58, 0
    s_cbranch_scc1 L_pd_25
    ds_read_b128 v[116:119], v9
    s_waitcnt lgkmcnt(0)
    v_min3_u32 v116, v116, v117, v118
    v_min_u32 v116, v116, v119
    v_cmp_gt_u32 vcc, s95, v116
    s_cbranch_vccnz L_pd_25
    buffer_atomic_add v5, v2, s[4:7], s37 offen
    s_mov_b32 s58, 268435456
L_pd_25:
    s_cmp_lg_u32 s58, 0
    s_cbranch_scc1 L_pd_26
    ds_read_b128 v[116:119], v9
    s_waitcnt lgkmcnt(0)
    v_min3_u32 v116, v116, v117, v118
    v_min_u32 v116, v116, v119
    v_cmp_gt_u32 vcc, s95, v116
    s_cbranch_vccnz L_pd_26
    buffer_atomic_add v5, v2, s[4:7], s37 offen
    s_mov_b32 s58, 268435456
L_pd_26:
    s_cmp_gt_u32 s20, 128
    s_cbranch_scc1 L_WO_done
    s_waitcnt lgkmcnt(0)
    s_cmp_ge_u32 s62, s32
    s_cbranch_scc1 L_WO_sd0
L_WO_ss0:
    s_mov_b32 s3, 0
L_WO_sl0:
    s_cmp_lg_u32 s58, 0
    s_cbranch_scc1 L_pd_27
    ds_read_b128 v[116:119], v9
    s_waitcnt lgkmcnt(0)
    v_min3_u32 v116, v116, v117, v118
    v_min_u32 v116, v116, v119
    v_cmp_gt_u32 vcc, s95, v116
    s_cbranch_vccnz L_pd_27
    buffer_atomic_add v5, v2, s[4:7], s37 offen
    s_mov_b32 s58, 268435456
L_pd_27:
    s_buffer_load_dword s62, s[4:7], s33 glc
    s_waitcnt lgkmcnt(0)
    s_cmp_ge_u32 s62, s32
    s_cbranch_scc1 L_WO_sd0
    s_add_u32 s3, s3, 1
    s_cmp_lt_u32 s3, 40000
    s_cbranch_scc1 L_WO_sl0
    s_mov_b32 s3, 15
    s_branch L_abort
L_WO_sd0:
    s_mov_b32 s40, s31
    s_add_u32 s94, s40, 0
    s_add_u32 m0, s47, 75776
    s_nop 0
    buffer_load_dwordx4 v1, s[4:7], s94 offen offset:0 sc1 lds
    buffer_load_dwordx4 v1, s[4:7], s94 offen offset:1024 sc1 lds
    buffer_load_dwordx4 v1, s[4:7], s94 offen offset:2048 sc1 lds
    buffer_load_dwordx4 v1, s[4:7], s94 offen offset:3072 sc1 lds
    s_add_u32 s94, s40, 16384
    s_add_u32 m0, s47, 92160
    s_nop 0
    buffer_load_dwordx4 v1, s[4:7], s94 offen offset:0 sc1 lds
    buffer_load_dwordx4 v1, s[4:7], s94 offen offset:1024 sc1 lds
    buffer_load_dwordx4 v1, s[4:7], s94 offen offset:2048 sc1 lds
    buffer_load_dwordx4 v1, s[4:7], s94 offen offset:3072 sc1 lds
    s_add_u32 s94, s40, 32768
    s_add_u32 m0, s47, 108544
    s_nop 0
    buffer_load_dwordx4 v1, s[4:7], s94 offen offset:0 sc1 lds
    buffer_load_dwordx4 v1, s[4:7], s94 offen offset:1024 sc1 lds
    buffer_load_dwordx4 v1, s[4:7], s94 offen offset:2048 sc1 lds
    buffer_load_dwordx4 v1, s[4:7], s94 offen offset:3072 sc1 lds
    s_add_u32 s94, s40, 49152
    s_add_u32 m0, s47, 124928
    s_nop 0
    buffer_load_dwordx4 v1, s[4:7], s94 offen offset:0 sc1 lds
    buffer_load_dwordx4 v1, s[4:7], s94 offen offset:1024 sc1 lds
    buffer_load_dwordx4 v1, s[4:7], s94 offen offset:2048 sc1 lds
    buffer_load_dwordx4 v1, s[4:7], s94 offen offset:3072 sc1 lds
    s_waitcnt vmcnt(4)
    s_barrier
    ds_read_b128 v[72:75], v7 offset:10240
    ds_read_b128 v[76:79], v7 offset:10496
    ds_read_b128 v[80:83], v7 offset:12288
    ds_read_b128 v[84:87], v7 offset:12544
    ds_read_b128 v[88:91], v7 offset:14336
    ds_read_b128 v[92:95], v7 offset:14592
    s_waitcnt lgkmcnt(4)
    v_mfma_f32_16x16x32_bf16 v[40:43], a[0:3], v[72:75], 0
    ds_read_b128 v[64:67], v7 offset:16384
    s_add_u32 s94, s40, 65536
    v_mfma_f32_16x16x32_bf16 v[48:51], a[0:3], v[76:79], 0
    ds_read_b128 v[68:71], v7 offset:16640
    s_add_u32 m0, s47, 141312
    v_mfma_f32_16x16x32_bf16 v[52:55], a[4:7], v[76:79], 0
    buffer_load_dwordx4 v1, s[4:7], s94 offen offset:0 sc1 lds
    s_lshl2_add_u32 s37, s36, s43
    v_mfma_f32_16x16x32_bf16 v[44:47], a[4:7], v[72:75], 0
    s_waitcnt lgkmcnt(4)
    s_mov_b32 s34, s28
    s_mov_b32 s35, s29
    v_mfma_f32_16x16x32_bf16 v[40:43], a[8:11], v[80:83], v[40:43]
    ds_read_b128 v[72:75], v7 offset:18432
    s_mov_b32 s36, s30
    v_mfma_f32_16x16x32_bf16 v[48:51], a[8:11], v[84:87], v[48:51]
    ds_read_b128 v[76:79], v7 offset:18688
    s_add_u32 s59, s59, 1
    v_mfma_f32_16x16x32_bf16 v[52:55], a[12:15], v[84:87], v[52:55]
    buffer_load_dwordx4 v1, s[4:7], s94 offen offset:1024 sc1 lds
    v_mfma_f32_16x16x32_bf16 v[44:47], a[12:15], v[80:83], v[44:47]
    s_waitcnt lgkmcnt(2)
    s_cmp_lt_u32 s20, 64
    s_cselect_b64 s[88:89], s[24:25], s[26:27]
    v_mfma_f32_16x16x32_bf16 v[40:43], a[16:19], v[88:91], v[40:43]
    ds_read_b128 v[80:83], v7 offset:20480
    v_mfma_f32_16x16x32_bf16 v[48:51], a[16:19], v[92:95], v[48:51]
    ds_read_b128 v[84:87], v7 offset:20736
    v_mfma_f32_16x16x32_bf16 v[52:55], a[20:23], v[92:95], v[52:55]
    buffer_load_dwordx4 v1, s[4:7], s94 offen offset:2048 sc1 lds
    v_mfma_f32_16x16x32_bf16 v[44:47], a[20:23], v[88:91], v[44:47]
    s_bitcmp1_b64 s[88:89], s20
    s_cselect_b32 s28, 1, 0
    s_cselect_b32 s29, s22, s21
    v_mfma_f32_16x16x32_bf16 v[40:43], a[24:27], v[64:67], v[40:43]
    ds_read_b128 v[88:91], v7 offset:22528
    s_add_u32 s22, s22, s28
    v_mfma_f32_16x16x32_bf16 v[48:51], a[24:27], v[68:71], v[48:51]
    ds_read_b128 v[92:95], v7 offset:22784
    s_xor_b32 s88, s28, 1
    v_mfma_f32_16x16x32_bf16 v[52:55], a[28:31], v[68:71], v[52:55]
    buffer_load_dwordx4 v1, s[4:7], s94 offen offset:3072 sc1 lds
    s_add_u32 s21, s21, s88
    v_mfma_f32_16x16x32_bf16 v[44:47], a[28:31], v[64:67], v[44:47]
    s_waitcnt lgkmcnt(2)
    s_lshl_b32 s30, s28, 6
    s_add_u32 s30, s30, s29
    v_mfma_f32_16x16x32_bf16 v[40:43], a[32:35], v[72:75], v[40:43]
    ds_read_b128 v[64:67], v7 offset:24576
    s_add_u32 s94, s40, s96
    v_mfma_f32_16x16x32_bf16 v[48:51], a[32:35], v[76:79], v[48:51]
    ds_read_b128 v[68:71], v7 offset:24832
    s_add_u32 s94, s94, 81920
    v_mfma_f32_16x16x32_bf16 v[52:55], a[36:39], v[76:79], v[52:55]
    s_add_u32 m0, s97, 157696
    s_and_b32 s31, s30, 95
    s_mul_i32 s31, s31, 262144
    v_mfma_f32_16x16x32_bf16 v[44:47], a[36:39], v[72:75], v[44:47]
    buffer_load_dwordx4 v1, s[4:7], s94 offen offset:0 sc1 lds
    s_add_u32 s31, s31, s42
    v_mfma_f32_16x16x32_bf16 v[40:43], a[40:43], v[80:83], v[40:43]
    ds_read_b128 v[72:75], v7 offset:26624
    s_lshl2_add_u32 s33, s30, s60
    v_mfma_f32_16x16x32_bf16 v[48:51], a[40:43], v[84:87], v[48:51]
    ds_read_b128 v[76:79], v7 offset:26880
    v_mfma_f32_16x16x32_bf16 v[52:55], a[44:47], v[84:87], v[52:55]
    s_cmp_lt_u32 s18, 2
    s_cbranch_scc0 L_sk_28
    s_add_u32 s94, s40, s96
    s_add_u32 s94, s94, 86016
    s_add_u32 m0, s97, 161792
    s_nop 0
    buffer_load_dwordx4 v1, s[4:7], s94 offen offset:0 sc1 lds
L_sk_28:
    v_mfma_f32_16x16x32_bf16 v[44:47], a[44:47], v[80:83], v[44:47]
    s_waitcnt lgkmcnt(2)
    v_mfma_f32_16x16x32_bf16 v[40:43], a[48:51], v[88:91], v[40:43]
    ds_read_b128 v[80:83], v7 offset:28672
    v_mfma_f32_16x16x32_bf16 v[48:51], a[48:51], v[92:95], v[48:51]
    ds_read_b128 v[84:87], v7 offset:28928
    v_mfma_f32_16x16x32_bf16 v[52:55], a[52:55], v[92:95], v[52:55]
    s_cmp_lt_u32 s20, 128
    s_cselect_b32 s31, s31, 268435456
    s_cselect_b32 s32, s61, 0
    v_mfma_f32_16x16x32_bf16 v[44:47], a[52:55], v[88:91], v[44:47]
    s_add_u32 s20, s20, 1
    s_andn2_b32 s23, s34, s28
    v_mfma_f32_16x16x32_bf16 v[40:43], a[56:59], v[64:67], v[40:43]
    ds_read_b128 v[88:91], v7 offset:30720
    v_mfma_f32_16x16x32_bf16 v[48:51], a[56:59], v[68:71], v[48:51]
    ds_read_b128 v[92:95], v7 offset:30976
    v_mfma_f32_16x16x32_bf16 v[52:55], a[60:63], v[68:71], v[52:55]
    v_mfma_f32_16x16x32_bf16 v[44:47], a[60:63], v[64:67], v[44:47]
    s_waitcnt lgkmcnt(2)
    v_mfma_f32_16x16x32_bf16 v[40:43], a[64:67], v[72:75], v[40:43]
    ds_read_b128 v[64:67], v7 offset:32768
    v_mfma_f32_16x16x32_bf16 v[48:51], a[64:67], v[76:79], v[48:51]
    ds_read_b128 v[68:71], v7 offset:33024
    v_mfma_f32_16x16x32_bf16 v[52:55], a[68:71], v[76:79], v[52:55]
    v_mfma_f32_16x16x32_bf16 v[44:47], a[68:71], v[72:75], v[44:47]
    s_buffer_load_dword s62, s[4:7], s33 glc
    v_mfma_f32_16x16x32_bf16 v[40:43], a[72:75], v[80:83], v[40:43]
    ds_read_b128 v[72:75], v7 offset:34816
    v_mfma_f32_16x16x32_bf16 v[48:51], a[72:75], v[84:87], v[48:51]
    ds_read_b128 v[76:79], v7 offset:35072
    v_mfma_f32_16x16x32_bf16 v[52:55], a[76:79], v[84:87], v[52:55]
    v_mfma_f32_16x16x32_bf16 v[44:47], a[76:79], v[80:83], v[44:47]
    s_waitcnt lgkmcnt(4)
    v_mfma_f32_16x16x32_bf16 v[40:43], a[80:83], v[88:91], v[40:43]
    ds_read_b128 v[80:83], v7 offset:36864
    v_mfma_f32_16x16x32_bf16 v[48:51], a[80:83], v[92:95], v[48:51]
    ds_read_b128 v[84:87], v7 offset:37120
    v_mfma_f32_16x16x32_bf16 v[52:55], a[84:87], v[92:95], v[52:55]
    v_mfma_f32_16x16x32_bf16 v[44:47], a[84:87], v[88:91], v[44:47]
    s_waitcnt lgkmcnt(4)
    v_mfma_f32_16x16x32_bf16 v[40:43], a[88:91], v[64:67], v[40:43]
    ds_read_b128 v[88:91], v7 offset:38912
    v_mfma_f32_16x16x32_bf16 v[48:51], a[88:91], v[68:71], v[48:51]
    ds_read_b128 v[92:95], v7 offset:39168
    v_mfma_f32_16x16x32_bf16 v[52:55], a[92:95], v[68:71], v[52:55]
    v_mfma_f32_16x16x32_bf16 v[44:47], a[92:95], v[64:67], v[44:47]
    s_waitcnt lgkmcnt(4)
    v_mfma_f32_16x16x32_bf16 v[40:43], a[96:99], v[72:75], v[40:43]
    ds_read_b128 v[64:67], v7 offset:40960
    v_mfma_f32_16x16x32_bf16 v[48:51], a[96:99], v[76:79], v[48:51]
    ds_read_b128 v[68:71], v7 offset:41216
    v_mfma_f32_16x16x32_bf16 v[52:55], a[100:103], v[76:79], v[52:55]
    v_mfma_f32_16x16x32_bf16 v[44:47], a[100:103], v[72:75], v[44:47]
    s_waitcnt lgkmcnt(4)
    v_mfma_f32_16x16x32_bf16 v[40:43], a[104:107], v[80:83], v[40:43]
    ds_read_b128 v[72:75], v7 offset:43008
    v_mfma_f32_16x16x32_bf16 v[48:51], a[104:107], v[84:87], v[48:51]
    ds_read_b128 v[76:79], v7 offset:43264
    v_mfma_f32_16x16x32_bf16 v[52:55], a[108:111], v[84:87], v[52:55]
    v_mfma_f32_16x16x32_bf16 v[44:47], a[108:111], v[80:83], v[44:47]
    s_waitcnt lgkmcnt(4)
    v_mfma_f32_16x16x32_bf16 v[40:43], a[112:115], v[88:91], v[40:43]
    ds_read_b128 v[80:83], v7 offset:45056
    v_mfma_f32_16x16x32_bf16 v[48:51], a[112:115], v[92:95], v[48:51]
    ds_read_b128 v[84:87], v7 offset:45312
    v_mfma_f32_16x16x32_bf16 v[52:55], a[116:119], v[92:95], v[52:55]
    v_mfma_f32_16x16x32_bf16 v[44:47], a[116:119], v[88:91], v[44:47]
    s_waitcnt lgkmcnt(4)
    v_mfma_f32_16x16x32_bf16 v[40:43], a[120:123], v[64:67], v[40:43]
    ds_read_b128 v[88:91], v7 offset:47104
    v_mfma_f32_16x16x32_bf16 v[48:51], a[120:123], v[68:71], v[48:51]
    ds_read_b128 v[92:95], v7 offset:47360
    v_mfma_f32_16x16x32_bf16 v[52:55], a[124:127], v[68:71], v[52:55]
    v_mfma_f32_16x16x32_bf16 v[44:47], a[124:127], v[64:67], v[44:47]
    s_waitcnt lgkmcnt(4)
    v_mfma_f32_16x16x32_bf16 v[40:43], a[128:131], v[72:75], v[40:43]
    ds_read_b128 v[64:67], v7 offset:49152
    v_mfma_f32_16x16x32_bf16 v[48:51], a[128:131], v[76:79], v[48:51]
    ds_read_b128 v[68:71], v7 offset:49408
    v_mfma_f32_16x16x32_bf16 v[52:55], a[132:135], v[76:79], v[52:55]
    v_mfma_f32_16x16x32_bf16 v[44:47], a[132:135], v[72:75], v[44:47]
    s_waitcnt vmcnt(0)
    s_branch L_WO_mid1
L_WO_nr1:
    s_mov_b32 s40, 268435456
    s_cmp_eq_u32 s23, 0
    s_cbranch_scc1 L_WO_go1
    s_mov_b32 s3, 0
L_WO_hl1:
    s_buffer_load_dword s62, s[4:7], s33 glc
    s_waitcnt lgkmcnt(0)
    s_cmp_ge_u32 s62, s32
    s_cbranch_scc1 L_WO_hd1
    s_add_u32 s3, s3, 1
    s_cmp_lt_u32 s3, 40000
    s_cbranch_scc1 L_WO_hl1
    s_mov_b32 s3, 35
    s_branch L_abort
L_WO_hd1:
    s_branch L_WO_rd1
L_WO_slow1:
    s_waitcnt lgkmcnt(5)
    v_mfma_f32_16x16x32_bf16 v[40:43], v[192:195], v[72:75], v[40:43]
    s_waitcnt lgkmcnt(4)
    v_mfma_f32_16x16x32_bf16 v[48:51], v[192:195], v[76:79], v[48:51]
    v_mfma_f32_16x16x32_bf16 v[52:55], v[196:199], v[76:79], v[52:55]
    v_mfma_f32_16x16x32_bf16 v[44:47], v[196:199], v[72:75], v[44:47]
    s_waitcnt lgkmcnt(3)
    v_mfma_f32_16x16x32_bf16 v[40:43], v[200:203], v[80:83], v[40:43]
    s_waitcnt lgkmcnt(2)
    v_mfma_f32_16x16x32_bf16 v[48:51], v[200:203], v[84:87], v[48:51]
    v_mfma_f32_16x16x32_bf16 v[52:55], v[204:207], v[84:87], v[52:55]
    v_mfma_f32_16x16x32_bf16 v[44:47], v[204:207], v[80:83], v[44:47]
    s_waitcnt lgkmcnt(1)
    v_mfma_f32_16x16x32_bf16 v[40:43], v[208:211], v[88:91], v[40:43]
    s_waitcnt lgkmcnt(0)
    v_mfma_f32_16x16x32_bf16 v[48:51], v[208:211], v[92:95], v[48:51]
    v_mfma_f32_16x16x32_bf16 v[52:55], v[212:215], v[92:95], v[52:55]
    v_mfma_f32_16x16x32_bf16 v[44:47], v[212:215], v[88:91], v[44:47]
    s_and_b32 s86, s36, 95
    s_mul_i32 s86, s86, 196608
    s_add_u32 s87, s86, s45
    s_add_u32 s86, s86, s44
    s_lshl2_add_u32 s37, s36, s43
    v_cvt_pk_bf16_f32 v96, v40, v41
    v_cvt_pk_bf16_f32 v97, v42, v43
    s_nop 0
    v_cvt_pk_bf16_f32 v98, v44, v45
    v_cvt_pk_bf16_f32 v99, v46, v47
    buffer_store_dwordx4 v[96:99], v4, s[4:7], s86 offen sc1
    v_cvt_pk_bf16_f32 v100, v48, v49
    v_cvt_pk_bf16_f32 v101, v50, v51
    v_cvt_pk_bf16_f32 v102, v52, v53
    v_cvt_pk_bf16_f32 v103, v54, v55
    buffer_store_dwordx4 v[100:103], v4, s[4:7], s87 offen sc1
    s_buffer_load_dword s62, s[4:7], s33 glc
    s_waitcnt vmcnt(0)
    s_add_u32 s92, s59, 1
    v_mov_b32 v12, s92
    s_and_b32 s95, s92, s57
    ds_write_b32 v11, v12
    s_cmp_lg_u32 s58, 0
    s_cbranch_scc1 L_pd_29
    ds_read_b128 v[116:119], v9
    s_waitcnt lgkmcnt(0)
    v_min3_u32 v116, v116, v117, v118
    v_min_u32 v116, v116, v119
    v_cmp_gt_u32 vcc, s95, v116
    s_cbranch_vccnz L_pd_29
    buffer_atomic_add v5, v2, s[4:7], s37 offen
    s_mov_b32 s58, 268435456
L_pd_29:
    s_cmp_lg_u32 s58, 0
    s_cbranch_scc1 L_pd_30
    ds_read_b128 v[116:119], v9
    s_waitcnt lgkmcnt(0)
    v_min3_u32 v116, v116, v117, v118
    v_min_u32 v116, v116, v119
    v_cmp_gt_u32 vcc, s95, v116
    s_cbranch_vccnz L_pd_30
    buffer_atomic_add v5, v2, s[4:7], s37 offen
    s_mov_b32 s58, 268435456
L_pd_30:
    s_cmp_gt_u32 s20, 128
    s_cbranch_scc1 L_WO_done
    s_waitcnt lgkmcnt(0)
    s_cmp_ge_u32 s62, s32
    s_cbranch_scc1 L_WO_sd1
L_WO_ss1:
    s_mov_b32 s3, 0
L_WO_sl1:
    s_cmp_lg_u32 s58, 0
    s_cbranch_scc1 L_pd_31
    ds_read_b128 v[116:119], v9
    s_waitcnt lgkmcnt(0)
    v_min3_u32 v116, v116, v117, v118
    v_min_u32 v116, v116, v119
    v_cmp_gt_u32 vcc, s95, v116
    s_cbranch_vccnz L_pd_31
    buffer_atomic_add v5, v2, s[4:7], s37 offen
    s_mov_b32 s58, 268435456
L_pd_31:
    s_buffer_load_dword s62, s[4:7], s33 glc
    s_waitcnt lgkmcnt(0)
    s_cmp_ge_u32 s62, s32
    s_cbranch_scc1 L_WO_sd1
    s_add_u32 s3, s3, 1
    s_cmp_lt_u32 s3, 40000
    s_cbranch_scc1 L_WO_sl1
    s_mov_b32 s3, 15
    s_branch L_abort
L_WO_sd1:
    s_mov_b32 s40, s31
    s_add_u32 s94, s40, 0
    s_add_u32 m0, s46, 86016
    s_nop 0
    buffer_load_dwordx4 v1, s[4:7], s94 offen offset:0 sc1 lds
    buffer_load_dwordx4 v1, s[4:7], s94 offen offset:1024 sc1 lds
    buffer_load_dwordx4 v1, s[4:7], s94 offen offset:2048 sc1 lds
    buffer_load_dwordx4 v1, s[4:7], s94 offen offset:3072 sc1 lds
    s_add_u32 s94, s40, 16384
    s_add_u32 m0, s46, 69632
    s_nop 0
    buffer_load_dwordx4 v1, s[4:7], s94 offen offset:0 sc1 lds
    buffer_load_dwordx4 v1, s[4:7], s94 offen offset:1024 sc1 lds
    buffer_load_dwordx4 v1, s[4:7], s94 offen offset:2048 sc1 lds
    buffer_load_dwordx4 v1, s[4:7], s94 offen offset:3072 sc1 lds
    s_add_u32 s94, s40, 32768
    s_add_u32 m0, s46, 53248
    s_nop 0
    buffer_load_dwordx4 v1, s[4:7], s94 offen offset:0 sc1 lds
    buffer_load_dwordx4 v1, s[4:7], s94 offen offset:1024 sc1 lds
    buffer_load_dwordx4 v1, s[4:7], s94 offen offset:2048 sc1 lds
    buffer_load_dwordx4 v1, s[4:7], s94 offen offset:3072 sc1 lds
    s_add_u32 s94, s40, 49152
    s_add_u32 m0, s46, 36864
    s_nop 0
    buffer_load_dwordx4 v1, s[4:7], s94 offen offset:0 sc1 lds
    buffer_load_dwordx4 v1, s[4:7], s94 offen offset:1024 sc1 lds
    buffer_load_dwordx4 v1, s[4:7], s94 offen offset:2048 sc1 lds
    buffer_load_dwordx4 v1, s[4:7], s94 offen offset:3072 sc1 lds
    s_waitcnt vmcnt(4)
    s_barrier
    ds_read_b128 v[64:67], v7 offset:20480
    ds_read_b128 v[68:71], v7 offset:20736
    ds_read_b128 v[72:75], v7 offset:22528
    ds_read_b128 v[76:79], v7 offset:22784
    ds_read_b128 v[80:83], v7 offset:16384
    ds_read_b128 v[84:87], v7 offset:16640
    s_waitcnt lgkmcnt(4)
    v_mfma_f32_16x16x32_bf16 v[16:19], a[0:3], v[64:67], 0
    ds_read_b128 v[88:91], v7 offset:18432
    s_add_u32 s94, s40, 65536
    v_mfma_f32_16x16x32_bf16 v[24:27], a[0:3], v[68:71], 0
    ds_read_b128 v[92:95], v7 offset:18688
    s_add_u32 m0, s46, 20480
    v_mfma_f32_16x16x32_bf16 v[28:31], a[4:7], v[68:71], 0
    buffer_load_dwordx4 v1, s[4:7], s94 offen offset:0 sc1 lds
    s_lshl2_add_u32 s37, s36, s43
    v_mfma_f32_16x16x32_bf16 v[20:23], a[4:7], v[64:67], 0
    s_waitcnt lgkmcnt(4)
    s_mov_b32 s34, s28
    s_mov_b32 s35, s29
    v_mfma_f32_16x16x32_bf16 v[16:19], a[8:11], v[72:75], v[16:19]
    ds_read_b128 v[216:219], v7 offset:12288
    s_mov_b32 s36, s30
    v_mfma_f32_16x16x32_bf16 v[24:27], a[8:11], v[76:79], v[24:27]
    ds_read_b128 v[220:223], v7 offset:12544
    s_add_u32 s59, s59, 1
    v_mfma_f32_16x16x32_bf16 v[28:31], a[12:15], v[76:79], v[28:31]
    buffer_load_dwordx4 v1, s[4:7], s94 offen offset:1024 sc1 lds
    v_mfma_f32_16x16x32_bf16 v[20:23], a[12:15], v[72:75], v[20:23]
    s_waitcnt lgkmcnt(2)
    s_cmp_lt_u32 s20, 64
    s_cselect_b64 s[88:89], s[24:25], s[26:27]
    v_mfma_f32_16x16x32_bf16 v[16:19], a[16:19], v[80:83], v[16:19]
    ds_read_b128 v[64:67], v7 offset:14336
    v_mfma_f32_16x16x32_bf16 v[24:27], a[16:19], v[84:87], v[24:27]
    ds_read_b128 v[68:71], v7 offset:14592
    v_mfma_f32_16x16x32_bf16 v[28:31], a[20:23], v[84:87], v[28:31]
    buffer_load_dwordx4 v1, s[4:7], s94 offen offset:2048 sc1 lds
    v_mfma_f32_16x16x32_bf16 v[20:23], a[20:23], v[80:83], v[20:23]
    s_bitcmp1_b64 s[88:89], s20
    s_cselect_b32 s28, 1, 0
    s_cselect_b32 s29, s22, s21
    v_mfma_f32_16x16x32_bf16 v[16:19], a[24:27], v[88:91], v[16:19]
    ds_read_b128 v[72:75], v7 offset:8192
    s_add_u32 s22, s22, s28
    v_mfma_f32_16x16x32_bf16 v[24:27], a[24:27], v[92:95], v[24:27]
    ds_read_b128 v[76:79], v7 offset:8448
    s_xor_b32 s88, s28, 1
    v_mfma_f32_16x16x32_bf16 v[28:31], a[28:31], v[92:95], v[28:31]
    buffer_load_dwordx4 v1, s[4:7], s94 offen offset:3072 sc1 lds
    s_add_u32 s21, s21, s88
    v_mfma_f32_16x16x32_bf16 v[20:23], a[28:31], v[88:91], v[20:23]
    s_waitcnt lgkmcnt(2)
    s_lshl_b32 s30, s28, 6
    s_add_u32 s30, s30, s29
    v_mfma_f32_16x16x32_bf16 v[16:19], a[32:35], v[216:219], v[16:19]
    ds_read_b128 v[80:83], v7 offset:10240
    s_add_u32 s94, s40, s96
    v_mfma_f32_16x16x32_bf16 v[24:27], a[32:35], v[220:223], v[24:27]
    ds_read_b128 v[84:87], v7 offset:10496
    s_add_u32 s94, s94, 81920
    v_mfma_f32_16x16x32_bf16 v[28:31], a[36:39], v[220:223], v[28:31]
    s_add_u32 m0, s97, 4096
    s_and_b32 s31, s30, 95
    s_mul_i32 s31, s31, 262144
    v_mfma_f32_16x16x32_bf16 v[20:23], a[36:39], v[216:219], v[20:23]
    buffer_load_dwordx4 v1, s[4:7], s94 offen offset:0 sc1 lds
    s_add_u32 s31, s31, s42
    v_mfma_f32_16x16x32_bf16 v[16:19], a[40:43], v[64:67], v[16:19]
    ds_read_b128 v[88:91], v7 offset:4096
    s_lshl2_add_u32 s33, s30, s60
    v_mfma_f32_16x16x32_bf16 v[24:27], a[40:43], v[68:71], v[24:27]
    ds_read_b128 v[92:95], v7 offset:4352
    v_mfma_f32_16x16x32_bf16 v[28:31], a[44:47], v[68:71], v[28:31]
    s_cmp_lt_u32 s18, 2
    s_cbranch_scc0 L_sk_32
    s_add_u32 s94, s40, s96
    s_add_u32 s94, s94, 86016
    s_add_u32 m0, s97, 0
    s_nop 0
    buffer_load_dwordx4 v1, s[4:7], s94 offen offset:0 sc1 lds
L_sk_32:
    v_mfma_f32_16x16x32_bf16 v[20:23], a[44:47], v[64:67], v[20:23]
    s_waitcnt lgkmcnt(2)
    v_mfma_f32_16x16x32_bf16 v[16:19], a[48:51], v[72:75], v[16:19]
    ds_read_b128 v[216:219], v7 offset:6144
    v_mfma_f32_16x16x32_bf16 v[24:27], a[48:51], v[76:79], v[24:27]
    ds_read_b128 v[220:223], v7 offset:6400
    v_mfma_f32_16x16x32_bf16 v[28:31], a[52:55], v[76:79], v[28:31]
    s_cmp_lt_u32 s20, 128
    s_cselect_b32 s31, s31, 268435456
    s_cselect_b32 s32, s61, 0
    v_mfma_f32_16x16x32_bf16 v[20:23], a[52:55], v[72:75], v[20:23]
    s_add_u32 s20, s20, 1
    s_andn2_b32 s23, s34, s28
    v_mfma_f32_16x16x32_bf16 v[16:19], a[56:59], v[80:83], v[16:19]
    ds_read_b128 v[64:67], v7 offset:0
    v_mfma_f32_16x16x32_bf16 v[24:27], a[56:59], v[84:87], v[24:27]
    ds_read_b128 v[68:71], v7 offset:256
    v_mfma_f32_16x16x32_bf16 v[28:31], a[60:63], v[84:87], v[28:31]
    v_mfma_f32_16x16x32_bf16 v[20:23], a[60:63], v[80:83], v[20:23]
    s_waitcnt lgkmcnt(2)
    v_mfma_f32_16x16x32_bf16 v[16:19], a[64:67], v[88:91], v[16:19]
    ds_read_b128 v[72:75], v7 offset:2048
    v_mfma_f32_16x16x32_bf16 v[24:27], a[64:67], v[92:95], v[24:27]
    ds_read_b128 v[76:79], v7 offset:2304
    v_mfma_f32_16x16x32_bf16 v[28:31], a[68:71], v[92:95], v[28:31]
    v_mfma_f32_16x16x32_bf16 v[20:23], a[68:71], v[88:91], v[20:23]
    s_buffer_load_dword s62, s[4:7], s33 glc
    v_mfma_f32_16x16x32_bf16 v[16:19], a[72:75], v[216:219], v[16:19]
    ds_read_b128 v[80:83], v6 offset:61440
    v_mfma_f32_16x16x32_bf16 v[24:27], a[72:75], v[220:223], v[24:27]
    ds_read_b128 v[84:87], v6 offset:61696
    v_mfma_f32_16x16x32_bf16 v[28:31], a[76:79], v[220:223], v[28:31]
    v_mfma_f32_16x16x32_bf16 v[20:23], a[76:79], v[216:219], v[20:23]
    s_waitcnt lgkmcnt(4)
    v_mfma_f32_16x16x32_bf16 v[16:19], a[80:83], v[64:67], v[16:19]
    ds_read_b128 v[88:91], v6 offset:63488
    v_mfma_f32_16x16x32_bf16 v[24:27], a[80:83], v[68:71], v[24:27]
    ds_read_b128 v[92:95], v6 offset:63744
    v_mfma_f32_16x16x32_bf16 v[28:31], a[84:87], v[68:71], v[28:31]
    v_mfma_f32_16x16x32_bf16 v[20:23], a[84:87], v[64:67], v[20:23]
    s_waitcnt lgkmcnt(4)
    v_mfma_f32_16x16x32_bf16 v[16:19], a[88:91], v[72:75], v[16:19]
    ds_read_b128 v[64:67], v6 offset:57344
    v_mfma_f32_16x16x32_bf16 v[24:27], a[88:91], v[76:79], v[24:27]
    ds_read_b128 v[68:71], v6 offset:57600
    v_mfma_f32_16x16x32_bf16 v[28:31], a[92:95], v[76:79], v[28:31]
    v_mfma_f32_16x16x32_bf16 v[20:23], a[92:95], v[72:75], v[20:23]
    s_waitcnt lgkmcnt(4)
    v_mfma_f32_16x16x32_bf16 v[16:19], a[96:99], v[80:83], v[16:19]
    ds_read_b128 v[72:75], v6 offset:59392
    v_mfma_f32_16x16x32_bf16 v[24:27], a[96:99], v[84:87], v[24:27]
    ds_read_b128 v[76:79], v6 offset:59648
    v_mfma_f32_16x16x32_bf16 v[28:31], a[100:103], v[84:87], v[28:31]
    v_mfma_f32_16x16x32_bf16 v[20:23], a[100:103], v[80:83], v[20:23]
    s_waitcnt lgkmcnt(4)
    v_mfma_f32_16x16x32_bf16 v[16:19], a[104:107], v[88:91], v[16:19]
    ds_read_b128 v[80:83], v6 offset:53248
    v_mfma_f32_16x16x32_bf16 v[24:27], a[104:107], v[92:95], v[24:27]
    ds_read_b128 v[84:87], v6 offset:53504
    v_mfma_f32_16x16x32_bf16 v[28:31], a[108:111], v[92:95], v[28:31]
    v_mfma_f32_16x16x32_bf16 v[20:23], a[108:111], v[88:91], v[20:23]
    s_waitcnt lgkmcnt(4)
    v_mfma_f32_16x16x32_bf16 v[16:19], a[112:115], v[64:67], v[16:19]
    ds_read_b128 v[88:91], v6 offset:55296
    v_mfma_f32_16x16x32_bf16 v[24:27], a[112:115], v[68:71], v[24:27]
    ds_read_b128 v[92:95], v6 offset:55552
    v_mfma_f32_16x16x32_bf16 v[28:31], a[116:119], v[68:71], v[28:31]
    v_mfma_f32_16x16x32_bf16 v[20:23], a[116:119], v[64:67], v[20:23]
    s_waitcnt lgkmcnt(4)
    v_mfma_f32_16x16x32_bf16 v[16:19], a[120:123], v[72:75], v[16:19]
    ds_read_b128 v[64:67], v6 offset:49152
    v_mfma_f32_16x16x32_bf16 v[24:27], a[120:123], v[76:79], v[24:27]
    ds_read_b128 v[68:71], v6 offset:49408
    v_mfma_f32_16x16x32_bf16 v[28:31], a[124:127], v[76:79], v[28:31]
    v_mfma_f32_16x16x32_bf16 v[20:23], a[124:127], v[72:75], v[20:23]
    s_waitcnt lgkmcnt(4)
    v_mfma_f32_16x16x32_bf16 v[16:19], a[128:131], v[80:83], v[16:19]
    ds_read_b128 v[72:75], v6 offset:51200
    v_mfma_f32_16x16x32_bf16 v[24:27], a[128:131], v[84:87], v[24:27]
    ds_read_b128 v[76:79], v6 offset:51456
    v_mfma_f32_16x16x32_bf16 v[28:31], a[132:135], v[84:87], v[28:31]
    v_mfma_f32_16x16x32_bf16 v[20:23], a[132:135], v[80:83], v[20:23]
    s_waitcnt vmcnt(0)
    s_branch L_WO_mid0
L_WO_done:
    s_mov_b32 s3, 0
L_WO_dl:
    s_cmp_lg_u32 s58, 0
    s_cbranch_scc1 L_pd_33
    ds_read_b128 v[116:119], v9
    s_waitcnt lgkmcnt(0)
    v_min3_u32 v116, v116, v117, v118
    v_min_u32 v116, v116, v119
    v_cmp_gt_u32 vcc, s95, v116
    s_cbranch_vccnz L_pd_33
    buffer_atomic_add v5, v2, s[4:7], s37 offen
    s_mov_b32 s58, 268435456
L_pd_33:
    s_cmp_lg_u32 s58, 0
    s_cbranch_scc1 L_WO_dd
    s_add_u32 s3, s3, 1
    s_cmp_lt_u32 s3, 40000
    s_cbranch_scc1 L_WO_dl
    s_mov_b32 s3, 55
    s_branch L_abort
L_WO_dd:
    s_endpgm
L_role_DN:
    v_mov_b32 v20, v0
    v_lshlrev_b32 v0, 4, v20
    v_mov_b32 v3, 0
    v_and_b32 v21, 15, v20
    v_lshlrev_b32 v21, 4, v21
    v_lshrrev_b32 v22, 4, v20
    v_lshl_add_u32 v19, v22, 9, v21
    v_mov_b32 v1, v0
    v_mov_b32 v6, v19
    v_add_u32 v7, 0x10000, v6
    v_add_u32 v8, 0x20000, v6
    s_mov_b32 s24, 0x55555000
    s_mov_b32 s25, 0x55555555
    s_mov_b32 s26, 0xaaaaa955
    s_mov_b32 s27, 0xfffaaaaa
    s_lshr_b32 s48, s19, 3
    s_and_b32 s49, s19, 7
    s_mul_i32 s50, s48, 37
    s_mul_i32 s60, s19, 640
    s_add_u32 s60, s60, 1670144
    s_and_b32 s61, s48, 1
    s_add_u32 s61, s61, 19
    s_mov_b32 s43, 1731584
    v_add_u32 v21, 0, v20
    v_mul_u32_u24 v21, 640, v21
    v_mov_b32 v22, 0x40000000
    v_cmp_gt_u32 vcc, 8, v20
    s_nop 1
    v_cndmask_b32 v2, v22, v21, vcc
    v_mov_b32 v5, 1
    s_lshl_b32 s92, s50, 11
    s_lshl_b32 s93, s18, 12
    s_add_u32 s42, s92, s93
    s_add_u32 s42, s42, 150994944
    s_lshl_b32 s92, s48, 16
    s_lshl_b32 s93, s49, 10
    s_add_u32 s92, s92, s93
    s_lshl_b32 s93, s18, 8
    s_add_u32 s92, s92, s93
    s_add_u32 s44, s92, 209715200
    v_bfe_u32 v21, v20, 2, 2
    v_lshlrev_b32 v21, 13, v21
    v_lshrrev_b32 v22, 4, v20
    v_lshl_add_u32 v21, v22, 6, v21
    v_and_b32 v22, 3, v20
    v_lshl_add_u32 v4, v22, 4, v21
    s_mov_b32 s93, 2048
    s_mul_i32 s94, s18, 16384
    s_and_b32 s95, s18, 1
    s_lshl_b32 s95, s95, 2
    v_lshrrev_b32 v24, 4, v20
    v_mul_lo_u32 v21, v24, s93
    v_and_b32 v22, 15, v20
    v_lshlrev_b32 v23, 2, v24
    v_xor_b32 v22, v22, v23
    v_lshl_add_u32 v21, v22, 4, v21
    v_add_u32 v31, s94, v21
    v_lshrrev_b32 v21, 3, v20
    v_mul_lo_u32 v21, v21, s93
    v_and_b32 v22, 7, v20
    v_and_b32 v23, 1, v24
    v_lshl_add_u32 v23, v23, 1, s95
    v_xor_b32 v22, v22, v23
    v_lshl_add_u32 v21, v22, 4, v21
    v_add_u32 v32, s94, v21
    v_bfe_u32 v25, v20, 2, 2
    v_and_b32 v22, 3, v20
    v_xor_b32 v26, s18, v25
    v_lshlrev_b32 v26, 6, v26
    v_lshl_add_u32 v26, v25, 8, v26
    v_add_u32 v26, 0, v26
    v_lshl_add_u32 v27, v24, 11, v26
    v_lshl_add_u32 v100, v22, 4, v27
    v_lshl_add_u32 v103, v22, 3, v27
    v_lshl_add_u32 v27, v24, 10, v26
    v_lshl_add_u32 v106, v22, 4, v27
    v_lshrrev_b32 v26, 1, v25
    v_and_b32 v27, 1, v24
    v_lshl_add_u32 v26, v27, 1, v26
    v_xor_b32 v26, s18, v26
    v_lshlrev_b32 v26, 5, v26
    v_lshl_add_u32 v26, v25, 7, v26
    v_lshl_add_u32 v26, v24, 10, v26
    v_lshl_add_u32 v26, v22, 3, v26
    v_add_u32 v109, 0, v26
    v_add_u32 v101, 0x10000, v100
    v_add_u32 v102, 0x20000, v100
    v_add_u32 v104, 0x10000, v103
    v_add_u32 v105, 0x20000, v103
    v_add_u32 v107, 0x10000, v106
    v_add_u32 v108, 0x20000, v106
    v_add_u32 v110, 0x10000, v109
    v_add_u32 v111, 0x20000, v109
    s_cmp_eq_u32 s79, 2
    s_cbranch_scc1 L_fl_34
    s_waitcnt vmcnt(0)
    s_barrier
    s_cmp_lg_u32 s18, 0
    s_cbranch_scc1 L_arr_35
    s_mov_b32 s3, 1
    s_buffer_atomic_add s3, s[12:15], 4 glc
    s_waitcnt lgkmcnt(0)
    s_add_u32 s3, s3, 1
    s_and_b32 s92, s3, 0xffff
    s_cmp_lg_u32 s92, 256
    s_cbranch_scc1 L_arr_35
    v_mov_b32 v20, s3
    v_lshlrev_b32 v21, 3, v0
    s_mov_b32 s92, 163840
    buffer_store_dword v20, v21, s[4:7], s92 offen sc1
    s_mov_b32 s92, 172032
    buffer_store_dword v20, v21, s[4:7], s92 offen sc1
    s_mov_b32 s92, 180224
    buffer_store_dword v20, v21, s[4:7], s92 offen sc1
    s_mov_b32 s92, 188416
    buffer_store_dword v20, v21, s[4:7], s92 offen sc1
    s_waitcnt vmcnt(0)
L_arr_35:
L_fl_34:
    s_mov_b32 s8, s84
    s_mov_b32 s9, s85
    s_mov_b32 s10, 7340032
    s_mov_b32 s11, 0x20000
    s_lshl_b32 s92, s50, 16
    s_lshl_b32 s93, s49, 8
    s_add_u32 s51, s92, s93
    s_lshl_b32 s93, s16, 5
    s_add_u32 s93, s93, s17
    s_lshl_b32 s93, s93, 7
    s_add_u32 s93, s93, 163840
    s_mov_b32 s3, 0
L_ws_36:
    s_buffer_load_dword s92, s[4:7], s93 glc
    s_waitcnt lgkmcnt(0)
    s_cmp_lg_u32 s92, 0
    s_cbranch_scc1 L_wsd_37
    s_add_u32 s3, s3, 1
    s_cmp_lt_u32 s3, 40000
    s_cbranch_scc1 L_ws_36
    s_mov_b32 s3, 14
    s_branch L_abort
L_wsd_37:
    s_and_b32 s92, s19, 31
    s_mul_i32 s92, s92, 640
    s_add_u32 s92, s92, 1572864
    s_mov_b32 s3, 0
L_wf_38:
    s_buffer_load_dword s62, s[4:7], s92 glc
    s_waitcnt lgkmcnt(0)
    s_cmp_ge_u32 s62, 1
    s_cbranch_scc1 L_wfd_39
    s_sleep 16
    s_add_u32 s3, s3, 1
    s_cmp_lt_u32 s3, 40000
    s_cbranch_scc1 L_wf_38
    s_mov_b32 s3, 62
    s_branch L_abort
L_wfd_39:
    s_lshl_b32 s46, s18, 11
    s_lshl_b32 s47, s18, 10
    s_add_u32 s92, s51, 0
    s_add_u32 m0, s46, 0
    s_nop 0
    buffer_load_dwordx4 v31, s[8:11], s92 offen nt lds
    s_add_u32 s92, s51, 8192
    s_add_u32 m0, s46, 1024
    s_nop 0
    buffer_load_dwordx4 v31, s[8:11], s92 offen nt lds
    s_add_u32 s92, s51, 65536
    s_add_u32 m0, s46, 8192
    s_nop 0
    buffer_load_dwordx4 v31, s[8:11], s92 offen nt lds
    s_add_u32 s92, s51, 73728
    s_add_u32 m0, s46, 9216
    s_nop 0
    buffer_load_dwordx4 v31, s[8:11], s92 offen nt lds
    s_add_u32 s92, s51, 131072
    s_add_u32 m0, s46, 16384
    s_nop 0
    buffer_load_dwordx4 v31, s[8:11], s92 offen nt lds
    s_add_u32 s92, s51, 139264
    s_add_u32 m0, s46, 17408
    s_nop 0
    buffer_load_dwordx4 v31, s[8:11], s92 offen nt lds
    s_add_u32 s92, s51, 196608
    s_add_u32 m0, s46, 24576
    s_nop 0
    buffer_load_dwordx4 v31, s[8:11], s92 offen nt lds
    s_add_u32 s92, s51, 204800
    s_add_u32 m0, s46, 25600
    s_nop 0
    buffer_load_dwordx4 v31, s[8:11], s92 offen nt lds
    s_add_u32 s92, s51, 262144
    s_add_u32 m0, s46, 32768
    s_nop 0
    buffer_load_dwordx4 v31, s[8:11], s92 offen nt lds
    s_add_u32 s92, s51, 270336
    s_add_u32 m0, s46, 33792
    s_nop 0
    buffer_load_dwordx4 v31, s[8:11], s92 offen nt lds
    s_add_u32 s92, s51, 327680
    s_add_u32 m0, s46, 40960
    s_nop 0
    buffer_load_dwordx4 v31, s[8:11], s92 offen nt lds
    s_add_u32 s92, s51, 335872
    s_add_u32 m0, s46, 41984
    s_nop 0
    buffer_load_dwordx4 v31, s[8:11], s92 offen nt lds
    s_add_u32 s92, s51, 393216
    s_add_u32 m0, s46, 49152
    s_nop 0
    buffer_load_dwordx4 v31, s[8:11], s92 offen nt lds
    s_add_u32 s92, s51, 401408
    s_add_u32 m0, s46, 50176
    s_nop 0
    buffer_load_dwordx4 v31, s[8:11], s92 offen nt lds
    s_add_u32 s92, s51, 458752
    s_add_u32 m0, s46, 57344
    s_nop 0
    buffer_load_dwordx4 v31, s[8:11], s92 offen nt lds
    s_add_u32 s92, s51, 466944
    s_add_u32 m0, s46, 58368
    s_nop 0
    buffer_load_dwordx4 v31, s[8:11], s92 offen nt lds
    s_add_u32 s92, s51, 524288
    s_add_u32 m0, s46, 65536
    s_nop 0
    buffer_load_dwordx4 v31, s[8:11], s92 offen nt lds
    s_add_u32 s92, s51, 532480
    s_add_u32 m0, s46, 66560
    s_nop 0
    buffer_load_dwordx4 v31, s[8:11], s92 offen nt lds
    s_add_u32 s92, s51, 589824
    s_add_u32 m0, s46, 73728
    s_nop 0
    buffer_load_dwordx4 v31, s[8:11], s92 offen nt lds
    s_add_u32 s92, s51, 598016
    s_add_u32 m0, s46, 74752
    s_nop 0
    buffer_load_dwordx4 v31, s[8:11], s92 offen nt lds
    s_add_u32 s92, s51, 655360
    s_add_u32 m0, s46, 81920
    s_nop 0
    buffer_load_dwordx4 v31, s[8:11], s92 offen nt lds
    s_add_u32 s92, s51, 663552
    s_add_u32 m0, s46, 82944
    s_nop 0
    buffer_load_dwordx4 v31, s[8:11], s92 offen nt lds
    s_add_u32 s92, s51, 720896
    s_add_u32 m0, s46, 90112
    s_nop 0
    buffer_load_dwordx4 v31, s[8:11], s92 offen nt lds
    s_add_u32 s92, s51, 729088
    s_add_u32 m0, s46, 91136
    s_nop 0
    buffer_load_dwordx4 v31, s[8:11], s92 offen nt lds
    s_waitcnt vmcnt(16)
    s_barrier
    s_add_u32 s92, s51, 786432
    s_add_u32 m0, s46, 98304
    s_nop 0
    buffer_load_dwordx4 v31, s[8:11], s92 offen nt lds
    s_add_u32 s92, s51, 794624
    s_add_u32 m0, s46, 99328
    s_nop 0
    buffer_load_dwordx4 v31, s[8:11], s92 offen nt lds
    s_add_u32 s92, s51, 851968
    s_add_u32 m0, s46, 106496
    s_nop 0
    buffer_load_dwordx4 v31, s[8:11], s92 offen nt lds
    s_add_u32 s92, s51, 860160
    s_add_u32 m0, s46, 107520
    s_nop 0
    buffer_load_dwordx4 v31, s[8:11], s92 offen nt lds
    s_add_u32 s92, s51, 917504
    s_add_u32 m0, s46, 114688
    s_nop 0
    buffer_load_dwordx4 v31, s[8:11], s92 offen nt lds
    s_add_u32 s92, s51, 925696
    s_add_u32 m0, s46, 115712
    s_nop 0
    buffer_load_dwordx4 v31, s[8:11], s92 offen nt lds
    s_add_u32 s92, s51, 983040
    s_add_u32 m0, s46, 122880
    s_nop 0
    buffer_load_dwordx4 v31, s[8:11], s92 offen nt lds
    s_add_u32 s92, s51, 991232
    s_add_u32 m0, s46, 123904
    s_nop 0
    buffer_load_dwordx4 v31, s[8:11], s92 offen nt lds
    ds_read_b64_tr_b16 a[0:1], v100 offset:0
    ds_read_b64_tr_b16 a[2:3], v100 offset:1024
    ds_read_b64_tr_b16 a[4:5], v100 offset:8
    ds_read_b64_tr_b16 a[6:7], v100 offset:1032
    ds_read_b64_tr_b16 a[8:9], v100 offset:8192
    ds_read_b64_tr_b16 a[10:11], v100 offset:9216
    ds_read_b64_tr_b16 a[12:13], v100 offset:8200
    ds_read_b64_tr_b16 a[14:15], v100 offset:9224
    ds_read_b64_tr_b16 a[16:17], v100 offset:16384
    ds_read_b64_tr_b16 a[18:19], v100 offset:17408
    ds_read_b64_tr_b16 a[20:21], v100 offset:16392
    ds_read_b64_tr_b16 a[22:23], v100 offset:17416
    ds_read_b64_tr_b16 a[24:25], v100 offset:24576
    ds_read_b64_tr_b16 a[26:27], v100 offset:25600
    ds_read_b64_tr_b16 a[28:29], v100 offset:24584
    ds_read_b64_tr_b16 a[30:31], v100 offset:25608
    s_waitcnt lgkmcnt(0)
    s_waitcnt vmcnt(16)
    s_barrier
    s_add_u32 s92, s51, 1048576
    s_add_u32 m0, s46, 0
    s_nop 0
    buffer_load_dwordx4 v31, s[8:11], s92 offen nt lds
    s_add_u32 s92, s51, 1056768
    s_add_u32 m0, s46, 1024
    s_nop 0
    buffer_load_dwordx4 v31, s[8:11], s92 offen nt lds
    s_add_u32 s92, s51, 1114112
    s_add_u32 m0, s46, 8192
    s_nop 0
    buffer_load_dwordx4 v31, s[8:11], s92 offen nt lds
    s_add_u32 s92, s51, 1122304
    s_add_u32 m0, s46, 9216
    s_nop 0
    buffer_load_dwordx4 v31, s[8:11], s92 offen nt lds
    s_add_u32 s92, s51, 1179648
    s_add_u32 m0, s46, 16384
    s_nop 0
    buffer_load_dwordx4 v31, s[8:11], s92 offen nt lds
    s_add_u32 s92, s51, 1187840
    s_add_u32 m0, s46, 17408
    s_nop 0
    buffer_load_dwordx4 v31, s[8:11], s92 offen nt lds
    s_add_u32 s92, s51, 1245184
    s_add_u32 m0, s46, 24576
    s_nop 0
    buffer_load_dwordx4 v31, s[8:11], s92 offen nt lds
    s_add_u32 s92, s51, 1253376
    s_add_u32 m0, s46, 25600
    s_nop 0
    buffer_load_dwordx4 v31, s[8:11], s92 offen nt lds
    ds_read_b64_tr_b16 a[32:33], v100 offset:32768
    ds_read_b64_tr_b16 a[34:35], v100 offset:33792
    ds_read_b64_tr_b16 a[36:37], v100 offset:32776
    ds_read_b64_tr_b16 a[38:39], v100 offset:33800
    ds_read_b64_tr_b16 a[40:41], v100 offset:40960
    ds_read_b64_tr_b16 a[42:43], v100 offset:41984
    ds_read_b64_tr_b16 a[44:45], v100 offset:40968
    ds_read_b64_tr_b16 a[46:47], v100 offset:41992
    ds_read_b64_tr_b16 a[48:49], v100 offset:49152
    ds_read_b64_tr_b16 a[50:51], v100 offset:50176
    ds_read_b64_tr_b16 a[52:53], v100 offset:49160
    ds_read_b64_tr_b16 a[54:55], v100 offset:50184
    ds_read_b64_tr_b16 a[56:57], v100 offset:57344
    ds_read_b64_tr_b16 a[58:59], v100 offset:58368
    ds_read_b64_tr_b16 a[60:61], v100 offset:57352
    ds_read_b64_tr_b16 a[62:63], v100 offset:58376
    s_waitcnt lgkmcnt(0)
    s_waitcnt vmcnt(16)
    s_barrier
    s_add_u32 s92, s51, 1310720
    s_add_u32 m0, s46, 32768
    s_nop 0
    buffer_load_dwordx4 v31, s[8:11], s92 offen nt lds
    s_add_u32 s92, s51, 1318912
    s_add_u32 m0, s46, 33792
    s_nop 0
    buffer_load_dwordx4 v31, s[8:11], s92 offen nt lds
    s_add_u32 s92, s51, 1376256
    s_add_u32 m0, s46, 40960
    s_nop 0
    buffer_load_dwordx4 v31, s[8:11], s92 offen nt lds
    s_add_u32 s92, s51, 1384448
    s_add_u32 m0, s46, 41984
    s_nop 0
    buffer_load_dwordx4 v31, s[8:11], s92 offen nt lds
    s_add_u32 s92, s51, 1441792
    s_add_u32 m0, s46, 49152
    s_nop 0
    buffer_load_dwordx4 v31, s[8:11], s92 offen nt lds
    s_add_u32 s92, s51, 1449984
    s_add_u32 m0, s46, 50176
    s_nop 0
    buffer_load_dwordx4 v31, s[8:11], s92 offen nt lds
    s_add_u32 s92, s51, 1507328
    s_add_u32 m0, s46, 57344
    s_nop 0
    buffer_load_dwordx4 v31, s[8:11], s92 offen nt lds
    s_add_u32 s92, s51, 1515520
    s_add_u32 m0, s46, 58368
    s_nop 0
    buffer_load_dwordx4 v31, s[8:11], s92 offen nt lds
    ds_read_b64_tr_b16 a[64:65], v101 offset:0
    ds_read_b64_tr_b16 a[66:67], v101 offset:1024
    ds_read_b64_tr_b16 a[68:69], v101 offset:8
    ds_read_b64_tr_b16 a[70:71], v101 offset:1032
    ds_read_b64_tr_b16 a[72:73], v101 offset:8192
    ds_read_b64_tr_b16 a[74:75], v101 offset:9216
    ds_read_b64_tr_b16 a[76:77], v101 offset:8200
    ds_read_b64_tr_b16 a[78:79], v101 offset:9224
    ds_read_b64_tr_b16 a[80:81], v101 offset:16384
    ds_read_b64_tr_b16 a[82:83], v101 offset:17408
    ds_read_b64_tr_b16 a[84:85], v101 offset:16392
    ds_read_b64_tr_b16 a[86:87], v101 offset:17416
    ds_read_b64_tr_b16 a[88:89], v101 offset:24576
    ds_read_b64_tr_b16 a[90:91], v101 offset:25600
    ds_read_b64_tr_b16 a[92:93], v101 offset:24584
    ds_read_b64_tr_b16 a[94:95], v101 offset:25608
    s_waitcnt lgkmcnt(0)
    s_waitcnt vmcnt(16)
    s_barrier
    s_add_u32 s92, s51, 1572864
    s_add_u32 m0, s46, 65536
    s_nop 0
    buffer_load_dwordx4 v31, s[8:11], s92 offen nt lds
    s_add_u32 s92, s51, 1581056
    s_add_u32 m0, s46, 66560
    s_nop 0
    buffer_load_dwordx4 v31, s[8:11], s92 offen nt lds
    s_add_u32 s92, s51, 1638400
    s_add_u32 m0, s46, 73728
    s_nop 0
    buffer_load_dwordx4 v31, s[8:11], s92 offen nt lds
    s_add_u32 s92, s51, 1646592
    s_add_u32 m0, s46, 74752
    s_nop 0
    buffer_load_dwordx4 v31, s[8:11], s92 offen nt lds
    s_add_u32 s92, s51, 1703936
    s_add_u32 m0, s46, 81920
    s_nop 0
    buffer_load_dwordx4 v31, s[8:11], s92 offen nt lds
    s_add_u32 s92, s51, 1712128
    s_add_u32 m0, s46, 82944
    s_nop 0
    buffer_load_dwordx4 v31, s[8:11], s92 offen nt lds
    s_add_u32 s92, s51, 1769472
    s_add_u32 m0, s46, 90112
    s_nop 0
    buffer_load_dwordx4 v31, s[8:11], s92 offen nt lds
    s_add_u32 s92, s51, 1777664
    s_add_u32 m0, s46, 91136
    s_nop 0
    buffer_load_dwordx4 v31, s[8:11], s92 offen nt lds
    ds_read_b64_tr_b16 a[96:97], v101 offset:32768
    ds_read_b64_tr_b16 a[98:99], v101 offset:33792
    ds_read_b64_tr_b16 a[100:101], v101 offset:32776
    ds_read_b64_tr_b16 a[102:103], v101 offset:33800
    ds_read_b64_tr_b16 a[104:105], v101 offset:40960
    ds_read_b64_tr_b16 a[106:107], v101 offset:41984
    ds_read_b64_tr_b16 a[108:109], v101 offset:40968
    ds_read_b64_tr_b16 a[110:111], v101 offset:41992
    ds_read_b64_tr_b16 a[112:113], v101 offset:49152
    ds_read_b64_tr_b16 a[114:115], v101 offset:50176
    ds_read_b64_tr_b16 a[116:117], v101 offset:49160
    ds_read_b64_tr_b16 a[118:119], v101 offset:50184
    ds_read_b64_tr_b16 a[120:121], v101 offset:57344
    ds_read_b64_tr_b16 a[122:123], v101 offset:58368
    ds_read_b64_tr_b16 a[124:125], v101 offset:57352
    ds_read_b64_tr_b16 a[126:127], v101 offset:58376
    s_waitcnt lgkmcnt(0)
    s_waitcnt vmcnt(16)
    s_barrier
    s_add_u32 s92, s51, 1835008
    s_add_u32 m0, s46, 98304
    s_nop 0
    buffer_load_dwordx4 v31, s[8:11], s92 offen nt lds
    s_add_u32 s92, s51, 1843200
    s_add_u32 m0, s46, 99328
    s_nop 0
    buffer_load_dwordx4 v31, s[8:11], s92 offen nt lds
    s_add_u32 s92, s51, 1900544
    s_add_u32 m0, s46, 106496
    s_nop 0
    buffer_load_dwordx4 v31, s[8:11], s92 offen nt lds
    s_add_u32 s92, s51, 1908736
    s_add_u32 m0, s46, 107520
    s_nop 0
    buffer_load_dwordx4 v31, s[8:11], s92 offen nt lds
    s_add_u32 s92, s51, 1966080
    s_add_u32 m0, s46, 114688
    s_nop 0
    buffer_load_dwordx4 v31, s[8:11], s92 offen nt lds
    s_add_u32 s92, s51, 1974272
    s_add_u32 m0, s46, 115712
    s_nop 0
    buffer_load_dwordx4 v31, s[8:11], s92 offen nt lds
    s_add_u32 s92, s51, 2031616
    s_add_u32 m0, s46, 122880
    s_nop 0
    buffer_load_dwordx4 v31, s[8:11], s92 offen nt lds
    s_add_u32 s92, s51, 2039808
    s_add_u32 m0, s46, 123904
    s_nop 0
    buffer_load_dwordx4 v31, s[8:11], s92 offen nt lds
    ds_read_b64_tr_b16 a[128:129], v100 offset:0
    ds_read_b64_tr_b16 a[130:131], v100 offset:1024
    ds_read_b64_tr_b16 a[132:133], v100 offset:8
    ds_read_b64_tr_b16 a[134:135], v100 offset:1032
    ds_read_b64_tr_b16 a[136:137], v100 offset:8192
    ds_read_b64_tr_b16 a[138:139], v100 offset:9216
    ds_read_b64_tr_b16 a[140:141], v100 offset:8200
    ds_read_b64_tr_b16 a[142:143], v100 offset:9224
    ds_read_b64_tr_b16 a[144:145], v100 offset:16384
    ds_read_b64_tr_b16 a[146:147], v100 offset:17408
    ds_read_b64_tr_b16 a[148:149], v100 offset:16392
    ds_read_b64_tr_b16 a[150:151], v100 offset:17416
    ds_read_b64_tr_b16 a[152:153], v100 offset:24576
    ds_read_b64_tr_b16 a[154:155], v100 offset:25600
    ds_read_b64_tr_b16 a[156:157], v100 offset:24584
    ds_read_b64_tr_b16 a[158:159], v100 offset:25608
    s_waitcnt lgkmcnt(0)
    s_waitcnt vmcnt(16)
    s_barrier
    s_add_u32 s92, s51, 2097152
    s_add_u32 m0, s46, 0
    s_nop 0
    buffer_load_dwordx4 v31, s[8:11], s92 offen nt lds
    s_add_u32 s92, s51, 2105344
    s_add_u32 m0, s46, 1024
    s_nop 0
    buffer_load_dwordx4 v31, s[8:11], s92 offen nt lds
    s_add_u32 s92, s51, 2162688
    s_add_u32 m0, s46, 8192
    s_nop 0
    buffer_load_dwordx4 v31, s[8:11], s92 offen nt lds
    s_add_u32 s92, s51, 2170880
    s_add_u32 m0, s46, 9216
    s_nop 0
    buffer_load_dwordx4 v31, s[8:11], s92 offen nt lds
    s_add_u32 s92, s51, 2228224
    s_add_u32 m0, s46, 16384
    s_nop 0
    buffer_load_dwordx4 v31, s[8:11], s92 offen nt lds
    s_add_u32 s92, s51, 2236416
    s_add_u32 m0, s46, 17408
    s_nop 0
    buffer_load_dwordx4 v31, s[8:11], s92 offen nt lds
    s_add_u32 s92, s51, 2293760
    s_add_u32 m0, s46, 24576
    s_nop 0
    buffer_load_dwordx4 v31, s[8:11], s92 offen nt lds
    s_add_u32 s92, s51, 2301952
    s_add_u32 m0, s46, 25600
    s_nop 0
    buffer_load_dwordx4 v31, s[8:11], s92 offen nt lds
    ds_read_b64_tr_b16 a[160:161], v100 offset:32768
    ds_read_b64_tr_b16 a[162:163], v100 offset:33792
    ds_read_b64_tr_b16 a[164:165], v100 offset:32776
    ds_read_b64_tr_b16 a[166:167], v100 offset:33800
    ds_read_b64_tr_b16 a[168:169], v100 offset:40960
    ds_read_b64_tr_b16 a[170:171], v100 offset:41984
    ds_read_b64_tr_b16 a[172:173], v100 offset:40968
    ds_read_b64_tr_b16 a[174:175], v100 offset:41992
    ds_read_b64_tr_b16 a[176:177], v100 offset:49152
    ds_read_b64_tr_b16 a[178:179], v100 offset:50176
    ds_read_b64_tr_b16 a[180:181], v100 offset:49160
    ds_read_b64_tr_b16 a[182:183], v100 offset:50184
    ds_read_b64_tr_b16 a[184:185], v100 offset:57344
    ds_read_b64_tr_b16 a[186:187], v100 offset:58368
    ds_read_b64_tr_b16 a[188:189], v100 offset:57352
    ds_read_b64_tr_b16 a[190:191], v100 offset:58376
    s_waitcnt lgkmcnt(0)
    s_waitcnt vmcnt(16)
    s_barrier
    s_add_u32 s92, s51, 2359296
    s_add_u32 m0, s46, 32768
    s_nop 0
    buffer_load_dwordx4 v31, s[8:11], s92 offen nt lds
    s_add_u32 s92, s51, 2367488
    s_add_u32 m0, s46, 33792
    s_nop 0
    buffer_load_dwordx4 v31, s[8:11], s92 offen nt lds
    s_add_u32 s92, s51, 2424832
    s_add_u32 m0, s46, 40960
    s_nop 0
    buffer_load_dwordx4 v31, s[8:11], s92 offen nt lds
    s_add_u32 s92, s51, 2433024
    s_add_u32 m0, s46, 41984
    s_nop 0
    buffer_load_dwordx4 v31, s[8:11], s92 offen nt lds
    ds_read_b64_tr_b16 a[192:193], v101 offset:0
    ds_read_b64_tr_b16 a[194:195], v101 offset:1024
    ds_read_b64_tr_b16 a[196:197], v101 offset:8
    ds_read_b64_tr_b16 a[198:199], v101 offset:1032
    ds_read_b64_tr_b16 a[200:201], v101 offset:8192
    ds_read_b64_tr_b16 a[202:203], v101 offset:9216
    ds_read_b64_tr_b16 a[204:205], v101 offset:8200
    ds_read_b64_tr_b16 a[206:207], v101 offset:9224
    ds_read_b64_tr_b16 a[208:209], v101 offset:16384
    ds_read_b64_tr_b16 a[210:211], v101 offset:17408
    ds_read_b64_tr_b16 a[212:213], v101 offset:16392
    ds_read_b64_tr_b16 a[214:215], v101 offset:17416
    ds_read_b64_tr_b16 a[216:217], v101 offset:24576
    ds_read_b64_tr_b16 a[218:219], v101 offset:25600
    ds_read_b64_tr_b16 a[220:221], v101 offset:24584
    ds_read_b64_tr_b16 a[222:223], v101 offset:25608
    s_waitcnt lgkmcnt(0)
    s_waitcnt vmcnt(12)
    s_barrier
    ds_read_b64_tr_b16 a[224:225], v101 offset:32768
    ds_read_b64_tr_b16 a[226:227], v101 offset:33792
    ds_read_b64_tr_b16 a[228:229], v101 offset:32776
    ds_read_b64_tr_b16 a[230:231], v101 offset:33800
    ds_read_b64_tr_b16 a[232:233], v101 offset:40960
    ds_read_b64_tr_b16 a[234:235], v101 offset:41984
    ds_read_b64_tr_b16 a[236:237], v101 offset:40968
    ds_read_b64_tr_b16 a[238:239], v101 offset:41992
    ds_read_b64_tr_b16 a[240:241], v101 offset:49152
    ds_read_b64_tr_b16 a[242:243], v101 offset:50176
    ds_read_b64_tr_b16 a[244:245], v101 offset:49160
    ds_read_b64_tr_b16 a[246:247], v101 offset:50184
    ds_read_b64_tr_b16 a[248:249], v101 offset:57344
    ds_read_b64_tr_b16 a[250:251], v101 offset:58368
    ds_read_b64_tr_b16 a[252:253], v101 offset:57352
    ds_read_b64_tr_b16 a[254:255], v101 offset:58376
    s_waitcnt lgkmcnt(0)
    s_waitcnt vmcnt(4)
    s_barrier
    ds_read_b64_tr_b16 v[128:129], v100 offset:0
    ds_read_b64_tr_b16 v[130:131], v100 offset:1024
    ds_read_b64_tr_b16 v[132:133], v100 offset:8
    ds_read_b64_tr_b16 v[134:135], v100 offset:1032
    ds_read_b64_tr_b16 v[136:137], v100 offset:8192
    ds_read_b64_tr_b16 v[138:139], v100 offset:9216
    ds_read_b64_tr_b16 v[140:141], v100 offset:8200
    ds_read_b64_tr_b16 v[142:143], v100 offset:9224
    ds_read_b64_tr_b16 v[144:145], v100 offset:16384
    ds_read_b64_tr_b16 v[146:147], v100 offset:17408
    ds_read_b64_tr_b16 v[148:149], v100 offset:16392
    ds_read_b64_tr_b16 v[150:151], v100 offset:17416
    ds_read_b64_tr_b16 v[152:153], v100 offset:24576
    ds_read_b64_tr_b16 v[154:155], v100 offset:25600
    ds_read_b64_tr_b16 v[156:157], v100 offset:24584
    ds_read_b64_tr_b16 v[158:159], v100 offset:25608
    s_waitcnt lgkmcnt(0)
    s_waitcnt vmcnt(0)
    s_barrier
    ds_read_b64_tr_b16 v[160:161], v100 offset:32768
    ds_read_b64_tr_b16 v[162:163], v100 offset:33792
    ds_read_b64_tr_b16 v[164:165], v100 offset:32776
    ds_read_b64_tr_b16 v[166:167], v100 offset:33800
    ds_read_b64_tr_b16 v[168:169], v100 offset:40960
    ds_read_b64_tr_b16 v[170:171], v100 offset:41984
    ds_read_b64_tr_b16 v[172:173], v100 offset:40968
    ds_read_b64_tr_b16 v[174:175], v100 offset:41992
    s_waitcnt lgkmcnt(0)
    s_cmp_lt_u32 s48, 1
    s_cbranch_scc1 L_z_40
    v_accvgpr_write_b32 a0, 0
    v_accvgpr_write_b32 a1, 0
    v_accvgpr_write_b32 a2, 0
    v_accvgpr_write_b32 a3, 0
    v_accvgpr_write_b32 a4, 0
    v_accvgpr_write_b32 a5, 0
    v_accvgpr_write_b32 a6, 0
    v_accvgpr_write_b32 a7, 0
L_z_40:
    s_add_u32 s45, s44, 32768
    s_mul_i32 s46, s18, 4096
    s_mul_i32 s47, s18, 4096
    s_mul_i32 s96, s18, -3072
    s_lshl_b32 s97, s18, 10
    s_mov_b32 s20, 0
    s_mov_b32 s21, 0
    s_mov_b32 s22, 0
    s_mov_b32 s34, 0
    s_mov_b32 s35, 0
    s_mov_b32 s36, 0
    s_cmp_lt_u32 s20, 64
    s_cselect_b64 s[88:89], s[24:25], s[26:27]
    s_bitcmp1_b64 s[88:89], s20
    s_cselect_b32 s28, 1, 0
    s_cselect_b32 s29, s22, s21
    s_add_u32 s22, s22, s28
    s_xor_b32 s88, s28, 1
    s_add_u32 s21, s21, s88
    s_lshl_b32 s30, s28, 6
    s_add_u32 s30, s30, s29
    s_and_b32 s31, s30, 95
    s_mul_i32 s31, s31, 229376
    s_add_u32 s31, s31, s42
    s_lshl2_add_u32 s33, s30, s60
    s_cmp_lt_u32 s20, 128
    s_cselect_b32 s31, s31, 268435456
    s_cselect_b32 s32, s61, 0
    s_add_u32 s20, s20, 1
    s_barrier
    v_mov_b32 v9, 163824
    s_lshl_b32 s92, s18, 2
    v_add_u32 v11, s92, v9
    ds_write_b32 v11, v3
    s_mov_b32 s58, 268435456
    s_mov_b32 s59, -1
    s_cmp_eq_u32 s18, 0
    s_cselect_b32 s57, -1, 0
    s_cselect_b32 s43, s43, 268435456
    s_branch L_DN_ss1
L_DN_top0:
    s_waitcnt lgkmcnt(4)
    v_mfma_f32_16x16x32_bf16 v[16:19], a[0:3], v[64:67], 0
    ds_read_b128 v[88:91], v6 offset:6144
    s_mul_i32 s86, s36, 196608
    s_add_u32 s87, s86, s45
    s_add_u32 s86, s86, s44
    v_mfma_f32_16x16x32_bf16 v[24:27], a[0:3], v[68:71], 0
    ds_read_b128 v[92:95], v6 offset:6400
    s_lshl2_add_u32 s37, s36, s43
    s_mov_b32 s34, s28
    s_mov_b32 s35, s29
    v_mfma_f32_16x16x32_bf16 v[28:31], a[4:7], v[68:71], 0
    s_mov_b32 s36, s30
    s_add_u32 s59, s59, 1
    s_cmp_lt_u32 s20, 64
    s_cselect_b64 s[88:89], s[24:25], s[26:27]
    v_mfma_f32_16x16x32_bf16 v[20:23], a[4:7], v[64:67], 0
    s_waitcnt lgkmcnt(4)
    v_cvt_pk_bf16_f32 v96, v40, v41
    v_cvt_pk_bf16_f32 v97, v42, v43
    v_cvt_pk_bf16_f32 v98, v44, v45
    v_cvt_pk_bf16_f32 v99, v46, v47
    v_mfma_f32_16x16x32_bf16 v[16:19], a[8:11], v[72:75], v[16:19]
    ds_read_b128 v[64:67], v6 offset:8192
    buffer_store_dwordx4 v[96:99], v4, s[4:7], s86 offen sc1
    v_mfma_f32_16x16x32_bf16 v[24:27], a[8:11], v[76:79], v[24:27]
    ds_read_b128 v[68:71], v6 offset:8448
    v_cvt_pk_bf16_f32 v100, v48, v49
    v_cvt_pk_bf16_f32 v101, v50, v51
    v_cvt_pk_bf16_f32 v102, v52, v53
    v_mfma_f32_16x16x32_bf16 v[28:31], a[12:15], v[76:79], v[28:31]
    s_bitcmp1_b64 s[88:89], s20
    s_cselect_b32 s28, 1, 0
    s_cselect_b32 s29, s22, s21
    v_cvt_pk_bf16_f32 v103, v54, v55
    s_add_u32 s22, s22, s28
    v_mfma_f32_16x16x32_bf16 v[20:23], a[12:15], v[72:75], v[20:23]
    s_waitcnt lgkmcnt(2)
    buffer_store_dwordx4 v[100:103], v4, s[4:7], s87 offen sc1
    s_xor_b32 s88, s28, 1
    v_mfma_f32_16x16x32_bf16 v[16:19], a[16:19], v[80:83], v[16:19]
    ds_read_b128 v[72:75], v6 offset:10240
    s_add_u32 s21, s21, s88
    v_mfma_f32_16x16x32_bf16 v[24:27], a[16:19], v[84:87], v[24:27]
    ds_read_b128 v[76:79], v6 offset:10496
    s_lshl_b32 s30, s28, 6
    v_mfma_f32_16x16x32_bf16 v[28:31], a[20:23], v[84:87], v[28:31]
    s_add_u32 s30, s30, s29
    s_and_b32 s31, s30, 95
    s_mul_i32 s31, s31, 229376
    v_mfma_f32_16x16x32_bf16 v[20:23], a[20:23], v[80:83], v[20:23]
    s_add_u32 s31, s31, s42
    s_lshl2_add_u32 s33, s30, s60
    v_mfma_f32_16x16x32_bf16 v[16:19], a[24:27], v[88:91], v[16:19]
    ds_read_b128 v[80:83], v6 offset:12288
    v_mfma_f32_16x16x32_bf16 v[24:27], a[24:27], v[92:95], v[24:27]
    ds_read_b128 v[84:87], v6 offset:12544
    v_mfma_f32_16x16x32_bf16 v[28:31], a[28:31], v[92:95], v[28:31]
    s_cmp_lt_u32 s20, 128
    s_cselect_b32 s31, s31, 268435456
    s_cselect_b32 s32, s61, 0
    v_mfma_f32_16x16x32_bf16 v[20:23], a[28:31], v[88:91], v[20:23]
    s_waitcnt lgkmcnt(2)
    s_add_u32 s20, s20, 1
    s_andn2_b32 s23, s34, s28
    v_mfma_f32_16x16x32_bf16 v[16:19], a[32:35], v[64:67], v[16:19]
    ds_read_b128 v[88:91], v6 offset:14336
    v_mfma_f32_16x16x32_bf16 v[24:27], a[32:35], v[68:71], v[24:27]
    ds_read_b128 v[92:95], v6 offset:14592
    v_mfma_f32_16x16x32_bf16 v[28:31], a[36:39], v[68:71], v[28:31]
    v_mfma_f32_16x16x32_bf16 v[20:23], a[36:39], v[64:67], v[20:23]
    v_mfma_f32_16x16x32_bf16 v[16:19], a[40:43], v[72:75], v[16:19]
    ds_read_b128 v[64:67], v6 offset:16384
    v_mfma_f32_16x16x32_bf16 v[24:27], a[40:43], v[76:79], v[24:27]
    ds_read_b128 v[68:71], v6 offset:16640
    v_mfma_f32_16x16x32_bf16 v[28:31], a[44:47], v[76:79], v[28:31]
    v_mfma_f32_16x16x32_bf16 v[20:23], a[44:47], v[72:75], v[20:23]
    s_waitcnt lgkmcnt(2)
    v_mfma_f32_16x16x32_bf16 v[16:19], a[48:51], v[80:83], v[16:19]
    ds_read_b128 v[72:75], v6 offset:18432
    v_mfma_f32_16x16x32_bf16 v[24:27], a[48:51], v[84:87], v[24:27]
    ds_read_b128 v[76:79], v6 offset:18688
    v_mfma_f32_16x16x32_bf16 v[28:31], a[52:55], v[84:87], v[28:31]
    v_mfma_f32_16x16x32_bf16 v[20:23], a[52:55], v[80:83], v[20:23]
    s_buffer_load_dword s62, s[4:7], s33 glc
    v_mfma_f32_16x16x32_bf16 v[16:19], a[56:59], v[88:91], v[16:19]
    ds_read_b128 v[80:83], v6 offset:20480
    v_mfma_f32_16x16x32_bf16 v[24:27], a[56:59], v[92:95], v[24:27]
    ds_read_b128 v[84:87], v6 offset:20736
    v_mfma_f32_16x16x32_bf16 v[28:31], a[60:63], v[92:95], v[28:31]
    v_mfma_f32_16x16x32_bf16 v[20:23], a[60:63], v[88:91], v[20:23]
    s_waitcnt lgkmcnt(4)
    v_mfma_f32_16x16x32_bf16 v[16:19], a[64:67], v[64:67], v[16:19]
    ds_read_b128 v[88:91], v6 offset:22528
    v_mfma_f32_16x16x32_bf16 v[24:27], a[64:67], v[68:71], v[24:27]
    ds_read_b128 v[92:95], v6 offset:22784
    v_mfma_f32_16x16x32_bf16 v[28:31], a[68:71], v[68:71], v[28:31]
    v_mfma_f32_16x16x32_bf16 v[20:23], a[68:71], v[64:67], v[20:23]
    s_waitcnt lgkmcnt(4)
    v_mfma_f32_16x16x32_bf16 v[16:19], a[72:75], v[72:75], v[16:19]
    ds_read_b128 v[64:67], v6 offset:24576
    v_mfma_f32_16x16x32_bf16 v[24:27], a[72:75], v[76:79], v[24:27]
    ds_read_b128 v[68:71], v6 offset:24832
    v_mfma_f32_16x16x32_bf16 v[28:31], a[76:79], v[76:79], v[28:31]
    v_mfma_f32_16x16x32_bf16 v[20:23], a[76:79], v[72:75], v[20:23]
    s_waitcnt lgkmcnt(4)
    v_mfma_f32_16x16x32_bf16 v[16:19], a[80:83], v[80:83], v[16:19]
    ds_read_b128 v[72:75], v6 offset:26624
    v_mfma_f32_16x16x32_bf16 v[24:27], a[80:83], v[84:87], v[24:27]
    ds_read_b128 v[76:79], v6 offset:26880
    v_mfma_f32_16x16x32_bf16 v[28:31], a[84:87], v[84:87], v[28:31]
    v_mfma_f32_16x16x32_bf16 v[20:23], a[84:87], v[80:83], v[20:23]
    s_waitcnt lgkmcnt(4)
    v_mfma_f32_16x16x32_bf16 v[16:19], a[88:91], v[88:91], v[16:19]
    ds_read_b128 v[80:83], v6 offset:28672
    v_mfma_f32_16x16x32_bf16 v[24:27], a[88:91], v[92:95], v[24:27]
    ds_read_b128 v[84:87], v6 offset:28928
    v_mfma_f32_16x16x32_bf16 v[28:31], a[92:95], v[92:95], v[28:31]
    v_mfma_f32_16x16x32_bf16 v[20:23], a[92:95], v[88:91], v[20:23]
    s_waitcnt lgkmcnt(4)
    v_mfma_f32_16x16x32_bf16 v[16:19], a[96:99], v[64:67], v[16:19]
    ds_read_b128 v[88:91], v6 offset:30720
    v_mfma_f32_16x16x32_bf16 v[24:27], a[96:99], v[68:71], v[24:27]
    ds_read_b128 v[92:95], v6 offset:30976
    v_mfma_f32_16x16x32_bf16 v[28:31], a[100:103], v[68:71], v[28:31]
    v_mfma_f32_16x16x32_bf16 v[20:23], a[100:103], v[64:67], v[20:23]
    s_waitcnt lgkmcnt(4)
    v_mfma_f32_16x16x32_bf16 v[16:19], a[104:107], v[72:75], v[16:19]
    ds_read_b128 v[64:67], v6 offset:32768
    v_mfma_f32_16x16x32_bf16 v[24:27], a[104:107], v[76:79], v[24:27]
    ds_read_b128 v[68:71], v6 offset:33024
    v_mfma_f32_16x16x32_bf16 v[28:31], a[108:111], v[76:79], v[28:31]
    v_mfma_f32_16x16x32_bf16 v[20:23], a[108:111], v[72:75], v[20:23]
    s_waitcnt lgkmcnt(4)
    v_mfma_f32_16x16x32_bf16 v[16:19], a[112:115], v[80:83], v[16:19]
    ds_read_b128 v[72:75], v6 offset:34816
    v_mfma_f32_16x16x32_bf16 v[24:27], a[112:115], v[84:87], v[24:27]
    ds_read_b128 v[76:79], v6 offset:35072
    v_mfma_f32_16x16x32_bf16 v[28:31], a[116:119], v[84:87], v[28:31]
    v_mfma_f32_16x16x32_bf16 v[20:23], a[116:119], v[80:83], v[20:23]
    s_waitcnt vmcnt(0)
L_DN_mid0:
    s_barrier
    s_waitcnt lgkmcnt(4)
    v_mfma_f32_16x16x32_bf16 v[16:19], a[120:123], v[88:91], v[16:19]
    s_max_u32 s37, s37, s58
    s_mov_b32 s58, 0
    v_mfma_f32_16x16x32_bf16 v[24:27], a[120:123], v[92:95], v[24:27]
    buffer_atomic_add v5, v2, s[4:7], s37 offen
    v_mfma_f32_16x16x32_bf16 v[28:31], a[124:127], v[92:95], v[28:31]
    v_mfma_f32_16x16x32_bf16 v[20:23], a[124:127], v[88:91], v[20:23]
    s_waitcnt lgkmcnt(0)
    s_cmp_ge_u32 s62, s32
    s_cbranch_scc0 L_DN_nr0
L_DN_rd0:
    s_mov_b32 s40, s31
L_DN_go0:
    v_mfma_f32_16x16x32_bf16 v[16:19], a[128:131], v[64:67], v[16:19]
    ds_read_b128 v[80:83], v6 offset:36864
    s_add_u32 s94, s40, 0
    v_mfma_f32_16x16x32_bf16 v[24:27], a[128:131], v[68:71], v[24:27]
    ds_read_b128 v[84:87], v6 offset:37120
    s_add_u32 m0, s47, 77824
    v_mfma_f32_16x16x32_bf16 v[28:31], a[132:135], v[68:71], v[28:31]
    buffer_load_dwordx4 v1, s[4:7], s94 offen offset:0 sc1 lds
    v_mfma_f32_16x16x32_bf16 v[20:23], a[132:135], v[64:67], v[20:23]
    ds_read_b128 v[88:91], v6 offset:38912
    v_mfma_f32_16x16x32_bf16 v[16:19], a[136:139], v[72:75], v[16:19]
    ds_read_b128 v[92:95], v6 offset:39168
    v_mfma_f32_16x16x32_bf16 v[24:27], a[136:139], v[76:79], v[24:27]
    ds_read_b128 v[64:67], v6 offset:40960
    v_mfma_f32_16x16x32_bf16 v[28:31], a[140:143], v[76:79], v[28:31]
    buffer_load_dwordx4 v1, s[4:7], s94 offen offset:1024 sc1 lds
    v_mfma_f32_16x16x32_bf16 v[20:23], a[140:143], v[72:75], v[20:23]
    ds_read_b128 v[68:71], v6 offset:41216
    s_waitcnt lgkmcnt(4)
    v_mfma_f32_16x16x32_bf16 v[16:19], a[144:147], v[80:83], v[16:19]
    ds_read_b128 v[72:75], v6 offset:43008
    v_mfma_f32_16x16x32_bf16 v[24:27], a[144:147], v[84:87], v[24:27]
    ds_read_b128 v[76:79], v6 offset:43264
    v_mfma_f32_16x16x32_bf16 v[28:31], a[148:151], v[84:87], v[28:31]
    buffer_load_dwordx4 v1, s[4:7], s94 offen offset:2048 sc1 lds
    v_mfma_f32_16x16x32_bf16 v[20:23], a[148:151], v[80:83], v[20:23]
    s_waitcnt lgkmcnt(4)
    v_mfma_f32_16x16x32_bf16 v[16:19], a[152:155], v[88:91], v[16:19]
    ds_read_b128 v[80:83], v6 offset:45056
    v_mfma_f32_16x16x32_bf16 v[24:27], a[152:155], v[92:95], v[24:27]
    ds_read_b128 v[84:87], v6 offset:45312
    v_mfma_f32_16x16x32_bf16 v[28:31], a[156:159], v[92:95], v[28:31]
    buffer_load_dwordx4 v1, s[4:7], s94 offen offset:3072 sc1 lds
    v_mfma_f32_16x16x32_bf16 v[20:23], a[156:159], v[88:91], v[20:23]
    s_waitcnt lgkmcnt(2)
    v_mfma_f32_16x16x32_bf16 v[16:19], a[160:163], v[64:67], v[16:19]
    ds_read_b128 v[88:91], v6 offset:47104
    s_add_u32 s94, s40, 16384
    v_mfma_f32_16x16x32_bf16 v[24:27], a[160:163], v[68:71], v[24:27]
    ds_read_b128 v[92:95], v6 offset:47360
    s_add_u32 m0, s47, 94208
    v_mfma_f32_16x16x32_bf16 v[28:31], a[164:167], v[68:71], v[28:31]
    buffer_load_dwordx4 v1, s[4:7], s94 offen offset:0 sc1 lds
    v_mfma_f32_16x16x32_bf16 v[20:23], a[164:167], v[64:67], v[20:23]
    v_mfma_f32_16x16x32_bf16 v[16:19], a[168:171], v[72:75], v[16:19]
    ds_read_b128 v[64:67], v6 offset:49152
    v_mfma_f32_16x16x32_bf16 v[24:27], a[168:171], v[76:79], v[24:27]
    ds_read_b128 v[68:71], v6 offset:49408
    v_mfma_f32_16x16x32_bf16 v[28:31], a[172:175], v[76:79], v[28:31]
    buffer_load_dwordx4 v1, s[4:7], s94 offen offset:1024 sc1 lds
    v_mfma_f32_16x16x32_bf16 v[20:23], a[172:175], v[72:75], v[20:23]
    s_waitcnt lgkmcnt(2)
    v_mfma_f32_16x16x32_bf16 v[16:19], a[176:179], v[80:83], v[16:19]
    ds_read_b128 v[72:75], v6 offset:51200
    v_mfma_f32_16x16x32_bf16 v[24:27], a[176:179], v[84:87], v[24:27]
    ds_read_b128 v[76:79], v6 offset:51456
    v_mfma_f32_16x16x32_bf16 v[28:31], a[180:183], v[84:87], v[28:31]
    buffer_load_dwordx4 v1, s[4:7], s94 offen offset:2048 sc1 lds
    v_mfma_f32_16x16x32_bf16 v[20:23], a[180:183], v[80:83], v[20:23]
    v_mfma_f32_16x16x32_bf16 v[16:19], a[184:187], v[88:91], v[16:19]
    ds_read_b128 v[80:83], v6 offset:53248
    v_mfma_f32_16x16x32_bf16 v[24:27], a[184:187], v[92:95], v[24:27]
    ds_read_b128 v[84:87], v6 offset:53504
    v_mfma_f32_16x16x32_bf16 v[28:31], a[188:191], v[92:95], v[28:31]
    buffer_load_dwordx4 v1, s[4:7], s94 offen offset:3072 sc1 lds
    v_mfma_f32_16x16x32_bf16 v[20:23], a[188:191], v[88:91], v[20:23]
    s_waitcnt lgkmcnt(2)
    v_mfma_f32_16x16x32_bf16 v[16:19], a[192:195], v[64:67], v[16:19]
    ds_read_b128 v[88:91], v6 offset:55296
    s_add_u32 s94, s40, 32768
    v_mfma_f32_16x16x32_bf16 v[24:27], a[192:195], v[68:71], v[24:27]
    ds_read_b128 v[92:95], v6 offset:55552
    s_add_u32 m0, s47, 110592
    v_mfma_f32_16x16x32_bf16 v[28:31], a[196:199], v[68:71], v[28:31]
    buffer_load_dwordx4 v1, s[4:7], s94 offen offset:0 sc1 lds
    v_mfma_f32_16x16x32_bf16 v[20:23], a[196:199], v[64:67], v[20:23]
    v_mfma_f32_16x16x32_bf16 v[16:19], a[200:203], v[72:75], v[16:19]
    ds_read_b128 v[64:67], v6 offset:57344
    v_mfma_f32_16x16x32_bf16 v[24:27], a[200:203], v[76:79], v[24:27]
    ds_read_b128 v[68:71], v6 offset:57600
    v_mfma_f32_16x16x32_bf16 v[28:31], a[204:207], v[76:79], v[28:31]
    buffer_load_dwordx4 v1, s[4:7], s94 offen offset:1024 sc1 lds
    v_mfma_f32_16x16x32_bf16 v[20:23], a[204:207], v[72:75], v[20:23]
    s_waitcnt lgkmcnt(2)
    v_mfma_f32_16x16x32_bf16 v[16:19], a[208:211], v[80:83], v[16:19]
    ds_read_b128 v[72:75], v6 offset:59392
    v_mfma_f32_16x16x32_bf16 v[24:27], a[208:211], v[84:87], v[24:27]
    ds_read_b128 v[76:79], v6 offset:59648
    v_mfma_f32_16x16x32_bf16 v[28:31], a[212:215], v[84:87], v[28:31]
    buffer_load_dwordx4 v1, s[4:7], s94 offen offset:2048 sc1 lds
    v_mfma_f32_16x16x32_bf16 v[20:23], a[212:215], v[80:83], v[20:23]
    v_mfma_f32_16x16x32_bf16 v[16:19], a[216:219], v[88:91], v[16:19]
    ds_read_b128 v[80:83], v6 offset:61440
    v_mfma_f32_16x16x32_bf16 v[24:27], a[216:219], v[92:95], v[24:27]
    ds_read_b128 v[84:87], v6 offset:61696
    v_mfma_f32_16x16x32_bf16 v[28:31], a[220:223], v[92:95], v[28:31]
    buffer_load_dwordx4 v1, s[4:7], s94 offen offset:3072 sc1 lds
    v_mfma_f32_16x16x32_bf16 v[20:23], a[220:223], v[88:91], v[20:23]
    s_waitcnt lgkmcnt(2)
    v_mfma_f32_16x16x32_bf16 v[16:19], a[224:227], v[64:67], v[16:19]
    ds_read_b128 v[88:91], v6 offset:63488
    s_add_u32 s94, s40, 49152
    v_mfma_f32_16x16x32_bf16 v[24:27], a[224:227], v[68:71], v[24:27]
    ds_read_b128 v[92:95], v6 offset:63744
    s_add_u32 m0, s47, 126976
    v_mfma_f32_16x16x32_bf16 v[28:31], a[228:231], v[68:71], v[28:31]
    buffer_load_dwordx4 v1, s[4:7], s94 offen offset:0 sc1 lds
    v_mfma_f32_16x16x32_bf16 v[20:23], a[228:231], v[64:67], v[20:23]
    v_mfma_f32_16x16x32_bf16 v[16:19], a[232:235], v[72:75], v[16:19]
    ds_read_b128 v[64:67], v7 offset:0
    v_mfma_f32_16x16x32_bf16 v[24:27], a[232:235], v[76:79], v[24:27]
    ds_read_b128 v[68:71], v7 offset:256
    v_mfma_f32_16x16x32_bf16 v[28:31], a[236:239], v[76:79], v[28:31]
    buffer_load_dwordx4 v1, s[4:7], s94 offen offset:1024 sc1 lds
    v_mfma_f32_16x16x32_bf16 v[20:23], a[236:239], v[72:75], v[20:23]
    s_waitcnt lgkmcnt(2)
    v_mfma_f32_16x16x32_bf16 v[16:19], a[240:243], v[80:83], v[16:19]
    ds_read_b128 v[72:75], v7 offset:2048
    v_mfma_f32_16x16x32_bf16 v[24:27], a[240:243], v[84:87], v[24:27]
    ds_read_b128 v[76:79], v7 offset:2304
    v_mfma_f32_16x16x32_bf16 v[28:31], a[244:247], v[84:87], v[28:31]
    buffer_load_dwordx4 v1, s[4:7], s94 offen offset:2048 sc1 lds
    v_mfma_f32_16x16x32_bf16 v[20:23], a[244:247], v[80:83], v[20:23]
    v_mfma_f32_16x16x32_bf16 v[16:19], a[248:251], v[88:91], v[16:19]
    ds_read_b128 v[80:83], v7 offset:4096
    v_mfma_f32_16x16x32_bf16 v[24:27], a[248:251], v[92:95], v[24:27]
    ds_read_b128 v[84:87], v7 offset:4352
    v_mfma_f32_16x16x32_bf16 v[28:31], a[252:255], v[92:95], v[28:31]
    buffer_load_dwordx4 v1, s[4:7], s94 offen offset:3072 sc1 lds
    v_mfma_f32_16x16x32_bf16 v[20:23], a[252:255], v[88:91], v[20:23]
    s_waitcnt lgkmcnt(2)
    v_mfma_f32_16x16x32_bf16 v[16:19], v[128:131], v[64:67], v[16:19]
    ds_read_b128 v[88:91], v7 offset:6144
    s_add_u32 s94, s40, s96
    v_mfma_f32_16x16x32_bf16 v[24:27], v[128:131], v[68:71], v[24:27]
    ds_read_b128 v[92:95], v7 offset:6400
    s_add_u32 s94, s94, 65536
    v_mfma_f32_16x16x32_bf16 v[28:31], v[132:135], v[68:71], v[28:31]
    s_add_u32 m0, s97, 143360
    v_mfma_f32_16x16x32_bf16 v[20:23], v[132:135], v[64:67], v[20:23]
    buffer_load_dwordx4 v1, s[4:7], s94 offen offset:0 sc1 lds
    v_mfma_f32_16x16x32_bf16 v[16:19], v[136:139], v[72:75], v[16:19]
    ds_read_b128 v[64:67], v7 offset:8192
    s_add_u32 s94, s40, s96
    v_mfma_f32_16x16x32_bf16 v[24:27], v[136:139], v[76:79], v[24:27]
    ds_read_b128 v[68:71], v7 offset:8448
    s_add_u32 s94, s94, 69632
    v_mfma_f32_16x16x32_bf16 v[28:31], v[140:143], v[76:79], v[28:31]
    s_add_u32 m0, s97, 147456
    v_mfma_f32_16x16x32_bf16 v[20:23], v[140:143], v[72:75], v[20:23]
    s_waitcnt lgkmcnt(2)
    v_mfma_f32_16x16x32_bf16 v[16:19], v[144:147], v[80:83], v[16:19]
    ds_read_b128 v[72:75], v7 offset:10240
    v_mfma_f32_16x16x32_bf16 v[24:27], v[144:147], v[84:87], v[24:27]
    ds_read_b128 v[76:79], v7 offset:10496
    v_mfma_f32_16x16x32_bf16 v[28:31], v[148:151], v[84:87], v[28:31]
    buffer_load_dwordx4 v1, s[4:7], s94 offen offset:0 sc1 lds
    s_add_u32 s94, s40, s96
    v_mfma_f32_16x16x32_bf16 v[20:23], v[148:151], v[80:83], v[20:23]
    s_add_u32 s94, s94, 73728
    s_add_u32 m0, s97, 151552
    s_nop 0
    buffer_load_dwordx4 v1, s[4:7], s94 offen offset:0 sc1 lds
    s_cmp_ge_u32 s40, 268435456
    s_cbranch_scc1 L_DN_slow0
    v_mfma_f32_16x16x32_bf16 v[16:19], v[152:155], v[88:91], v[16:19]
    v_mfma_f32_16x16x32_bf16 v[24:27], v[152:155], v[92:95], v[24:27]
    s_waitcnt vmcnt(7) lgkmcnt(0)
    s_barrier
    v_mfma_f32_16x16x32_bf16 v[28:31], v[156:159], v[92:95], v[28:31]
    ds_read_b128 v[80:83], v7 offset:12288
    v_mfma_f32_16x16x32_bf16 v[20:23], v[156:159], v[88:91], v[20:23]
    ds_read_b128 v[84:87], v7 offset:12544
    v_mfma_f32_16x16x32_bf16 v[16:19], v[160:163], v[64:67], v[16:19]
    ds_read_b128 v[88:91], v7 offset:14336
    v_mfma_f32_16x16x32_bf16 v[24:27], v[160:163], v[68:71], v[24:27]
    ds_read_b128 v[92:95], v7 offset:14592
    v_mfma_f32_16x16x32_bf16 v[28:31], v[164:167], v[68:71], v[28:31]
    v_mfma_f32_16x16x32_bf16 v[20:23], v[164:167], v[64:67], v[20:23]
    v_mfma_f32_16x16x32_bf16 v[16:19], v[168:171], v[72:75], v[16:19]
    ds_read_b128 v[64:67], v7 offset:16384
    v_mfma_f32_16x16x32_bf16 v[24:27], v[168:171], v[76:79], v[24:27]
    ds_read_b128 v[68:71], v7 offset:16640
    v_mfma_f32_16x16x32_bf16 v[28:31], v[172:175], v[76:79], v[28:31]
    v_mfma_f32_16x16x32_bf16 v[20:23], v[172:175], v[72:75], v[20:23]
L_DN_top1:
    s_waitcnt lgkmcnt(4)
    v_mfma_f32_16x16x32_bf16 v[40:43], a[0:3], v[80:83], 0
    ds_read_b128 v[72:75], v7 offset:18432
    s_mul_i32 s86, s36, 196608
    s_add_u32 s87, s86, s45
    s_add_u32 s86, s86, s44
    v_mfma_f32_16x16x32_bf16 v[48:51], a[0:3], v[84:87], 0
    ds_read_b128 v[76:79], v7 offset:18688
    s_lshl2_add_u32 s37, s36, s43
    s_mov_b32 s34, s28
    s_mov_b32 s35, s29
    v_mfma_f32_16x16x32_bf16 v[52:55], a[4:7], v[84:87], 0
    s_mov_b32 s36, s30
    s_add_u32 s59, s59, 1
    s_cmp_lt_u32 s20, 64
    s_cselect_b64 s[88:89], s[24:25], s[26:27]
    v_mfma_f32_16x16x32_bf16 v[44:47], a[4:7], v[80:83], 0
    s_waitcnt lgkmcnt(4)
    v_cvt_pk_bf16_f32 v96, v16, v17
    v_cvt_pk_bf16_f32 v97, v18, v19
    v_cvt_pk_bf16_f32 v98, v20, v21
    v_cvt_pk_bf16_f32 v99, v22, v23
    v_mfma_f32_16x16x32_bf16 v[40:43], a[8:11], v[88:91], v[40:43]
    ds_read_b128 v[80:83], v7 offset:20480
    buffer_store_dwordx4 v[96:99], v4, s[4:7], s86 offen sc1
    v_mfma_f32_16x16x32_bf16 v[48:51], a[8:11], v[92:95], v[48:51]
    ds_read_b128 v[84:87], v7 offset:20736
    v_cvt_pk_bf16_f32 v100, v24, v25
    v_cvt_pk_bf16_f32 v101, v26, v27
    v_cvt_pk_bf16_f32 v102, v28, v29
    v_mfma_f32_16x16x32_bf16 v[52:55], a[12:15], v[92:95], v[52:55]
    s_bitcmp1_b64 s[88:89], s20
    s_cselect_b32 s28, 1, 0
    s_cselect_b32 s29, s22, s21
    v_cvt_pk_bf16_f32 v103, v30, v31
    s_add_u32 s22, s22, s28
    v_mfma_f32_16x16x32_bf16 v[44:47], a[12:15], v[88:91], v[44:47]
    s_waitcnt lgkmcnt(2)
    buffer_store_dwordx4 v[100:103], v4, s[4:7], s87 offen sc1
    s_xor_b32 s88, s28, 1
    v_mfma_f32_16x16x32_bf16 v[40:43], a[16:19], v[64:67], v[40:43]
    ds_read_b128 v[88:91], v7 offset:22528
    s_add_u32 s21, s21, s88
    v_mfma_f32_16x16x32_bf16 v[48:51], a[16:19], v[68:71], v[48:51]
    ds_read_b128 v[92:95], v7 offset:22784
    s_lshl_b32 s30, s28, 6
    v_mfma_f32_16x16x32_bf16 v[52:55], a[20:23], v[68:71], v[52:55]
    s_add_u32 s30, s30, s29
    s_and_b32 s31, s30, 95
    s_mul_i32 s31, s31, 229376
    v_mfma_f32_16x16x32_bf16 v[44:47], a[20:23], v[64:67], v[44:47]
    s_add_u32 s31, s31, s42
    s_lshl2_add_u32 s33, s30, s60
    v_mfma_f32_16x16x32_bf16 v[40:43], a[24:27], v[72:75], v[40:43]
    ds_read_b128 v[64:67], v7 offset:24576
    v_mfma_f32_16x16x32_bf16 v[48:51], a[24:27], v[76:79], v[48:51]
    ds_read_b128 v[68:71], v7 offset:24832
    v_mfma_f32_16x16x32_bf16 v[52:55], a[28:31], v[76:79], v[52:55]
    s_cmp_lt_u32 s20, 128
    s_cselect_b32 s31, s31, 268435456
    s_cselect_b32 s32, s61, 0
    v_mfma_f32_16x16x32_bf16 v[44:47], a[28:31], v[72:75], v[44:47]
    s_waitcnt lgkmcnt(2)
    s_add_u32 s20, s20, 1
    s_andn2_b32 s23, s34, s28
    v_mfma_f32_16x16x32_bf16 v[40:43], a[32:35], v[80:83], v[40:43]
    ds_read_b128 v[72:75], v7 offset:26624
    v_mfma_f32_16x16x32_bf16 v[48:51], a[32:35], v[84:87], v[48:51]
    ds_read_b128 v[76:79], v7 offset:26880
    v_mfma_f32_16x16x32_bf16 v[52:55], a[36:39], v[84:87], v[52:55]
    v_mfma_f32_16x16x32_bf16 v[44:47], a[36:39], v[80:83], v[44:47]
    v_mfma_f32_16x16x32_bf16 v[40:43], a[40:43], v[88:91], v[40:43]
    ds_read_b128 v[80:83], v7 offset:28672
    v_mfma_f32_16x16x32_bf16 v[48:51], a[40:43], v[92:95], v[48:51]
    ds_read_b128 v[84:87], v7 offset:28928
    v_mfma_f32_16x16x32_bf16 v[52:55], a[44:47], v[92:95], v[52:55]
    v_mfma_f32_16x16x32_bf16 v[44:47], a[44:47], v[88:91], v[44:47]
    s_waitcnt lgkmcnt(2)
    v_mfma_f32_16x16x32_bf16 v[40:43], a[48:51], v[64:67], v[40:43]
    ds_read_b128 v[88:91], v7 offset:30720
    v_mfma_f32_16x16x32_bf16 v[48:51], a[48:51], v[68:71], v[48:51]
    ds_read_b128 v[92:95], v7 offset:30976
    v_mfma_f32_16x16x32_bf16 v[52:55], a[52:55], v[68:71], v[52:55]
    v_mfma_f32_16x16x32_bf16 v[44:47], a[52:55], v[64:67], v[44:47]
    s_buffer_load_dword s62, s[4:7], s33 glc
    v_mfma_f32_16x16x32_bf16 v[40:43], a[56:59], v[72:75], v[40:43]
    ds_read_b128 v[64:67], v7 offset:32768
    v_mfma_f32_16x16x32_bf16 v[48:51], a[56:59], v[76:79], v[48:51]
    ds_read_b128 v[68:71], v7 offset:33024
    v_mfma_f32_16x16x32_bf16 v[52:55], a[60:63], v[76:79], v[52:55]
    v_mfma_f32_16x16x32_bf16 v[44:47], a[60:63], v[72:75], v[44:47]
    s_waitcnt lgkmcnt(4)
    v_mfma_f32_16x16x32_bf16 v[40:43], a[64:67], v[80:83], v[40:43]
    ds_read_b128 v[72:75], v7 offset:34816
    v_mfma_f32_16x16x32_bf16 v[48:51], a[64:67], v[84:87], v[48:51]
    ds_read_b128 v[76:79], v7 offset:35072
    v_mfma_f32_16x16x32_bf16 v[52:55], a[68:71], v[84:87], v[52:55]
    v_mfma_f32_16x16x32_bf16 v[44:47], a[68:71], v[80:83], v[44:47]
    s_waitcnt lgkmcnt(4)
    v_mfma_f32_16x16x32_bf16 v[40:43], a[72:75], v[88:91], v[40:43]
    ds_read_b128 v[80:83], v7 offset:36864
    v_mfma_f32_16x16x32_bf16 v[48:51], a[72:75], v[92:95], v[48:51]
    ds_read_b128 v[84:87], v7 offset:37120
    v_mfma_f32_16x16x32_bf16 v[52:55], a[76:79], v[92:95], v[52:55]
    v_mfma_f32_16x16x32_bf16 v[44:47], a[76:79], v[88:91], v[44:47]
    s_waitcnt lgkmcnt(4)
    v_mfma_f32_16x16x32_bf16 v[40:43], a[80:83], v[64:67], v[40:43]
    ds_read_b128 v[88:91], v7 offset:38912
    v_mfma_f32_16x16x32_bf16 v[48:51], a[80:83], v[68:71], v[48:51]
    ds_read_b128 v[92:95], v7 offset:39168
    v_mfma_f32_16x16x32_bf16 v[52:55], a[84:87], v[68:71], v[52:55]
    v_mfma_f32_16x16x32_bf16 v[44:47], a[84:87], v[64:67], v[44:47]
    s_waitcnt lgkmcnt(4)
    v_mfma_f32_16x16x32_bf16 v[40:43], a[88:91], v[72:75], v[40:43]
    ds_read_b128 v[64:67], v7 offset:40960
    v_mfma_f32_16x16x32_bf16 v[48:51], a[88:91], v[76:79], v[48:51]
    ds_read_b128 v[68:71], v7 offset:41216
    v_mfma_f32_16x16x32_bf16 v[52:55], a[92:95], v[76:79], v[52:55]
    v_mfma_f32_16x16x32_bf16 v[44:47], a[92:95], v[72:75], v[44:47]
    s_waitcnt lgkmcnt(4)
    v_mfma_f32_16x16x32_bf16 v[40:43], a[96:99], v[80:83], v[40:43]
    ds_read_b128 v[72:75], v7 offset:43008
    v_mfma_f32_16x16x32_bf16 v[48:51], a[96:99], v[84:87], v[48:51]
    ds_read_b128 v[76:79], v7 offset:43264
    v_mfma_f32_16x16x32_bf16 v[52:55], a[100:103], v[84:87], v[52:55]
    v_mfma_f32_16x16x32_bf16 v[44:47], a[100:103], v[80:83], v[44:47]
    s_waitcnt lgkmcnt(4)
    v_mfma_f32_16x16x32_bf16 v[40:43], a[104:107], v[88:91], v[40:43]
    ds_read_b128 v[80:83], v7 offset:45056
    v_mfma_f32_16x16x32_bf16 v[48:51], a[104:107], v[92:95], v[48:51]
    ds_read_b128 v[84:87], v7 offset:45312
    v_mfma_f32_16x16x32_bf16 v[52:55], a[108:111], v[92:95], v[52:55]
    v_mfma_f32_16x16x32_bf16 v[44:47], a[108:111], v[88:91], v[44:47]
    s_waitcnt lgkmcnt(4)
    v_mfma_f32_16x16x32_bf16 v[40:43], a[112:115], v[64:67], v[40:43]
    ds_read_b128 v[88:91], v7 offset:47104
    v_mfma_f32_16x16x32_bf16 v[48:51], a[112:115], v[68:71], v[48:51]
    ds_read_b128 v[92:95], v7 offset:47360
    v_mfma_f32_16x16x32_bf16 v[52:55], a[116:119], v[68:71], v[52:55]
    v_mfma_f32_16x16x32_bf16 v[44:47], a[116:119], v[64:67], v[44:47]
    s_waitcnt vmcnt(0)
L_DN_mid1:
    s_barrier
    s_waitcnt lgkmcnt(4)
    v_mfma_f32_16x16x32_bf16 v[40:43], a[120:123], v[72:75], v[40:43]
    s_max_u32 s37, s37, s58
    s_mov_b32 s58, 0
    v_mfma_f32_16x16x32_bf16 v[48:51], a[120:123], v[76:79], v[48:51]
    buffer_atomic_add v5, v2, s[4:7], s37 offen
    v_mfma_f32_16x16x32_bf16 v[52:55], a[124:127], v[76:79], v[52:55]
    v_mfma_f32_16x16x32_bf16 v[44:47], a[124:127], v[72:75], v[44:47]
    s_waitcnt lgkmcnt(0)
    s_cmp_ge_u32 s62, s32
    s_cbranch_scc0 L_DN_nr1
L_DN_rd1:
    s_mov_b32 s40, s31
L_DN_go1:
    v_mfma_f32_16x16x32_bf16 v[40:43], a[128:131], v[80:83], v[40:43]
    ds_read_b128 v[64:67], v7 offset:49152
    s_add_u32 s94, s40, 0
    v_mfma_f32_16x16x32_bf16 v[48:51], a[128:131], v[84:87], v[48:51]
    ds_read_b128 v[68:71], v7 offset:49408
    s_add_u32 m0, s46, 0
    v_mfma_f32_16x16x32_bf16 v[52:55], a[132:135], v[84:87], v[52:55]
    buffer_load_dwordx4 v1, s[4:7], s94 offen offset:0 sc1 lds
    v_mfma_f32_16x16x32_bf16 v[44:47], a[132:135], v[80:83], v[44:47]
    ds_read_b128 v[72:75], v7 offset:51200
    v_mfma_f32_16x16x32_bf16 v[40:43], a[136:139], v[88:91], v[40:43]
    ds_read_b128 v[76:79], v7 offset:51456
    v_mfma_f32_16x16x32_bf16 v[48:51], a[136:139], v[92:95], v[48:51]
    ds_read_b128 v[80:83], v7 offset:53248
    v_mfma_f32_16x16x32_bf16 v[52:55], a[140:143], v[92:95], v[52:55]
    buffer_load_dwordx4 v1, s[4:7], s94 offen offset:1024 sc1 lds
    v_mfma_f32_16x16x32_bf16 v[44:47], a[140:143], v[88:91], v[44:47]
    ds_read_b128 v[84:87], v7 offset:53504
    s_waitcnt lgkmcnt(4)
    v_mfma_f32_16x16x32_bf16 v[40:43], a[144:147], v[64:67], v[40:43]
    ds_read_b128 v[88:91], v7 offset:55296
    v_mfma_f32_16x16x32_bf16 v[48:51], a[144:147], v[68:71], v[48:51]
    ds_read_b128 v[92:95], v7 offset:55552
    v_mfma_f32_16x16x32_bf16 v[52:55], a[148:151], v[68:71], v[52:55]
    buffer_load_dwordx4 v1, s[4:7], s94 offen offset:2048 sc1 lds
    v_mfma_f32_16x16x32_bf16 v[44:47], a[148:151], v[64:67], v[44:47]
    s_waitcnt lgkmcnt(4)
    v_mfma_f32_16x16x32_bf16 v[40:43], a[152:155], v[72:75], v[40:43]
    ds_read_b128 v[64:67], v7 offset:57344
    v_mfma_f32_16x16x32_bf16 v[48:51], a[152:155], v[76:79], v[48:51]
    ds_read_b128 v[68:71], v7 offset:57600
    v_mfma_f32_16x16x32_bf16 v[52:55], a[156:159], v[76:79], v[52:55]
    buffer_load_dwordx4 v1, s[4:7], s94 offen offset:3072 sc1 lds
    v_mfma_f32_16x16x32_bf16 v[44:47], a[156:159], v[72:75], v[44:47]
    s_waitcnt lgkmcnt(2)
    v_mfma_f32_16x16x32_bf16 v[40:43], a[160:163], v[80:83], v[40:43]
    ds_read_b128 v[72:75], v7 offset:59392
    s_add_u32 s94, s40, 16384
    v_mfma_f32_16x16x32_bf16 v[48:51], a[160:163], v[84:87], v[48:51]
    ds_read_b128 v[76:79], v7 offset:59648
    s_add_u32 m0, s46, 16384
    v_mfma_f32_16x16x32_bf16 v[52:55], a[164:167], v[84:87], v[52:55]
    buffer_load_dwordx4 v1, s[4:7], s94 offen offset:0 sc1 lds
    v_mfma_f32_16x16x32_bf16 v[44:47], a[164:167], v[80:83], v[44:47]
    v_mfma_f32_16x16x32_bf16 v[40:43], a[168:171], v[88:91], v[40:43]
    ds_read_b128 v[80:83], v7 offset:61440
    v_mfma_f32_16x16x32_bf16 v[48:51], a[168:171], v[92:95], v[48:51]
    ds_read_b128 v[84:87], v7 offset:61696
    v_mfma_f32_16x16x32_bf16 v[52:55], a[172:175], v[92:95], v[52:55]
    buffer_load_dwordx4 v1, s[4:7], s94 offen offset:1024 sc1 lds
    v_mfma_f32_16x16x32_bf16 v[44:47], a[172:175], v[88:91], v[44:47]
    s_waitcnt lgkmcnt(2)
    v_mfma_f32_16x16x32_bf16 v[40:43], a[176:179], v[64:67], v[40:43]
    ds_read_b128 v[88:91], v7 offset:63488
    v_mfma_f32_16x16x32_bf16 v[48:51], a[176:179], v[68:71], v[48:51]
    ds_read_b128 v[92:95], v7 offset:63744
    v_mfma_f32_16x16x32_bf16 v[52:55], a[180:183], v[68:71], v[52:55]
    buffer_load_dwordx4 v1, s[4:7], s94 offen offset:2048 sc1 lds
    v_mfma_f32_16x16x32_bf16 v[44:47], a[180:183], v[64:67], v[44:47]
    v_mfma_f32_16x16x32_bf16 v[40:43], a[184:187], v[72:75], v[40:43]
    ds_read_b128 v[64:67], v8 offset:0
    v_mfma_f32_16x16x32_bf16 v[48:51], a[184:187], v[76:79], v[48:51]
    ds_read_b128 v[68:71], v8 offset:256
    v_mfma_f32_16x16x32_bf16 v[52:55], a[188:191], v[76:79], v[52:55]
    buffer_load_dwordx4 v1, s[4:7], s94 offen offset:3072 sc1 lds
    v_mfma_f32_16x16x32_bf16 v[44:47], a[188:191], v[72:75], v[44:47]
    s_waitcnt lgkmcnt(2)
    v_mfma_f32_16x16x32_bf16 v[40:43], a[192:195], v[80:83], v[40:43]
    ds_read_b128 v[72:75], v8 offset:2048
    s_add_u32 s94, s40, 32768
    v_mfma_f32_16x16x32_bf16 v[48:51], a[192:195], v[84:87], v[48:51]
    ds_read_b128 v[76:79], v8 offset:2304
    s_add_u32 m0, s46, 32768
    v_mfma_f32_16x16x32_bf16 v[52:55], a[196:199], v[84:87], v[52:55]
    buffer_load_dwordx4 v1, s[4:7], s94 offen offset:0 sc1 lds
    v_mfma_f32_16x16x32_bf16 v[44:47], a[196:199], v[80:83], v[44:47]
    v_mfma_f32_16x16x32_bf16 v[40:43], a[200:203], v[88:91], v[40:43]
    ds_read_b128 v[80:83], v8 offset:4096
    v_mfma_f32_16x16x32_bf16 v[48:51], a[200:203], v[92:95], v[48:51]
    ds_read_b128 v[84:87], v8 offset:4352
    v_mfma_f32_16x16x32_bf16 v[52:55], a[204:207], v[92:95], v[52:55]
    buffer_load_dwordx4 v1, s[4:7], s94 offen offset:1024 sc1 lds
    v_mfma_f32_16x16x32_bf16 v[44:47], a[204:207], v[88:91], v[44:47]
    s_waitcnt lgkmcnt(2)
    v_mfma_f32_16x16x32_bf16 v[40:43], a[208:211], v[64:67], v[40:43]
    ds_read_b128 v[88:91], v8 offset:6144
    v_mfma_f32_16x16x32_bf16 v[48:51], a[208:211], v[68:71], v[48:51]
    ds_read_b128 v[92:95], v8 offset:6400
    v_mfma_f32_16x16x32_bf16 v[52:55], a[212:215], v[68:71], v[52:55]
    buffer_load_dwordx4 v1, s[4:7], s94 offen offset:2048 sc1 lds
    v_mfma_f32_16x16x32_bf16 v[44:47], a[212:215], v[64:67], v[44:47]
    v_mfma_f32_16x16x32_bf16 v[40:43], a[216:219], v[72:75], v[40:43]
    ds_read_b128 v[64:67], v8 offset:8192
    v_mfma_f32_16x16x32_bf16 v[48:51], a[216:219], v[76:79], v[48:51]
    ds_read_b128 v[68:71], v8 offset:8448
    v_mfma_f32_16x16x32_bf16 v[52:55], a[220:223], v[76:79], v[52:55]
    buffer_load_dwordx4 v1, s[4:7], s94 offen offset:3072 sc1 lds
    v_mfma_f32_16x16x32_bf16 v[44:47], a[220:223], v[72:75], v[44:47]
    s_waitcnt lgkmcnt(2)
    v_mfma_f32_16x16x32_bf16 v[40:43], a[224:227], v[80:83], v[40:43]
    ds_read_b128 v[72:75], v8 offset:10240
    s_add_u32 s94, s40, 49152
    v_mfma_f32_16x16x32_bf16 v[48:51], a[224:227], v[84:87], v[48:51]
    ds_read_b128 v[76:79], v8 offset:10496
    s_add_u32 m0, s46, 49152
    v_mfma_f32_16x16x32_bf16 v[52:55], a[228:231], v[84:87], v[52:55]
    buffer_load_dwordx4 v1, s[4:7], s94 offen offset:0 sc1 lds
    v_mfma_f32_16x16x32_bf16 v[44:47], a[228:231], v[80:83], v[44:47]
    v_mfma_f32_16x16x32_bf16 v[40:43], a[232:235], v[88:91], v[40:43]
    ds_read_b128 v[80:83], v8 offset:12288
    v_mfma_f32_16x16x32_bf16 v[48:51], a[232:235], v[92:95], v[48:51]
    ds_read_b128 v[84:87], v8 offset:12544
    v_mfma_f32_16x16x32_bf16 v[52:55], a[236:239], v[92:95], v[52:55]
    buffer_load_dwordx4 v1, s[4:7], s94 offen offset:1024 sc1 lds
    v_mfma_f32_16x16x32_bf16 v[44:47], a[236:239], v[88:91], v[44:47]
    s_waitcnt lgkmcnt(2)
    v_mfma_f32_16x16x32_bf16 v[40:43], a[240:243], v[64:67], v[40:43]
    ds_read_b128 v[88:91], v8 offset:14336
    v_mfma_f32_16x16x32_bf16 v[48:51], a[240:243], v[68:71], v[48:51]
    ds_read_b128 v[92:95], v8 offset:14592
    v_mfma_f32_16x16x32_bf16 v[52:55], a[244:247], v[68:71], v[52:55]
    buffer_load_dwordx4 v1, s[4:7], s94 offen offset:2048 sc1 lds
    v_mfma_f32_16x16x32_bf16 v[44:47], a[244:247], v[64:67], v[44:47]
    v_mfma_f32_16x16x32_bf16 v[40:43], a[248:251], v[72:75], v[40:43]
    ds_read_b128 v[64:67], v8 offset:16384
    v_mfma_f32_16x16x32_bf16 v[48:51], a[248:251], v[76:79], v[48:51]
    ds_read_b128 v[68:71], v8 offset:16640
    v_mfma_f32_16x16x32_bf16 v[52:55], a[252:255], v[76:79], v[52:55]
    buffer_load_dwordx4 v1, s[4:7], s94 offen offset:3072 sc1 lds
    v_mfma_f32_16x16x32_bf16 v[44:47], a[252:255], v[72:75], v[44:47]
    s_waitcnt lgkmcnt(2)
    v_mfma_f32_16x16x32_bf16 v[40:43], v[128:131], v[80:83], v[40:43]
    ds_read_b128 v[72:75], v8 offset:18432
    s_add_u32 s94, s40, s96
    v_mfma_f32_16x16x32_bf16 v[48:51], v[128:131], v[84:87], v[48:51]
    ds_read_b128 v[76:79], v8 offset:18688
    s_add_u32 s94, s94, 65536
    v_mfma_f32_16x16x32_bf16 v[52:55], v[132:135], v[84:87], v[52:55]
    s_add_u32 m0, s97, 65536
    v_mfma_f32_16x16x32_bf16 v[44:47], v[132:135], v[80:83], v[44:47]
    buffer_load_dwordx4 v1, s[4:7], s94 offen offset:0 sc1 lds
    v_mfma_f32_16x16x32_bf16 v[40:43], v[136:139], v[88:91], v[40:43]
    ds_read_b128 v[80:83], v8 offset:20480
    s_add_u32 s94, s40, s96
    v_mfma_f32_16x16x32_bf16 v[48:51], v[136:139], v[92:95], v[48:51]
    ds_read_b128 v[84:87], v8 offset:20736
    s_add_u32 s94, s94, 69632
    v_mfma_f32_16x16x32_bf16 v[52:55], v[140:143], v[92:95], v[52:55]
    s_add_u32 m0, s97, 69632
    v_mfma_f32_16x16x32_bf16 v[44:47], v[140:143], v[88:91], v[44:47]
    s_waitcnt lgkmcnt(2)
    v_mfma_f32_16x16x32_bf16 v[40:43], v[144:147], v[64:67], v[40:43]
    ds_read_b128 v[88:91], v8 offset:22528
    v_mfma_f32_16x16x32_bf16 v[48:51], v[144:147], v[68:71], v[48:51]
    ds_read_b128 v[92:95], v8 offset:22784
    v_mfma_f32_16x16x32_bf16 v[52:55], v[148:151], v[68:71], v[52:55]
    buffer_load_dwordx4 v1, s[4:7], s94 offen offset:0 sc1 lds
    s_add_u32 s94, s40, s96
    v_mfma_f32_16x16x32_bf16 v[44:47], v[148:151], v[64:67], v[44:47]
    s_add_u32 s94, s94, 73728
    s_add_u32 m0, s97, 73728
    s_nop 0
    buffer_load_dwordx4 v1, s[4:7], s94 offen offset:0 sc1 lds
    s_cmp_ge_u32 s40, 268435456
    s_cbranch_scc1 L_DN_slow1
    v_mfma_f32_16x16x32_bf16 v[40:43], v[152:155], v[72:75], v[40:43]
    v_mfma_f32_16x16x32_bf16 v[48:51], v[152:155], v[76:79], v[48:51]
    s_waitcnt vmcnt(7) lgkmcnt(0)
    s_barrier
    v_mfma_f32_16x16x32_bf16 v[52:55], v[156:159], v[76:79], v[52:55]
    ds_read_b128 v[64:67], v6 offset:0
    v_mfma_f32_16x16x32_bf16 v[44:47], v[156:159], v[72:75], v[44:47]
    ds_read_b128 v[68:71], v6 offset:256
    v_mfma_f32_16x16x32_bf16 v[40:43], v[160:163], v[80:83], v[40:43]
    ds_read_b128 v[72:75], v6 offset:2048
    v_mfma_f32_16x16x32_bf16 v[48:51], v[160:163], v[84:87], v[48:51]
    ds_read_b128 v[76:79], v6 offset:2304
    v_mfma_f32_16x16x32_bf16 v[52:55], v[164:167], v[84:87], v[52:55]
    v_mfma_f32_16x16x32_bf16 v[44:47], v[164:167], v[80:83], v[44:47]
    v_mfma_f32_16x16x32_bf16 v[40:43], v[168:171], v[88:91], v[40:43]
    ds_read_b128 v[80:83], v6 offset:4096
    v_mfma_f32_16x16x32_bf16 v[48:51], v[168:171], v[92:95], v[48:51]
    ds_read_b128 v[84:87], v6 offset:4352
    v_mfma_f32_16x16x32_bf16 v[52:55], v[172:175], v[92:95], v[52:55]
    v_mfma_f32_16x16x32_bf16 v[44:47], v[172:175], v[88:91], v[44:47]
    s_branch L_DN_top0
L_DN_nr0:
    s_mov_b32 s40, 268435456
    s_cmp_eq_u32 s23, 0
    s_cbranch_scc1 L_DN_go0
    s_mov_b32 s3, 0
L_DN_hl0:
    s_buffer_load_dword s62, s[4:7], s33 glc
    s_waitcnt lgkmcnt(0)
    s_cmp_ge_u32 s62, s32
    s_cbranch_scc1 L_DN_hd0
    s_add_u32 s3, s3, 1
    s_cmp_lt_u32 s3, 40000
    s_cbranch_scc1 L_DN_hl0
    s_mov_b32 s3, 36
    s_branch L_abort
L_DN_hd0:
    s_branch L_DN_rd0
L_DN_slow0:
    v_mfma_f32_16x16x32_bf16 v[16:19], v[152:155], v[88:91], v[16:19]
    v_mfma_f32_16x16x32_bf16 v[24:27], v[152:155], v[92:95], v[24:27]
    v_mfma_f32_16x16x32_bf16 v[28:31], v[156:159], v[92:95], v[28:31]
    v_mfma_f32_16x16x32_bf16 v[20:23], v[156:159], v[88:91], v[20:23]
    s_waitcnt lgkmcnt(3)
    v_mfma_f32_16x16x32_bf16 v[16:19], v[160:163], v[64:67], v[16:19]
    s_waitcnt lgkmcnt(2)
    v_mfma_f32_16x16x32_bf16 v[24:27], v[160:163], v[68:71], v[24:27]
    v_mfma_f32_16x16x32_bf16 v[28:31], v[164:167], v[68:71], v[28:31]
    v_mfma_f32_16x16x32_bf16 v[20:23], v[164:167], v[64:67], v[20:23]
    s_waitcnt lgkmcnt(1)
    v_mfma_f32_16x16x32_bf16 v[16:19], v[168:171], v[72:75], v[16:19]
    s_waitcnt lgkmcnt(0)
    v_mfma_f32_16x16x32_bf16 v[24:27], v[168:171], v[76:79], v[24:27]
    v_mfma_f32_16x16x32_bf16 v[28:31], v[172:175], v[76:79], v[28:31]
    v_mfma_f32_16x16x32_bf16 v[20:23], v[172:175], v[72:75], v[20:23]
    s_mul_i32 s86, s36, 196608
    s_add_u32 s87, s86, s45
    s_add_u32 s86, s86, s44
    s_lshl2_add_u32 s37, s36, s43
    v_cvt_pk_bf16_f32 v96, v16, v17
    v_cvt_pk_bf16_f32 v97, v18, v19
    s_nop 1
    v_cvt_pk_bf16_f32 v98, v20, v21
    v_cvt_pk_bf16_f32 v99, v22, v23
    buffer_store_dwordx4 v[96:99], v4, s[4:7], s86 offen sc1
    v_cvt_pk_bf16_f32 v100, v24, v25
    v_cvt_pk_bf16_f32 v101, v26, v27
    v_cvt_pk_bf16_f32 v102, v28, v29
    v_cvt_pk_bf16_f32 v103, v30, v31
    buffer_store_dwordx4 v[100:103], v4, s[4:7], s87 offen sc1
    s_buffer_load_dword s62, s[4:7], s33 glc
    s_waitcnt vmcnt(0)
    s_add_u32 s92, s59, 1
    v_mov_b32 v12, s92
    s_and_b32 s95, s92, s57
    ds_write_b32 v11, v12
    s_cmp_lg_u32 s58, 0
    s_cbranch_scc1 L_pd_41
    ds_read_b128 v[116:119], v9
    s_waitcnt lgkmcnt(0)
    v_min3_u32 v116, v116, v117, v118
    v_min_u32 v116, v116, v119
    v_cmp_gt_u32 vcc, s95, v116
    s_cbranch_vccnz L_pd_41
    buffer_atomic_add v5, v2, s[4:7], s37 offen
    s_mov_b32 s58, 268435456
L_pd_41:
    s_cmp_lg_u32 s58, 0
    s_cbranch_scc1 L_pd_42
    ds_read_b128 v[116:119], v9
    s_waitcnt lgkmcnt(0)
    v_min3_u32 v116, v116, v117, v118
    v_min_u32 v116, v116, v119
    v_cmp_gt_u32 vcc, s95, v116
    s_cbranch_vccnz L_pd_42
    buffer_atomic_add v5, v2, s[4:7], s37 offen
    s_mov_b32 s58, 268435456
L_pd_42:
    s_cmp_gt_u32 s20, 128
    s_cbranch_scc1 L_DN_done
    s_waitcnt lgkmcnt(0)
    s_cmp_ge_u32 s62, s32
    s_cbranch_scc1 L_DN_sd0
L_DN_ss0:
    s_mov_b32 s3, 0
L_DN_sl0:
    s_cmp_lg_u32 s58, 0
    s_cbranch_scc1 L_pd_43
    ds_read_b128 v[116:119], v9
    s_waitcnt lgkmcnt(0)
    v_min3_u32 v116, v116, v117, v118
    v_min_u32 v116, v116, v119
    v_cmp_gt_u32 vcc, s95, v116
    s_cbranch_vccnz L_pd_43
    buffer_atomic_add v5, v2, s[4:7], s37 offen
    s_mov_b32 s58, 268435456
L_pd_43:
    s_buffer_load_dword s62, s[4:7], s33 glc
    s_waitcnt lgkmcnt(0)
    s_cmp_ge_u32 s62, s32
    s_cbranch_scc1 L_DN_sd0
    s_add_u32 s3, s3, 1
    s_cmp_lt_u32 s3, 40000
    s_cbranch_scc1 L_DN_sl0
    s_mov_b32 s3, 16
    s_branch L_abort
L_DN_sd0:
    s_mov_b32 s40, s31
    s_add_u32 s94, s40, 0
    s_add_u32 m0, s47, 77824
    s_nop 0
    buffer_load_dwordx4 v1, s[4:7], s94 offen offset:0 sc1 lds
    buffer_load_dwordx4 v1, s[4:7], s94 offen offset:1024 sc1 lds
    buffer_load_dwordx4 v1, s[4:7], s94 offen offset:2048 sc1 lds
    buffer_load_dwordx4 v1, s[4:7], s94 offen offset:3072 sc1 lds
    s_add_u32 s94, s40, 16384
    s_add_u32 m0, s47, 94208
    s_nop 0
    buffer_load_dwordx4 v1, s[4:7], s94 offen offset:0 sc1 lds
    buffer_load_dwordx4 v1, s[4:7], s94 offen offset:1024 sc1 lds
    buffer_load_dwordx4 v1, s[4:7], s94 offen offset:2048 sc1 lds
    buffer_load_dwordx4 v1, s[4:7], s94 offen offset:3072 sc1 lds
    s_add_u32 s94, s40, 32768
    s_add_u32 m0, s47, 110592
    s_nop 0
    buffer_load_dwordx4 v1, s[4:7], s94 offen offset:0 sc1 lds
    buffer_load_dwordx4 v1, s[4:7], s94 offen offset:1024 sc1 lds
    buffer_load_dwordx4 v1, s[4:7], s94 offen offset:2048 sc1 lds
    buffer_load_dwordx4 v1, s[4:7], s94 offen offset:3072 sc1 lds
    s_add_u32 s94, s40, 49152
    s_add_u32 m0, s47, 126976
    s_nop 0
    buffer_load_dwordx4 v1, s[4:7], s94 offen offset:0 sc1 lds
    buffer_load_dwordx4 v1, s[4:7], s94 offen offset:1024 sc1 lds
    buffer_load_dwordx4 v1, s[4:7], s94 offen offset:2048 sc1 lds
    buffer_load_dwordx4 v1, s[4:7], s94 offen offset:3072 sc1 lds
    s_waitcnt vmcnt(4)
    s_barrier
    ds_read_b128 v[80:83], v7 offset:12288
    ds_read_b128 v[84:87], v7 offset:12544
    ds_read_b128 v[88:91], v7 offset:14336
    ds_read_b128 v[92:95], v7 offset:14592
    ds_read_b128 v[64:67], v7 offset:16384
    ds_read_b128 v[68:71], v7 offset:16640
    s_waitcnt lgkmcnt(4)
    v_mfma_f32_16x16x32_bf16 v[40:43], a[0:3], v[80:83], 0
    ds_read_b128 v[72:75], v7 offset:18432
    s_add_u32 s94, s40, s96
    v_mfma_f32_16x16x32_bf16 v[48:51], a[0:3], v[84:87], 0
    ds_read_b128 v[76:79], v7 offset:18688
    s_add_u32 s94, s94, 65536
    v_mfma_f32_16x16x32_bf16 v[52:55], a[4:7], v[84:87], 0
    s_add_u32 m0, s97, 143360
    s_lshl2_add_u32 s37, s36, s43
    s_mov_b32 s34, s28
    v_mfma_f32_16x16x32_bf16 v[44:47], a[4:7], v[80:83], 0
    s_waitcnt lgkmcnt(4)
    s_mov_b32 s35, s29
    s_mov_b32 s36, s30
    v_mfma_f32_16x16x32_bf16 v[40:43], a[8:11], v[88:91], v[40:43]
    ds_read_b128 v[80:83], v7 offset:20480
    s_add_u32 s59, s59, 1
    v_mfma_f32_16x16x32_bf16 v[48:51], a[8:11], v[92:95], v[48:51]
    ds_read_b128 v[84:87], v7 offset:20736
    v_mfma_f32_16x16x32_bf16 v[52:55], a[12:15], v[92:95], v[52:55]
    buffer_load_dwordx4 v1, s[4:7], s94 offen offset:0 sc1 lds
    s_add_u32 s94, s40, s96
    v_mfma_f32_16x16x32_bf16 v[44:47], a[12:15], v[88:91], v[44:47]
    s_waitcnt lgkmcnt(2)
    s_add_u32 s94, s94, 69632
    s_add_u32 m0, s97, 147456
    v_mfma_f32_16x16x32_bf16 v[40:43], a[16:19], v[64:67], v[40:43]
    ds_read_b128 v[88:91], v7 offset:22528
    v_mfma_f32_16x16x32_bf16 v[48:51], a[16:19], v[68:71], v[48:51]
    ds_read_b128 v[92:95], v7 offset:22784
    v_mfma_f32_16x16x32_bf16 v[52:55], a[20:23], v[68:71], v[52:55]
    buffer_load_dwordx4 v1, s[4:7], s94 offen offset:0 sc1 lds
    s_add_u32 s94, s40, s96
    v_mfma_f32_16x16x32_bf16 v[44:47], a[20:23], v[64:67], v[44:47]
    s_add_u32 s94, s94, 73728
    s_add_u32 m0, s97, 151552
    v_mfma_f32_16x16x32_bf16 v[40:43], a[24:27], v[72:75], v[40:43]
    ds_read_b128 v[64:67], v7 offset:24576
    v_mfma_f32_16x16x32_bf16 v[48:51], a[24:27], v[76:79], v[48:51]
    ds_read_b128 v[68:71], v7 offset:24832
    v_mfma_f32_16x16x32_bf16 v[52:55], a[28:31], v[76:79], v[52:55]
    buffer_load_dwordx4 v1, s[4:7], s94 offen offset:0 sc1 lds
    v_mfma_f32_16x16x32_bf16 v[44:47], a[28:31], v[72:75], v[44:47]
    s_waitcnt lgkmcnt(2)
    s_cmp_lt_u32 s20, 64
    s_cselect_b64 s[88:89], s[24:25], s[26:27]
    v_mfma_f32_16x16x32_bf16 v[40:43], a[32:35], v[80:83], v[40:43]
    ds_read_b128 v[72:75], v7 offset:26624
    v_mfma_f32_16x16x32_bf16 v[48:51], a[32:35], v[84:87], v[48:51]
    ds_read_b128 v[76:79], v7 offset:26880
    v_mfma_f32_16x16x32_bf16 v[52:55], a[36:39], v[84:87], v[52:55]
    s_bitcmp1_b64 s[88:89], s20
    s_cselect_b32 s28, 1, 0
    s_cselect_b32 s29, s22, s21
    v_mfma_f32_16x16x32_bf16 v[44:47], a[36:39], v[80:83], v[44:47]
    s_add_u32 s22, s22, s28
    s_xor_b32 s88, s28, 1
    s_add_u32 s21, s21, s88
    v_mfma_f32_16x16x32_bf16 v[40:43], a[40:43], v[88:91], v[40:43]
    ds_read_b128 v[80:83], v7 offset:28672
    s_lshl_b32 s30, s28, 6
    v_mfma_f32_16x16x32_bf16 v[48:51], a[40:43], v[92:95], v[48:51]
    ds_read_b128 v[84:87], v7 offset:28928
    s_add_u32 s30, s30, s29
    v_mfma_f32_16x16x32_bf16 v[52:55], a[44:47], v[92:95], v[52:55]
    s_and_b32 s31, s30, 95
    s_mul_i32 s31, s31, 229376
    s_add_u32 s31, s31, s42
    v_mfma_f32_16x16x32_bf16 v[44:47], a[44:47], v[88:91], v[44:47]
    s_waitcnt lgkmcnt(2)
    s_lshl2_add_u32 s33, s30, s60
    v_mfma_f32_16x16x32_bf16 v[40:43], a[48:51], v[64:67], v[40:43]
    ds_read_b128 v[88:91], v7 offset:30720
    v_mfma_f32_16x16x32_bf16 v[48:51], a[48:51], v[68:71], v[48:51]
    ds_read_b128 v[92:95], v7 offset:30976
    v_mfma_f32_16x16x32_bf16 v[52:55], a[52:55], v[68:71], v[52:55]
    s_cmp_lt_u32 s20, 128
    s_cselect_b32 s31, s31, 268435456
    s_cselect_b32 s32, s61, 0
    v_mfma_f32_16x16x32_bf16 v[44:47], a[52:55], v[64:67], v[44:47]
    s_add_u32 s20, s20, 1
    s_andn2_b32 s23, s34, s28
    s_buffer_load_dword s62, s[4:7], s33 glc
    v_mfma_f32_16x16x32_bf16 v[40:43], a[56:59], v[72:75], v[40:43]
    ds_read_b128 v[64:67], v7 offset:32768
    v_mfma_f32_16x16x32_bf16 v[48:51], a[56:59], v[76:79], v[48:51]
    ds_read_b128 v[68:71], v7 offset:33024
    v_mfma_f32_16x16x32_bf16 v[52:55], a[60:63], v[76:79], v[52:55]
    v_mfma_f32_16x16x32_bf16 v[44:47], a[60:63], v[72:75], v[44:47]
    s_waitcnt lgkmcnt(4)
    v_mfma_f32_16x16x32_bf16 v[40:43], a[64:67], v[80:83], v[40:43]
    ds_read_b128 v[72:75], v7 offset:34816
    v_mfma_f32_16x16x32_bf16 v[48:51], a[64:67], v[84:87], v[48:51]
    ds_read_b128 v[76:79], v7 offset:35072
    v_mfma_f32_16x16x32_bf16 v[52:55], a[68:71], v[84:87], v[52:55]
    v_mfma_f32_16x16x32_bf16 v[44:47], a[68:71], v[80:83], v[44:47]
    s_waitcnt lgkmcnt(4)
    v_mfma_f32_16x16x32_bf16 v[40:43], a[72:75], v[88:91], v[40:43]
    ds_read_b128 v[80:83], v7 offset:36864
    v_mfma_f32_16x16x32_bf16 v[48:51], a[72:75], v[92:95], v[48:51]
    ds_read_b128 v[84:87], v7 offset:37120
    v_mfma_f32_16x16x32_bf16 v[52:55], a[76:79], v[92:95], v[52:55]
    v_mfma_f32_16x16x32_bf16 v[44:47], a[76:79], v[88:91], v[44:47]
    s_waitcnt lgkmcnt(4)
    v_mfma_f32_16x16x32_bf16 v[40:43], a[80:83], v[64:67], v[40:43]
    ds_read_b128 v[88:91], v7 offset:38912
    v_mfma_f32_16x16x32_bf16 v[48:51], a[80:83], v[68:71], v[48:51]
    ds_read_b128 v[92:95], v7 offset:39168
    v_mfma_f32_16x16x32_bf16 v[52:55], a[84:87], v[68:71], v[52:55]
    v_mfma_f32_16x16x32_bf16 v[44:47], a[84:87], v[64:67], v[44:47]
    s_waitcnt lgkmcnt(4)
    v_mfma_f32_16x16x32_bf16 v[40:43], a[88:91], v[72:75], v[40:43]
    ds_read_b128 v[64:67], v7 offset:40960
    v_mfma_f32_16x16x32_bf16 v[48:51], a[88:91], v[76:79], v[48:51]
    ds_read_b128 v[68:71], v7 offset:41216
    v_mfma_f32_16x16x32_bf16 v[52:55], a[92:95], v[76:79], v[52:55]
    v_mfma_f32_16x16x32_bf16 v[44:47], a[92:95], v[72:75], v[44:47]
    s_waitcnt lgkmcnt(4)
    v_mfma_f32_16x16x32_bf16 v[40:43], a[96:99], v[80:83], v[40:43]
    ds_read_b128 v[72:75], v7 offset:43008
    v_mfma_f32_16x16x32_bf16 v[48:51], a[96:99], v[84:87], v[48:51]
    ds_read_b128 v[76:79], v7 offset:43264
    v_mfma_f32_16x16x32_bf16 v[52:55], a[100:103], v[84:87], v[52:55]
    v_mfma_f32_16x16x32_bf16 v[44:47], a[100:103], v[80:83], v[44:47]
    s_waitcnt lgkmcnt(4)
    v_mfma_f32_16x16x32_bf16 v[40:43], a[104:107], v[88:91], v[40:43]
    ds_read_b128 v[80:83], v7 offset:45056
    v_mfma_f32_16x16x32_bf16 v[48:51], a[104:107], v[92:95], v[48:51]
    ds_read_b128 v[84:87], v7 offset:45312
    v_mfma_f32_16x16x32_bf16 v[52:55], a[108:111], v[92:95], v[52:55]
    v_mfma_f32_16x16x32_bf16 v[44:47], a[108:111], v[88:91], v[44:47]
    s_waitcnt lgkmcnt(4)
    v_mfma_f32_16x16x32_bf16 v[40:43], a[112:115], v[64:67], v[40:43]
    ds_read_b128 v[88:91], v7 offset:47104
    v_mfma_f32_16x16x32_bf16 v[48:51], a[112:115], v[68:71], v[48:51]
    ds_read_b128 v[92:95], v7 offset:47360
    v_mfma_f32_16x16x32_bf16 v[52:55], a[116:119], v[68:71], v[52:55]
    v_mfma_f32_16x16x32_bf16 v[44:47], a[116:119], v[64:67], v[44:47]
    s_waitcnt vmcnt(0)
    s_branch L_DN_mid1
L_DN_nr1:
    s_mov_b32 s40, 268435456
    s_cmp_eq_u32 s23, 0
    s_cbranch_scc1 L_DN_go1
    s_mov_b32 s3, 0
L_DN_hl1:
    s_buffer_load_dword s62, s[4:7], s33 glc
    s_waitcnt lgkmcnt(0)
    s_cmp_ge_u32 s62, s32
    s_cbranch_scc1 L_DN_hd1
    s_add_u32 s3, s3, 1
    s_cmp_lt_u32 s3, 40000
    s_cbranch_scc1 L_DN_hl1
    s_mov_b32 s3, 36
    s_branch L_abort
L_DN_hd1:
    s_branch L_DN_rd1
L_DN_slow1:
    v_mfma_f32_16x16x32_bf16 v[40:43], v[152:155], v[72:75], v[40:43]
    v_mfma_f32_16x16x32_bf16 v[48:51], v[152:155], v[76:79], v[48:51]
    v_mfma_f32_16x16x32_bf16 v[52:55], v[156:159], v[76:79], v[52:55]
    v_mfma_f32_16x16x32_bf16 v[44:47], v[156:159], v[72:75], v[44:47]
    s_waitcnt lgkmcnt(3)
    v_mfma_f32_16x16x32_bf16 v[40:43], v[160:163], v[80:83], v[40:43]
    s_waitcnt lgkmcnt(2)
    v_mfma_f32_16x16x32_bf16 v[48:51], v[160:163], v[84:87], v[48:51]
    v_mfma_f32_16x16x32_bf16 v[52:55], v[164:167], v[84:87], v[52:55]
    v_mfma_f32_16x16x32_bf16 v[44:47], v[164:167], v[80:83], v[44:47]
    s_waitcnt lgkmcnt(1)
    v_mfma_f32_16x16x32_bf16 v[40:43], v[168:171], v[88:91], v[40:43]
    s_waitcnt lgkmcnt(0)
    v_mfma_f32_16x16x32_bf16 v[48:51], v[168:171], v[92:95], v[48:51]
    v_mfma_f32_16x16x32_bf16 v[52:55], v[172:175], v[92:95], v[52:55]
    v_mfma_f32_16x16x32_bf16 v[44:47], v[172:175], v[88:91], v[44:47]
    s_mul_i32 s86, s36, 196608
    s_add_u32 s87, s86, s45
    s_add_u32 s86, s86, s44
    s_lshl2_add_u32 s37, s36, s43
    v_cvt_pk_bf16_f32 v96, v40, v41
    v_cvt_pk_bf16_f32 v97, v42, v43
    s_nop 1
    v_cvt_pk_bf16_f32 v98, v44, v45
    v_cvt_pk_bf16_f32 v99, v46, v47
    buffer_store_dwordx4 v[96:99], v4, s[4:7], s86 offen sc1
    v_cvt_pk_bf16_f32 v100, v48, v49
    v_cvt_pk_bf16_f32 v101, v50, v51
    v_cvt_pk_bf16_f32 v102, v52, v53
    v_cvt_pk_bf16_f32 v103, v54, v55
    buffer_store_dwordx4 v[100:103], v4, s[4:7], s87 offen sc1
    s_buffer_load_dword s62, s[4:7], s33 glc
    s_waitcnt vmcnt(0)
    s_add_u32 s92, s59, 1
    v_mov_b32 v12, s92
    s_and_b32 s95, s92, s57
    ds_write_b32 v11, v12
    s_cmp_lg_u32 s58, 0
    s_cbranch_scc1 L_pd_44
    ds_read_b128 v[116:119], v9
    s_waitcnt lgkmcnt(0)
    v_min3_u32 v116, v116, v117, v118
    v_min_u32 v116, v116, v119
    v_cmp_gt_u32 vcc, s95, v116
    s_cbranch_vccnz L_pd_44
    buffer_atomic_add v5, v2, s[4:7], s37 offen
    s_mov_b32 s58, 268435456
L_pd_44:
    s_cmp_lg_u32 s58, 0
    s_cbranch_scc1 L_pd_45
    ds_read_b128 v[116:119], v9
    s_waitcnt lgkmcnt(0)
    v_min3_u32 v116, v116, v117, v118
    v_min_u32 v116, v116, v119
    v_cmp_gt_u32 vcc, s95, v116
    s_cbranch_vccnz L_pd_45
    buffer_atomic_add v5, v2, s[4:7], s37 offen
    s_mov_b32 s58, 268435456
L_pd_45:
    s_cmp_gt_u32 s20, 128
    s_cbranch_scc1 L_DN_done
    s_waitcnt lgkmcnt(0)
    s_cmp_ge_u32 s62, s32
    s_cbranch_scc1 L_DN_sd1
L_DN_ss1:
    s_mov_b32 s3, 0
L_DN_sl1:
    s_cmp_lg_u32 s58, 0
    s_cbranch_scc1 L_pd_46
    ds_read_b128 v[116:119], v9
    s_waitcnt lgkmcnt(0)
    v_min3_u32 v116, v116, v117, v118
    v_min_u32 v116, v116, v119
    v_cmp_gt_u32 vcc, s95, v116
    s_cbranch_vccnz L_pd_46
    buffer_atomic_add v5, v2, s[4:7], s37 offen
    s_mov_b32 s58, 268435456
L_pd_46:
    s_buffer_load_dword s62, s[4:7], s33 glc
    s_waitcnt lgkmcnt(0)
    s_cmp_ge_u32 s62, s32
    s_cbranch_scc1 L_DN_sd1
    s_add_u32 s3, s3, 1
    s_cmp_lt_u32 s3, 40000
    s_cbranch_scc1 L_DN_sl1
    s_mov_b32 s3, 16
    s_branch L_abort
L_DN_sd1:
    s_mov_b32 s40, s31
    s_add_u32 s94, s40, 0
    s_add_u32 m0, s46, 0
    s_nop 0
    buffer_load_dwordx4 v1, s[4:7], s94 offen offset:0 sc1 lds
    buffer_load_dwordx4 v1, s[4:7], s94 offen offset:1024 sc1 lds
    buffer_load_dwordx4 v1, s[4:7], s94 offen offset:2048 sc1 lds
    buffer_load_dwordx4 v1, s[4:7], s94 offen offset:3072 sc1 lds
    s_add_u32 s94, s40, 16384
    s_add_u32 m0, s46, 16384
    s_nop 0
    buffer_load_dwordx4 v1, s[4:7], s94 offen offset:0 sc1 lds
    buffer_load_dwordx4 v1, s[4:7], s94 offen offset:1024 sc1 lds
    buffer_load_dwordx4 v1, s[4:7], s94 offen offset:2048 sc1 lds
    buffer_load_dwordx4 v1, s[4:7], s94 offen offset:3072 sc1 lds
    s_add_u32 s94, s40, 32768
    s_add_u32 m0, s46, 32768
    s_nop 0
    buffer_load_dwordx4 v1, s[4:7], s94 offen offset:0 sc1 lds
    buffer_load_dwordx4 v1, s[4:7], s94 offen offset:1024 sc1 lds
    buffer_load_dwordx4 v1, s[4:7], s94 offen offset:2048 sc1 lds
    buffer_load_dwordx4 v1, s[4:7], s94 offen offset:3072 sc1 lds
    s_add_u32 s94, s40, 49152
    s_add_u32 m0, s46, 49152
    s_nop 0
    buffer_load_dwordx4 v1, s[4:7], s94 offen offset:0 sc1 lds
    buffer_load_dwordx4 v1, s[4:7], s94 offen offset:1024 sc1 lds
    buffer_load_dwordx4 v1, s[4:7], s94 offen offset:2048 sc1 lds
    buffer_load_dwordx4 v1, s[4:7], s94 offen offset:3072 sc1 lds
    s_waitcnt vmcnt(4)
    s_barrier
    ds_read_b128 v[64:67], v6 offset:0
    ds_read_b128 v[68:71], v6 offset:256
    ds_read_b128 v[72:75], v6 offset:2048
    ds_read_b128 v[76:79], v6 offset:2304
    ds_read_b128 v[80:83], v6 offset:4096
    ds_read_b128 v[84:87], v6 offset:4352
    s_waitcnt lgkmcnt(4)
    v_mfma_f32_16x16x32_bf16 v[16:19], a[0:3], v[64:67], 0
    ds_read_b128 v[88:91], v6 offset:6144
    s_add_u32 s94, s40, s96
    v_mfma_f32_16x16x32_bf16 v[24:27], a[0:3], v[68:71], 0
    ds_read_b128 v[92:95], v6 offset:6400
    s_add_u32 s94, s94, 65536
    v_mfma_f32_16x16x32_bf16 v[28:31], a[4:7], v[68:71], 0
    s_add_u32 m0, s97, 65536
    s_lshl2_add_u32 s37, s36, s43
    s_mov_b32 s34, s28
    v_mfma_f32_16x16x32_bf16 v[20:23], a[4:7], v[64:67], 0
    s_waitcnt lgkmcnt(4)
    s_mov_b32 s35, s29
    s_mov_b32 s36, s30
    v_mfma_f32_16x16x32_bf16 v[16:19], a[8:11], v[72:75], v[16:19]
    ds_read_b128 v[64:67], v6 offset:8192
    s_add_u32 s59, s59, 1
    v_mfma_f32_16x16x32_bf16 v[24:27], a[8:11], v[76:79], v[24:27]
    ds_read_b128 v[68:71], v6 offset:8448
    v_mfma_f32_16x16x32_bf16 v[28:31], a[12:15], v[76:79], v[28:31]
    buffer_load_dwordx4 v1, s[4:7], s94 offen offset:0 sc1 lds
    s_add_u32 s94, s40, s96
    v_mfma_f32_16x16x32_bf16 v[20:23], a[12:15], v[72:75], v[20:23]
    s_waitcnt lgkmcnt(2)
    s_add_u32 s94, s94, 69632
    s_add_u32 m0, s97, 69632
    v_mfma_f32_16x16x32_bf16 v[16:19], a[16:19], v[80:83], v[16:19]
    ds_read_b128 v[72:75], v6 offset:10240
    v_mfma_f32_16x16x32_bf16 v[24:27], a[16:19], v[84:87], v[24:27]
    ds_read_b128 v[76:79], v6 offset:10496
    v_mfma_f32_16x16x32_bf16 v[28:31], a[20:23], v[84:87], v[28:31]
    buffer_load_dwordx4 v1, s[4:7], s94 offen offset:0 sc1 lds
    s_add_u32 s94, s40, s96
    v_mfma_f32_16x16x32_bf16 v[20:23], a[20:23], v[80:83], v[20:23]
    s_add_u32 s94, s94, 73728
    s_add_u32 m0, s97, 73728
    v_mfma_f32_16x16x32_bf16 v[16:19], a[24:27], v[88:91], v[16:19]
    ds_read_b128 v[80:83], v6 offset:12288
    v_mfma_f32_16x16x32_bf16 v[24:27], a[24:27], v[92:95], v[24:27]
    ds_read_b128 v[84:87], v6 offset:12544
    v_mfma_f32_16x16x32_bf16 v[28:31], a[28:31], v[92:95], v[28:31]
    buffer_load_dwordx4 v1, s[4:7], s94 offen offset:0 sc1 lds
    v_mfma_f32_16x16x32_bf16 v[20:23], a[28:31], v[88:91], v[20:23]
    s_waitcnt lgkmcnt(2)
    s_cmp_lt_u32 s20, 64
    s_cselect_b64 s[88:89], s[24:25], s[26:27]
    v_mfma_f32_16x16x32_bf16 v[16:19], a[32:35], v[64:67], v[16:19]
    ds_read_b128 v[88:91], v6 offset:14336
    v_mfma_f32_16x16x32_bf16 v[24:27], a[32:35], v[68:71], v[24:27]
    ds_read_b128 v[92:95], v6 offset:14592
    v_mfma_f32_16x16x32_bf16 v[28:31], a[36:39], v[68:71], v[28:31]
    s_bitcmp1_b64 s[88:89], s20
    s_cselect_b32 s28, 1, 0
    s_cselect_b32 s29, s22, s21
    v_mfma_f32_16x16x32_bf16 v[20:23], a[36:39], v[64:67], v[20:23]
    s_add_u32 s22, s22, s28
    s_xor_b32 s88, s28, 1
    s_add_u32 s21, s21, s88
    v_mfma_f32_16x16x32_bf16 v[16:19], a[40:43], v[72:75], v[16:19]
    ds_read_b128 v[64:67], v6 offset:16384
    s_lshl_b32 s30, s28, 6
    v_mfma_f32_16x16x32_bf16 v[24:27], a[40:43], v[76:79], v[24:27]
    ds_read_b128 v[68:71], v6 offset:16640
    s_add_u32 s30, s30, s29
    v_mfma_f32_16x16x32_bf16 v[28:31], a[44:47], v[76:79], v[28:31]
    s_and_b32 s31, s30, 95
    s_mul_i32 s31, s31, 229376
    s_add_u32 s31, s31, s42
    v_mfma_f32_16x16x32_bf16 v[20:23], a[44:47], v[72:75], v[20:23]
    s_waitcnt lgkmcnt(2)
    s_lshl2_add_u32 s33, s30, s60
    v_mfma_f32_16x16x32_bf16 v[16:19], a[48:51], v[80:83], v[16:19]
    ds_read_b128 v[72:75], v6 offset:18432
    v_mfma_f32_16x16x32_bf16 v[24:27], a[48:51], v[84:87], v[24:27]
    ds_read_b128 v[76:79], v6 offset:18688
    v_mfma_f32_16x16x32_bf16 v[28:31], a[52:55], v[84:87], v[28:31]
    s_cmp_lt_u32 s20, 128
    s_cselect_b32 s31, s31, 268435456
    s_cselect_b32 s32, s61, 0
    v_mfma_f32_16x16x32_bf16 v[20:23], a[52:55], v[80:83], v[20:23]
    s_add_u32 s20, s20, 1
    s_andn2_b32 s23, s34, s28
    s_buffer_load_dword s62, s[4:7], s33 glc
    v_mfma_f32_16x16x32_bf16 v[16:19], a[56:59], v[88:91], v[16:19]
    ds_read_b128 v[80:83], v6 offset:20480
    v_mfma_f32_16x16x32_bf16 v[24:27], a[56:59], v[92:95], v[24:27]
    ds_read_b128 v[84:87], v6 offset:20736
    v_mfma_f32_16x16x32_bf16 v[28:31], a[60:63], v[92:95], v[28:31]
    v_mfma_f32_16x16x32_bf16 v[20:23], a[60:63], v[88:91], v[20:23]
    s_waitcnt lgkmcnt(4)
    v_mfma_f32_16x16x32_bf16 v[16:19], a[64:67], v[64:67], v[16:19]
    ds_read_b128 v[88:91], v6 offset:22528
    v_mfma_f32_16x16x32_bf16 v[24:27], a[64:67], v[68:71], v[24:27]
    ds_read_b128 v[92:95], v6 offset:22784
    v_mfma_f32_16x16x32_bf16 v[28:31], a[68:71], v[68:71], v[28:31]
    v_mfma_f32_16x16x32_bf16 v[20:23], a[68:71], v[64:67], v[20:23]
    s_waitcnt lgkmcnt(4)
    v_mfma_f32_16x16x32_bf16 v[16:19], a[72:75], v[72:75], v[16:19]
    ds_read_b128 v[64:67], v6 offset:24576
    v_mfma_f32_16x16x32_bf16 v[24:27], a[72:75], v[76:79], v[24:27]
    ds_read_b128 v[68:71], v6 offset:24832
    v_mfma_f32_16x16x32_bf16 v[28:31], a[76:79], v[76:79], v[28:31]
    v_mfma_f32_16x16x32_bf16 v[20:23], a[76:79], v[72:75], v[20:23]
    s_waitcnt lgkmcnt(4)
    v_mfma_f32_16x16x32_bf16 v[16:19], a[80:83], v[80:83], v[16:19]
    ds_read_b128 v[72:75], v6 offset:26624
    v_mfma_f32_16x16x32_bf16 v[24:27], a[80:83], v[84:87], v[24:27]
    ds_read_b128 v[76:79], v6 offset:26880
    v_mfma_f32_16x16x32_bf16 v[28:31], a[84:87], v[84:87], v[28:31]
    v_mfma_f32_16x16x32_bf16 v[20:23], a[84:87], v[80:83], v[20:23]
    s_waitcnt lgkmcnt(4)
    v_mfma_f32_16x16x32_bf16 v[16:19], a[88:91], v[88:91], v[16:19]
    ds_read_b128 v[80:83], v6 offset:28672
    v_mfma_f32_16x16x32_bf16 v[24:27], a[88:91], v[92:95], v[24:27]
    ds_read_b128 v[84:87], v6 offset:28928
    v_mfma_f32_16x16x32_bf16 v[28:31], a[92:95], v[92:95], v[28:31]
    v_mfma_f32_16x16x32_bf16 v[20:23], a[92:95], v[88:91], v[20:23]
    s_waitcnt lgkmcnt(4)
    v_mfma_f32_16x16x32_bf16 v[16:19], a[96:99], v[64:67], v[16:19]
    ds_read_b128 v[88:91], v6 offset:30720
    v_mfma_f32_16x16x32_bf16 v[24:27], a[96:99], v[68:71], v[24:27]
    ds_read_b128 v[92:95], v6 offset:30976
    v_mfma_f32_16x16x32_bf16 v[28:31], a[100:103], v[68:71], v[28:31]
    v_mfma_f32_16x16x32_bf16 v[20:23], a[100:103], v[64:67], v[20:23]
    s_waitcnt lgkmcnt(4)
    v_mfma_f32_16x16x32_bf16 v[16:19], a[104:107], v[72:75], v[16:19]
    ds_read_b128 v[64:67], v6 offset:32768
    v_mfma_f32_16x16x32_bf16 v[24:27], a[104:107], v[76:79], v[24:27]
    ds_read_b128 v[68:71], v6 offset:33024
    v_mfma_f32_16x16x32_bf16 v[28:31], a[108:111], v[76:79], v[28:31]
    v_mfma_f32_16x16x32_bf16 v[20:23], a[108:111], v[72:75], v[20:23]
    s_waitcnt lgkmcnt(4)
    v_mfma_f32_16x16x32_bf16 v[16:19], a[112:115], v[80:83], v[16:19]
    ds_read_b128 v[72:75], v6 offset:34816
    v_mfma_f32_16x16x32_bf16 v[24:27], a[112:115], v[84:87], v[24:27]
    ds_read_b128 v[76:79], v6 offset:35072
    v_mfma_f32_16x16x32_bf16 v[28:31], a[116:119], v[84:87], v[28:31]
    v_mfma_f32_16x16x32_bf16 v[20:23], a[116:119], v[80:83], v[20:23]
    s_waitcnt vmcnt(0)
    s_branch L_DN_mid0
L_DN_done:
    s_mov_b32 s3, 0
L_DN_dl:
    s_cmp_lg_u32 s58, 0
    s_cbranch_scc1 L_pd_47
    ds_read_b128 v[116:119], v9
    s_waitcnt lgkmcnt(0)
    v_min3_u32 v116, v116, v117, v118
    v_min_u32 v116, v116, v119
    v_cmp_gt_u32 vcc, s95, v116
    s_cbranch_vccnz L_pd_47
    buffer_atomic_add v5, v2, s[4:7], s37 offen
    s_mov_b32 s58, 268435456
L_pd_47:
    s_cmp_lg_u32 s58, 0
    s_cbranch_scc1 L_DN_dd
    s_add_u32 s3, s3, 1
    s_cmp_lt_u32 s3, 40000
    s_cbranch_scc1 L_DN_dl
    s_mov_b32 s3, 56
    s_branch L_abort
L_DN_dd:
    s_endpgm
L_role_GU:
    v_mov_b32 v20, v0
    v_lshlrev_b32 v0, 4, v20
    v_mov_b32 v3, 0
    v_and_b32 v21, 15, v20
    v_lshlrev_b32 v21, 4, v21
    v_lshrrev_b32 v22, 4, v20
    v_lshl_add_u32 v19, v22, 9, v21
    s_and_b32 s92, s18, 1
    s_lshl_b32 s92, s92, 7
    v_xor_b32 v1, s92, v0
    v_bfe_u32 v21, v20, 2, 2
    v_lshlrev_b32 v23, 13, v21
    v_and_b32 v21, 1, v21
    v_lshlrev_b32 v21, 1, v21
    v_xor_b32 v22, v22, v21
    v_lshl_add_u32 v23, v22, 6, v23
    v_and_b32 v22, 3, v20
    v_lshl_add_u32 v6, v22, 4, v23
    v_add_u32 v7, 0x10000, v6
    v_add_u32 v8, 0x20000, v6
    s_mov_b32 s24, 0xaaaaa800
    s_mov_b32 s25, 0xaaaaaaaa
    s_mov_b32 s26, 0x555554aa
    s_mov_b32 s27, 0xfff55555
    s_mul_i32 s60, s19, 640
    s_add_u32 s60, s60, 1736704
    s_mov_b32 s61, 8
    s_mov_b32 s43, 1670144
    s_cmp_gt_u32 s19, 18
    s_cselect_b32 s92, 8, 0
    s_cmp_gt_u32 s19, 37
    s_cselect_b32 s92, 16, s92
    s_cmp_eq_u32 s19, 18
    s_cselect_b32 s93, 16, 8
    s_cmp_eq_u32 s19, 37
    s_cselect_b32 s93, 16, s93
    v_add_u32 v21, s92, v20
    v_mul_u32_u24 v21, 640, v21
    v_mov_b32 v22, 0x40000000
    v_cmp_gt_u32 vcc, s93, v20
    s_nop 1
    v_cndmask_b32 v2, v22, v21, vcc
    v_mov_b32 v5, 1
    s_lshl_b32 s92, s19, 2
    s_add_u32 s92, s92, s18
    s_lshl_b32 s49, s19, 7
    s_lshl_b32 s92, s92, 10
    s_add_u32 s44, s92, 150994944
    s_mov_b32 s45, 0
    s_lshl_b32 s92, s18, 13
    s_add_u32 s42, s92, 92274688
    s_mov_b32 s93, 7168
    s_mul_i32 s94, s18, 57344
    s_and_b32 s95, s18, 1
    s_lshl_b32 s95, s95, 2
    v_lshrrev_b32 v24, 4, v20
    v_mul_lo_u32 v21, v24, s93
    v_and_b32 v22, 15, v20
    v_lshlrev_b32 v23, 2, v24
    v_xor_b32 v22, v22, v23
    v_lshl_add_u32 v21, v22, 4, v21
    v_add_u32 v31, s94, v21
    v_lshrrev_b32 v21, 3, v20
    v_mul_lo_u32 v21, v21, s93
    v_and_b32 v22, 7, v20
    v_and_b32 v23, 1, v24
    v_lshl_add_u32 v23, v23, 1, s95
    v_xor_b32 v22, v22, v23
    v_lshl_add_u32 v21, v22, 4, v21
    v_add_u32 v32, s94, v21
    v_bfe_u32 v25, v20, 2, 2
    v_and_b32 v22, 3, v20
    v_xor_b32 v26, s18, v25
    v_lshlrev_b32 v26, 6, v26
    v_lshl_add_u32 v26, v25, 8, v26
    v_add_u32 v26, 0, v26
    v_lshl_add_u32 v27, v24, 11, v26
    v_lshl_add_u32 v100, v22, 4, v27
    v_lshl_add_u32 v103, v22, 3, v27
    v_lshl_add_u32 v27, v24, 10, v26
    v_lshl_add_u32 v106, v22, 4, v27
    v_lshrrev_b32 v26, 1, v25
    v_and_b32 v27, 1, v24
    v_lshl_add_u32 v26, v27, 1, v26
    v_xor_b32 v26, s18, v26
    v_lshlrev_b32 v26, 5, v26
    v_lshl_add_u32 v26, v25, 7, v26
    v_lshl_add_u32 v26, v24, 10, v26
    v_lshl_add_u32 v26, v22, 3, v26
    v_add_u32 v109, 0, v26
    v_add_u32 v101, 0x10000, v100
    v_add_u32 v102, 0x20000, v100
    v_add_u32 v104, 0x10000, v103
    v_add_u32 v105, 0x20000, v103
    v_add_u32 v107, 0x10000, v106
    v_add_u32 v108, 0x20000, v106
    v_add_u32 v110, 0x10000, v109
    v_add_u32 v111, 0x20000, v109
    s_mov_b32 s56, 1
    s_cmp_lg_u32 s16, 2
    s_cbranch_scc1 L_np_48
    s_mul_i32 s54, s19, 43
    s_lshr_b32 s54, s54, 8
    s_lshl_b32 s52, s54, 21
    s_add_u32 s52, s52, 71303168
    s_add_u32 s53, s54, 17
    s_cmp_eq_u32 s54, 8
    s_cselect_b32 s52, 131072, s52
    s_cselect_b32 s53, 16, s53
    s_waitcnt vmcnt(0)
    s_barrier
    v_mov_b32 v21, 0
    s_mov_b32 s95, 0
    s_mov_b32 s92, s52
    s_cmp_lg_u32 s18, 0
    s_cbranch_scc1 L_pr_49
L_pp_50:
    s_mov_b32 s3, 0
    buffer_store_dword v21, v21, s[4:7], s92 offen sc1
L_pl_51:
    s_add_u32 s3, s3, 1
    s_getreg_b32 s93, hwreg(HW_REG_IB_STS, 0, 4)
    s_cmp_lt_u32 s3, 4096
    s_cselect_b32 s93, s93, 0
    s_cmp_lg_u32 s93, 0
    s_cbranch_scc1 L_pl_51
    s_waitcnt vmcnt(0)
    s_xor_b32 s92, s92, 8192
    s_mov_b32 s94, s3
    s_mov_b32 s3, 0
    buffer_store_dword v21, v21, s[4:7], s92 offen sc1
L_pl_52:
    s_add_u32 s3, s3, 1
    s_getreg_b32 s93, hwreg(HW_REG_IB_STS, 0, 4)
    s_cmp_lt_u32 s3, 4096
    s_cselect_b32 s93, s93, 0
    s_cmp_lg_u32 s93, 0
    s_cbranch_scc1 L_pl_52
    s_waitcnt vmcnt(0)
    s_xor_b32 s92, s92, 8192
    s_cmp_lt_u32 s3, s94
    s_addc_u32 s95, s95, 0
    s_add_u32 s92, s92, 1024
    s_and_b32 s93, s92, 8191
    s_cmp_lt_u32 s93, 7168
    s_cbranch_scc1 L_pp_50
L_pr_49:
    s_cmp_ge_u32 s95, 4
    s_cselect_b32 s95, 1, 0
    s_lshl_b32 s95, s95, s53
    s_add_u32 s56, s56, s95
L_np_48:
    s_waitcnt vmcnt(0)
    s_barrier
    s_cmp_lg_u32 s18, 0
    s_cbranch_scc1 L_arr_53
    s_mov_b32 s3, s56
    s_buffer_atomic_add s3, s[12:15], 4 glc
    s_waitcnt lgkmcnt(0)
    s_add_u32 s3, s3, s56
    s_and_b32 s92, s3, 0xffff
    s_cmp_lg_u32 s92, 256
    s_cbranch_scc1 L_arr_53
    v_mov_b32 v20, s3
    v_lshlrev_b32 v21, 3, v0
    s_mov_b32 s92, 163840
    buffer_store_dword v20, v21, s[4:7], s92 offen sc1
    s_mov_b32 s92, 172032
    buffer_store_dword v20, v21, s[4:7], s92 offen sc1
    s_mov_b32 s92, 180224
    buffer_store_dword v20, v21, s[4:7], s92 offen sc1
    s_mov_b32 s92, 188416
    buffer_store_dword v20, v21, s[4:7], s92 offen sc1
    s_waitcnt vmcnt(0)
L_arr_53:
    s_mov_b32 s8, s80
    s_mov_b32 s9, s81
    s_mov_b32 s10, 7340032
    s_mov_b32 s11, 0x20000
    s_mov_b32 s52, s82
    s_mov_b32 s53, s83
    s_mov_b32 s54, 7340032
    s_mov_b32 s55, 0x20000
    s_lshl_b32 s93, s16, 5
    s_add_u32 s93, s93, s17
    s_lshl_b32 s93, s93, 7
    s_add_u32 s93, s93, 163840
    s_mov_b32 s3, 0
L_ws_54:
    s_buffer_load_dword s92, s[4:7], s93 glc
    s_waitcnt lgkmcnt(0)
    s_cmp_lg_u32 s92, 0
    s_cbranch_scc1 L_wsd_55
    s_add_u32 s3, s3, 1
    s_cmp_lt_u32 s3, 40000
    s_cbranch_scc1 L_ws_54
    s_mov_b32 s3, 12
    s_branch L_abort
L_wsd_55:
    s_and_b32 s92, s19, 31
    s_mul_i32 s92, s92, 640
    s_add_u32 s92, s92, 1572864
    s_mov_b32 s3, 0
L_wf_56:
    s_buffer_load_dword s62, s[4:7], s92 glc
    s_waitcnt lgkmcnt(0)
    s_cmp_ge_u32 s62, 1
    s_cbranch_scc1 L_wfd_57
    s_sleep 16
    s_add_u32 s3, s3, 1
    s_cmp_lt_u32 s3, 40000
    s_cbranch_scc1 L_wf_56
    s_mov_b32 s3, 61
    s_branch L_abort
L_wfd_57:
    s_lshl_b32 s46, s18, 11
    s_lshl_b32 s47, s18, 10
    s_add_u32 s92, s49, 0
    s_add_u32 m0, s47, 0
    s_nop 0
    buffer_load_dwordx4 v32, s[8:11], s92 offen nt lds
    s_add_u32 s92, s49, 0
    s_add_u32 m0, s47, 4096
    s_nop 0
    buffer_load_dwordx4 v32, s[52:55], s92 offen nt lds
    s_add_u32 s92, s49, 229376
    s_add_u32 m0, s47, 8192
    s_nop 0
    buffer_load_dwordx4 v32, s[8:11], s92 offen nt lds
    s_add_u32 s92, s49, 229376
    s_add_u32 m0, s47, 12288
    s_nop 0
    buffer_load_dwordx4 v32, s[52:55], s92 offen nt lds
    s_add_u32 s92, s49, 458752
    s_add_u32 m0, s47, 16384
    s_nop 0
    buffer_load_dwordx4 v32, s[8:11], s92 offen nt lds
    s_add_u32 s92, s49, 458752
    s_add_u32 m0, s47, 20480
    s_nop 0
    buffer_load_dwordx4 v32, s[52:55], s92 offen nt lds
    s_add_u32 s92, s49, 688128
    s_add_u32 m0, s47, 24576
    s_nop 0
    buffer_load_dwordx4 v32, s[8:11], s92 offen nt lds
    s_add_u32 s92, s49, 688128
    s_add_u32 m0, s47, 28672
    s_nop 0
    buffer_load_dwordx4 v32, s[52:55], s92 offen nt lds
    s_add_u32 s92, s49, 917504
    s_add_u32 m0, s47, 32768
    s_nop 0
    buffer_load_dwordx4 v32, s[8:11], s92 offen nt lds
    s_add_u32 s92, s49, 917504
    s_add_u32 m0, s47, 36864
    s_nop 0
    buffer_load_dwordx4 v32, s[52:55], s92 offen nt lds
    s_add_u32 s92, s49, 1146880
    s_add_u32 m0, s47, 40960
    s_nop 0
    buffer_load_dwordx4 v32, s[8:11], s92 offen nt lds
    s_add_u32 s92, s49, 1146880
    s_add_u32 m0, s47, 45056
    s_nop 0
    buffer_load_dwordx4 v32, s[52:55], s92 offen nt lds
    s_add_u32 s92, s49, 1376256
    s_add_u32 m0, s47, 49152
    s_nop 0
    buffer_load_dwordx4 v32, s[8:11], s92 offen nt lds
    s_add_u32 s92, s49, 1376256
    s_add_u32 m0, s47, 53248
    s_nop 0
    buffer_load_dwordx4 v32, s[52:55], s92 offen nt lds
    s_add_u32 s92, s49, 1605632
    s_add_u32 m0, s47, 57344
    s_nop 0
    buffer_load_dwordx4 v32, s[8:11], s92 offen nt lds
    s_add_u32 s92, s49, 1605632
    s_add_u32 m0, s47, 61440
    s_nop 0
    buffer_load_dwordx4 v32, s[52:55], s92 offen nt lds
    s_add_u32 s92, s49, 1835008
    s_add_u32 m0, s47, 65536
    s_nop 0
    buffer_load_dwordx4 v32, s[8:11], s92 offen nt lds
    s_add_u32 s92, s49, 1835008
    s_add_u32 m0, s47, 69632
    s_nop 0
    buffer_load_dwordx4 v32, s[52:55], s92 offen nt lds
    s_add_u32 s92, s49, 2064384
    s_add_u32 m0, s47, 73728
    s_nop 0
    buffer_load_dwordx4 v32, s[8:11], s92 offen nt lds
    s_add_u32 s92, s49, 2064384
    s_add_u32 m0, s47, 77824
    s_nop 0
    buffer_load_dwordx4 v32, s[52:55], s92 offen nt lds
    s_add_u32 s92, s49, 2293760
    s_add_u32 m0, s47, 81920
    s_nop 0
    buffer_load_dwordx4 v32, s[8:11], s92 offen nt lds
    s_add_u32 s92, s49, 2293760
    s_add_u32 m0, s47, 86016
    s_nop 0
    buffer_load_dwordx4 v32, s[52:55], s92 offen nt lds
    s_add_u32 s92, s49, 2523136
    s_add_u32 m0, s47, 90112
    s_nop 0
    buffer_load_dwordx4 v32, s[8:11], s92 offen nt lds
    s_add_u32 s92, s49, 2523136
    s_add_u32 m0, s47, 94208
    s_nop 0
    buffer_load_dwordx4 v32, s[52:55], s92 offen nt lds
    s_waitcnt vmcnt(16)
    s_barrier
    s_add_u32 s92, s49, 2752512
    s_add_u32 m0, s47, 98304
    s_nop 0
    buffer_load_dwordx4 v32, s[8:11], s92 offen nt lds
    s_add_u32 s92, s49, 2752512
    s_add_u32 m0, s47, 102400
    s_nop 0
    buffer_load_dwordx4 v32, s[52:55], s92 offen nt lds
    s_add_u32 s92, s49, 2981888
    s_add_u32 m0, s47, 106496
    s_nop 0
    buffer_load_dwordx4 v32, s[8:11], s92 offen nt lds
    s_add_u32 s92, s49, 2981888
    s_add_u32 m0, s47, 110592
    s_nop 0
    buffer_load_dwordx4 v32, s[52:55], s92 offen nt lds
    s_add_u32 s92, s49, 3211264
    s_add_u32 m0, s47, 114688
    s_nop 0
    buffer_load_dwordx4 v32, s[8:11], s92 offen nt lds
    s_add_u32 s92, s49, 3211264
    s_add_u32 m0, s47, 118784
    s_nop 0
    buffer_load_dwordx4 v32, s[52:55], s92 offen nt lds
    s_add_u32 s92, s49, 3440640
    s_add_u32 m0, s47, 122880
    s_nop 0
    buffer_load_dwordx4 v32, s[8:11], s92 offen nt lds
    s_add_u32 s92, s49, 3440640
    s_add_u32 m0, s47, 126976
    s_nop 0
    buffer_load_dwordx4 v32, s[52:55], s92 offen nt lds
    ds_read_b64_tr_b16 a[0:1], v109 offset:0
    ds_read_b64_tr_b16 a[2:3], v109 offset:512
    ds_read_b64_tr_b16 a[4:5], v109 offset:4096
    ds_read_b64_tr_b16 a[6:7], v109 offset:4608
    ds_read_b64_tr_b16 a[8:9], v109 offset:8192
    ds_read_b64_tr_b16 a[10:11], v109 offset:8704
    ds_read_b64_tr_b16 a[12:13], v109 offset:12288
    ds_read_b64_tr_b16 a[14:15], v109 offset:12800
    ds_read_b64_tr_b16 a[16:17], v109 offset:16384
    ds_read_b64_tr_b16 a[18:19], v109 offset:16896
    ds_read_b64_tr_b16 a[20:21], v109 offset:20480
    ds_read_b64_tr_b16 a[22:23], v109 offset:20992
    ds_read_b64_tr_b16 a[24:25], v109 offset:24576
    ds_read_b64_tr_b16 a[26:27], v109 offset:25088
    ds_read_b64_tr_b16 a[28:29], v109 offset:28672
    ds_read_b64_tr_b16 a[30:31], v109 offset:29184
    s_waitcnt lgkmcnt(0)
    s_waitcnt vmcnt(16)
    s_barrier
    s_add_u32 s92, s49, 3670016
    s_add_u32 m0, s47, 0
    s_nop 0
    buffer_load_dwordx4 v32, s[8:11], s92 offen nt lds
    s_add_u32 s92, s49, 3670016
    s_add_u32 m0, s47, 4096
    s_nop 0
    buffer_load_dwordx4 v32, s[52:55], s92 offen nt lds
    s_add_u32 s92, s49, 3899392
    s_add_u32 m0, s47, 8192
    s_nop 0
    buffer_load_dwordx4 v32, s[8:11], s92 offen nt lds
    s_add_u32 s92, s49, 3899392
    s_add_u32 m0, s47, 12288
    s_nop 0
    buffer_load_dwordx4 v32, s[52:55], s92 offen nt lds
    s_add_u32 s92, s49, 4128768
    s_add_u32 m0, s47, 16384
    s_nop 0
    buffer_load_dwordx4 v32, s[8:11], s92 offen nt lds
    s_add_u32 s92, s49, 4128768
    s_add_u32 m0, s47, 20480
    s_nop 0
    buffer_load_dwordx4 v32, s[52:55], s92 offen nt lds
    s_add_u32 s92, s49, 4358144
    s_add_u32 m0, s47, 24576
    s_nop 0
    buffer_load_dwordx4 v32, s[8:11], s92 offen nt lds
    s_add_u32 s92, s49, 4358144
    s_add_u32 m0, s47, 28672
    s_nop 0
    buffer_load_dwordx4 v32, s[52:55], s92 offen nt lds
    ds_read_b64_tr_b16 a[32:33], v109 offset:32768
    ds_read_b64_tr_b16 a[34:35], v109 offset:33280
    ds_read_b64_tr_b16 a[36:37], v109 offset:36864
    ds_read_b64_tr_b16 a[38:39], v109 offset:37376
    ds_read_b64_tr_b16 a[40:41], v109 offset:40960
    ds_read_b64_tr_b16 a[42:43], v109 offset:41472
    ds_read_b64_tr_b16 a[44:45], v109 offset:45056
    ds_read_b64_tr_b16 a[46:47], v109 offset:45568
    ds_read_b64_tr_b16 a[48:49], v109 offset:49152
    ds_read_b64_tr_b16 a[50:51], v109 offset:49664
    ds_read_b64_tr_b16 a[52:53], v109 offset:53248
    ds_read_b64_tr_b16 a[54:55], v109 offset:53760
    ds_read_b64_tr_b16 a[56:57], v109 offset:57344
    ds_read_b64_tr_b16 a[58:59], v109 offset:57856
    ds_read_b64_tr_b16 a[60:61], v109 offset:61440
    ds_read_b64_tr_b16 a[62:63], v109 offset:61952
    s_waitcnt lgkmcnt(0)
    s_waitcnt vmcnt(16)
    s_barrier
    s_add_u32 s92, s49, 4587520
    s_add_u32 m0, s47, 32768
    s_nop 0
    buffer_load_dwordx4 v32, s[8:11], s92 offen nt lds
    s_add_u32 s92, s49, 4587520
    s_add_u32 m0, s47, 36864
    s_nop 0
    buffer_load_dwordx4 v32, s[52:55], s92 offen nt lds
    s_add_u32 s92, s49, 4816896
    s_add_u32 m0, s47, 40960
    s_nop 0
    buffer_load_dwordx4 v32, s[8:11], s92 offen nt lds
    s_add_u32 s92, s49, 4816896
    s_add_u32 m0, s47, 45056
    s_nop 0
    buffer_load_dwordx4 v32, s[52:55], s92 offen nt lds
    s_add_u32 s92, s49, 5046272
    s_add_u32 m0, s47, 49152
    s_nop 0
    buffer_load_dwordx4 v32, s[8:11], s92 offen nt lds
    s_add_u32 s92, s49, 5046272
    s_add_u32 m0, s47, 53248
    s_nop 0
    buffer_load_dwordx4 v32, s[52:55], s92 offen nt lds
    s_add_u32 s92, s49, 5275648
    s_add_u32 m0, s47, 57344
    s_nop 0
    buffer_load_dwordx4 v32, s[8:11], s92 offen nt lds
    s_add_u32 s92, s49, 5275648
    s_add_u32 m0, s47, 61440
    s_nop 0
    buffer_load_dwordx4 v32, s[52:55], s92 offen nt lds
    ds_read_b64_tr_b16 a[64:65], v110 offset:0
    ds_read_b64_tr_b16 a[66:67], v110 offset:512
    ds_read_b64_tr_b16 a[68:69], v110 offset:4096
    ds_read_b64_tr_b16 a[70:71], v110 offset:4608
    ds_read_b64_tr_b16 a[72:73], v110 offset:8192
    ds_read_b64_tr_b16 a[74:75], v110 offset:8704
    ds_read_b64_tr_b16 a[76:77], v110 offset:12288
    ds_read_b64_tr_b16 a[78:79], v110 offset:12800
    ds_read_b64_tr_b16 a[80:81], v110 offset:16384
    ds_read_b64_tr_b16 a[82:83], v110 offset:16896
    ds_read_b64_tr_b16 a[84:85], v110 offset:20480
    ds_read_b64_tr_b16 a[86:87], v110 offset:20992
    ds_read_b64_tr_b16 a[88:89], v110 offset:24576
    ds_read_b64_tr_b16 a[90:91], v110 offset:25088
    ds_read_b64_tr_b16 a[92:93], v110 offset:28672
    ds_read_b64_tr_b16 a[94:95], v110 offset:29184
    s_waitcnt lgkmcnt(0)
    s_waitcnt vmcnt(16)
    s_barrier
    s_add_u32 s92, s49, 5505024
    s_add_u32 m0, s47, 65536
    s_nop 0
    buffer_load_dwordx4 v32, s[8:11], s92 offen nt lds
    s_add_u32 s92, s49, 5505024
    s_add_u32 m0, s47, 69632
    s_nop 0
    buffer_load_dwordx4 v32, s[52:55], s92 offen nt lds
    s_add_u32 s92, s49, 5734400
    s_add_u32 m0, s47, 73728
    s_nop 0
    buffer_load_dwordx4 v32, s[8:11], s92 offen nt lds
    s_add_u32 s92, s49, 5734400
    s_add_u32 m0, s47, 77824
    s_nop 0
    buffer_load_dwordx4 v32, s[52:55], s92 offen nt lds
    s_add_u32 s92, s49, 5963776
    s_add_u32 m0, s47, 81920
    s_nop 0
    buffer_load_dwordx4 v32, s[8:11], s92 offen nt lds
    s_add_u32 s92, s49, 5963776
    s_add_u32 m0, s47, 86016
    s_nop 0
    buffer_load_dwordx4 v32, s[52:55], s92 offen nt lds
    s_add_u32 s92, s49, 6193152
    s_add_u32 m0, s47, 90112
    s_nop 0
    buffer_load_dwordx4 v32, s[8:11], s92 offen nt lds
    s_add_u32 s92, s49, 6193152
    s_add_u32 m0, s47, 94208
    s_nop 0
    buffer_load_dwordx4 v32, s[52:55], s92 offen nt lds
    ds_read_b64_tr_b16 a[96:97], v110 offset:32768
    ds_read_b64_tr_b16 a[98:99], v110 offset:33280
    ds_read_b64_tr_b16 a[100:101], v110 offset:36864
    ds_read_b64_tr_b16 a[102:103], v110 offset:37376
    ds_read_b64_tr_b16 a[104:105], v110 offset:40960
    ds_read_b64_tr_b16 a[106:107], v110 offset:41472
    ds_read_b64_tr_b16 a[108:109], v110 offset:45056
    ds_read_b64_tr_b16 a[110:111], v110 offset:45568
    ds_read_b64_tr_b16 a[112:113], v110 offset:49152
    ds_read_b64_tr_b16 a[114:115], v110 offset:49664
    ds_read_b64_tr_b16 a[116:117], v110 offset:53248
    ds_read_b64_tr_b16 a[118:119], v110 offset:53760
    ds_read_b64_tr_b16 a[120:121], v110 offset:57344
    ds_read_b64_tr_b16 a[122:123], v110 offset:57856
    ds_read_b64_tr_b16 a[124:125], v110 offset:61440
    ds_read_b64_tr_b16 a[126:127], v110 offset:61952
    s_waitcnt lgkmcnt(0)
    s_waitcnt vmcnt(16)
    s_barrier
    s_add_u32 s92, s49, 6422528
    s_add_u32 m0, s47, 98304
    s_nop 0
    buffer_load_dwordx4 v32, s[8:11], s92 offen nt lds
    s_add_u32 s92, s49, 6422528
    s_add_u32 m0, s47, 102400
    s_nop 0
    buffer_load_dwordx4 v32, s[52:55], s92 offen nt lds
    s_add_u32 s92, s49, 6651904
    s_add_u32 m0, s47, 106496
    s_nop 0
    buffer_load_dwordx4 v32, s[8:11], s92 offen nt lds
    s_add_u32 s92, s49, 6651904
    s_add_u32 m0, s47, 110592
    s_nop 0
    buffer_load_dwordx4 v32, s[52:55], s92 offen nt lds
    s_add_u32 s92, s49, 6881280
    s_add_u32 m0, s47, 114688
    s_nop 0
    buffer_load_dwordx4 v32, s[8:11], s92 offen nt lds
    s_add_u32 s92, s49, 6881280
    s_add_u32 m0, s47, 118784
    s_nop 0
    buffer_load_dwordx4 v32, s[52:55], s92 offen nt lds
    s_add_u32 s92, s49, 7110656
    s_add_u32 m0, s47, 122880
    s_nop 0
    buffer_load_dwordx4 v32, s[8:11], s92 offen nt lds
    s_add_u32 s92, s49, 7110656
    s_add_u32 m0, s47, 126976
    s_nop 0
    buffer_load_dwordx4 v32, s[52:55], s92 offen nt lds
    ds_read_b64_tr_b16 a[128:129], v109 offset:0
    ds_read_b64_tr_b16 a[130:131], v109 offset:512
    ds_read_b64_tr_b16 a[132:133], v109 offset:4096
    ds_read_b64_tr_b16 a[134:135], v109 offset:4608
    ds_read_b64_tr_b16 a[136:137], v109 offset:8192
    ds_read_b64_tr_b16 a[138:139], v109 offset:8704
    ds_read_b64_tr_b16 a[140:141], v109 offset:12288
    ds_read_b64_tr_b16 a[142:143], v109 offset:12800
    ds_read_b64_tr_b16 a[144:145], v109 offset:16384
    ds_read_b64_tr_b16 a[146:147], v109 offset:16896
    ds_read_b64_tr_b16 a[148:149], v109 offset:20480
    ds_read_b64_tr_b16 a[150:151], v109 offset:20992
    ds_read_b64_tr_b16 a[152:153], v109 offset:24576
    ds_read_b64_tr_b16 a[154:155], v109 offset:25088
    ds_read_b64_tr_b16 a[156:157], v109 offset:28672
    ds_read_b64_tr_b16 a[158:159], v109 offset:29184
    s_waitcnt lgkmcnt(0)
    s_waitcnt vmcnt(16)
    s_barrier
    ds_read_b64_tr_b16 a[160:161], v109 offset:32768
    ds_read_b64_tr_b16 a[162:163], v109 offset:33280
    ds_read_b64_tr_b16 a[164:165], v109 offset:36864
    ds_read_b64_tr_b16 a[166:167], v109 offset:37376
    ds_read_b64_tr_b16 a[168:169], v109 offset:40960
    ds_read_b64_tr_b16 a[170:171], v109 offset:41472
    ds_read_b64_tr_b16 a[172:173], v109 offset:45056
    ds_read_b64_tr_b16 a[174:175], v109 offset:45568
    ds_read_b64_tr_b16 a[176:177], v109 offset:49152
    ds_read_b64_tr_b16 a[178:179], v109 offset:49664
    ds_read_b64_tr_b16 a[180:181], v109 offset:53248
    ds_read_b64_tr_b16 a[182:183], v109 offset:53760
    ds_read_b64_tr_b16 a[184:185], v109 offset:57344
    ds_read_b64_tr_b16 a[186:187], v109 offset:57856
    ds_read_b64_tr_b16 a[188:189], v109 offset:61440
    ds_read_b64_tr_b16 a[190:191], v109 offset:61952
    s_waitcnt lgkmcnt(0)
    s_waitcnt vmcnt(8)
    s_barrier
    ds_read_b64_tr_b16 a[192:193], v110 offset:0
    ds_read_b64_tr_b16 a[194:195], v110 offset:512
    ds_read_b64_tr_b16 a[196:197], v110 offset:4096
    ds_read_b64_tr_b16 a[198:199], v110 offset:4608
    ds_read_b64_tr_b16 a[200:201], v110 offset:8192
    ds_read_b64_tr_b16 a[202:203], v110 offset:8704
    ds_read_b64_tr_b16 a[204:205], v110 offset:12288
    ds_read_b64_tr_b16 a[206:207], v110 offset:12800
    ds_read_b64_tr_b16 a[208:209], v110 offset:16384
    ds_read_b64_tr_b16 a[210:211], v110 offset:16896
    ds_read_b64_tr_b16 a[212:213], v110 offset:20480
    ds_read_b64_tr_b16 a[214:215], v110 offset:20992
    ds_read_b64_tr_b16 a[216:217], v110 offset:24576
    ds_read_b64_tr_b16 a[218:219], v110 offset:25088
    ds_read_b64_tr_b16 a[220:221], v110 offset:28672
    ds_read_b64_tr_b16 a[222:223], v110 offset:29184
    s_waitcnt lgkmcnt(0)
    s_waitcnt vmcnt(0)
    s_barrier
    ds_read_b64_tr_b16 a[224:225], v110 offset:32768
    ds_read_b64_tr_b16 a[226:227], v110 offset:33280
    ds_read_b64_tr_b16 a[228:229], v110 offset:36864
    ds_read_b64_tr_b16 a[230:231], v110 offset:37376
    ds_read_b64_tr_b16 a[232:233], v110 offset:40960
    ds_read_b64_tr_b16 a[234:235], v110 offset:41472
    ds_read_b64_tr_b16 a[236:237], v110 offset:45056
    ds_read_b64_tr_b16 a[238:239], v110 offset:45568
    ds_read_b64_tr_b16 a[240:241], v110 offset:49152
    ds_read_b64_tr_b16 a[242:243], v110 offset:49664
    ds_read_b64_tr_b16 a[244:245], v110 offset:53248
    ds_read_b64_tr_b16 a[246:247], v110 offset:53760
    ds_read_b64_tr_b16 a[248:249], v110 offset:57344
    ds_read_b64_tr_b16 a[250:251], v110 offset:57856
    ds_read_b64_tr_b16 a[252:253], v110 offset:61440
    ds_read_b64_tr_b16 a[254:255], v110 offset:61952
    s_waitcnt lgkmcnt(0)
    s_mov_b32 s50, 0xbdd2d3e8
    s_mov_b32 s51, s50
    v_mov_b32 v10, 0xc0135761
    s_mul_i32 s46, s18, 8192
    s_mul_i32 s47, s18, 8192
    s_mul_i32 s96, s18, -3072
    s_lshl_b32 s97, s18, 10
    s_mov_b32 s20, 0
    s_mov_b32 s21, 0
    s_mov_b32 s22, 0
    s_mov_b32 s34, 0
    s_mov_b32 s35, 0
    s_mov_b32 s36, 0
    s_cmp_lt_u32 s20, 64
    s_cselect_b64 s[88:89], s[24:25], s[26:27]
    s_bitcmp1_b64 s[88:89], s20
    s_cselect_b32 s28, 1, 0
    s_cselect_b32 s29, s22, s21
    s_add_u32 s22, s22, s28
    s_xor_b32 s88, s28, 1
    s_add_u32 s21, s21, s88
    s_lshl_b32 s30, s28, 6
    s_add_u32 s30, s30, s29
    s_mul_i32 s88, s28, 8388608
    s_mul_i32 s89, s29, 65536
    s_add_u32 s31, s88, s89
    s_add_u32 s31, s31, s42
    s_lshl2_add_u32 s33, s30, s60
    s_cmp_lt_u32 s20, 128
    s_cselect_b32 s31, s31, 268435456
    s_cselect_b32 s32, s61, 0
    s_add_u32 s20, s20, 1
    s_barrier
    v_mov_b32 v9, 163824
    s_lshl_b32 s92, s18, 2
    v_add_u32 v11, s92, v9
    ds_write_b32 v11, v3
    s_mov_b32 s58, 268435456
    s_mov_b32 s59, -1
    s_cmp_eq_u32 s18, 0
    s_cselect_b32 s57, -1, 0
    s_cselect_b32 s43, s43, 268435456
    s_branch L_GU_ss1
L_GU_top0:
    s_waitcnt lgkmcnt(4)
    v_mfma_f32_16x16x32_bf16 v[16:19], a[0:3], v[64:67], 0
    ds_read_b128 v[88:91], v6 offset:768
    s_and_b32 s86, s36, 95
    s_mul_i32 s86, s86, 229376
    s_add_u32 s87, s86, s45
    s_add_u32 s86, s86, s44
    s_lshl2_add_u32 s37, s36, s43
    s_mov_b32 s34, s28
    v_mfma_f32_16x16x32_bf16 v[24:27], a[0:3], v[68:71], 0
    ds_read_b128 v[92:95], v6 offset:33536
    s_mov_b32 s35, s29
    s_mov_b32 s36, s30
    s_add_u32 s59, s59, 1
    s_cmp_lt_u32 s20, 64
    s_cselect_b64 s[88:89], s[24:25], s[26:27]
    v_mfma_f32_16x16x32_bf16 v[28:31], a[4:7], v[68:71], 0
    s_bitcmp1_b64 s[88:89], s20
    s_cselect_b32 s28, 1, 0
    s_cselect_b32 s29, s22, s21
    s_add_u32 s22, s22, s28
    s_xor_b32 s88, s28, 1
    s_add_u32 s21, s21, s88
    s_lshl_b32 s30, s28, 6
    s_add_u32 s30, s30, s29
    v_mfma_f32_16x16x32_bf16 v[20:23], a[4:7], v[64:67], 0
    s_waitcnt lgkmcnt(4)
    v_mul_f32 v96, v40, v40
    v_mul_f32 v97, v41, v41
    v_mul_f32 v98, v42, v42
    v_mul_f32 v99, v43, v43
    v_mul_f32 v100, v48, v48
    v_mul_f32 v101, v49, v49
    v_mul_f32 v102, v50, v50
    v_mfma_f32_16x16x32_bf16 v[16:19], a[8:11], v[72:75], v[16:19]
    ds_read_b128 v[64:67], v6 offset:1024
    v_mul_f32 v103, v51, v51
    v_fma_f32 v96, v96, s50, v10
    v_fma_f32 v97, v97, s50, v10
    v_fma_f32 v98, v98, s50, v10
    v_fma_f32 v99, v99, s50, v10
    v_fma_f32 v100, v100, s50, v10
    v_mfma_f32_16x16x32_bf16 v[24:27], a[8:11], v[76:79], v[24:27]
    ds_read_b128 v[68:71], v6 offset:33792
    v_fma_f32 v101, v101, s50, v10
    v_fma_f32 v102, v102, s50, v10
    v_fma_f32 v103, v103, s50, v10
    v_mul_f32 v96, v96, v40
    v_mul_f32 v97, v97, v41
    v_mul_f32 v98, v98, v42
    v_mfma_f32_16x16x32_bf16 v[28:31], a[12:15], v[76:79], v[28:31]
    s_mul_i32 s88, s28, 8388608
    v_mul_f32 v99, v99, v43
    v_mul_f32 v100, v100, v48
    v_mul_f32 v101, v101, v49
    v_mul_f32 v102, v102, v50
    v_mul_f32 v103, v103, v51
    v_exp_f32 v96, v96
    v_mfma_f32_16x16x32_bf16 v[20:23], a[12:15], v[72:75], v[20:23]
    s_waitcnt lgkmcnt(2)
    v_exp_f32 v97, v97
    v_exp_f32 v98, v98
    v_exp_f32 v99, v99
    s_mul_i32 s89, s29, 65536
    v_mfma_f32_16x16x32_bf16 v[16:19], a[16:19], v[80:83], v[16:19]
    ds_read_b128 v[72:75], v6 offset:1280
    v_exp_f32 v100, v100
    v_exp_f32 v101, v101
    v_exp_f32 v102, v102
    v_mfma_f32_16x16x32_bf16 v[24:27], a[16:19], v[84:87], v[24:27]
    ds_read_b128 v[76:79], v6 offset:34048
    v_exp_f32 v103, v103
    v_mul_f32 v104, v40, v44
    v_mul_f32 v105, v41, v45
    v_mul_f32 v106, v42, v46
    v_mul_f32 v107, v43, v47
    v_mfma_f32_16x16x32_bf16 v[28:31], a[20:23], v[84:87], v[28:31]
    s_add_u32 s31, s88, s89
    v_mul_f32 v108, v48, v52
    v_mul_f32 v109, v49, v53
    v_mul_f32 v110, v50, v54
    v_mul_f32 v111, v51, v55
    v_add_f32 v96, 1.0, v96
    v_add_f32 v97, 1.0, v97
    v_add_f32 v98, 1.0, v98
    v_mfma_f32_16x16x32_bf16 v[20:23], a[20:23], v[80:83], v[20:23]
    s_add_u32 s31, s31, s42
    v_add_f32 v99, 1.0, v99
    v_add_f32 v100, 1.0, v100
    v_add_f32 v101, 1.0, v101
    v_add_f32 v102, 1.0, v102
    v_add_f32 v103, 1.0, v103
    v_rcp_f32 v96, v96
    v_mfma_f32_16x16x32_bf16 v[16:19], a[24:27], v[88:91], v[16:19]
    ds_read_b128 v[80:83], v6 offset:1536
    v_rcp_f32 v97, v97
    v_rcp_f32 v98, v98
    v_rcp_f32 v99, v99
    v_mfma_f32_16x16x32_bf16 v[24:27], a[24:27], v[92:95], v[24:27]
    ds_read_b128 v[84:87], v6 offset:34304
    v_rcp_f32 v100, v100
    v_rcp_f32 v101, v101
    v_rcp_f32 v102, v102
    v_mfma_f32_16x16x32_bf16 v[28:31], a[28:31], v[92:95], v[28:31]
    s_lshl2_add_u32 s33, s30, s60
    v_rcp_f32 v103, v103
    v_mul_f32 v96, v96, v104
    v_mul_f32 v97, v97, v105
    v_mul_f32 v98, v98, v106
    v_mul_f32 v99, v99, v107
    v_mul_f32 v100, v100, v108
    v_mfma_f32_16x16x32_bf16 v[20:23], a[28:31], v[88:91], v[20:23]
    s_waitcnt lgkmcnt(4)
    v_mul_f32 v101, v101, v109
    v_mul_f32 v102, v102, v110
    v_mul_f32 v103, v103, v111
    v_cvt_pk_bf16_f32 v112, v96, v97
    v_cvt_pk_bf16_f32 v113, v98, v99
    v_cvt_pk_bf16_f32 v114, v100, v101
    v_cvt_pk_bf16_f32 v115, v102, v103
    v_mfma_f32_16x16x32_bf16 v[16:19], a[32:35], v[64:67], v[16:19]
    ds_read_b128 v[88:91], v6 offset:1792
    v_permlane16_swap_b32 v112, v114
    v_permlane16_swap_b32 v113, v115
    v_mfma_f32_16x16x32_bf16 v[24:27], a[32:35], v[68:71], v[24:27]
    ds_read_b128 v[92:95], v6 offset:34560
    buffer_store_dwordx4 v[112:115], v0, s[4:7], s86 offen sc1
    s_cmp_lt_u32 s20, 128
    s_cselect_b32 s31, s31, 268435456
    s_cselect_b32 s32, s61, 0
    v_mfma_f32_16x16x32_bf16 v[28:31], a[36:39], v[68:71], v[28:31]
    s_add_u32 s20, s20, 1
    s_andn2_b32 s23, s34, s28
    s_buffer_load_dword s62, s[4:7], s33 glc
    v_mfma_f32_16x16x32_bf16 v[20:23], a[36:39], v[64:67], v[20:23]
    s_waitcnt lgkmcnt(4)
    v_mfma_f32_16x16x32_bf16 v[16:19], a[40:43], v[72:75], v[16:19]
    ds_read_b128 v[64:67], v6 offset:2048
    v_mfma_f32_16x16x32_bf16 v[24:27], a[40:43], v[76:79], v[24:27]
    ds_read_b128 v[68:71], v6 offset:34816
    v_mfma_f32_16x16x32_bf16 v[28:31], a[44:47], v[76:79], v[28:31]
    v_mfma_f32_16x16x32_bf16 v[20:23], a[44:47], v[72:75], v[20:23]
    s_waitcnt lgkmcnt(4)
    v_mfma_f32_16x16x32_bf16 v[16:19], a[48:51], v[80:83], v[16:19]
    ds_read_b128 v[72:75], v6 offset:2304
    v_mfma_f32_16x16x32_bf16 v[24:27], a[48:51], v[84:87], v[24:27]
    ds_read_b128 v[76:79], v6 offset:35072
    v_mfma_f32_16x16x32_bf16 v[28:31], a[52:55], v[84:87], v[28:31]
    v_mfma_f32_16x16x32_bf16 v[20:23], a[52:55], v[80:83], v[20:23]
    s_waitcnt lgkmcnt(4)
    v_mfma_f32_16x16x32_bf16 v[16:19], a[56:59], v[88:91], v[16:19]
    ds_read_b128 v[80:83], v6 offset:2560
    v_mfma_f32_16x16x32_bf16 v[24:27], a[56:59], v[92:95], v[24:27]
    ds_read_b128 v[84:87], v6 offset:35328
    v_mfma_f32_16x16x32_bf16 v[28:31], a[60:63], v[92:95], v[28:31]
    v_mfma_f32_16x16x32_bf16 v[20:23], a[60:63], v[88:91], v[20:23]
    s_waitcnt lgkmcnt(4)
    v_mfma_f32_16x16x32_bf16 v[16:19], a[64:67], v[64:67], v[16:19]
    ds_read_b128 v[88:91], v6 offset:2816
    v_mfma_f32_16x16x32_bf16 v[24:27], a[64:67], v[68:71], v[24:27]
    ds_read_b128 v[92:95], v6 offset:35584
    v_mfma_f32_16x16x32_bf16 v[28:31], a[68:71], v[68:71], v[28:31]
    v_mfma_f32_16x16x32_bf16 v[20:23], a[68:71], v[64:67], v[20:23]
    s_waitcnt lgkmcnt(4)
    v_mfma_f32_16x16x32_bf16 v[16:19], a[72:75], v[72:75], v[16:19]
    ds_read_b128 v[64:67], v6 offset:3072
    v_mfma_f32_16x16x32_bf16 v[24:27], a[72:75], v[76:79], v[24:27]
    ds_read_b128 v[68:71], v6 offset:35840
    v_mfma_f32_16x16x32_bf16 v[28:31], a[76:79], v[76:79], v[28:31]
    v_mfma_f32_16x16x32_bf16 v[20:23], a[76:79], v[72:75], v[20:23]
    s_waitcnt lgkmcnt(4)
    v_mfma_f32_16x16x32_bf16 v[16:19], a[80:83], v[80:83], v[16:19]
    ds_read_b128 v[72:75], v6 offset:3328
    v_mfma_f32_16x16x32_bf16 v[24:27], a[80:83], v[84:87], v[24:27]
    ds_read_b128 v[76:79], v6 offset:36096
    v_mfma_f32_16x16x32_bf16 v[28:31], a[84:87], v[84:87], v[28:31]
    v_mfma_f32_16x16x32_bf16 v[20:23], a[84:87], v[80:83], v[20:23]
    s_waitcnt lgkmcnt(4)
    v_mfma_f32_16x16x32_bf16 v[16:19], a[88:91], v[88:91], v[16:19]
    ds_read_b128 v[80:83], v6 offset:3584
    v_mfma_f32_16x16x32_bf16 v[24:27], a[88:91], v[92:95], v[24:27]
    ds_read_b128 v[84:87], v6 offset:36352
    v_mfma_f32_16x16x32_bf16 v[28:31], a[92:95], v[92:95], v[28:31]
    v_mfma_f32_16x16x32_bf16 v[20:23], a[92:95], v[88:91], v[20:23]
    s_waitcnt lgkmcnt(4)
    v_mfma_f32_16x16x32_bf16 v[16:19], a[96:99], v[64:67], v[16:19]
    v_mfma_f32_16x16x32_bf16 v[24:27], a[96:99], v[68:71], v[24:27]
    v_mfma_f32_16x16x32_bf16 v[28:31], a[100:103], v[68:71], v[28:31]
    v_mfma_f32_16x16x32_bf16 v[20:23], a[100:103], v[64:67], v[20:23]
    s_waitcnt vmcnt(1)
L_GU_mid0:
    s_barrier
    s_waitcnt lgkmcnt(0)
    s_cmp_ge_u32 s62, s32
    s_cbranch_scc0 L_GU_nr0
L_GU_rd0:
    s_mov_b32 s40, s31
L_GU_go0:
    v_mfma_f32_16x16x32_bf16 v[16:19], a[104:107], v[72:75], v[16:19]
    ds_read_b128 v[88:91], v6 offset:3840
    s_add_u32 s94, s40, 0
    v_mfma_f32_16x16x32_bf16 v[24:27], a[104:107], v[76:79], v[24:27]
    ds_read_b128 v[92:95], v6 offset:36608
    s_add_u32 m0, s47, 65536
    v_mfma_f32_16x16x32_bf16 v[28:31], a[108:111], v[76:79], v[28:31]
    buffer_load_dwordx4 v1, s[4:7], s94 offen offset:0 sc1 lds
    v_mfma_f32_16x16x32_bf16 v[20:23], a[108:111], v[72:75], v[20:23]
    ds_read_b128 v[64:67], v6 offset:4096
    v_mfma_f32_16x16x32_bf16 v[16:19], a[112:115], v[80:83], v[16:19]
    ds_read_b128 v[68:71], v6 offset:36864
    v_mfma_f32_16x16x32_bf16 v[24:27], a[112:115], v[84:87], v[24:27]
    ds_read_b128 v[72:75], v6 offset:4352
    v_mfma_f32_16x16x32_bf16 v[28:31], a[116:119], v[84:87], v[28:31]
    buffer_load_dwordx4 v1, s[4:7], s94 offen offset:1024 sc1 lds
    v_mfma_f32_16x16x32_bf16 v[20:23], a[116:119], v[80:83], v[20:23]
    ds_read_b128 v[76:79], v6 offset:37120
    s_waitcnt lgkmcnt(4)
    v_mfma_f32_16x16x32_bf16 v[16:19], a[120:123], v[88:91], v[16:19]
    ds_read_b128 v[80:83], v6 offset:4608
    v_mfma_f32_16x16x32_bf16 v[24:27], a[120:123], v[92:95], v[24:27]
    ds_read_b128 v[84:87], v6 offset:37376
    v_mfma_f32_16x16x32_bf16 v[28:31], a[124:127], v[92:95], v[28:31]
    buffer_load_dwordx4 v1, s[4:7], s94 offen offset:2048 sc1 lds
    v_mfma_f32_16x16x32_bf16 v[20:23], a[124:127], v[88:91], v[20:23]
    s_waitcnt lgkmcnt(4)
    v_mfma_f32_16x16x32_bf16 v[16:19], a[128:131], v[64:67], v[16:19]
    ds_read_b128 v[88:91], v6 offset:4864
    v_mfma_f32_16x16x32_bf16 v[24:27], a[128:131], v[68:71], v[24:27]
    ds_read_b128 v[92:95], v6 offset:37632
    v_mfma_f32_16x16x32_bf16 v[28:31], a[132:135], v[68:71], v[28:31]
    buffer_load_dwordx4 v1, s[4:7], s94 offen offset:3072 sc1 lds
    v_mfma_f32_16x16x32_bf16 v[20:23], a[132:135], v[64:67], v[20:23]
    s_waitcnt lgkmcnt(4)
    v_mfma_f32_16x16x32_bf16 v[16:19], a[136:139], v[72:75], v[16:19]
    ds_read_b128 v[64:67], v6 offset:5120
    s_add_u32 s94, s40, 32768
    v_mfma_f32_16x16x32_bf16 v[24:27], a[136:139], v[76:79], v[24:27]
    ds_read_b128 v[68:71], v6 offset:37888
    s_add_u32 m0, s47, 98304
    v_mfma_f32_16x16x32_bf16 v[28:31], a[140:143], v[76:79], v[28:31]
    buffer_load_dwordx4 v1, s[4:7], s94 offen offset:0 sc1 lds
    v_mfma_f32_16x16x32_bf16 v[20:23], a[140:143], v[72:75], v[20:23]
    s_waitcnt lgkmcnt(2)
    v_mfma_f32_16x16x32_bf16 v[16:19], a[144:147], v[80:83], v[16:19]
    ds_read_b128 v[72:75], v6 offset:5376
    v_mfma_f32_16x16x32_bf16 v[24:27], a[144:147], v[84:87], v[24:27]
    ds_read_b128 v[76:79], v6 offset:38144
    v_mfma_f32_16x16x32_bf16 v[28:31], a[148:151], v[84:87], v[28:31]
    buffer_load_dwordx4 v1, s[4:7], s94 offen offset:1024 sc1 lds
    v_mfma_f32_16x16x32_bf16 v[20:23], a[148:151], v[80:83], v[20:23]
    v_mfma_f32_16x16x32_bf16 v[16:19], a[152:155], v[88:91], v[16:19]
    ds_read_b128 v[80:83], v6 offset:5632
    v_mfma_f32_16x16x32_bf16 v[24:27], a[152:155], v[92:95], v[24:27]
    ds_read_b128 v[84:87], v6 offset:38400
    v_mfma_f32_16x16x32_bf16 v[28:31], a[156:159], v[92:95], v[28:31]
    buffer_load_dwordx4 v1, s[4:7], s94 offen offset:2048 sc1 lds
    v_mfma_f32_16x16x32_bf16 v[20:23], a[156:159], v[88:91], v[20:23]
    s_waitcnt lgkmcnt(2)
    v_mfma_f32_16x16x32_bf16 v[16:19], a[160:163], v[64:67], v[16:19]
    ds_read_b128 v[88:91], v6 offset:5888
    v_mfma_f32_16x16x32_bf16 v[24:27], a[160:163], v[68:71], v[24:27]
    ds_read_b128 v[92:95], v6 offset:38656
    v_mfma_f32_16x16x32_bf16 v[28:31], a[164:167], v[68:71], v[28:31]
    buffer_load_dwordx4 v1, s[4:7], s94 offen offset:3072 sc1 lds
    v_mfma_f32_16x16x32_bf16 v[20:23], a[164:167], v[64:67], v[20:23]
    v_mfma_f32_16x16x32_bf16 v[16:19], a[168:171], v[72:75], v[16:19]
    ds_read_b128 v[64:67], v6 offset:6144
    s_add_u32 s94, s40, 4096
    v_mfma_f32_16x16x32_bf16 v[24:27], a[168:171], v[76:79], v[24:27]
    ds_read_b128 v[68:71], v6 offset:38912
    s_add_u32 m0, s47, 69632
    v_mfma_f32_16x16x32_bf16 v[28:31], a[172:175], v[76:79], v[28:31]
    s_waitcnt vmcnt(8)
    s_barrier
    s_max_u32 s37, s37, s58
    v_mfma_f32_16x16x32_bf16 v[20:23], a[172:175], v[72:75], v[20:23]
    s_waitcnt lgkmcnt(2)
    s_mov_b32 s58, 0
    v_mfma_f32_16x16x32_bf16 v[16:19], a[176:179], v[80:83], v[16:19]
    ds_read_b128 v[72:75], v6 offset:6400
    v_mfma_f32_16x16x32_bf16 v[24:27], a[176:179], v[84:87], v[24:27]
    ds_read_b128 v[76:79], v6 offset:39168
    v_mfma_f32_16x16x32_bf16 v[28:31], a[180:183], v[84:87], v[28:31]
    buffer_atomic_add v5, v2, s[4:7], s37 offen
    v_mfma_f32_16x16x32_bf16 v[20:23], a[180:183], v[80:83], v[20:23]
    buffer_load_dwordx4 v1, s[4:7], s94 offen offset:0 sc1 lds
    v_mfma_f32_16x16x32_bf16 v[16:19], a[184:187], v[88:91], v[16:19]
    ds_read_b128 v[80:83], v6 offset:6656
    v_mfma_f32_16x16x32_bf16 v[24:27], a[184:187], v[92:95], v[24:27]
    ds_read_b128 v[84:87], v6 offset:39424
    v_mfma_f32_16x16x32_bf16 v[28:31], a[188:191], v[92:95], v[28:31]
    buffer_load_dwordx4 v1, s[4:7], s94 offen offset:1024 sc1 lds
    v_mfma_f32_16x16x32_bf16 v[20:23], a[188:191], v[88:91], v[20:23]
    s_waitcnt lgkmcnt(2)
    v_mfma_f32_16x16x32_bf16 v[16:19], a[192:195], v[64:67], v[16:19]
    ds_read_b128 v[88:91], v6 offset:6912
    v_mfma_f32_16x16x32_bf16 v[24:27], a[192:195], v[68:71], v[24:27]
    ds_read_b128 v[92:95], v6 offset:39680
    v_mfma_f32_16x16x32_bf16 v[28:31], a[196:199], v[68:71], v[28:31]
    buffer_load_dwordx4 v1, s[4:7], s94 offen offset:2048 sc1 lds
    v_mfma_f32_16x16x32_bf16 v[20:23], a[196:199], v[64:67], v[20:23]
    buffer_load_dwordx4 v1, s[4:7], s94 offen offset:3072 sc1 lds
    v_mfma_f32_16x16x32_bf16 v[16:19], a[200:203], v[72:75], v[16:19]
    ds_read_b128 v[64:67], v6 offset:7168
    s_add_u32 s94, s40, 36864
    v_mfma_f32_16x16x32_bf16 v[24:27], a[200:203], v[76:79], v[24:27]
    ds_read_b128 v[68:71], v6 offset:39936
    s_add_u32 m0, s47, 102400
    v_mfma_f32_16x16x32_bf16 v[28:31], a[204:207], v[76:79], v[28:31]
    buffer_load_dwordx4 v1, s[4:7], s94 offen offset:0 sc1 lds
    v_mfma_f32_16x16x32_bf16 v[20:23], a[204:207], v[72:75], v[20:23]
    s_waitcnt lgkmcnt(2)
    v_mfma_f32_16x16x32_bf16 v[16:19], a[208:211], v[80:83], v[16:19]
    ds_read_b128 v[72:75], v6 offset:7424
    v_mfma_f32_16x16x32_bf16 v[24:27], a[208:211], v[84:87], v[24:27]
    ds_read_b128 v[76:79], v6 offset:40192
    v_mfma_f32_16x16x32_bf16 v[28:31], a[212:215], v[84:87], v[28:31]
    buffer_load_dwordx4 v1, s[4:7], s94 offen offset:1024 sc1 lds
    v_mfma_f32_16x16x32_bf16 v[20:23], a[212:215], v[80:83], v[20:23]
    v_mfma_f32_16x16x32_bf16 v[16:19], a[216:219], v[88:91], v[16:19]
    ds_read_b128 v[80:83], v6 offset:7680
    v_mfma_f32_16x16x32_bf16 v[24:27], a[216:219], v[92:95], v[24:27]
    ds_read_b128 v[84:87], v6 offset:40448
    v_mfma_f32_16x16x32_bf16 v[28:31], a[220:223], v[92:95], v[28:31]
    buffer_load_dwordx4 v1, s[4:7], s94 offen offset:2048 sc1 lds
    v_mfma_f32_16x16x32_bf16 v[20:23], a[220:223], v[88:91], v[20:23]
    s_waitcnt lgkmcnt(2)
    v_mfma_f32_16x16x32_bf16 v[16:19], a[224:227], v[64:67], v[16:19]
    ds_read_b128 v[88:91], v6 offset:7936
    v_mfma_f32_16x16x32_bf16 v[24:27], a[224:227], v[68:71], v[24:27]
    ds_read_b128 v[92:95], v6 offset:40704
    v_mfma_f32_16x16x32_bf16 v[28:31], a[228:231], v[68:71], v[28:31]
    buffer_load_dwordx4 v1, s[4:7], s94 offen offset:3072 sc1 lds
    v_mfma_f32_16x16x32_bf16 v[20:23], a[228:231], v[64:67], v[20:23]
    s_cmp_ge_u32 s40, 268435456
    s_cbranch_scc1 L_GU_slow0
    v_mfma_f32_16x16x32_bf16 v[16:19], a[232:235], v[72:75], v[16:19]
    v_mfma_f32_16x16x32_bf16 v[24:27], a[232:235], v[76:79], v[24:27]
    s_waitcnt vmcnt(9) lgkmcnt(0)
    s_barrier
    v_mfma_f32_16x16x32_bf16 v[28:31], a[236:239], v[76:79], v[28:31]
    ds_read_b128 v[64:67], v7 offset:0
    v_mfma_f32_16x16x32_bf16 v[20:23], a[236:239], v[72:75], v[20:23]
    ds_read_b128 v[68:71], v7 offset:32768
    v_mfma_f32_16x16x32_bf16 v[16:19], a[240:243], v[80:83], v[16:19]
    ds_read_b128 v[72:75], v7 offset:256
    v_mfma_f32_16x16x32_bf16 v[24:27], a[240:243], v[84:87], v[24:27]
    ds_read_b128 v[76:79], v7 offset:33024
    v_mfma_f32_16x16x32_bf16 v[28:31], a[244:247], v[84:87], v[28:31]
    v_mfma_f32_16x16x32_bf16 v[20:23], a[244:247], v[80:83], v[20:23]
    v_mfma_f32_16x16x32_bf16 v[16:19], a[248:251], v[88:91], v[16:19]
    ds_read_b128 v[80:83], v7 offset:512
    v_mfma_f32_16x16x32_bf16 v[24:27], a[248:251], v[92:95], v[24:27]
    ds_read_b128 v[84:87], v7 offset:33280
    v_mfma_f32_16x16x32_bf16 v[28:31], a[252:255], v[92:95], v[28:31]
    v_mfma_f32_16x16x32_bf16 v[20:23], a[252:255], v[88:91], v[20:23]
L_GU_top1:
    s_waitcnt lgkmcnt(4)
    v_mfma_f32_16x16x32_bf16 v[40:43], a[0:3], v[64:67], 0
    ds_read_b128 v[88:91], v7 offset:768
    s_and_b32 s86, s36, 95
    s_mul_i32 s86, s86, 229376
    s_add_u32 s87, s86, s45
    s_add_u32 s86, s86, s44
    s_lshl2_add_u32 s37, s36, s43
    s_mov_b32 s34, s28
    v_mfma_f32_16x16x32_bf16 v[48:51], a[0:3], v[68:71], 0
    ds_read_b128 v[92:95], v7 offset:33536
    s_mov_b32 s35, s29
    s_mov_b32 s36, s30
    s_add_u32 s59, s59, 1
    s_cmp_lt_u32 s20, 64
    s_cselect_b64 s[88:89], s[24:25], s[26:27]
    v_mfma_f32_16x16x32_bf16 v[52:55], a[4:7], v[68:71], 0
    s_bitcmp1_b64 s[88:89], s20
    s_cselect_b32 s28, 1, 0
    s_cselect_b32 s29, s22, s21
    s_add_u32 s22, s22, s28
    s_xor_b32 s88, s28, 1
    s_add_u32 s21, s21, s88
    s_lshl_b32 s30, s28, 6
    s_add_u32 s30, s30, s29
    v_mfma_f32_16x16x32_bf16 v[44:47], a[4:7], v[64:67], 0
    s_waitcnt lgkmcnt(4)
    v_mul_f32 v96, v16, v16
    v_mul_f32 v97, v17, v17
    v_mul_f32 v98, v18, v18
    v_mul_f32 v99, v19, v19
    v_mul_f32 v100, v24, v24
    v_mul_f32 v101, v25, v25
    v_mul_f32 v102, v26, v26
    v_mfma_f32_16x16x32_bf16 v[40:43], a[8:11], v[72:75], v[40:43]
    ds_read_b128 v[64:67], v7 offset:1024
    v_mul_f32 v103, v27, v27
    v_fma_f32 v96, v96, s50, v10
    v_fma_f32 v97, v97, s50, v10
    v_fma_f32 v98, v98, s50, v10
    v_fma_f32 v99, v99, s50, v10
    v_fma_f32 v100, v100, s50, v10
    v_mfma_f32_16x16x32_bf16 v[48:51], a[8:11], v[76:79], v[48:51]
    ds_read_b128 v[68:71], v7 offset:33792
    v_fma_f32 v101, v101, s50, v10
    v_fma_f32 v102, v102, s50, v10
    v_fma_f32 v103, v103, s50, v10
    v_mul_f32 v96, v96, v16
    v_mul_f32 v97, v97, v17
    v_mul_f32 v98, v98, v18
    v_mfma_f32_16x16x32_bf16 v[52:55], a[12:15], v[76:79], v[52:55]
    s_mul_i32 s88, s28, 8388608
    v_mul_f32 v99, v99, v19
    v_mul_f32 v100, v100, v24
    v_mul_f32 v101, v101, v25
    v_mul_f32 v102, v102, v26
    v_mul_f32 v103, v103, v27
    v_exp_f32 v96, v96
    v_mfma_f32_16x16x32_bf16 v[44:47], a[12:15], v[72:75], v[44:47]
    s_waitcnt lgkmcnt(2)
    v_exp_f32 v97, v97
    v_exp_f32 v98, v98
    v_exp_f32 v99, v99
    s_mul_i32 s89, s29, 65536
    v_mfma_f32_16x16x32_bf16 v[40:43], a[16:19], v[80:83], v[40:43]
    ds_read_b128 v[72:75], v7 offset:1280
    v_exp_f32 v100, v100
    v_exp_f32 v101, v101
    v_exp_f32 v102, v102
    v_mfma_f32_16x16x32_bf16 v[48:51], a[16:19], v[84:87], v[48:51]
    ds_read_b128 v[76:79], v7 offset:34048
    v_exp_f32 v103, v103
    v_mul_f32 v104, v16, v20
    v_mul_f32 v105, v17, v21
    v_mul_f32 v106, v18, v22
    v_mul_f32 v107, v19, v23
    v_mfma_f32_16x16x32_bf16 v[52:55], a[20:23], v[84:87], v[52:55]
    s_add_u32 s31, s88, s89
    v_mul_f32 v108, v24, v28
    v_mul_f32 v109, v25, v29
    v_mul_f32 v110, v26, v30
    v_mul_f32 v111, v27, v31
    v_add_f32 v96, 1.0, v96
    v_add_f32 v97, 1.0, v97
    v_add_f32 v98, 1.0, v98
    v_mfma_f32_16x16x32_bf16 v[44:47], a[20:23], v[80:83], v[44:47]
    s_add_u32 s31, s31, s42
    v_add_f32 v99, 1.0, v99
    v_add_f32 v100, 1.0, v100
    v_add_f32 v101, 1.0, v101
    v_add_f32 v102, 1.0, v102
    v_add_f32 v103, 1.0, v103
    v_rcp_f32 v96, v96
    v_mfma_f32_16x16x32_bf16 v[40:43], a[24:27], v[88:91], v[40:43]
    ds_read_b128 v[80:83], v7 offset:1536
    v_rcp_f32 v97, v97
    v_rcp_f32 v98, v98
    v_rcp_f32 v99, v99
    v_mfma_f32_16x16x32_bf16 v[48:51], a[24:27], v[92:95], v[48:51]
    ds_read_b128 v[84:87], v7 offset:34304
    v_rcp_f32 v100, v100
    v_rcp_f32 v101, v101
    v_rcp_f32 v102, v102
    v_mfma_f32_16x16x32_bf16 v[52:55], a[28:31], v[92:95], v[52:55]
    s_lshl2_add_u32 s33, s30, s60
    v_rcp_f32 v103, v103
    v_mul_f32 v96, v96, v104
    v_mul_f32 v97, v97, v105
    v_mul_f32 v98, v98, v106
    v_mul_f32 v99, v99, v107
    v_mul_f32 v100, v100, v108
    v_mfma_f32_16x16x32_bf16 v[44:47], a[28:31], v[88:91], v[44:47]
    s_waitcnt lgkmcnt(4)
    v_mul_f32 v101, v101, v109
    v_mul_f32 v102, v102, v110
    v_mul_f32 v103, v103, v111
    v_cvt_pk_bf16_f32 v112, v96, v97
    v_cvt_pk_bf16_f32 v113, v98, v99
    v_cvt_pk_bf16_f32 v114, v100, v101
    v_cvt_pk_bf16_f32 v115, v102, v103
    v_mfma_f32_16x16x32_bf16 v[40:43], a[32:35], v[64:67], v[40:43]
    ds_read_b128 v[88:91], v7 offset:1792
    v_permlane16_swap_b32 v112, v114
    v_permlane16_swap_b32 v113, v115
    v_mfma_f32_16x16x32_bf16 v[48:51], a[32:35], v[68:71], v[48:51]
    ds_read_b128 v[92:95], v7 offset:34560
    buffer_store_dwordx4 v[112:115], v0, s[4:7], s86 offen sc1
    s_cmp_lt_u32 s20, 128
    s_cselect_b32 s31, s31, 268435456
    s_cselect_b32 s32, s61, 0
    v_mfma_f32_16x16x32_bf16 v[52:55], a[36:39], v[68:71], v[52:55]
    s_add_u32 s20, s20, 1
    s_andn2_b32 s23, s34, s28
    s_buffer_load_dword s62, s[4:7], s33 glc
    v_mfma_f32_16x16x32_bf16 v[44:47], a[36:39], v[64:67], v[44:47]
    s_waitcnt lgkmcnt(4)
    v_mfma_f32_16x16x32_bf16 v[40:43], a[40:43], v[72:75], v[40:43]
    ds_read_b128 v[64:67], v7 offset:2048
    v_mfma_f32_16x16x32_bf16 v[48:51], a[40:43], v[76:79], v[48:51]
    ds_read_b128 v[68:71], v7 offset:34816
    v_mfma_f32_16x16x32_bf16 v[52:55], a[44:47], v[76:79], v[52:55]
    v_mfma_f32_16x16x32_bf16 v[44:47], a[44:47], v[72:75], v[44:47]
    s_waitcnt lgkmcnt(4)
    v_mfma_f32_16x16x32_bf16 v[40:43], a[48:51], v[80:83], v[40:43]
    ds_read_b128 v[72:75], v7 offset:2304
    v_mfma_f32_16x16x32_bf16 v[48:51], a[48:51], v[84:87], v[48:51]
    ds_read_b128 v[76:79], v7 offset:35072
    v_mfma_f32_16x16x32_bf16 v[52:55], a[52:55], v[84:87], v[52:55]
    v_mfma_f32_16x16x32_bf16 v[44:47], a[52:55], v[80:83], v[44:47]
    s_waitcnt lgkmcnt(4)
    v_mfma_f32_16x16x32_bf16 v[40:43], a[56:59], v[88:91], v[40:43]
    ds_read_b128 v[80:83], v7 offset:2560
    v_mfma_f32_16x16x32_bf16 v[48:51], a[56:59], v[92:95], v[48:51]
    ds_read_b128 v[84:87], v7 offset:35328
    v_mfma_f32_16x16x32_bf16 v[52:55], a[60:63], v[92:95], v[52:55]
    v_mfma_f32_16x16x32_bf16 v[44:47], a[60:63], v[88:91], v[44:47]
    s_waitcnt lgkmcnt(4)
    v_mfma_f32_16x16x32_bf16 v[40:43], a[64:67], v[64:67], v[40:43]
    ds_read_b128 v[88:91], v7 offset:2816
    v_mfma_f32_16x16x32_bf16 v[48:51], a[64:67], v[68:71], v[48:51]
    ds_read_b128 v[92:95], v7 offset:35584
    v_mfma_f32_16x16x32_bf16 v[52:55], a[68:71], v[68:71], v[52:55]
    v_mfma_f32_16x16x32_bf16 v[44:47], a[68:71], v[64:67], v[44:47]
    s_waitcnt lgkmcnt(4)
    v_mfma_f32_16x16x32_bf16 v[40:43], a[72:75], v[72:75], v[40:43]
    ds_read_b128 v[64:67], v7 offset:3072
    v_mfma_f32_16x16x32_bf16 v[48:51], a[72:75], v[76:79], v[48:51]
    ds_read_b128 v[68:71], v7 offset:35840
    v_mfma_f32_16x16x32_bf16 v[52:55], a[76:79], v[76:79], v[52:55]
    v_mfma_f32_16x16x32_bf16 v[44:47], a[76:79], v[72:75], v[44:47]
    s_waitcnt lgkmcnt(4)
    v_mfma_f32_16x16x32_bf16 v[40:43], a[80:83], v[80:83], v[40:43]
    ds_read_b128 v[72:75], v7 offset:3328
    v_mfma_f32_16x16x32_bf16 v[48:51], a[80:83], v[84:87], v[48:51]
    ds_read_b128 v[76:79], v7 offset:36096
    v_mfma_f32_16x16x32_bf16 v[52:55], a[84:87], v[84:87], v[52:55]
    v_mfma_f32_16x16x32_bf16 v[44:47], a[84:87], v[80:83], v[44:47]
    s_waitcnt lgkmcnt(4)
    v_mfma_f32_16x16x32_bf16 v[40:43], a[88:91], v[88:91], v[40:43]
    ds_read_b128 v[80:83], v7 offset:3584
    v_mfma_f32_16x16x32_bf16 v[48:51], a[88:91], v[92:95], v[48:51]
    ds_read_b128 v[84:87], v7 offset:36352
    v_mfma_f32_16x16x32_bf16 v[52:55], a[92:95], v[92:95], v[52:55]
    v_mfma_f32_16x16x32_bf16 v[44:47], a[92:95], v[88:91], v[44:47]
    s_waitcnt lgkmcnt(4)
    v_mfma_f32_16x16x32_bf16 v[40:43], a[96:99], v[64:67], v[40:43]
    v_mfma_f32_16x16x32_bf16 v[48:51], a[96:99], v[68:71], v[48:51]
    v_mfma_f32_16x16x32_bf16 v[52:55], a[100:103], v[68:71], v[52:55]
    v_mfma_f32_16x16x32_bf16 v[44:47], a[100:103], v[64:67], v[44:47]
    s_waitcnt vmcnt(1)
L_GU_mid1:
    s_barrier
    s_waitcnt lgkmcnt(0)
    s_cmp_ge_u32 s62, s32
    s_cbranch_scc0 L_GU_nr1
L_GU_rd1:
    s_mov_b32 s40, s31
L_GU_go1:
    v_mfma_f32_16x16x32_bf16 v[40:43], a[104:107], v[72:75], v[40:43]
    ds_read_b128 v[88:91], v7 offset:3840
    s_add_u32 s94, s40, 0
    v_mfma_f32_16x16x32_bf16 v[48:51], a[104:107], v[76:79], v[48:51]
    ds_read_b128 v[92:95], v7 offset:36608
    s_add_u32 m0, s46, 0
    v_mfma_f32_16x16x32_bf16 v[52:55], a[108:111], v[76:79], v[52:55]
    buffer_load_dwordx4 v1, s[4:7], s94 offen offset:0 sc1 lds
    v_mfma_f32_16x16x32_bf16 v[44:47], a[108:111], v[72:75], v[44:47]
    ds_read_b128 v[64:67], v7 offset:4096
    v_mfma_f32_16x16x32_bf16 v[40:43], a[112:115], v[80:83], v[40:43]
    ds_read_b128 v[68:71], v7 offset:36864
    v_mfma_f32_16x16x32_bf16 v[48:51], a[112:115], v[84:87], v[48:51]
    ds_read_b128 v[72:75], v7 offset:4352
    v_mfma_f32_16x16x32_bf16 v[52:55], a[116:119], v[84:87], v[52:55]
    buffer_load_dwordx4 v1, s[4:7], s94 offen offset:1024 sc1 lds
    v_mfma_f32_16x16x32_bf16 v[44:47], a[116:119], v[80:83], v[44:47]
    ds_read_b128 v[76:79], v7 offset:37120
    s_waitcnt lgkmcnt(4)
    v_mfma_f32_16x16x32_bf16 v[40:43], a[120:123], v[88:91], v[40:43]
    ds_read_b128 v[80:83], v7 offset:4608
    v_mfma_f32_16x16x32_bf16 v[48:51], a[120:123], v[92:95], v[48:51]
    ds_read_b128 v[84:87], v7 offset:37376
    v_mfma_f32_16x16x32_bf16 v[52:55], a[124:127], v[92:95], v[52:55]
    buffer_load_dwordx4 v1, s[4:7], s94 offen offset:2048 sc1 lds
    v_mfma_f32_16x16x32_bf16 v[44:47], a[124:127], v[88:91], v[44:47]
    s_waitcnt lgkmcnt(4)
    v_mfma_f32_16x16x32_bf16 v[40:43], a[128:131], v[64:67], v[40:43]
    ds_read_b128 v[88:91], v7 offset:4864
    v_mfma_f32_16x16x32_bf16 v[48:51], a[128:131], v[68:71], v[48:51]
    ds_read_b128 v[92:95], v7 offset:37632
    v_mfma_f32_16x16x32_bf16 v[52:55], a[132:135], v[68:71], v[52:55]
    buffer_load_dwordx4 v1, s[4:7], s94 offen offset:3072 sc1 lds
    v_mfma_f32_16x16x32_bf16 v[44:47], a[132:135], v[64:67], v[44:47]
    s_waitcnt lgkmcnt(4)
    v_mfma_f32_16x16x32_bf16 v[40:43], a[136:139], v[72:75], v[40:43]
    ds_read_b128 v[64:67], v7 offset:5120
    s_add_u32 s94, s40, 32768
    v_mfma_f32_16x16x32_bf16 v[48:51], a[136:139], v[76:79], v[48:51]
    ds_read_b128 v[68:71], v7 offset:37888
    s_add_u32 m0, s46, 32768
    v_mfma_f32_16x16x32_bf16 v[52:55], a[140:143], v[76:79], v[52:55]
    buffer_load_dwordx4 v1, s[4:7], s94 offen offset:0 sc1 lds
    v_mfma_f32_16x16x32_bf16 v[44:47], a[140:143], v[72:75], v[44:47]
    s_waitcnt lgkmcnt(2)
    v_mfma_f32_16x16x32_bf16 v[40:43], a[144:147], v[80:83], v[40:43]
    ds_read_b128 v[72:75], v7 offset:5376
    v_mfma_f32_16x16x32_bf16 v[48:51], a[144:147], v[84:87], v[48:51]
    ds_read_b128 v[76:79], v7 offset:38144
    v_mfma_f32_16x16x32_bf16 v[52:55], a[148:151], v[84:87], v[52:55]
    buffer_load_dwordx4 v1, s[4:7], s94 offen offset:1024 sc1 lds
    v_mfma_f32_16x16x32_bf16 v[44:47], a[148:151], v[80:83], v[44:47]
    v_mfma_f32_16x16x32_bf16 v[40:43], a[152:155], v[88:91], v[40:43]
    ds_read_b128 v[80:83], v7 offset:5632
    v_mfma_f32_16x16x32_bf16 v[48:51], a[152:155], v[92:95], v[48:51]
    ds_read_b128 v[84:87], v7 offset:38400
    v_mfma_f32_16x16x32_bf16 v[52:55], a[156:159], v[92:95], v[52:55]
    buffer_load_dwordx4 v1, s[4:7], s94 offen offset:2048 sc1 lds
    v_mfma_f32_16x16x32_bf16 v[44:47], a[156:159], v[88:91], v[44:47]
    s_waitcnt lgkmcnt(2)
    v_mfma_f32_16x16x32_bf16 v[40:43], a[160:163], v[64:67], v[40:43]
    ds_read_b128 v[88:91], v7 offset:5888
    v_mfma_f32_16x16x32_bf16 v[48:51], a[160:163], v[68:71], v[48:51]
    ds_read_b128 v[92:95], v7 offset:38656
    v_mfma_f32_16x16x32_bf16 v[52:55], a[164:167], v[68:71], v[52:55]
    buffer_load_dwordx4 v1, s[4:7], s94 offen offset:3072 sc1 lds
    v_mfma_f32_16x16x32_bf16 v[44:47], a[164:167], v[64:67], v[44:47]
    v_mfma_f32_16x16x32_bf16 v[40:43], a[168:171], v[72:75], v[40:43]
    ds_read_b128 v[64:67], v7 offset:6144
    s_add_u32 s94, s40, 4096
    v_mfma_f32_16x16x32_bf16 v[48:51], a[168:171], v[76:79], v[48:51]
    ds_read_b128 v[68:71], v7 offset:38912
    s_add_u32 m0, s46, 4096
    v_mfma_f32_16x16x32_bf16 v[52:55], a[172:175], v[76:79], v[52:55]
    s_waitcnt vmcnt(8)
    s_barrier
    s_max_u32 s37, s37, s58
    v_mfma_f32_16x16x32_bf16 v[44:47], a[172:175], v[72:75], v[44:47]
    s_waitcnt lgkmcnt(2)
    s_mov_b32 s58, 0
    v_mfma_f32_16x16x32_bf16 v[40:43], a[176:179], v[80:83], v[40:43]
    ds_read_b128 v[72:75], v7 offset:6400
    v_mfma_f32_16x16x32_bf16 v[48:51], a[176:179], v[84:87], v[48:51]
    ds_read_b128 v[76:79], v7 offset:39168
    v_mfma_f32_16x16x32_bf16 v[52:55], a[180:183], v[84:87], v[52:55]
    buffer_atomic_add v5, v2, s[4:7], s37 offen
    v_mfma_f32_16x16x32_bf16 v[44:47], a[180:183], v[80:83], v[44:47]
    buffer_load_dwordx4 v1, s[4:7], s94 offen offset:0 sc1 lds
    v_mfma_f32_16x16x32_bf16 v[40:43], a[184:187], v[88:91], v[40:43]
    ds_read_b128 v[80:83], v7 offset:6656
    v_mfma_f32_16x16x32_bf16 v[48:51], a[184:187], v[92:95], v[48:51]
    ds_read_b128 v[84:87], v7 offset:39424
    v_mfma_f32_16x16x32_bf16 v[52:55], a[188:191], v[92:95], v[52:55]
    buffer_load_dwordx4 v1, s[4:7], s94 offen offset:1024 sc1 lds
    v_mfma_f32_16x16x32_bf16 v[44:47], a[188:191], v[88:91], v[44:47]
    s_waitcnt lgkmcnt(2)
    v_mfma_f32_16x16x32_bf16 v[40:43], a[192:195], v[64:67], v[40:43]
    ds_read_b128 v[88:91], v7 offset:6912
    v_mfma_f32_16x16x32_bf16 v[48:51], a[192:195], v[68:71], v[48:51]
    ds_read_b128 v[92:95], v7 offset:39680
    v_mfma_f32_16x16x32_bf16 v[52:55], a[196:199], v[68:71], v[52:55]
    buffer_load_dwordx4 v1, s[4:7], s94 offen offset:2048 sc1 lds
    v_mfma_f32_16x16x32_bf16 v[44:47], a[196:199], v[64:67], v[44:47]
    buffer_load_dwordx4 v1, s[4:7], s94 offen offset:3072 sc1 lds
    v_mfma_f32_16x16x32_bf16 v[40:43], a[200:203], v[72:75], v[40:43]
    ds_read_b128 v[64:67], v7 offset:7168
    s_add_u32 s94, s40, 36864
    v_mfma_f32_16x16x32_bf16 v[48:51], a[200:203], v[76:79], v[48:51]
    ds_read_b128 v[68:71], v7 offset:39936
    s_add_u32 m0, s46, 36864
    v_mfma_f32_16x16x32_bf16 v[52:55], a[204:207], v[76:79], v[52:55]
    buffer_load_dwordx4 v1, s[4:7], s94 offen offset:0 sc1 lds
    v_mfma_f32_16x16x32_bf16 v[44:47], a[204:207], v[72:75], v[44:47]
    s_waitcnt lgkmcnt(2)
    v_mfma_f32_16x16x32_bf16 v[40:43], a[208:211], v[80:83], v[40:43]
    ds_read_b128 v[72:75], v7 offset:7424
    v_mfma_f32_16x16x32_bf16 v[48:51], a[208:211], v[84:87], v[48:51]
    ds_read_b128 v[76:79], v7 offset:40192
    v_mfma_f32_16x16x32_bf16 v[52:55], a[212:215], v[84:87], v[52:55]
    buffer_load_dwordx4 v1, s[4:7], s94 offen offset:1024 sc1 lds
    v_mfma_f32_16x16x32_bf16 v[44:47], a[212:215], v[80:83], v[44:47]
    v_mfma_f32_16x16x32_bf16 v[40:43], a[216:219], v[88:91], v[40:43]
    ds_read_b128 v[80:83], v7 offset:7680
    v_mfma_f32_16x16x32_bf16 v[48:51], a[216:219], v[92:95], v[48:51]
    ds_read_b128 v[84:87], v7 offset:40448
    v_mfma_f32_16x16x32_bf16 v[52:55], a[220:223], v[92:95], v[52:55]
    buffer_load_dwordx4 v1, s[4:7], s94 offen offset:2048 sc1 lds
    v_mfma_f32_16x16x32_bf16 v[44:47], a[220:223], v[88:91], v[44:47]
    s_waitcnt lgkmcnt(2)
    v_mfma_f32_16x16x32_bf16 v[40:43], a[224:227], v[64:67], v[40:43]
    ds_read_b128 v[88:91], v7 offset:7936
    v_mfma_f32_16x16x32_bf16 v[48:51], a[224:227], v[68:71], v[48:51]
    ds_read_b128 v[92:95], v7 offset:40704
    v_mfma_f32_16x16x32_bf16 v[52:55], a[228:231], v[68:71], v[52:55]
    buffer_load_dwordx4 v1, s[4:7], s94 offen offset:3072 sc1 lds
    v_mfma_f32_16x16x32_bf16 v[44:47], a[228:231], v[64:67], v[44:47]
    s_cmp_ge_u32 s40, 268435456
    s_cbranch_scc1 L_GU_slow1
    v_mfma_f32_16x16x32_bf16 v[40:43], a[232:235], v[72:75], v[40:43]
    v_mfma_f32_16x16x32_bf16 v[48:51], a[232:235], v[76:79], v[48:51]
    s_waitcnt vmcnt(9) lgkmcnt(0)
    s_barrier
    v_mfma_f32_16x16x32_bf16 v[52:55], a[236:239], v[76:79], v[52:55]
    ds_read_b128 v[64:67], v6 offset:0
    v_mfma_f32_16x16x32_bf16 v[44:47], a[236:239], v[72:75], v[44:47]
    ds_read_b128 v[68:71], v6 offset:32768
    v_mfma_f32_16x16x32_bf16 v[40:43], a[240:243], v[80:83], v[40:43]
    ds_read_b128 v[72:75], v6 offset:256
    v_mfma_f32_16x16x32_bf16 v[48:51], a[240:243], v[84:87], v[48:51]
    ds_read_b128 v[76:79], v6 offset:33024
    v_mfma_f32_16x16x32_bf16 v[52:55], a[244:247], v[84:87], v[52:55]
    v_mfma_f32_16x16x32_bf16 v[44:47], a[244:247], v[80:83], v[44:47]
    v_mfma_f32_16x16x32_bf16 v[40:43], a[248:251], v[88:91], v[40:43]
    ds_read_b128 v[80:83], v6 offset:512
    v_mfma_f32_16x16x32_bf16 v[48:51], a[248:251], v[92:95], v[48:51]
    ds_read_b128 v[84:87], v6 offset:33280
    v_mfma_f32_16x16x32_bf16 v[52:55], a[252:255], v[92:95], v[52:55]
    v_mfma_f32_16x16x32_bf16 v[44:47], a[252:255], v[88:91], v[44:47]
    s_branch L_GU_top0
L_GU_nr0:
    s_mov_b32 s40, 268435456
    s_cmp_eq_u32 s23, 0
    s_cbranch_scc1 L_GU_go0
    s_mov_b32 s3, 0
    s_waitcnt vmcnt(0)
    s_add_u32 s92, s59, 0
    v_mov_b32 v12, s92
    s_and_b32 s95, s92, s57
    ds_write_b32 v11, v12
    s_cmp_lg_u32 s58, 0
    s_cbranch_scc1 L_pd_58
    ds_read_b128 v[116:119], v9
    s_waitcnt lgkmcnt(0)
    v_min3_u32 v116, v116, v117, v118
    v_min_u32 v116, v116, v119
    v_cmp_gt_u32 vcc, s95, v116
    s_cbranch_vccnz L_pd_58
    buffer_atomic_add v5, v2, s[4:7], s37 offen
    s_mov_b32 s58, 268435456
L_pd_58:
L_GU_hl0:
    s_cmp_lg_u32 s58, 0
    s_cbranch_scc1 L_pd_59
    ds_read_b128 v[116:119], v9
    s_waitcnt lgkmcnt(0)
    v_min3_u32 v116, v116, v117, v118
    v_min_u32 v116, v116, v119
    v_cmp_gt_u32 vcc, s95, v116
    s_cbranch_vccnz L_pd_59
    buffer_atomic_add v5, v2, s[4:7], s37 offen
    s_mov_b32 s58, 268435456
L_pd_59:
    s_buffer_load_dword s62, s[4:7], s33 glc
    s_waitcnt lgkmcnt(0)
    s_cmp_ge_u32 s62, s32
    s_cbranch_scc1 L_GU_hd0
    s_add_u32 s3, s3, 1
    s_cmp_lt_u32 s3, 40000
    s_cbranch_scc1 L_GU_hl0
    s_mov_b32 s3, 33
    s_branch L_abort
L_GU_hd0:
    s_branch L_GU_rd0
L_GU_slow0:
    v_mfma_f32_16x16x32_bf16 v[16:19], a[232:235], v[72:75], v[16:19]
    v_mfma_f32_16x16x32_bf16 v[24:27], a[232:235], v[76:79], v[24:27]
    v_mfma_f32_16x16x32_bf16 v[28:31], a[236:239], v[76:79], v[28:31]
    v_mfma_f32_16x16x32_bf16 v[20:23], a[236:239], v[72:75], v[20:23]
    s_waitcnt lgkmcnt(3)
    v_mfma_f32_16x16x32_bf16 v[16:19], a[240:243], v[80:83], v[16:19]
    s_waitcnt lgkmcnt(2)
    v_mfma_f32_16x16x32_bf16 v[24:27], a[240:243], v[84:87], v[24:27]
    v_mfma_f32_16x16x32_bf16 v[28:31], a[244:247], v[84:87], v[28:31]
    v_mfma_f32_16x16x32_bf16 v[20:23], a[244:247], v[80:83], v[20:23]
    s_waitcnt lgkmcnt(1)
    v_mfma_f32_16x16x32_bf16 v[16:19], a[248:251], v[88:91], v[16:19]
    s_waitcnt lgkmcnt(0)
    v_mfma_f32_16x16x32_bf16 v[24:27], a[248:251], v[92:95], v[24:27]
    v_mfma_f32_16x16x32_bf16 v[28:31], a[252:255], v[92:95], v[28:31]
    v_mfma_f32_16x16x32_bf16 v[20:23], a[252:255], v[88:91], v[20:23]
    s_and_b32 s86, s36, 95
    s_mul_i32 s86, s86, 229376
    s_add_u32 s87, s86, s45
    s_add_u32 s86, s86, s44
    s_lshl2_add_u32 s37, s36, s43
    v_mul_f32 v96, v16, v16
    v_mul_f32 v97, v17, v17
    v_mul_f32 v98, v18, v18
    v_mul_f32 v99, v19, v19
    v_mul_f32 v100, v24, v24
    v_mul_f32 v101, v25, v25
    v_mul_f32 v102, v26, v26
    v_mul_f32 v103, v27, v27
    v_fma_f32 v96, v96, s50, v10
    v_fma_f32 v97, v97, s50, v10
    v_fma_f32 v98, v98, s50, v10
    v_fma_f32 v99, v99, s50, v10
    v_fma_f32 v100, v100, s50, v10
    v_fma_f32 v101, v101, s50, v10
    v_fma_f32 v102, v102, s50, v10
    v_fma_f32 v103, v103, s50, v10
    v_mul_f32 v96, v96, v16
    v_mul_f32 v97, v97, v17
    v_mul_f32 v98, v98, v18
    v_mul_f32 v99, v99, v19
    v_mul_f32 v100, v100, v24
    v_mul_f32 v101, v101, v25
    v_mul_f32 v102, v102, v26
    v_mul_f32 v103, v103, v27
    v_exp_f32 v96, v96
    v_exp_f32 v97, v97
    v_exp_f32 v98, v98
    v_exp_f32 v99, v99
    v_exp_f32 v100, v100
    v_exp_f32 v101, v101
    v_exp_f32 v102, v102
    v_exp_f32 v103, v103
    v_mul_f32 v104, v16, v20
    v_mul_f32 v105, v17, v21
    v_mul_f32 v106, v18, v22
    v_mul_f32 v107, v19, v23
    v_mul_f32 v108, v24, v28
    v_mul_f32 v109, v25, v29
    v_mul_f32 v110, v26, v30
    v_mul_f32 v111, v27, v31
    v_add_f32 v96, 1.0, v96
    v_add_f32 v97, 1.0, v97
    v_add_f32 v98, 1.0, v98
    v_add_f32 v99, 1.0, v99
    v_add_f32 v100, 1.0, v100
    v_add_f32 v101, 1.0, v101
    v_add_f32 v102, 1.0, v102
    v_add_f32 v103, 1.0, v103
    v_rcp_f32 v96, v96
    v_rcp_f32 v97, v97
    v_rcp_f32 v98, v98
    v_rcp_f32 v99, v99
    v_rcp_f32 v100, v100
    v_rcp_f32 v101, v101
    v_rcp_f32 v102, v102
    v_rcp_f32 v103, v103
    v_mul_f32 v96, v96, v104
    v_mul_f32 v97, v97, v105
    v_mul_f32 v98, v98, v106
    v_mul_f32 v99, v99, v107
    v_mul_f32 v100, v100, v108
    v_mul_f32 v101, v101, v109
    v_mul_f32 v102, v102, v110
    v_mul_f32 v103, v103, v111
    v_cvt_pk_bf16_f32 v112, v96, v97
    v_cvt_pk_bf16_f32 v113, v98, v99
    v_cvt_pk_bf16_f32 v114, v100, v101
    v_cvt_pk_bf16_f32 v115, v102, v103
    s_nop 0
    v_permlane16_swap_b32 v112, v114
    v_permlane16_swap_b32 v113, v115
    buffer_store_dwordx4 v[112:115], v0, s[4:7], s86 offen sc1
    s_buffer_load_dword s62, s[4:7], s33 glc
    s_waitcnt vmcnt(0)
    s_add_u32 s92, s59, 1
    v_mov_b32 v12, s92
    s_and_b32 s95, s92, s57
    ds_write_b32 v11, v12
    s_cmp_lg_u32 s58, 0
    s_cbranch_scc1 L_pd_60
    ds_read_b128 v[116:119], v9
    s_waitcnt lgkmcnt(0)
    v_min3_u32 v116, v116, v117, v118
    v_min_u32 v116, v116, v119
    v_cmp_gt_u32 vcc, s95, v116
    s_cbranch_vccnz L_pd_60
    buffer_atomic_add v5, v2, s[4:7], s37 offen
    s_mov_b32 s58, 268435456
L_pd_60:
    s_cmp_lg_u32 s58, 0
    s_cbranch_scc1 L_pd_61
    ds_read_b128 v[116:119], v9
    s_waitcnt lgkmcnt(0)
    v_min3_u32 v116, v116, v117, v118
    v_min_u32 v116, v116, v119
    v_cmp_gt_u32 vcc, s95, v116
    s_cbranch_vccnz L_pd_61
    buffer_atomic_add v5, v2, s[4:7], s37 offen
    s_mov_b32 s58, 268435456
L_pd_61:
    s_cmp_gt_u32 s20, 128
    s_cbranch_scc1 L_GU_done
    s_waitcnt lgkmcnt(0)
    s_cmp_ge_u32 s62, s32
    s_cbranch_scc1 L_GU_sd0
L_GU_ss0:
    s_mov_b32 s3, 0
L_GU_sl0:
    s_cmp_lg_u32 s58, 0
    s_cbranch_scc1 L_pd_62
    ds_read_b128 v[116:119], v9
    s_waitcnt lgkmcnt(0)
    v_min3_u32 v116, v116, v117, v118
    v_min_u32 v116, v116, v119
    v_cmp_gt_u32 vcc, s95, v116
    s_cbranch_vccnz L_pd_62
    buffer_atomic_add v5, v2, s[4:7], s37 offen
    s_mov_b32 s58, 268435456
L_pd_62:
    s_buffer_load_dword s62, s[4:7], s33 glc
    s_waitcnt lgkmcnt(0)
    s_cmp_ge_u32 s62, s32
    s_cbranch_scc1 L_GU_sd0
    s_add_u32 s3, s3, 1
    s_cmp_lt_u32 s3, 40000
    s_cbranch_scc1 L_GU_sl0
    s_mov_b32 s3, 13
    s_branch L_abort
L_GU_sd0:
    s_mov_b32 s40, s31
    s_add_u32 s94, s40, 0
    s_add_u32 m0, s47, 65536
    s_nop 0
    buffer_load_dwordx4 v1, s[4:7], s94 offen offset:0 sc1 lds
    buffer_load_dwordx4 v1, s[4:7], s94 offen offset:1024 sc1 lds
    buffer_load_dwordx4 v1, s[4:7], s94 offen offset:2048 sc1 lds
    buffer_load_dwordx4 v1, s[4:7], s94 offen offset:3072 sc1 lds
    s_add_u32 s94, s40, 32768
    s_add_u32 m0, s47, 98304
    s_nop 0
    buffer_load_dwordx4 v1, s[4:7], s94 offen offset:0 sc1 lds
    buffer_load_dwordx4 v1, s[4:7], s94 offen offset:1024 sc1 lds
    buffer_load_dwordx4 v1, s[4:7], s94 offen offset:2048 sc1 lds
    buffer_load_dwordx4 v1, s[4:7], s94 offen offset:3072 sc1 lds
    s_add_u32 s94, s40, 4096
    s_add_u32 m0, s47, 69632
    s_nop 0
    buffer_load_dwordx4 v1, s[4:7], s94 offen offset:0 sc1 lds
    buffer_load_dwordx4 v1, s[4:7], s94 offen offset:1024 sc1 lds
    buffer_load_dwordx4 v1, s[4:7], s94 offen offset:2048 sc1 lds
    buffer_load_dwordx4 v1, s[4:7], s94 offen offset:3072 sc1 lds
    s_waitcnt vmcnt(4)
    s_barrier
    ds_read_b128 v[64:67], v7 offset:0
    ds_read_b128 v[68:71], v7 offset:32768
    ds_read_b128 v[72:75], v7 offset:256
    ds_read_b128 v[76:79], v7 offset:33024
    ds_read_b128 v[80:83], v7 offset:512
    ds_read_b128 v[84:87], v7 offset:33280
    s_waitcnt lgkmcnt(4)
    v_mfma_f32_16x16x32_bf16 v[40:43], a[0:3], v[64:67], 0
    ds_read_b128 v[88:91], v7 offset:768
    s_add_u32 s94, s40, 36864
    v_mfma_f32_16x16x32_bf16 v[48:51], a[0:3], v[68:71], 0
    ds_read_b128 v[92:95], v7 offset:33536
    s_add_u32 m0, s47, 102400
    v_mfma_f32_16x16x32_bf16 v[52:55], a[4:7], v[68:71], 0
    buffer_load_dwordx4 v1, s[4:7], s94 offen offset:0 sc1 lds
    s_lshl2_add_u32 s37, s36, s43
    v_mfma_f32_16x16x32_bf16 v[44:47], a[4:7], v[64:67], 0
    s_waitcnt lgkmcnt(4)
    s_mov_b32 s34, s28
    s_mov_b32 s35, s29
    v_mfma_f32_16x16x32_bf16 v[40:43], a[8:11], v[72:75], v[40:43]
    ds_read_b128 v[64:67], v7 offset:1024
    s_mov_b32 s36, s30
    v_mfma_f32_16x16x32_bf16 v[48:51], a[8:11], v[76:79], v[48:51]
    ds_read_b128 v[68:71], v7 offset:33792
    s_add_u32 s59, s59, 1
    v_mfma_f32_16x16x32_bf16 v[52:55], a[12:15], v[76:79], v[52:55]
    buffer_load_dwordx4 v1, s[4:7], s94 offen offset:1024 sc1 lds
    v_mfma_f32_16x16x32_bf16 v[44:47], a[12:15], v[72:75], v[44:47]
    s_waitcnt lgkmcnt(2)
    s_cmp_lt_u32 s20, 64
    s_cselect_b64 s[88:89], s[24:25], s[26:27]
    v_mfma_f32_16x16x32_bf16 v[40:43], a[16:19], v[80:83], v[40:43]
    ds_read_b128 v[72:75], v7 offset:1280
    v_mfma_f32_16x16x32_bf16 v[48:51], a[16:19], v[84:87], v[48:51]
    ds_read_b128 v[76:79], v7 offset:34048
    v_mfma_f32_16x16x32_bf16 v[52:55], a[20:23], v[84:87], v[52:55]
    buffer_load_dwordx4 v1, s[4:7], s94 offen offset:2048 sc1 lds
    v_mfma_f32_16x16x32_bf16 v[44:47], a[20:23], v[80:83], v[44:47]
    s_bitcmp1_b64 s[88:89], s20
    s_cselect_b32 s28, 1, 0
    s_cselect_b32 s29, s22, s21
    v_mfma_f32_16x16x32_bf16 v[40:43], a[24:27], v[88:91], v[40:43]
    ds_read_b128 v[80:83], v7 offset:1536
    s_add_u32 s22, s22, s28
    v_mfma_f32_16x16x32_bf16 v[48:51], a[24:27], v[92:95], v[48:51]
    ds_read_b128 v[84:87], v7 offset:34304
    s_xor_b32 s88, s28, 1
    v_mfma_f32_16x16x32_bf16 v[52:55], a[28:31], v[92:95], v[52:55]
    buffer_load_dwordx4 v1, s[4:7], s94 offen offset:3072 sc1 lds
    s_add_u32 s21, s21, s88
    v_mfma_f32_16x16x32_bf16 v[44:47], a[28:31], v[88:91], v[44:47]
    s_waitcnt lgkmcnt(4)
    s_lshl_b32 s30, s28, 6
    s_add_u32 s30, s30, s29
    v_mfma_f32_16x16x32_bf16 v[40:43], a[32:35], v[64:67], v[40:43]
    ds_read_b128 v[88:91], v7 offset:1792
    s_mul_i32 s88, s28, 8388608
    v_mfma_f32_16x16x32_bf16 v[48:51], a[32:35], v[68:71], v[48:51]
    ds_read_b128 v[92:95], v7 offset:34560
    s_mul_i32 s89, s29, 65536
    v_mfma_f32_16x16x32_bf16 v[52:55], a[36:39], v[68:71], v[52:55]
    s_add_u32 s31, s88, s89
    s_add_u32 s31, s31, s42
    s_lshl2_add_u32 s33, s30, s60
    v_mfma_f32_16x16x32_bf16 v[44:47], a[36:39], v[64:67], v[44:47]
    s_waitcnt lgkmcnt(4)
    v_mfma_f32_16x16x32_bf16 v[40:43], a[40:43], v[72:75], v[40:43]
    ds_read_b128 v[64:67], v7 offset:2048
    v_mfma_f32_16x16x32_bf16 v[48:51], a[40:43], v[76:79], v[48:51]
    ds_read_b128 v[68:71], v7 offset:34816
    v_mfma_f32_16x16x32_bf16 v[52:55], a[44:47], v[76:79], v[52:55]
    s_cmp_lt_u32 s20, 128
    s_cselect_b32 s31, s31, 268435456
    s_cselect_b32 s32, s61, 0
    v_mfma_f32_16x16x32_bf16 v[44:47], a[44:47], v[72:75], v[44:47]
    s_waitcnt lgkmcnt(4)
    s_add_u32 s20, s20, 1
    s_andn2_b32 s23, s34, s28
    v_mfma_f32_16x16x32_bf16 v[40:43], a[48:51], v[80:83], v[40:43]
    ds_read_b128 v[72:75], v7 offset:2304
    s_buffer_load_dword s62, s[4:7], s33 glc
    v_mfma_f32_16x16x32_bf16 v[48:51], a[48:51], v[84:87], v[48:51]
    ds_read_b128 v[76:79], v7 offset:35072
    v_mfma_f32_16x16x32_bf16 v[52:55], a[52:55], v[84:87], v[52:55]
    v_mfma_f32_16x16x32_bf16 v[44:47], a[52:55], v[80:83], v[44:47]
    s_waitcnt lgkmcnt(4)
    v_mfma_f32_16x16x32_bf16 v[40:43], a[56:59], v[88:91], v[40:43]
    ds_read_b128 v[80:83], v7 offset:2560
    v_mfma_f32_16x16x32_bf16 v[48:51], a[56:59], v[92:95], v[48:51]
    ds_read_b128 v[84:87], v7 offset:35328
    v_mfma_f32_16x16x32_bf16 v[52:55], a[60:63], v[92:95], v[52:55]
    v_mfma_f32_16x16x32_bf16 v[44:47], a[60:63], v[88:91], v[44:47]
    s_waitcnt lgkmcnt(4)
    v_mfma_f32_16x16x32_bf16 v[40:43], a[64:67], v[64:67], v[40:43]
    ds_read_b128 v[88:91], v7 offset:2816
    v_mfma_f32_16x16x32_bf16 v[48:51], a[64:67], v[68:71], v[48:51]
    ds_read_b128 v[92:95], v7 offset:35584
    v_mfma_f32_16x16x32_bf16 v[52:55], a[68:71], v[68:71], v[52:55]
    v_mfma_f32_16x16x32_bf16 v[44:47], a[68:71], v[64:67], v[44:47]
    s_waitcnt lgkmcnt(4)
    v_mfma_f32_16x16x32_bf16 v[40:43], a[72:75], v[72:75], v[40:43]
    ds_read_b128 v[64:67], v7 offset:3072
    v_mfma_f32_16x16x32_bf16 v[48:51], a[72:75], v[76:79], v[48:51]
    ds_read_b128 v[68:71], v7 offset:35840
    v_mfma_f32_16x16x32_bf16 v[52:55], a[76:79], v[76:79], v[52:55]
    v_mfma_f32_16x16x32_bf16 v[44:47], a[76:79], v[72:75], v[44:47]
    s_waitcnt lgkmcnt(4)
    v_mfma_f32_16x16x32_bf16 v[40:43], a[80:83], v[80:83], v[40:43]
    ds_read_b128 v[72:75], v7 offset:3328
    v_mfma_f32_16x16x32_bf16 v[48:51], a[80:83], v[84:87], v[48:51]
    ds_read_b128 v[76:79], v7 offset:36096
    v_mfma_f32_16x16x32_bf16 v[52:55], a[84:87], v[84:87], v[52:55]
    v_mfma_f32_16x16x32_bf16 v[44:47], a[84:87], v[80:83], v[44:47]
    s_waitcnt lgkmcnt(4)
    v_mfma_f32_16x16x32_bf16 v[40:43], a[88:91], v[88:91], v[40:43]
    ds_read_b128 v[80:83], v7 offset:3584
    v_mfma_f32_16x16x32_bf16 v[48:51], a[88:91], v[92:95], v[48:51]
    ds_read_b128 v[84:87], v7 offset:36352
    v_mfma_f32_16x16x32_bf16 v[52:55], a[92:95], v[92:95], v[52:55]
    v_mfma_f32_16x16x32_bf16 v[44:47], a[92:95], v[88:91], v[44:47]
    s_waitcnt lgkmcnt(4)
    v_mfma_f32_16x16x32_bf16 v[40:43], a[96:99], v[64:67], v[40:43]
    v_mfma_f32_16x16x32_bf16 v[48:51], a[96:99], v[68:71], v[48:51]
    v_mfma_f32_16x16x32_bf16 v[52:55], a[100:103], v[68:71], v[52:55]
    v_mfma_f32_16x16x32_bf16 v[44:47], a[100:103], v[64:67], v[44:47]
    s_waitcnt vmcnt(0)
    s_branch L_GU_mid1
L_GU_nr1:
    s_mov_b32 s40, 268435456
    s_cmp_eq_u32 s23, 0
    s_cbranch_scc1 L_GU_go1
    s_mov_b32 s3, 0
    s_waitcnt vmcnt(0)
    s_add_u32 s92, s59, 0
    v_mov_b32 v12, s92
    s_and_b32 s95, s92, s57
    ds_write_b32 v11, v12
    s_cmp_lg_u32 s58, 0
    s_cbranch_scc1 L_pd_63
    ds_read_b128 v[116:119], v9
    s_waitcnt lgkmcnt(0)
    v_min3_u32 v116, v116, v117, v118
    v_min_u32 v116, v116, v119
    v_cmp_gt_u32 vcc, s95, v116
    s_cbranch_vccnz L_pd_63
    buffer_atomic_add v5, v2, s[4:7], s37 offen
    s_mov_b32 s58, 268435456
L_pd_63:
L_GU_hl1:
    s_cmp_lg_u32 s58, 0
    s_cbranch_scc1 L_pd_64
    ds_read_b128 v[116:119], v9
    s_waitcnt lgkmcnt(0)
    v_min3_u32 v116, v116, v117, v118
    v_min_u32 v116, v116, v119
    v_cmp_gt_u32 vcc, s95, v116
    s_cbranch_vccnz L_pd_64
    buffer_atomic_add v5, v2, s[4:7], s37 offen
    s_mov_b32 s58, 268435456
L_pd_64:
    s_buffer_load_dword s62, s[4:7], s33 glc
    s_waitcnt lgkmcnt(0)
    s_cmp_ge_u32 s62, s32
    s_cbranch_scc1 L_GU_hd1
    s_add_u32 s3, s3, 1
    s_cmp_lt_u32 s3, 40000
    s_cbranch_scc1 L_GU_hl1
    s_mov_b32 s3, 33
    s_branch L_abort
L_GU_hd1:
    s_branch L_GU_rd1
L_GU_slow1:
    v_mfma_f32_16x16x32_bf16 v[40:43], a[232:235], v[72:75], v[40:43]
    v_mfma_f32_16x16x32_bf16 v[48:51], a[232:235], v[76:79], v[48:51]
    v_mfma_f32_16x16x32_bf16 v[52:55], a[236:239], v[76:79], v[52:55]
    v_mfma_f32_16x16x32_bf16 v[44:47], a[236:239], v[72:75], v[44:47]
    s_waitcnt lgkmcnt(3)
    v_mfma_f32_16x16x32_bf16 v[40:43], a[240:243], v[80:83], v[40:43]
    s_waitcnt lgkmcnt(2)
    v_mfma_f32_16x16x32_bf16 v[48:51], a[240:243], v[84:87], v[48:51]
    v_mfma_f32_16x16x32_bf16 v[52:55], a[244:247], v[84:87], v[52:55]
    v_mfma_f32_16x16x32_bf16 v[44:47], a[244:247], v[80:83], v[44:47]
    s_waitcnt lgkmcnt(1)
    v_mfma_f32_16x16x32_bf16 v[40:43], a[248:251], v[88:91], v[40:43]
    s_waitcnt lgkmcnt(0)
    v_mfma_f32_16x16x32_bf16 v[48:51], a[248:251], v[92:95], v[48:51]
    v_mfma_f32_16x16x32_bf16 v[52:55], a[252:255], v[92:95], v[52:55]
    v_mfma_f32_16x16x32_bf16 v[44:47], a[252:255], v[88:91], v[44:47]
    s_and_b32 s86, s36, 95
    s_mul_i32 s86, s86, 229376
    s_add_u32 s87, s86, s45
    s_add_u32 s86, s86, s44
    s_lshl2_add_u32 s37, s36, s43
    v_mul_f32 v96, v40, v40
    v_mul_f32 v97, v41, v41
    v_mul_f32 v98, v42, v42
    v_mul_f32 v99, v43, v43
    v_mul_f32 v100, v48, v48
    v_mul_f32 v101, v49, v49
    v_mul_f32 v102, v50, v50
    v_mul_f32 v103, v51, v51
    v_fma_f32 v96, v96, s50, v10
    v_fma_f32 v97, v97, s50, v10
    v_fma_f32 v98, v98, s50, v10
    v_fma_f32 v99, v99, s50, v10
    v_fma_f32 v100, v100, s50, v10
    v_fma_f32 v101, v101, s50, v10
    v_fma_f32 v102, v102, s50, v10
    v_fma_f32 v103, v103, s50, v10
    v_mul_f32 v96, v96, v40
    v_mul_f32 v97, v97, v41
    v_mul_f32 v98, v98, v42
    v_mul_f32 v99, v99, v43
    v_mul_f32 v100, v100, v48
    v_mul_f32 v101, v101, v49
    v_mul_f32 v102, v102, v50
    v_mul_f32 v103, v103, v51
    v_exp_f32 v96, v96
    v_exp_f32 v97, v97
    v_exp_f32 v98, v98
    v_exp_f32 v99, v99
    v_exp_f32 v100, v100
    v_exp_f32 v101, v101
    v_exp_f32 v102, v102
    v_exp_f32 v103, v103
    v_mul_f32 v104, v40, v44
    v_mul_f32 v105, v41, v45
    v_mul_f32 v106, v42, v46
    v_mul_f32 v107, v43, v47
    v_mul_f32 v108, v48, v52
    v_mul_f32 v109, v49, v53
    v_mul_f32 v110, v50, v54
    v_mul_f32 v111, v51, v55
    v_add_f32 v96, 1.0, v96
    v_add_f32 v97, 1.0, v97
    v_add_f32 v98, 1.0, v98
    v_add_f32 v99, 1.0, v99
    v_add_f32 v100, 1.0, v100
    v_add_f32 v101, 1.0, v101
    v_add_f32 v102, 1.0, v102
    v_add_f32 v103, 1.0, v103
    v_rcp_f32 v96, v96
    v_rcp_f32 v97, v97
    v_rcp_f32 v98, v98
    v_rcp_f32 v99, v99
    v_rcp_f32 v100, v100
    v_rcp_f32 v101, v101
    v_rcp_f32 v102, v102
    v_rcp_f32 v103, v103
    v_mul_f32 v96, v96, v104
    v_mul_f32 v97, v97, v105
    v_mul_f32 v98, v98, v106
    v_mul_f32 v99, v99, v107
    v_mul_f32 v100, v100, v108
    v_mul_f32 v101, v101, v109
    v_mul_f32 v102, v102, v110
    v_mul_f32 v103, v103, v111
    v_cvt_pk_bf16_f32 v112, v96, v97
    v_cvt_pk_bf16_f32 v113, v98, v99
    v_cvt_pk_bf16_f32 v114, v100, v101
    v_cvt_pk_bf16_f32 v115, v102, v103
    s_nop 0
    v_permlane16_swap_b32 v112, v114
    v_permlane16_swap_b32 v113, v115
    buffer_store_dwordx4 v[112:115], v0, s[4:7], s86 offen sc1
    s_buffer_load_dword s62, s[4:7], s33 glc
    s_waitcnt vmcnt(0)
    s_add_u32 s92, s59, 1
    v_mov_b32 v12, s92
    s_and_b32 s95, s92, s57
    ds_write_b32 v11, v12
    s_cmp_lg_u32 s58, 0
    s_cbranch_scc1 L_pd_65
    ds_read_b128 v[116:119], v9
    s_waitcnt lgkmcnt(0)
    v_min3_u32 v116, v116, v117, v118
    v_min_u32 v116, v116, v119
    v_cmp_gt_u32 vcc, s95, v116
    s_cbranch_vccnz L_pd_65
    buffer_atomic_add v5, v2, s[4:7], s37 offen
    s_mov_b32 s58, 268435456
L_pd_65:
    s_cmp_lg_u32 s58, 0
    s_cbranch_scc1 L_pd_66
    ds_read_b128 v[116:119], v9
    s_waitcnt lgkmcnt(0)
    v_min3_u32 v116, v116, v117, v118
    v_min_u32 v116, v116, v119
    v_cmp_gt_u32 vcc, s95, v116
    s_cbranch_vccnz L_pd_66
    buffer_atomic_add v5, v2, s[4:7], s37 offen
    s_mov_b32 s58, 268435456
L_pd_66:
    s_cmp_gt_u32 s20, 128
    s_cbranch_scc1 L_GU_done
    s_waitcnt lgkmcnt(0)
    s_cmp_ge_u32 s62, s32
    s_cbranch_scc1 L_GU_sd1
L_GU_ss1:
    s_mov_b32 s3, 0
L_GU_sl1:
    s_cmp_lg_u32 s58, 0
    s_cbranch_scc1 L_pd_67
    ds_read_b128 v[116:119], v9
    s_waitcnt lgkmcnt(0)
    v_min3_u32 v116, v116, v117, v118
    v_min_u32 v116, v116, v119
    v_cmp_gt_u32 vcc, s95, v116
    s_cbranch_vccnz L_pd_67
    buffer_atomic_add v5, v2, s[4:7], s37 offen
    s_mov_b32 s58, 268435456
L_pd_67:
    s_buffer_load_dword s62, s[4:7], s33 glc
    s_waitcnt lgkmcnt(0)
    s_cmp_ge_u32 s62, s32
    s_cbranch_scc1 L_GU_sd1
    s_add_u32 s3, s3, 1
    s_cmp_lt_u32 s3, 40000
    s_cbranch_scc1 L_GU_sl1
    s_mov_b32 s3, 13
    s_branch L_abort
L_GU_sd1:
    s_mov_b32 s40, s31
    s_add_u32 s94, s40, 0
    s_add_u32 m0, s46, 0
    s_nop 0
    buffer_load_dwordx4 v1, s[4:7], s94 offen offset:0 sc1 lds
    buffer_load_dwordx4 v1, s[4:7], s94 offen offset:1024 sc1 lds
    buffer_load_dwordx4 v1, s[4:7], s94 offen offset:2048 sc1 lds
    buffer_load_dwordx4 v1, s[4:7], s94 offen offset:3072 sc1 lds
    s_add_u32 s94, s40, 32768
    s_add_u32 m0, s46, 32768
    s_nop 0
    buffer_load_dwordx4 v1, s[4:7], s94 offen offset:0 sc1 lds
    buffer_load_dwordx4 v1, s[4:7], s94 offen offset:1024 sc1 lds
    buffer_load_dwordx4 v1, s[4:7], s94 offen offset:2048 sc1 lds
    buffer_load_dwordx4 v1, s[4:7], s94 offen offset:3072 sc1 lds
    s_add_u32 s94, s40, 4096
    s_add_u32 m0, s46, 4096
    s_nop 0
    buffer_load_dwordx4 v1, s[4:7], s94 offen offset:0 sc1 lds
    buffer_load_dwordx4 v1, s[4:7], s94 offen offset:1024 sc1 lds
    buffer_load_dwordx4 v1, s[4:7], s94 offen offset:2048 sc1 lds
    buffer_load_dwordx4 v1, s[4:7], s94 offen offset:3072 sc1 lds
    s_waitcnt vmcnt(4)
    s_barrier
    ds_read_b128 v[64:67], v6 offset:0
    ds_read_b128 v[68:71], v6 offset:32768
    ds_read_b128 v[72:75], v6 offset:256
    ds_read_b128 v[76:79], v6 offset:33024
    ds_read_b128 v[80:83], v6 offset:512
    ds_read_b128 v[84:87], v6 offset:33280
    s_waitcnt lgkmcnt(4)
    v_mfma_f32_16x16x32_bf16 v[16:19], a[0:3], v[64:67], 0
    ds_read_b128 v[88:91], v6 offset:768
    s_add_u32 s94, s40, 36864
    v_mfma_f32_16x16x32_bf16 v[24:27], a[0:3], v[68:71], 0
    ds_read_b128 v[92:95], v6 offset:33536
    s_add_u32 m0, s46, 36864
    v_mfma_f32_16x16x32_bf16 v[28:31], a[4:7], v[68:71], 0
    buffer_load_dwordx4 v1, s[4:7], s94 offen offset:0 sc1 lds
    s_lshl2_add_u32 s37, s36, s43
    v_mfma_f32_16x16x32_bf16 v[20:23], a[4:7], v[64:67], 0
    s_waitcnt lgkmcnt(4)
    s_mov_b32 s34, s28
    s_mov_b32 s35, s29
    v_mfma_f32_16x16x32_bf16 v[16:19], a[8:11], v[72:75], v[16:19]
    ds_read_b128 v[64:67], v6 offset:1024
    s_mov_b32 s36, s30
    v_mfma_f32_16x16x32_bf16 v[24:27], a[8:11], v[76:79], v[24:27]
    ds_read_b128 v[68:71], v6 offset:33792
    s_add_u32 s59, s59, 1
    v_mfma_f32_16x16x32_bf16 v[28:31], a[12:15], v[76:79], v[28:31]
    buffer_load_dwordx4 v1, s[4:7], s94 offen offset:1024 sc1 lds
    v_mfma_f32_16x16x32_bf16 v[20:23], a[12:15], v[72:75], v[20:23]
    s_waitcnt lgkmcnt(2)
    s_cmp_lt_u32 s20, 64
    s_cselect_b64 s[88:89], s[24:25], s[26:27]
    v_mfma_f32_16x16x32_bf16 v[16:19], a[16:19], v[80:83], v[16:19]
    ds_read_b128 v[72:75], v6 offset:1280
    v_mfma_f32_16x16x32_bf16 v[24:27], a[16:19], v[84:87], v[24:27]
    ds_read_b128 v[76:79], v6 offset:34048
    v_mfma_f32_16x16x32_bf16 v[28:31], a[20:23], v[84:87], v[28:31]
    buffer_load_dwordx4 v1, s[4:7], s94 offen offset:2048 sc1 lds
    v_mfma_f32_16x16x32_bf16 v[20:23], a[20:23], v[80:83], v[20:23]
    s_bitcmp1_b64 s[88:89], s20
    s_cselect_b32 s28, 1, 0
    s_cselect_b32 s29, s22, s21
    v_mfma_f32_16x16x32_bf16 v[16:19], a[24:27], v[88:91], v[16:19]
    ds_read_b128 v[80:83], v6 offset:1536
    s_add_u32 s22, s22, s28
    v_mfma_f32_16x16x32_bf16 v[24:27], a[24:27], v[92:95], v[24:27]
    ds_read_b128 v[84:87], v6 offset:34304
    s_xor_b32 s88, s28, 1
    v_mfma_f32_16x16x32_bf16 v[28:31], a[28:31], v[92:95], v[28:31]
    buffer_load_dwordx4 v1, s[4:7], s94 offen offset:3072 sc1 lds
    s_add_u32 s21, s21, s88
    v_mfma_f32_16x16x32_bf16 v[20:23], a[28:31], v[88:91], v[20:23]
    s_waitcnt lgkmcnt(4)
    s_lshl_b32 s30, s28, 6
    s_add_u32 s30, s30, s29
    v_mfma_f32_16x16x32_bf16 v[16:19], a[32:35], v[64:67], v[16:19]
    ds_read_b128 v[88:91], v6 offset:1792
    s_mul_i32 s88, s28, 8388608
    v_mfma_f32_16x16x32_bf16 v[24:27], a[32:35], v[68:71], v[24:27]
    ds_read_b128 v[92:95], v6 offset:34560
    s_mul_i32 s89, s29, 65536
    v_mfma_f32_16x16x32_bf16 v[28:31], a[36:39], v[68:71], v[28:31]
    s_add_u32 s31, s88, s89
    s_add_u32 s31, s31, s42
    s_lshl2_add_u32 s33, s30, s60
    v_mfma_f32_16x16x32_bf16 v[20:23], a[36:39], v[64:67], v[20:23]
    s_waitcnt lgkmcnt(4)
    v_mfma_f32_16x16x32_bf16 v[16:19], a[40:43], v[72:75], v[16:19]
    ds_read_b128 v[64:67], v6 offset:2048
    v_mfma_f32_16x16x32_bf16 v[24:27], a[40:43], v[76:79], v[24:27]
    ds_read_b128 v[68:71], v6 offset:34816
    v_mfma_f32_16x16x32_bf16 v[28:31], a[44:47], v[76:79], v[28:31]
    s_cmp_lt_u32 s20, 128
    s_cselect_b32 s31, s31, 268435456
    s_cselect_b32 s32, s61, 0
    v_mfma_f32_16x16x32_bf16 v[20:23], a[44:47], v[72:75], v[20:23]
    s_waitcnt lgkmcnt(4)
    s_add_u32 s20, s20, 1
    s_andn2_b32 s23, s34, s28
    v_mfma_f32_16x16x32_bf16 v[16:19], a[48:51], v[80:83], v[16:19]
    ds_read_b128 v[72:75], v6 offset:2304
    s_buffer_load_dword s62, s[4:7], s33 glc
    v_mfma_f32_16x16x32_bf16 v[24:27], a[48:51], v[84:87], v[24:27]
    ds_read_b128 v[76:79], v6 offset:35072
    v_mfma_f32_16x16x32_bf16 v[28:31], a[52:55], v[84:87], v[28:31]
    v_mfma_f32_16x16x32_bf16 v[20:23], a[52:55], v[80:83], v[20:23]
    s_waitcnt lgkmcnt(4)
    v_mfma_f32_16x16x32_bf16 v[16:19], a[56:59], v[88:91], v[16:19]
    ds_read_b128 v[80:83], v6 offset:2560
    v_mfma_f32_16x16x32_bf16 v[24:27], a[56:59], v[92:95], v[24:27]
    ds_read_b128 v[84:87], v6 offset:35328
    v_mfma_f32_16x16x32_bf16 v[28:31], a[60:63], v[92:95], v[28:31]
    v_mfma_f32_16x16x32_bf16 v[20:23], a[60:63], v[88:91], v[20:23]
    s_waitcnt lgkmcnt(4)
    v_mfma_f32_16x16x32_bf16 v[16:19], a[64:67], v[64:67], v[16:19]
    ds_read_b128 v[88:91], v6 offset:2816
    v_mfma_f32_16x16x32_bf16 v[24:27], a[64:67], v[68:71], v[24:27]
    ds_read_b128 v[92:95], v6 offset:35584
    v_mfma_f32_16x16x32_bf16 v[28:31], a[68:71], v[68:71], v[28:31]
    v_mfma_f32_16x16x32_bf16 v[20:23], a[68:71], v[64:67], v[20:23]
    s_waitcnt lgkmcnt(4)
    v_mfma_f32_16x16x32_bf16 v[16:19], a[72:75], v[72:75], v[16:19]
    ds_read_b128 v[64:67], v6 offset:3072
    v_mfma_f32_16x16x32_bf16 v[24:27], a[72:75], v[76:79], v[24:27]
    ds_read_b128 v[68:71], v6 offset:35840
    v_mfma_f32_16x16x32_bf16 v[28:31], a[76:79], v[76:79], v[28:31]
    v_mfma_f32_16x16x32_bf16 v[20:23], a[76:79], v[72:75], v[20:23]
    s_waitcnt lgkmcnt(4)
    v_mfma_f32_16x16x32_bf16 v[16:19], a[80:83], v[80:83], v[16:19]
    ds_read_b128 v[72:75], v6 offset:3328
    v_mfma_f32_16x16x32_bf16 v[24:27], a[80:83], v[84:87], v[24:27]
    ds_read_b128 v[76:79], v6 offset:36096
    v_mfma_f32_16x16x32_bf16 v[28:31], a[84:87], v[84:87], v[28:31]
    v_mfma_f32_16x16x32_bf16 v[20:23], a[84:87], v[80:83], v[20:23]
    s_waitcnt lgkmcnt(4)
    v_mfma_f32_16x16x32_bf16 v[16:19], a[88:91], v[88:91], v[16:19]
    ds_read_b128 v[80:83], v6 offset:3584
    v_mfma_f32_16x16x32_bf16 v[24:27], a[88:91], v[92:95], v[24:27]
    ds_read_b128 v[84:87], v6 offset:36352
    v_mfma_f32_16x16x32_bf16 v[28:31], a[92:95], v[92:95], v[28:31]
    v_mfma_f32_16x16x32_bf16 v[20:23], a[92:95], v[88:91], v[20:23]
    s_waitcnt lgkmcnt(4)
    v_mfma_f32_16x16x32_bf16 v[16:19], a[96:99], v[64:67], v[16:19]
    v_mfma_f32_16x16x32_bf16 v[24:27], a[96:99], v[68:71], v[24:27]
    v_mfma_f32_16x16x32_bf16 v[28:31], a[100:103], v[68:71], v[28:31]
    v_mfma_f32_16x16x32_bf16 v[20:23], a[100:103], v[64:67], v[20:23]
    s_waitcnt vmcnt(0)
    s_branch L_GU_mid0
L_GU_done:
    s_mov_b32 s3, 0
L_GU_dl:
    s_cmp_lg_u32 s58, 0
    s_cbranch_scc1 L_pd_68
    ds_read_b128 v[116:119], v9
    s_waitcnt lgkmcnt(0)
    v_min3_u32 v116, v116, v117, v118
    v_min_u32 v116, v116, v119
    v_cmp_gt_u32 vcc, s95, v116
    s_cbranch_vccnz L_pd_68
    buffer_atomic_add v5, v2, s[4:7], s37 offen
    s_mov_b32 s58, 268435456
L_pd_68:
    s_cmp_lg_u32 s58, 0
    s_cbranch_scc1 L_GU_dd
    s_add_u32 s3, s3, 1
    s_cmp_lt_u32 s3, 40000
    s_cbranch_scc1 L_GU_dl
    s_mov_b32 s3, 53
    s_branch L_abort
L_GU_dd:
    s_endpgm
L_role_R:
    s_and_b32 s19, s17, 1
    s_lshr_b32 s20, s17, 1
    s_lshl_b32 s92, s2, 4
    s_add_u32 s20, s20, s92
    v_mov_b32 v20, v0
    v_lshlrev_b32 v0, 4, v20
    v_mov_b32 v44, -1
    v_mov_b32 v45, -1
    v_mov_b32 v46, -1
    v_mov_b32 v47, -1
    s_mov_b32 s8, s68
    s_mov_b32 s9, s69
    s_mov_b32 s10, 8388608
    s_mov_b32 s11, 0x20000
    s_mov_b32 s32, s70
    s_mov_b32 s33, s71
    s_mov_b32 s34, 8388608
    s_mov_b32 s35, 0x20000
    s_mov_b32 s36, s72
    s_mov_b32 s37, s73
    s_mov_b32 s38, 8388608
    s_mov_b32 s39, 0x20000
    s_mov_b32 s40, s74
    s_mov_b32 s41, s75
    s_mov_b32 s42, 8388608
    s_mov_b32 s43, 0x20000
    s_mov_b32 s93, 8192
    s_mul_i32 s94, s18, 65536
    s_and_b32 s95, s18, 1
    s_lshl_b32 s95, s95, 2
    v_lshrrev_b32 v24, 4, v20
    v_mul_lo_u32 v21, v24, s93
    v_and_b32 v22, 15, v20
    v_lshlrev_b32 v23, 2, v24
    v_xor_b32 v22, v22, v23
    v_lshl_add_u32 v21, v22, 4, v21
    v_add_u32 v31, s94, v21
    v_lshrrev_b32 v21, 3, v20
    v_mul_lo_u32 v21, v21, s93
    v_and_b32 v22, 7, v20
    v_and_b32 v23, 1, v24
    v_lshl_add_u32 v23, v23, 1, s95
    v_xor_b32 v22, v22, v23
    v_lshl_add_u32 v21, v22, 4, v21
    v_add_u32 v32, s94, v21
    v_bfe_u32 v25, v20, 2, 2
    v_and_b32 v22, 3, v20
    v_xor_b32 v26, s18, v25
    v_lshlrev_b32 v26, 6, v26
    v_lshl_add_u32 v26, v25, 8, v26
    v_add_u32 v26, 32768, v26
    v_lshl_add_u32 v27, v24, 11, v26
    v_lshl_add_u32 v100, v22, 4, v27
    v_lshl_add_u32 v103, v22, 3, v27
    v_lshl_add_u32 v27, v24, 10, v26
    v_lshl_add_u32 v106, v22, 4, v27
    v_lshrrev_b32 v26, 1, v25
    v_and_b32 v27, 1, v24
    v_lshl_add_u32 v26, v27, 1, v26
    v_xor_b32 v26, s18, v26
    v_lshlrev_b32 v26, 5, v26
    v_lshl_add_u32 v26, v25, 7, v26
    v_lshl_add_u32 v26, v24, 10, v26
    v_lshl_add_u32 v26, v22, 3, v26
    v_add_u32 v109, 32768, v26
    v_add_u32 v101, 0x10000, v100
    v_add_u32 v102, 0x20000, v100
    v_add_u32 v104, 0x10000, v103
    v_add_u32 v105, 0x20000, v103
    v_add_u32 v107, 0x10000, v106
    v_add_u32 v108, 0x20000, v106
    v_add_u32 v110, 0x10000, v109
    v_add_u32 v111, 0x20000, v109
    v_lshrrev_b32 v21, 2, v20
    v_lshlrev_b32 v23, 4, v22
    v_lshl_add_u32 v33, v21, 11, v23
    s_lshl_b32 s44, s18, 11
    s_add_u32 s44, s44, 0x8000
    v_lshl_add_u32 v26, v25, 6, s44
    v_lshl_add_u32 v26, v24, 8, v26
    v_add_u32 v42, v26, v23
    v_add_u32 v43, 0x10000, v42
    s_lshl_b32 s45, s19, 22
    s_lshl_b32 s92, s20, 8
    s_add_u32 s45, s45, s92
    s_lshl_b32 s44, s2, 22
    s_lshl_b32 s92, s18, 20
    s_add_u32 s44, s44, s92
    s_lshl_b32 s92, s17, 6
    s_add_u32 s44, s44, s92
    s_lshl_b32 s92, s18, 8
    v_lshl_add_u32 v1, v20, 2, s92
    v_bfe_u32 v21, v20, 3, 1
    v_cmp_eq_u32 s[92:93], s19, v21
    v_lshrrev_b32 v21, 5, v20
    v_cmp_eq_u32 s[56:57], s19, v21
    v_mov_b32 v22, 0x40000000
    v_cndmask_b32 v2, v0, v22, s[92:93]
    v_xor_b32 v23, 128, v0
    v_cndmask_b32 v3, v23, v22, s[92:93]
    v_and_b32 v24, 0x1f0, v0
    v_cndmask_b32 v4, v24, v22, s[56:57]
    v_cndmask_b32 v7, v22, v24, s[56:57]
    v_lshrrev_b32 v25, 4, v20
    v_lshlrev_b32 v25, 7, v25
    v_and_b32 v26, 7, v20
    v_lshl_add_u32 v25, v26, 4, v25
    v_cndmask_b32 v5, v25, v22, s[92:93]
    v_cndmask_b32 v6, v22, v25, s[92:93]
    v_bfe_u32 v21, v20, 3, 1
    v_lshl_add_u32 v8, v21, 9, v25
    v_lshl_add_u32 v18, v21, 10, v25
    s_lshl_b32 s94, s18, 11
    s_add_u32 s94, s94, 0x8000
    v_add_u32 v9, s94, v0
    v_add_u32 v14, 0x10000, v9
    s_add_u32 s94, s18, 0
    s_and_b32 s94, s94, 3
    s_lshl_b32 s84, s94, 11
    s_lshl_b32 s94, s94, 13
    v_add_u32 v10, s94, v0
    s_add_u32 s94, s18, 1
    s_and_b32 s94, s94, 3
    s_lshl_b32 s85, s94, 11
    s_lshl_b32 s94, s94, 13
    v_add_u32 v11, s94, v0
    s_add_u32 s94, s18, 2
    s_and_b32 s94, s94, 3
    s_lshl_b32 s86, s94, 11
    s_lshl_b32 s94, s94, 13
    v_add_u32 v12, s94, v0
    s_add_u32 s94, s18, 3
    s_and_b32 s94, s94, 3
    s_lshl_b32 s87, s94, 11
    s_lshl_b32 s94, s94, 13
    v_add_u32 v13, s94, v0
    v_and_b32 v15, 0x370, v0
    v_lshrrev_b32 v21, 2, v20
    v_lshlrev_b32 v21, 4, v21
    v_bfe_u32 v22, v20, 1, 1
    v_lshl_add_u32 v21, v22, 10, v21
    v_and_b32 v22, 1, v20
    v_lshl_add_u32 v21, v22, 3, v21
    s_lshl_b32 s94, s18, 8
    v_add_u32 v16, s94, v21
    s_mov_b32 s60, 0x00003f80
    s_mov_b32 s61, 0x3f800000
    s_mov_b32 s62, 0xbe0293ee
    s_mov_b32 s48, s66
    s_mov_b32 s49, s67
    s_mov_b32 s50, 16384
    s_mov_b32 s51, 0x20000
    v_bfe_u32 v21, v20, 2, 3
    v_lshlrev_b32 v21, 11, v21
    v_and_b32 v22, 3, v20
    v_lshl_add_u32 v21, v22, 2, v21
    s_lshl_b32 s94, s17, 6
    s_lshl_b32 s95, s18, 4
    s_add_u32 s94, s94, s95
    s_cmp_eq_u32 s2, 0
    s_cselect_b32 s94, s94, 0x100000
    buffer_load_dword v17, v21, s[48:51], s94 offen
    s_lshl_b32 s92, s19, 14
    s_lshl_b32 s93, s18, 12
    s_add_u32 s92, s92, s93
    s_lshl_b32 s93, s2, 15
    s_add_u32 s22, s92, s93
    s_add_u32 s22, s22, 262144
    s_xor_b32 s94, s93, 0x8000
    s_add_u32 s94, s94, s92
    s_lshr_b32 s95, s94, 13
    s_lshl_b32 s95, s95, 14
    s_and_b32 s23, s94, 8191
    s_add_u32 s23, s23, s95
    s_add_u32 s23, s23, 524288
    s_lshl_b32 s92, s17, 10
    s_add_u32 s94, s92, s93
    s_add_u32 s24, s94, 262144
    s_lshr_b32 s95, s94, 13
    s_lshl_b32 s95, s95, 14
    s_and_b32 s25, s94, 8191
    s_add_u32 s25, s25, s95
    s_add_u32 s25, s25, 524288
    s_lshl_b32 s92, s20, 1
    s_add_u32 s92, s92, s19
    s_lshl_b32 s92, s92, 13
    s_add_u32 s28, s92, 2097152
    s_lshl_b32 s93, s18, 9
    s_add_u32 s93, s93, 4096
    s_add_u32 s29, s28, s93
    s_xor_b32 s92, s28, 0x2000
    s_add_u32 s27, s92, s93
    s_lshl_b32 s93, s18, 10
    s_add_u32 s26, s92, s93
    s_add_u32 s28, s28, s93
    s_lshl_b32 s92, s20, 12
    s_add_u32 s92, s92, s93
    s_lshl_b32 s93, s19, 9
    s_add_u32 s92, s92, s93
    s_add_u32 s30, s92, 1048576
    s_lshl_b32 s92, s2, 16
    s_lshl_b32 s93, s18, 14
    s_add_u32 s92, s92, s93
    s_add_u32 s31, s92, 1048576
    s_lshl_b32 s92, s19, 11
    s_add_u32 s63, s92, s20
    s_lshl_b32 s92, s19, 5
    s_add_u32 s92, s92, s20
    s_mul_i32 s97, s92, 640
    s_add_u32 s89, s97, 1613824
    s_add_u32 s97, s97, 1572864
    s_lshl_b32 s92, s19, 9
    s_lshr_b32 s93, s20, 1
    s_add_u32 s92, s92, s93
    s_lshl_b32 s92, s92, 2
    s_and_b32 s93, s20, 1
    s_add_u32 s92, s92, s93
    s_lshl_b32 s92, s92, 12
    s_lshl_b32 s93, s18, 9
    s_add_u32 s92, s92, s93
    s_add_u32 s96, s92, 71303168
    v_lshl_add_u32 v48, s84, 2, v100
    v_add_u32 v49, 0x10000, v48
    v_lshl_add_u32 v56, s84, 2, v103
    v_add_u32 v57, 0x10000, v56
    v_lshl_add_u32 v50, s85, 2, v100
    v_add_u32 v51, 0x10000, v50
    v_lshl_add_u32 v58, s85, 2, v103
    v_add_u32 v59, 0x10000, v58
    v_lshl_add_u32 v52, s86, 2, v100
    v_add_u32 v53, 0x10000, v52
    v_lshl_add_u32 v60, s86, 2, v103
    v_add_u32 v61, 0x10000, v60
    v_lshl_add_u32 v54, s87, 2, v100
    v_add_u32 v55, 0x10000, v54
    v_lshl_add_u32 v62, s87, 2, v103
    v_add_u32 v63, 0x10000, v62
    s_add_u32 s93, s25, 0
    buffer_store_dword v44, v1, s[4:7], s93 offen sc1
    s_xor_b32 s93, s93, 8192
    buffer_store_dword v44, v1, s[4:7], s93 offen sc1
    s_add_u32 s93, s25, 131072
    buffer_store_dword v44, v1, s[4:7], s93 offen sc1
    s_xor_b32 s93, s93, 8192
    buffer_store_dword v44, v1, s[4:7], s93 offen sc1
    s_add_u32 s93, s25, 262144
    buffer_store_dword v44, v1, s[4:7], s93 offen sc1
    s_xor_b32 s93, s93, 8192
    buffer_store_dword v44, v1, s[4:7], s93 offen sc1
    s_add_u32 s93, s25, 393216
    buffer_store_dword v44, v1, s[4:7], s93 offen sc1
    s_xor_b32 s93, s93, 8192
    buffer_store_dword v44, v1, s[4:7], s93 offen sc1
    s_add_u32 s93, s24, 0
    buffer_store_dword v44, v1, s[4:7], s93 offen
    s_add_u32 s93, s26, 0
    buffer_store_dwordx4 v[44:47], v0, s[4:7], s93 offen
    s_add_u32 s93, s27, 0
    buffer_store_dwordx4 v[44:47], v4, s[4:7], s93 offen
    s_add_u32 s93, s30, 0
    buffer_store_dwordx4 v[44:47], v5, s[4:7], s93 offen
    s_add_u32 s93, s24, 65536
    buffer_store_dword v44, v1, s[4:7], s93 offen
    s_add_u32 s93, s26, 524288
    buffer_store_dwordx4 v[44:47], v0, s[4:7], s93 offen
    s_add_u32 s93, s27, 524288
    buffer_store_dwordx4 v[44:47], v4, s[4:7], s93 offen
    s_add_u32 s93, s30, 131072
    buffer_store_dwordx4 v[44:47], v5, s[4:7], s93 offen
    s_add_u32 s93, s24, 131072
    buffer_store_dword v44, v1, s[4:7], s93 offen
    s_add_u32 s93, s26, 1048576
    buffer_store_dwordx4 v[44:47], v0, s[4:7], s93 offen
    s_add_u32 s93, s27, 1048576
    buffer_store_dwordx4 v[44:47], v4, s[4:7], s93 offen
    s_add_u32 s93, s30, 262144
    buffer_store_dwordx4 v[44:47], v5, s[4:7], s93 offen
    s_add_u32 s93, s24, 196608
    buffer_store_dword v44, v1, s[4:7], s93 offen
    s_add_u32 s93, s26, 1572864
    buffer_store_dwordx4 v[44:47], v0, s[4:7], s93 offen
    s_add_u32 s93, s27, 1572864
    buffer_store_dwordx4 v[44:47], v4, s[4:7], s93 offen
    s_add_u32 s93, s30, 393216
    buffer_store_dwordx4 v[44:47], v5, s[4:7], s93 offen
    s_lshl_b32 s46, s18, 11
    s_lshl_b32 s47, s18, 10
    s_add_u32 s92, s45, 0
    s_add_u32 m0, s46, 32768
    s_nop 0
    buffer_load_dwordx4 v31, s[8:11], s92 offen lds
    s_add_u32 s92, s45, 32768
    s_add_u32 m0, s46, 33792
    s_nop 0
    buffer_load_dwordx4 v31, s[8:11], s92 offen lds
    s_add_u32 s92, s45, 1048576
    s_add_u32 m0, s46, 40960
    s_nop 0
    buffer_load_dwordx4 v31, s[8:11], s92 offen lds
    s_add_u32 s92, s45, 1081344
    s_add_u32 m0, s46, 41984
    s_nop 0
    buffer_load_dwordx4 v31, s[8:11], s92 offen lds
    s_add_u32 s92, s45, 2097152
    s_add_u32 m0, s46, 49152
    s_nop 0
    buffer_load_dwordx4 v31, s[8:11], s92 offen lds
    s_add_u32 s92, s45, 2129920
    s_add_u32 m0, s46, 50176
    s_nop 0
    buffer_load_dwordx4 v31, s[8:11], s92 offen lds
    s_add_u32 s92, s45, 3145728
    s_add_u32 m0, s46, 57344
    s_nop 0
    buffer_load_dwordx4 v31, s[8:11], s92 offen lds
    s_add_u32 s92, s45, 3178496
    s_add_u32 m0, s46, 58368
    s_nop 0
    buffer_load_dwordx4 v31, s[8:11], s92 offen lds
    s_add_u32 s92, s45, 262144
    s_add_u32 m0, s46, 65536
    s_nop 0
    buffer_load_dwordx4 v31, s[8:11], s92 offen lds
    s_add_u32 s92, s45, 294912
    s_add_u32 m0, s46, 66560
    s_nop 0
    buffer_load_dwordx4 v31, s[8:11], s92 offen lds
    s_add_u32 s92, s45, 1310720
    s_add_u32 m0, s46, 73728
    s_nop 0
    buffer_load_dwordx4 v31, s[8:11], s92 offen lds
    s_add_u32 s92, s45, 1343488
    s_add_u32 m0, s46, 74752
    s_nop 0
    buffer_load_dwordx4 v31, s[8:11], s92 offen lds
    s_add_u32 s92, s45, 2359296
    s_add_u32 m0, s46, 81920
    s_nop 0
    buffer_load_dwordx4 v31, s[8:11], s92 offen lds
    s_add_u32 s92, s45, 2392064
    s_add_u32 m0, s46, 82944
    s_nop 0
    buffer_load_dwordx4 v31, s[8:11], s92 offen lds
    s_add_u32 s92, s45, 3407872
    s_add_u32 m0, s46, 90112
    s_nop 0
    buffer_load_dwordx4 v31, s[8:11], s92 offen lds
    s_add_u32 s92, s45, 3440640
    s_add_u32 m0, s46, 91136
    s_nop 0
    buffer_load_dwordx4 v31, s[8:11], s92 offen lds
    s_add_u32 s92, s45, 524288
    s_add_u32 m0, s46, 98304
    s_nop 0
    buffer_load_dwordx4 v31, s[8:11], s92 offen lds
    s_add_u32 s92, s45, 557056
    s_add_u32 m0, s46, 99328
    s_nop 0
    buffer_load_dwordx4 v31, s[8:11], s92 offen lds
    s_add_u32 s92, s45, 1572864
    s_add_u32 m0, s46, 106496
    s_nop 0
    buffer_load_dwordx4 v31, s[8:11], s92 offen lds
    s_add_u32 s92, s45, 1605632
    s_add_u32 m0, s46, 107520
    s_nop 0
    buffer_load_dwordx4 v31, s[8:11], s92 offen lds
    s_add_u32 s92, s45, 2621440
    s_add_u32 m0, s46, 114688
    s_nop 0
    buffer_load_dwordx4 v31, s[8:11], s92 offen lds
    s_add_u32 s92, s45, 2654208
    s_add_u32 m0, s46, 115712
    s_nop 0
    buffer_load_dwordx4 v31, s[8:11], s92 offen lds
    s_add_u32 s92, s45, 3670016
    s_add_u32 m0, s46, 122880
    s_nop 0
    buffer_load_dwordx4 v31, s[8:11], s92 offen lds
    s_add_u32 s92, s45, 3702784
    s_add_u32 m0, s46, 123904
    s_nop 0
    buffer_load_dwordx4 v31, s[8:11], s92 offen lds
    s_waitcnt vmcnt(16)
    s_barrier
    s_add_u32 s92, s45, 786432
    s_add_u32 m0, s46, 131072
    s_nop 0
    buffer_load_dwordx4 v31, s[8:11], s92 offen lds
    s_add_u32 s92, s45, 819200
    s_add_u32 m0, s46, 132096
    s_nop 0
    buffer_load_dwordx4 v31, s[8:11], s92 offen lds
    s_add_u32 s92, s45, 1835008
    s_add_u32 m0, s46, 139264
    s_nop 0
    buffer_load_dwordx4 v31, s[8:11], s92 offen lds
    s_add_u32 s92, s45, 1867776
    s_add_u32 m0, s46, 140288
    s_nop 0
    buffer_load_dwordx4 v31, s[8:11], s92 offen lds
    s_add_u32 s92, s45, 2883584
    s_add_u32 m0, s46, 147456
    s_nop 0
    buffer_load_dwordx4 v31, s[8:11], s92 offen lds
    s_add_u32 s92, s45, 2916352
    s_add_u32 m0, s46, 148480
    s_nop 0
    buffer_load_dwordx4 v31, s[8:11], s92 offen lds
    s_add_u32 s92, s45, 3932160
    s_add_u32 m0, s46, 155648
    s_nop 0
    buffer_load_dwordx4 v31, s[8:11], s92 offen lds
    s_add_u32 s92, s45, 3964928
    s_add_u32 m0, s46, 156672
    s_nop 0
    buffer_load_dwordx4 v31, s[8:11], s92 offen lds
    ds_read_b64_tr_b16 a[0:1], v48 offset:0
    ds_read_b64_tr_b16 a[2:3], v48 offset:1024
    ds_read_b64_tr_b16 a[4:5], v48 offset:8
    ds_read_b64_tr_b16 a[6:7], v48 offset:1032
    ds_read_b64_tr_b16 a[32:33], v50 offset:0
    ds_read_b64_tr_b16 a[34:35], v50 offset:1024
    ds_read_b64_tr_b16 a[36:37], v50 offset:8
    ds_read_b64_tr_b16 a[38:39], v50 offset:1032
    ds_read_b64_tr_b16 a[64:65], v52 offset:0
    ds_read_b64_tr_b16 a[66:67], v52 offset:1024
    ds_read_b64_tr_b16 a[68:69], v52 offset:8
    ds_read_b64_tr_b16 a[70:71], v52 offset:1032
    ds_read_b64_tr_b16 a[96:97], v54 offset:0
    ds_read_b64_tr_b16 a[98:99], v54 offset:1024
    ds_read_b64_tr_b16 a[100:101], v54 offset:8
    ds_read_b64_tr_b16 a[102:103], v54 offset:1032
    s_cmp_lg_u32 s18, 0
    s_cbranch_scc1 L_arr_69
    s_mov_b32 s3, 1
    s_buffer_atomic_add s3, s[12:15], 4 glc
    s_waitcnt lgkmcnt(0)
    s_add_u32 s3, s3, 1
    s_and_b32 s92, s3, 0xffff
    s_cmp_lg_u32 s92, 256
    s_cbranch_scc1 L_arr_69
    v_mov_b32 v20, s3
    v_lshlrev_b32 v21, 3, v0
    s_mov_b32 s92, 163840
    buffer_store_dword v20, v21, s[4:7], s92 offen sc1
    s_mov_b32 s92, 172032
    buffer_store_dword v20, v21, s[4:7], s92 offen sc1
    s_mov_b32 s92, 180224
    buffer_store_dword v20, v21, s[4:7], s92 offen sc1
    s_mov_b32 s92, 188416
    buffer_store_dword v20, v21, s[4:7], s92 offen sc1
    s_waitcnt vmcnt(0)
L_arr_69:
    s_waitcnt lgkmcnt(0)
    s_waitcnt vmcnt(16)
    s_barrier
    s_add_u32 s92, s45, 0
    s_add_u32 m0, s46, 32768
    s_nop 0
    buffer_load_dwordx4 v31, s[32:35], s92 offen lds
    s_add_u32 s92, s45, 32768
    s_add_u32 m0, s46, 33792
    s_nop 0
    buffer_load_dwordx4 v31, s[32:35], s92 offen lds
    s_add_u32 s92, s45, 1048576
    s_add_u32 m0, s46, 40960
    s_nop 0
    buffer_load_dwordx4 v31, s[32:35], s92 offen lds
    s_add_u32 s92, s45, 1081344
    s_add_u32 m0, s46, 41984
    s_nop 0
    buffer_load_dwordx4 v31, s[32:35], s92 offen lds
    s_add_u32 s92, s45, 2097152
    s_add_u32 m0, s46, 49152
    s_nop 0
    buffer_load_dwordx4 v31, s[32:35], s92 offen lds
    s_add_u32 s92, s45, 2129920
    s_add_u32 m0, s46, 50176
    s_nop 0
    buffer_load_dwordx4 v31, s[32:35], s92 offen lds
    s_add_u32 s92, s45, 3145728
    s_add_u32 m0, s46, 57344
    s_nop 0
    buffer_load_dwordx4 v31, s[32:35], s92 offen lds
    s_add_u32 s92, s45, 3178496
    s_add_u32 m0, s46, 58368
    s_nop 0
    buffer_load_dwordx4 v31, s[32:35], s92 offen lds
    ds_read_b64_tr_b16 a[8:9], v48 offset:32768
    ds_read_b64_tr_b16 a[10:11], v48 offset:33792
    ds_read_b64_tr_b16 a[12:13], v48 offset:32776
    ds_read_b64_tr_b16 a[14:15], v48 offset:33800
    ds_read_b64_tr_b16 a[40:41], v50 offset:32768
    ds_read_b64_tr_b16 a[42:43], v50 offset:33792
    ds_read_b64_tr_b16 a[44:45], v50 offset:32776
    ds_read_b64_tr_b16 a[46:47], v50 offset:33800
    ds_read_b64_tr_b16 a[72:73], v52 offset:32768
    ds_read_b64_tr_b16 a[74:75], v52 offset:33792
    ds_read_b64_tr_b16 a[76:77], v52 offset:32776
    ds_read_b64_tr_b16 a[78:79], v52 offset:33800
    ds_read_b64_tr_b16 a[104:105], v54 offset:32768
    ds_read_b64_tr_b16 a[106:107], v54 offset:33792
    ds_read_b64_tr_b16 a[108:109], v54 offset:32776
    ds_read_b64_tr_b16 a[110:111], v54 offset:33800
    s_waitcnt lgkmcnt(0)
    s_waitcnt vmcnt(16)
    s_barrier
    s_add_u32 s92, s45, 262144
    s_add_u32 m0, s46, 65536
    s_nop 0
    buffer_load_dwordx4 v31, s[32:35], s92 offen lds
    s_add_u32 s92, s45, 294912
    s_add_u32 m0, s46, 66560
    s_nop 0
    buffer_load_dwordx4 v31, s[32:35], s92 offen lds
    s_add_u32 s92, s45, 1310720
    s_add_u32 m0, s46, 73728
    s_nop 0
    buffer_load_dwordx4 v31, s[32:35], s92 offen lds
    s_add_u32 s92, s45, 1343488
    s_add_u32 m0, s46, 74752
    s_nop 0
    buffer_load_dwordx4 v31, s[32:35], s92 offen lds
    s_add_u32 s92, s45, 2359296
    s_add_u32 m0, s46, 81920
    s_nop 0
    buffer_load_dwordx4 v31, s[32:35], s92 offen lds
    s_add_u32 s92, s45, 2392064
    s_add_u32 m0, s46, 82944
    s_nop 0
    buffer_load_dwordx4 v31, s[32:35], s92 offen lds
    s_add_u32 s92, s45, 3407872
    s_add_u32 m0, s46, 90112
    s_nop 0
    buffer_load_dwordx4 v31, s[32:35], s92 offen lds
    s_add_u32 s92, s45, 3440640
    s_add_u32 m0, s46, 91136
    s_nop 0
    buffer_load_dwordx4 v31, s[32:35], s92 offen lds
    ds_read_b64_tr_b16 a[16:17], v49 offset:0
    ds_read_b64_tr_b16 a[18:19], v49 offset:1024
    ds_read_b64_tr_b16 a[20:21], v49 offset:8
    ds_read_b64_tr_b16 a[22:23], v49 offset:1032
    ds_read_b64_tr_b16 a[48:49], v51 offset:0
    ds_read_b64_tr_b16 a[50:51], v51 offset:1024
    ds_read_b64_tr_b16 a[52:53], v51 offset:8
    ds_read_b64_tr_b16 a[54:55], v51 offset:1032
    ds_read_b64_tr_b16 a[80:81], v53 offset:0
    ds_read_b64_tr_b16 a[82:83], v53 offset:1024
    ds_read_b64_tr_b16 a[84:85], v53 offset:8
    ds_read_b64_tr_b16 a[86:87], v53 offset:1032
    ds_read_b64_tr_b16 a[112:113], v55 offset:0
    ds_read_b64_tr_b16 a[114:115], v55 offset:1024
    ds_read_b64_tr_b16 a[116:117], v55 offset:8
    ds_read_b64_tr_b16 a[118:119], v55 offset:1032
    s_waitcnt lgkmcnt(0)
    s_waitcnt vmcnt(16)
    s_barrier
    s_add_u32 s92, s45, 524288
    s_add_u32 m0, s46, 98304
    s_nop 0
    buffer_load_dwordx4 v31, s[32:35], s92 offen lds
    s_add_u32 s92, s45, 557056
    s_add_u32 m0, s46, 99328
    s_nop 0
    buffer_load_dwordx4 v31, s[32:35], s92 offen lds
    s_add_u32 s92, s45, 1572864
    s_add_u32 m0, s46, 106496
    s_nop 0
    buffer_load_dwordx4 v31, s[32:35], s92 offen lds
    s_add_u32 s92, s45, 1605632
    s_add_u32 m0, s46, 107520
    s_nop 0
    buffer_load_dwordx4 v31, s[32:35], s92 offen lds
    s_add_u32 s92, s45, 2621440
    s_add_u32 m0, s46, 114688
    s_nop 0
    buffer_load_dwordx4 v31, s[32:35], s92 offen lds
    s_add_u32 s92, s45, 2654208
    s_add_u32 m0, s46, 115712
    s_nop 0
    buffer_load_dwordx4 v31, s[32:35], s92 offen lds
    s_add_u32 s92, s45, 3670016
    s_add_u32 m0, s46, 122880
    s_nop 0
    buffer_load_dwordx4 v31, s[32:35], s92 offen lds
    s_add_u32 s92, s45, 3702784
    s_add_u32 m0, s46, 123904
    s_nop 0
    buffer_load_dwordx4 v31, s[32:35], s92 offen lds
    ds_read_b64_tr_b16 a[24:25], v49 offset:32768
    ds_read_b64_tr_b16 a[26:27], v49 offset:33792
    ds_read_b64_tr_b16 a[28:29], v49 offset:32776
    ds_read_b64_tr_b16 a[30:31], v49 offset:33800
    ds_read_b64_tr_b16 a[56:57], v51 offset:32768
    ds_read_b64_tr_b16 a[58:59], v51 offset:33792
    ds_read_b64_tr_b16 a[60:61], v51 offset:32776
    ds_read_b64_tr_b16 a[62:63], v51 offset:33800
    ds_read_b64_tr_b16 a[88:89], v53 offset:32768
    ds_read_b64_tr_b16 a[90:91], v53 offset:33792
    ds_read_b64_tr_b16 a[92:93], v53 offset:32776
    ds_read_b64_tr_b16 a[94:95], v53 offset:33800
    ds_read_b64_tr_b16 a[120:121], v55 offset:32768
    ds_read_b64_tr_b16 a[122:123], v55 offset:33792
    ds_read_b64_tr_b16 a[124:125], v55 offset:32776
    ds_read_b64_tr_b16 a[126:127], v55 offset:33800
    s_waitcnt lgkmcnt(0)
    s_waitcnt vmcnt(16)
    s_barrier
    s_add_u32 s92, s45, 786432
    s_add_u32 m0, s46, 131072
    s_nop 0
    buffer_load_dwordx4 v31, s[32:35], s92 offen lds
    s_add_u32 s92, s45, 819200
    s_add_u32 m0, s46, 132096
    s_nop 0
    buffer_load_dwordx4 v31, s[32:35], s92 offen lds
    s_add_u32 s92, s45, 1835008
    s_add_u32 m0, s46, 139264
    s_nop 0
    buffer_load_dwordx4 v31, s[32:35], s92 offen lds
    s_add_u32 s92, s45, 1867776
    s_add_u32 m0, s46, 140288
    s_nop 0
    buffer_load_dwordx4 v31, s[32:35], s92 offen lds
    s_add_u32 s92, s45, 2883584
    s_add_u32 m0, s46, 147456
    s_nop 0
    buffer_load_dwordx4 v31, s[32:35], s92 offen lds
    s_add_u32 s92, s45, 2916352
    s_add_u32 m0, s46, 148480
    s_nop 0
    buffer_load_dwordx4 v31, s[32:35], s92 offen lds
    s_add_u32 s92, s45, 3932160
    s_add_u32 m0, s46, 155648
    s_nop 0
    buffer_load_dwordx4 v31, s[32:35], s92 offen lds
    s_add_u32 s92, s45, 3964928
    s_add_u32 m0, s46, 156672
    s_nop 0
    buffer_load_dwordx4 v31, s[32:35], s92 offen lds
    ds_read_b64_tr_b16 a[128:129], v48 offset:0
    ds_read_b64_tr_b16 a[130:131], v48 offset:1024
    ds_read_b64_tr_b16 a[132:133], v48 offset:8
    ds_read_b64_tr_b16 a[134:135], v48 offset:1032
    ds_read_b64_tr_b16 a[160:161], v50 offset:0
    ds_read_b64_tr_b16 a[162:163], v50 offset:1024
    ds_read_b64_tr_b16 a[164:165], v50 offset:8
    ds_read_b64_tr_b16 a[166:167], v50 offset:1032
    ds_read_b64_tr_b16 a[192:193], v52 offset:0
    ds_read_b64_tr_b16 a[194:195], v52 offset:1024
    ds_read_b64_tr_b16 a[196:197], v52 offset:8
    ds_read_b64_tr_b16 a[198:199], v52 offset:1032
    ds_read_b64_tr_b16 a[224:225], v54 offset:0
    ds_read_b64_tr_b16 a[226:227], v54 offset:1024
    ds_read_b64_tr_b16 a[228:229], v54 offset:8
    ds_read_b64_tr_b16 a[230:231], v54 offset:1032
    s_waitcnt lgkmcnt(0)
    s_waitcnt vmcnt(16)
    s_barrier
    s_add_u32 s92, s45, 0
    s_add_u32 m0, s46, 32768
    s_nop 0
    buffer_load_dwordx4 v31, s[36:39], s92 offen lds
    s_add_u32 s92, s45, 32768
    s_add_u32 m0, s46, 33792
    s_nop 0
    buffer_load_dwordx4 v31, s[36:39], s92 offen lds
    s_add_u32 s92, s45, 1048576
    s_add_u32 m0, s46, 40960
    s_nop 0
    buffer_load_dwordx4 v31, s[36:39], s92 offen lds
    s_add_u32 s92, s45, 1081344
    s_add_u32 m0, s46, 41984
    s_nop 0
    buffer_load_dwordx4 v31, s[36:39], s92 offen lds
    s_add_u32 s92, s45, 2097152
    s_add_u32 m0, s46, 49152
    s_nop 0
    buffer_load_dwordx4 v31, s[36:39], s92 offen lds
    s_add_u32 s92, s45, 2129920
    s_add_u32 m0, s46, 50176
    s_nop 0
    buffer_load_dwordx4 v31, s[36:39], s92 offen lds
    s_add_u32 s92, s45, 3145728
    s_add_u32 m0, s46, 57344
    s_nop 0
    buffer_load_dwordx4 v31, s[36:39], s92 offen lds
    s_add_u32 s92, s45, 3178496
    s_add_u32 m0, s46, 58368
    s_nop 0
    buffer_load_dwordx4 v31, s[36:39], s92 offen lds
    ds_read_b64_tr_b16 a[136:137], v48 offset:32768
    ds_read_b64_tr_b16 a[138:139], v48 offset:33792
    ds_read_b64_tr_b16 a[140:141], v48 offset:32776
    ds_read_b64_tr_b16 a[142:143], v48 offset:33800
    ds_read_b64_tr_b16 a[168:169], v50 offset:32768
    ds_read_b64_tr_b16 a[170:171], v50 offset:33792
    ds_read_b64_tr_b16 a[172:173], v50 offset:32776
    ds_read_b64_tr_b16 a[174:175], v50 offset:33800
    ds_read_b64_tr_b16 a[200:201], v52 offset:32768
    ds_read_b64_tr_b16 a[202:203], v52 offset:33792
    ds_read_b64_tr_b16 a[204:205], v52 offset:32776
    ds_read_b64_tr_b16 a[206:207], v52 offset:33800
    ds_read_b64_tr_b16 a[232:233], v54 offset:32768
    ds_read_b64_tr_b16 a[234:235], v54 offset:33792
    ds_read_b64_tr_b16 a[236:237], v54 offset:32776
    ds_read_b64_tr_b16 a[238:239], v54 offset:33800
    s_waitcnt lgkmcnt(0)
    s_waitcnt vmcnt(16)
    s_barrier
    s_add_u32 s92, s45, 262144
    s_add_u32 m0, s46, 65536
    s_nop 0
    buffer_load_dwordx4 v31, s[36:39], s92 offen lds
    s_add_u32 s92, s45, 294912
    s_add_u32 m0, s46, 66560
    s_nop 0
    buffer_load_dwordx4 v31, s[36:39], s92 offen lds
    s_add_u32 s92, s45, 1310720
    s_add_u32 m0, s46, 73728
    s_nop 0
    buffer_load_dwordx4 v31, s[36:39], s92 offen lds
    s_add_u32 s92, s45, 1343488
    s_add_u32 m0, s46, 74752
    s_nop 0
    buffer_load_dwordx4 v31, s[36:39], s92 offen lds
    s_add_u32 s92, s45, 2359296
    s_add_u32 m0, s46, 81920
    s_nop 0
    buffer_load_dwordx4 v31, s[36:39], s92 offen lds
    s_add_u32 s92, s45, 2392064
    s_add_u32 m0, s46, 82944
    s_nop 0
    buffer_load_dwordx4 v31, s[36:39], s92 offen lds
    s_add_u32 s92, s45, 3407872
    s_add_u32 m0, s46, 90112
    s_nop 0
    buffer_load_dwordx4 v31, s[36:39], s92 offen lds
    s_add_u32 s92, s45, 3440640
    s_add_u32 m0, s46, 91136
    s_nop 0
    buffer_load_dwordx4 v31, s[36:39], s92 offen lds
    ds_read_b64_tr_b16 a[144:145], v49 offset:0
    ds_read_b64_tr_b16 a[146:147], v49 offset:1024
    ds_read_b64_tr_b16 a[148:149], v49 offset:8
    ds_read_b64_tr_b16 a[150:151], v49 offset:1032
    ds_read_b64_tr_b16 a[176:177], v51 offset:0
    ds_read_b64_tr_b16 a[178:179], v51 offset:1024
    ds_read_b64_tr_b16 a[180:181], v51 offset:8
    ds_read_b64_tr_b16 a[182:183], v51 offset:1032
    ds_read_b64_tr_b16 a[208:209], v53 offset:0
    ds_read_b64_tr_b16 a[210:211], v53 offset:1024
    ds_read_b64_tr_b16 a[212:213], v53 offset:8
    ds_read_b64_tr_b16 a[214:215], v53 offset:1032
    ds_read_b64_tr_b16 a[240:241], v55 offset:0
    ds_read_b64_tr_b16 a[242:243], v55 offset:1024
    ds_read_b64_tr_b16 a[244:245], v55 offset:8
    ds_read_b64_tr_b16 a[246:247], v55 offset:1032
    s_waitcnt lgkmcnt(0)
    s_waitcnt vmcnt(16)
    s_barrier
    s_add_u32 s92, s45, 524288
    s_add_u32 m0, s46, 98304
    s_nop 0
    buffer_load_dwordx4 v31, s[36:39], s92 offen lds
    s_add_u32 s92, s45, 557056
    s_add_u32 m0, s46, 99328
    s_nop 0
    buffer_load_dwordx4 v31, s[36:39], s92 offen lds
    s_add_u32 s92, s45, 1572864
    s_add_u32 m0, s46, 106496
    s_nop 0
    buffer_load_dwordx4 v31, s[36:39], s92 offen lds
    s_add_u32 s92, s45, 1605632
    s_add_u32 m0, s46, 107520
    s_nop 0
    buffer_load_dwordx4 v31, s[36:39], s92 offen lds
    s_add_u32 s92, s45, 2621440
    s_add_u32 m0, s46, 114688
    s_nop 0
    buffer_load_dwordx4 v31, s[36:39], s92 offen lds
    s_add_u32 s92, s45, 2654208
    s_add_u32 m0, s46, 115712
    s_nop 0
    buffer_load_dwordx4 v31, s[36:39], s92 offen lds
    s_add_u32 s92, s45, 3670016
    s_add_u32 m0, s46, 122880
    s_nop 0
    buffer_load_dwordx4 v31, s[36:39], s92 offen lds
    s_add_u32 s92, s45, 3702784
    s_add_u32 m0, s46, 123904
    s_nop 0
    buffer_load_dwordx4 v31, s[36:39], s92 offen lds
    ds_read_b64_tr_b16 a[152:153], v49 offset:32768
    ds_read_b64_tr_b16 a[154:155], v49 offset:33792
    ds_read_b64_tr_b16 a[156:157], v49 offset:32776
    ds_read_b64_tr_b16 a[158:159], v49 offset:33800
    ds_read_b64_tr_b16 a[184:185], v51 offset:32768
    ds_read_b64_tr_b16 a[186:187], v51 offset:33792
    ds_read_b64_tr_b16 a[188:189], v51 offset:32776
    ds_read_b64_tr_b16 a[190:191], v51 offset:33800
    ds_read_b64_tr_b16 a[216:217], v53 offset:32768
    ds_read_b64_tr_b16 a[218:219], v53 offset:33792
    ds_read_b64_tr_b16 a[220:221], v53 offset:32776
    ds_read_b64_tr_b16 a[222:223], v53 offset:33800
    ds_read_b64_tr_b16 a[248:249], v55 offset:32768
    ds_read_b64_tr_b16 a[250:251], v55 offset:33792
    ds_read_b64_tr_b16 a[252:253], v55 offset:32776
    ds_read_b64_tr_b16 a[254:255], v55 offset:33800
    s_waitcnt lgkmcnt(0)
    s_waitcnt vmcnt(16)
    s_barrier
    s_add_u32 s92, s45, 786432
    s_add_u32 m0, s46, 131072
    s_nop 0
    buffer_load_dwordx4 v31, s[36:39], s92 offen lds
    s_add_u32 s92, s45, 819200
    s_add_u32 m0, s46, 132096
    s_nop 0
    buffer_load_dwordx4 v31, s[36:39], s92 offen lds
    s_add_u32 s92, s45, 1835008
    s_add_u32 m0, s46, 139264
    s_nop 0
    buffer_load_dwordx4 v31, s[36:39], s92 offen lds
    s_add_u32 s92, s45, 1867776
    s_add_u32 m0, s46, 140288
    s_nop 0
    buffer_load_dwordx4 v31, s[36:39], s92 offen lds
    s_add_u32 s92, s45, 2883584
    s_add_u32 m0, s46, 147456
    s_nop 0
    buffer_load_dwordx4 v31, s[36:39], s92 offen lds
    s_add_u32 s92, s45, 2916352
    s_add_u32 m0, s46, 148480
    s_nop 0
    buffer_load_dwordx4 v31, s[36:39], s92 offen lds
    s_add_u32 s92, s45, 3932160
    s_add_u32 m0, s46, 155648
    s_nop 0
    buffer_load_dwordx4 v31, s[36:39], s92 offen lds
    s_add_u32 s92, s45, 3964928
    s_add_u32 m0, s46, 156672
    s_nop 0
    buffer_load_dwordx4 v31, s[36:39], s92 offen lds
    ds_read_b64_tr_b16 v[128:129], v56 offset:0
    ds_read_b64_tr_b16 v[130:131], v56 offset:1024
    ds_read_b64_tr_b16 v[132:133], v56 offset:32
    ds_read_b64_tr_b16 v[134:135], v56 offset:1056
    ds_read_b64_tr_b16 v[160:161], v58 offset:0
    ds_read_b64_tr_b16 v[162:163], v58 offset:1024
    ds_read_b64_tr_b16 v[164:165], v58 offset:32
    ds_read_b64_tr_b16 v[166:167], v58 offset:1056
    ds_read_b64_tr_b16 v[192:193], v60 offset:0
    ds_read_b64_tr_b16 v[194:195], v60 offset:1024
    ds_read_b64_tr_b16 v[196:197], v60 offset:32
    ds_read_b64_tr_b16 v[198:199], v60 offset:1056
    ds_read_b64_tr_b16 v[224:225], v62 offset:0
    ds_read_b64_tr_b16 v[226:227], v62 offset:1024
    ds_read_b64_tr_b16 v[228:229], v62 offset:32
    ds_read_b64_tr_b16 v[230:231], v62 offset:1056
    s_waitcnt lgkmcnt(0)
    s_waitcnt vmcnt(16)
    s_barrier
    s_add_u32 s92, s44, 0
    s_add_u32 m0, s46, 32768
    s_nop 0
    buffer_load_dwordx4 v33, s[40:43], s92 offen lds
    s_add_u32 s92, s44, 32768
    s_add_u32 m0, s46, 33792
    s_nop 0
    buffer_load_dwordx4 v33, s[40:43], s92 offen lds
    s_add_u32 s92, s44, 65536
    s_add_u32 m0, s46, 40960
    s_nop 0
    buffer_load_dwordx4 v33, s[40:43], s92 offen lds
    s_add_u32 s92, s44, 98304
    s_add_u32 m0, s46, 41984
    s_nop 0
    buffer_load_dwordx4 v33, s[40:43], s92 offen lds
    s_add_u32 s92, s44, 131072
    s_add_u32 m0, s46, 49152
    s_nop 0
    buffer_load_dwordx4 v33, s[40:43], s92 offen lds
    s_add_u32 s92, s44, 163840
    s_add_u32 m0, s46, 50176
    s_nop 0
    buffer_load_dwordx4 v33, s[40:43], s92 offen lds
    s_add_u32 s92, s44, 196608
    s_add_u32 m0, s46, 57344
    s_nop 0
    buffer_load_dwordx4 v33, s[40:43], s92 offen lds
    s_add_u32 s92, s44, 229376
    s_add_u32 m0, s46, 58368
    s_nop 0
    buffer_load_dwordx4 v33, s[40:43], s92 offen lds
    ds_read_b64_tr_b16 v[136:137], v56 offset:32768
    ds_read_b64_tr_b16 v[138:139], v56 offset:33792
    ds_read_b64_tr_b16 v[140:141], v56 offset:32800
    ds_read_b64_tr_b16 v[142:143], v56 offset:33824
    ds_read_b64_tr_b16 v[168:169], v58 offset:32768
    ds_read_b64_tr_b16 v[170:171], v58 offset:33792
    ds_read_b64_tr_b16 v[172:173], v58 offset:32800
    ds_read_b64_tr_b16 v[174:175], v58 offset:33824
    ds_read_b64_tr_b16 v[200:201], v60 offset:32768
    ds_read_b64_tr_b16 v[202:203], v60 offset:33792
    ds_read_b64_tr_b16 v[204:205], v60 offset:32800
    ds_read_b64_tr_b16 v[206:207], v60 offset:33824
    ds_read_b64_tr_b16 v[232:233], v62 offset:32768
    ds_read_b64_tr_b16 v[234:235], v62 offset:33792
    ds_read_b64_tr_b16 v[236:237], v62 offset:32800
    ds_read_b64_tr_b16 v[238:239], v62 offset:33824
    s_waitcnt lgkmcnt(0)
    s_waitcnt vmcnt(16)
    s_barrier
    s_add_u32 s92, s44, 262144
    s_add_u32 m0, s46, 65536
    s_nop 0
    buffer_load_dwordx4 v33, s[40:43], s92 offen lds
    s_add_u32 s92, s44, 294912
    s_add_u32 m0, s46, 66560
    s_nop 0
    buffer_load_dwordx4 v33, s[40:43], s92 offen lds
    s_add_u32 s92, s44, 327680
    s_add_u32 m0, s46, 73728
    s_nop 0
    buffer_load_dwordx4 v33, s[40:43], s92 offen lds
    s_add_u32 s92, s44, 360448
    s_add_u32 m0, s46, 74752
    s_nop 0
    buffer_load_dwordx4 v33, s[40:43], s92 offen lds
    s_add_u32 s92, s44, 393216
    s_add_u32 m0, s46, 81920
    s_nop 0
    buffer_load_dwordx4 v33, s[40:43], s92 offen lds
    s_add_u32 s92, s44, 425984
    s_add_u32 m0, s46, 82944
    s_nop 0
    buffer_load_dwordx4 v33, s[40:43], s92 offen lds
    s_add_u32 s92, s44, 458752
    s_add_u32 m0, s46, 90112
    s_nop 0
    buffer_load_dwordx4 v33, s[40:43], s92 offen lds
    s_add_u32 s92, s44, 491520
    s_add_u32 m0, s46, 91136
    s_nop 0
    buffer_load_dwordx4 v33, s[40:43], s92 offen lds
    ds_read_b64_tr_b16 v[144:145], v57 offset:0
    ds_read_b64_tr_b16 v[146:147], v57 offset:1024
    ds_read_b64_tr_b16 v[148:149], v57 offset:32
    ds_read_b64_tr_b16 v[150:151], v57 offset:1056
    ds_read_b64_tr_b16 v[176:177], v59 offset:0
    ds_read_b64_tr_b16 v[178:179], v59 offset:1024
    ds_read_b64_tr_b16 v[180:181], v59 offset:32
    ds_read_b64_tr_b16 v[182:183], v59 offset:1056
    ds_read_b64_tr_b16 v[208:209], v61 offset:0
    ds_read_b64_tr_b16 v[210:211], v61 offset:1024
    ds_read_b64_tr_b16 v[212:213], v61 offset:32
    ds_read_b64_tr_b16 v[214:215], v61 offset:1056
    ds_read_b64_tr_b16 v[240:241], v63 offset:0
    ds_read_b64_tr_b16 v[242:243], v63 offset:1024
    ds_read_b64_tr_b16 v[244:245], v63 offset:32
    ds_read_b64_tr_b16 v[246:247], v63 offset:1056
    s_waitcnt lgkmcnt(0)
    s_waitcnt vmcnt(16)
    s_barrier
    s_add_u32 s92, s44, 524288
    s_add_u32 m0, s46, 98304
    s_nop 0
    buffer_load_dwordx4 v33, s[40:43], s92 offen lds
    s_add_u32 s92, s44, 557056
    s_add_u32 m0, s46, 99328
    s_nop 0
    buffer_load_dwordx4 v33, s[40:43], s92 offen lds
    s_add_u32 s92, s44, 589824
    s_add_u32 m0, s46, 106496
    s_nop 0
    buffer_load_dwordx4 v33, s[40:43], s92 offen lds
    s_add_u32 s92, s44, 622592
    s_add_u32 m0, s46, 107520
    s_nop 0
    buffer_load_dwordx4 v33, s[40:43], s92 offen lds
    s_add_u32 s92, s44, 655360
    s_add_u32 m0, s46, 114688
    s_nop 0
    buffer_load_dwordx4 v33, s[40:43], s92 offen lds
    s_add_u32 s92, s44, 688128
    s_add_u32 m0, s46, 115712
    s_nop 0
    buffer_load_dwordx4 v33, s[40:43], s92 offen lds
    s_add_u32 s92, s44, 720896
    s_add_u32 m0, s46, 122880
    s_nop 0
    buffer_load_dwordx4 v33, s[40:43], s92 offen lds
    s_add_u32 s92, s44, 753664
    s_add_u32 m0, s46, 123904
    s_nop 0
    buffer_load_dwordx4 v33, s[40:43], s92 offen lds
    ds_read_b64_tr_b16 v[152:153], v57 offset:32768
    ds_read_b64_tr_b16 v[154:155], v57 offset:33792
    ds_read_b64_tr_b16 v[156:157], v57 offset:32800
    ds_read_b64_tr_b16 v[158:159], v57 offset:33824
    ds_read_b64_tr_b16 v[184:185], v59 offset:32768
    ds_read_b64_tr_b16 v[186:187], v59 offset:33792
    ds_read_b64_tr_b16 v[188:189], v59 offset:32800
    ds_read_b64_tr_b16 v[190:191], v59 offset:33824
    ds_read_b64_tr_b16 v[216:217], v61 offset:32768
    ds_read_b64_tr_b16 v[218:219], v61 offset:33792
    ds_read_b64_tr_b16 v[220:221], v61 offset:32800
    ds_read_b64_tr_b16 v[222:223], v61 offset:33824
    ds_read_b64_tr_b16 v[248:249], v63 offset:32768
    ds_read_b64_tr_b16 v[250:251], v63 offset:33792
    ds_read_b64_tr_b16 v[252:253], v63 offset:32800
    ds_read_b64_tr_b16 v[254:255], v63 offset:33824
    s_waitcnt lgkmcnt(0)
    s_waitcnt vmcnt(16)
    s_barrier
    s_add_u32 s92, s44, 786432
    s_add_u32 m0, s46, 131072
    s_nop 0
    buffer_load_dwordx4 v33, s[40:43], s92 offen lds
    s_add_u32 s92, s44, 819200
    s_add_u32 m0, s46, 132096
    s_nop 0
    buffer_load_dwordx4 v33, s[40:43], s92 offen lds
    s_add_u32 s92, s44, 851968
    s_add_u32 m0, s46, 139264
    s_nop 0
    buffer_load_dwordx4 v33, s[40:43], s92 offen lds
    s_add_u32 s92, s44, 884736
    s_add_u32 m0, s46, 140288
    s_nop 0
    buffer_load_dwordx4 v33, s[40:43], s92 offen lds
    s_add_u32 s92, s44, 917504
    s_add_u32 m0, s46, 147456
    s_nop 0
    buffer_load_dwordx4 v33, s[40:43], s92 offen lds
    s_add_u32 s92, s44, 950272
    s_add_u32 m0, s46, 148480
    s_nop 0
    buffer_load_dwordx4 v33, s[40:43], s92 offen lds
    s_add_u32 s92, s44, 983040
    s_add_u32 m0, s46, 155648
    s_nop 0
    buffer_load_dwordx4 v33, s[40:43], s92 offen lds
    s_add_u32 s92, s44, 1015808
    s_add_u32 m0, s46, 156672
    s_nop 0
    buffer_load_dwordx4 v33, s[40:43], s92 offen lds
    ds_read_b64_tr_b16 v[64:65], v42 offset:0
    ds_read_b64_tr_b16 v[66:67], v42 offset:1024
    ds_read_b64_tr_b16 v[68:69], v42 offset:8
    ds_read_b64_tr_b16 v[70:71], v42 offset:1032
    ds_read_b64_tr_b16 v[72:73], v42 offset:8192
    ds_read_b64_tr_b16 v[74:75], v42 offset:9216
    ds_read_b64_tr_b16 v[76:77], v42 offset:8200
    ds_read_b64_tr_b16 v[78:79], v42 offset:9224
    ds_read_b64_tr_b16 v[80:81], v42 offset:16384
    ds_read_b64_tr_b16 v[82:83], v42 offset:17408
    ds_read_b64_tr_b16 v[84:85], v42 offset:16392
    ds_read_b64_tr_b16 v[86:87], v42 offset:17416
    ds_read_b64_tr_b16 v[88:89], v42 offset:24576
    ds_read_b64_tr_b16 v[90:91], v42 offset:25600
    ds_read_b64_tr_b16 v[92:93], v42 offset:24584
    ds_read_b64_tr_b16 v[94:95], v42 offset:25608
    s_waitcnt lgkmcnt(0)
    s_waitcnt vmcnt(16)
    s_barrier
    ds_read_b64_tr_b16 v[96:97], v42 offset:32768
    ds_read_b64_tr_b16 v[98:99], v42 offset:33792
    ds_read_b64_tr_b16 v[100:101], v42 offset:32776
    ds_read_b64_tr_b16 v[102:103], v42 offset:33800
    ds_read_b64_tr_b16 v[104:105], v42 offset:40960
    ds_read_b64_tr_b16 v[106:107], v42 offset:41984
    ds_read_b64_tr_b16 v[108:109], v42 offset:40968
    ds_read_b64_tr_b16 v[110:111], v42 offset:41992
    ds_read_b64_tr_b16 v[112:113], v42 offset:49152
    ds_read_b64_tr_b16 v[114:115], v42 offset:50176
    ds_read_b64_tr_b16 v[116:117], v42 offset:49160
    ds_read_b64_tr_b16 v[118:119], v42 offset:50184
    ds_read_b64_tr_b16 v[120:121], v42 offset:57344
    ds_read_b64_tr_b16 v[122:123], v42 offset:58368
    ds_read_b64_tr_b16 v[124:125], v42 offset:57352
    ds_read_b64_tr_b16 v[126:127], v42 offset:58376
    s_waitcnt lgkmcnt(0)
    s_waitcnt vmcnt(8)
    s_barrier
    ds_read_b64_tr_b16 v[48:49], v43 offset:0
    ds_read_b64_tr_b16 v[50:51], v43 offset:1024
    ds_read_b64_tr_b16 v[52:53], v43 offset:8
    ds_read_b64_tr_b16 v[54:55], v43 offset:1032
    ds_read_b64_tr_b16 v[56:57], v43 offset:8192
    ds_read_b64_tr_b16 v[58:59], v43 offset:9216
    ds_read_b64_tr_b16 v[60:61], v43 offset:8200
    ds_read_b64_tr_b16 v[62:63], v43 offset:9224
    ds_read_b64_tr_b16 v[20:21], v43 offset:16384
    ds_read_b64_tr_b16 v[22:23], v43 offset:17408
    ds_read_b64_tr_b16 v[24:25], v43 offset:16392
    ds_read_b64_tr_b16 v[26:27], v43 offset:17416
    ds_read_b64_tr_b16 v[28:29], v43 offset:24576
    ds_read_b64_tr_b16 v[30:31], v43 offset:25600
    ds_read_b64_tr_b16 v[32:33], v43 offset:24584
    ds_read_b64_tr_b16 v[34:35], v43 offset:25608
    s_waitcnt lgkmcnt(0)
    s_waitcnt vmcnt(0)
    s_barrier
    s_lshl_b32 s93, s16, 5
    s_add_u32 s93, s93, s17
    s_lshl_b32 s93, s93, 7
    s_add_u32 s93, s93, 163840
    s_buffer_load_dword s92, s[4:7], s93 glc
    ds_write_b128 v9, v[64:67] offset:0
    ds_write_b128 v9, v[68:71] offset:1024
    ds_write_b128 v9, v[72:75] offset:8192
    ds_write_b128 v9, v[76:79] offset:9216
    ds_write_b128 v9, v[80:83] offset:16384
    ds_write_b128 v9, v[84:87] offset:17408
    ds_write_b128 v9, v[88:91] offset:24576
    ds_write_b128 v9, v[92:95] offset:25600
    ds_read_b64_tr_b16 v[64:65], v43 offset:32768
    ds_read_b64_tr_b16 v[66:67], v43 offset:33792
    ds_read_b64_tr_b16 v[68:69], v43 offset:32776
    ds_read_b64_tr_b16 v[70:71], v43 offset:33800
    ds_read_b64_tr_b16 v[72:73], v43 offset:40960
    ds_read_b64_tr_b16 v[74:75], v43 offset:41984
    ds_read_b64_tr_b16 v[76:77], v43 offset:40968
    ds_read_b64_tr_b16 v[78:79], v43 offset:41992
    ds_read_b64_tr_b16 v[80:81], v43 offset:49152
    ds_read_b64_tr_b16 v[82:83], v43 offset:50176
    ds_read_b64_tr_b16 v[84:85], v43 offset:49160
    ds_read_b64_tr_b16 v[86:87], v43 offset:50184
    ds_read_b64_tr_b16 v[88:89], v43 offset:57344
    ds_read_b64_tr_b16 v[90:91], v43 offset:58368
    ds_read_b64_tr_b16 v[92:93], v43 offset:57352
    ds_read_b64_tr_b16 v[94:95], v43 offset:58376
    ds_write_b128 v9, v[96:99] offset:32768
    s_add_u32 s94, s24, 0
    buffer_load_dword v44, v1, s[4:7], s94 offen sc1
    ds_write_b128 v9, v[100:103] offset:33792
    s_add_u32 s94, s26, 0
    buffer_load_dwordx4 v[44:47], v0, s[4:7], s94 offen sc1
    ds_write_b128 v9, v[104:107] offset:40960
    s_add_u32 s94, s27, 0
    buffer_load_dwordx4 v[44:47], v4, s[4:7], s94 offen sc1
    ds_write_b128 v9, v[108:111] offset:41984
    s_add_u32 s94, s30, 0
    buffer_load_dwordx4 v[44:47], v5, s[4:7], s94 offen sc1
    ds_write_b128 v9, v[112:115] offset:49152
    s_add_u32 s94, s24, 65536
    buffer_load_dword v44, v1, s[4:7], s94 offen sc1
    ds_write_b128 v9, v[116:119] offset:50176
    s_add_u32 s94, s26, 524288
    buffer_load_dwordx4 v[44:47], v0, s[4:7], s94 offen sc1
    ds_write_b128 v9, v[120:123] offset:57344
    s_add_u32 s94, s27, 524288
    buffer_load_dwordx4 v[44:47], v4, s[4:7], s94 offen sc1
    ds_write_b128 v9, v[124:127] offset:58368
    s_add_u32 s94, s30, 131072
    buffer_load_dwordx4 v[44:47], v5, s[4:7], s94 offen sc1
    ds_write_b128 v14, v[48:51] offset:0
    s_add_u32 s94, s24, 131072
    buffer_load_dword v44, v1, s[4:7], s94 offen sc1
    ds_write_b128 v14, v[52:55] offset:1024
    s_add_u32 s94, s26, 1048576
    buffer_load_dwordx4 v[44:47], v0, s[4:7], s94 offen sc1
    ds_write_b128 v14, v[56:59] offset:8192
    s_add_u32 s94, s27, 1048576
    buffer_load_dwordx4 v[44:47], v4, s[4:7], s94 offen sc1
    ds_write_b128 v14, v[60:63] offset:9216
    s_add_u32 s94, s30, 262144
    buffer_load_dwordx4 v[44:47], v5, s[4:7], s94 offen sc1
    ds_write_b128 v14, v[20:23] offset:16384
    s_add_u32 s94, s24, 196608
    buffer_load_dword v44, v1, s[4:7], s94 offen sc1
    ds_write_b128 v14, v[24:27] offset:17408
    s_add_u32 s94, s26, 1572864
    buffer_load_dwordx4 v[44:47], v0, s[4:7], s94 offen sc1
    ds_write_b128 v14, v[28:31] offset:24576
    s_add_u32 s94, s27, 1572864
    buffer_load_dwordx4 v[44:47], v4, s[4:7], s94 offen sc1
    ds_write_b128 v14, v[32:35] offset:25600
    s_add_u32 s94, s30, 393216
    buffer_load_dwordx4 v[44:47], v5, s[4:7], s94 offen sc1
    s_waitcnt lgkmcnt(0)
    ds_write_b128 v14, v[64:67] offset:32768
    ds_write_b128 v14, v[68:71] offset:33792
    ds_write_b128 v14, v[72:75] offset:40960
    ds_write_b128 v14, v[76:79] offset:41984
    ds_write_b128 v14, v[80:83] offset:49152
    ds_write_b128 v14, v[84:87] offset:50176
    ds_write_b128 v14, v[88:91] offset:57344
    ds_write_b128 v14, v[92:95] offset:58368
    s_waitcnt lgkmcnt(0)
    s_cmp_lg_u32 s92, 0
    s_cbranch_scc1 L_wsd_71
    s_lshl_b32 s93, s16, 5
    s_add_u32 s93, s93, s17
    s_lshl_b32 s93, s93, 7
    s_add_u32 s93, s93, 163840
    s_mov_b32 s3, 0
L_ws_70:
    s_buffer_load_dword s92, s[4:7], s93 glc
    s_waitcnt lgkmcnt(0)
    s_cmp_lg_u32 s92, 0
    s_cbranch_scc1 L_wsd_71
    s_add_u32 s3, s3, 1
    s_cmp_lt_u32 s3, 40000
    s_cbranch_scc1 L_ws_70
    s_mov_b32 s3, 1
    s_branch L_abort
L_wsd_71:
    s_lshl_b32 s85, s19, 2
    s_add_u32 s85, s85, 4
    s_lshr_b32 s85, s92, s85
    s_lshr_b32 s92, s92, 16
    s_and_b32 s92, s92, 1
    s_lshl_b32 s92, s92, 13
    s_add_u32 s23, s23, s92
    s_add_u32 s25, s25, s92
    v_min_u32 v17, -2, v17
    s_mov_b32 s21, 0
    s_mov_b32 s54, 268435456
    s_mov_b32 s45, 268435456
    s_mov_b32 s8, 0x3e0293ee
    s_mov_b32 s9, s8
    s_cmp_eq_u32 s19, 0
    s_cselect_b32 s10, 0x00ff00ff, 0
    s_cselect_b32 s11, 0, 0xff00ff00
    s_or_b32 s10, s10, s11
    s_mov_b32 s11, s10
    v_mov_b32 v40, 0
    v_mov_b32 v41, 0
    v_writelane_b32 v40, s60, 0
    v_writelane_b32 v40, s61, 1
    v_writelane_b32 v41, s60, 2
    v_writelane_b32 v41, s61, 3
    v_writelane_b32 v40, s60, 20
    v_writelane_b32 v40, s61, 21
    v_writelane_b32 v41, s60, 22
    v_writelane_b32 v41, s61, 23
    v_writelane_b32 v40, s60, 40
    v_writelane_b32 v40, s61, 41
    v_writelane_b32 v41, s60, 42
    v_writelane_b32 v41, s61, 43
    v_writelane_b32 v40, s60, 60
    v_writelane_b32 v40, s61, 61
    v_writelane_b32 v41, s60, 62
    v_writelane_b32 v41, s61, 63
    ds_write_b64 v10, v[40:41] offset:5120
    s_lshl_b32 s92, s18, 13
    s_add_u32 m0, s92, 6144
    ds_read_b64 v[110:111], v10 offset:5120
    s_waitcnt lgkmcnt(0)
    s_waitcnt vmcnt(0)
    buffer_store_dword v17, v1, s[4:7], s24 offen
    buffer_store_dword v17, v1, s[4:7], s25 offen sc1
L_R_step:
    s_and_b32 s92, s21, 3
    s_lshl_b32 s93, s92, 16
    s_add_u32 s32, s22, s93
    s_xor_b32 s93, s93, 0x20000
    s_add_u32 s51, s24, s93
    s_mov_b32 s3, 0
    s_lshl_b32 s93, s92, 17
    s_add_u32 s33, s23, s93
    s_add_u32 s41, s30, s93
    s_add_u32 s42, s31, s93
    s_xor_b32 s93, s93, 0x40000
    s_add_u32 s52, s25, s93
    s_add_u32 s50, s30, s93
    s_sub_u32 s94, s21, 9
    s_cmp_ge_u32 s94, 55
    s_cselect_b32 s36, 1, 0
    s_cbranch_scc1 L_R_o1
    v_mov_b32 v108, 0
    v_mov_b32 v109, 0
    v_mov_b32 v112, 0
    v_mov_b32 v113, 0
    s_waitcnt vmcnt(1)
    buffer_load_dwordx4 v[20:23], v0, s[4:7], s32 offen offset:0 sc1
    buffer_load_dwordx4 v[24:27], v0, s[4:7], s32 offen offset:1024 sc1
    buffer_load_dwordx4 v[28:31], v0, s[4:7], s32 offen offset:2048 sc1
    buffer_load_dwordx4 v[32:35], v0, s[4:7], s32 offen offset:3072 sc1
    s_lshl_b32 s93, s92, 19
    s_add_u32 s37, s26, s93
    s_add_u32 s38, s27, s93
    s_add_u32 s39, s28, s93
    s_add_u32 s40, s29, s93
    s_xor_b32 s93, s93, 0x100000
    s_add_u32 s48, s26, s93
    s_add_u32 s49, s27, s93
    s_add_u32 s92, s21, 1
    s_and_b32 s92, s92, 3
    s_lshl_b32 s93, s92, 16
    s_add_u32 s34, s24, s93
    s_lshl_b32 s93, s92, 17
    s_add_u32 s35, s25, s93
    s_cmp_eq_u32 s21, 8
    s_cselect_b32 s59, -1, 0
    s_mov_b32 s58, 0
L_R_x1l:
    s_waitcnt vmcnt(3)
    v_max3_u32 v19, v20, v21, v22
    v_max_u32 v19, v19, v23
    s_waitcnt vmcnt(2)
    v_max3_u32 v19, v19, v24, v25
    v_max3_u32 v19, v19, v26, v27
    s_waitcnt vmcnt(1)
    v_max3_u32 v19, v19, v28, v29
    v_max3_u32 v19, v19, v30, v31
    s_waitcnt vmcnt(0)
    v_max3_u32 v19, v19, v32, v33
    v_max3_u32 v19, v19, v34, v35
    v_cmp_eq_u32 vcc, -1, v19
    v_mfma_f32_16x16x32_bf16 v[76:79], v[110:113], v[20:23], 0
    s_cbranch_vccnz L_rt_72
    buffer_load_dwordx4 v[36:39], v0, s[4:7], s33 offen offset:0 sc1
    buffer_load_dwordx4 v[40:43], v0, s[4:7], s33 offen offset:1024 sc1
    buffer_load_dwordx4 v[44:47], v0, s[4:7], s33 offen offset:2048 sc1
    buffer_load_dwordx4 v[48:51], v0, s[4:7], s33 offen offset:3072 sc1
    s_buffer_load_dwordx2 s[86:87], s[4:7], s97 glc
    v_mfma_f32_16x16x32_bf16 v[80:83], v[108:111], v[20:23], 0
    v_mfma_f32_16x16x32_bf16 v[84:87], v[110:113], v[24:27], 0
    v_mfma_f32_16x16x32_bf16 v[88:91], v[108:111], v[24:27], 0
    v_mfma_f32_16x16x32_bf16 v[92:95], v[110:113], v[28:31], 0
    v_mfma_f32_16x16x32_bf16 v[96:99], v[108:111], v[28:31], 0
    v_mfma_f32_16x16x32_bf16 v[100:103], v[110:113], v[32:35], 0
    v_mfma_f32_16x16x32_bf16 v[104:107], v[108:111], v[32:35], 0
    s_mul_i32 s92, s19, 9
    s_sub_u32 s92, s21, s92
    s_add_u32 s55, s92, 1
    s_and_b32 s93, s92, 31
    s_lshl_b32 s93, s93, 5
    s_add_u32 s93, s93, s63
    s_lshl_b32 s94, s93, 13
    s_add_u32 s94, s94, s84
    s_add_u32 s43, s94, 4194304
    s_add_u32 s44, s94, 37748736
    s_and_b32 s94, s92, 31
    s_lshl_b32 s94, s94, 18
    s_add_u32 s45, s94, s96
    s_bfe_u32 s94, s92, 0x20003
    s_lshr_b32 s94, s85, s94
    s_and_b32 s94, s94, 8192
    s_add_u32 s45, s45, s94
    s_cmp_lt_u32 s92, 64
    s_cselect_b32 s43, s43, 268435456
    s_cselect_b32 s44, s44, 268435456
    s_cselect_b32 s54, s89, 268435456
    s_cselect_b32 s47, s55, 0
L_R_x1r:
    s_waitcnt vmcnt(3)
    v_mfma_f32_16x16x32_bf16 v[52:55], v[110:113], v[36:39], v[76:79]
    v_max3_u32 v19, v36, v37, v38
    v_max_u32 v19, v19, v39
    v_mfma_f32_16x16x32_bf16 v[56:59], v[108:111], v[36:39], v[80:83]
    s_waitcnt vmcnt(2)
    v_mfma_f32_16x16x32_bf16 v[60:63], v[110:113], v[40:43], v[84:87]
    v_max3_u32 v19, v19, v40, v41
    v_max3_u32 v19, v19, v42, v43
    v_mfma_f32_16x16x32_bf16 v[64:67], v[108:111], v[40:43], v[88:91]
    s_waitcnt vmcnt(1)
    v_cvt_pk_bf16_f32 v20, v52, v53
    v_cvt_pk_bf16_f32 v21, v54, v55
    v_mfma_f32_16x16x32_bf16 v[68:71], v[110:113], v[44:47], v[92:95]
    v_cvt_pk_bf16_f32 v22, v56, v57
    v_cvt_pk_bf16_f32 v23, v58, v59
    v_mfma_f32_16x16x32_bf16 v[72:75], v[108:111], v[44:47], v[96:99]
    ds_write_b128 v10, v[20:23] offset:0
    s_waitcnt vmcnt(0)
    v_mfma_f32_16x16x32_bf16 v[116:119], v[110:113], v[48:51], v[100:103]
    v_cvt_pk_bf16_f32 v24, v60, v61
    v_cvt_pk_bf16_f32 v25, v62, v63
    v_mfma_f32_16x16x32_bf16 v[120:123], v[108:111], v[48:51], v[104:107]
    v_cvt_pk_bf16_f32 v26, v64, v65
    v_cvt_pk_bf16_f32 v27, v66, v67
    ds_write_b128 v10, v[24:27] offset:1024
    v_cvt_pk_bf16_f32 v28, v68, v69
    v_cvt_pk_bf16_f32 v29, v70, v71
    v_cvt_pk_bf16_f32 v30, v72, v73
    v_cvt_pk_bf16_f32 v31, v74, v75
    ds_write_b128 v10, v[28:31] offset:2048
    v_cvt_pk_bf16_f32 v32, v116, v117
    v_cvt_pk_bf16_f32 v33, v118, v119
    v_cvt_pk_bf16_f32 v34, v120, v121
    v_cvt_pk_bf16_f32 v35, v122, v123
    ds_write_b128 v10, v[32:35] offset:3072
    v_max3_u32 v19, v19, v44, v45
    v_max3_u32 v19, v19, v46, v47
    v_max3_u32 v19, v19, v48, v49
    v_max3_u32 v19, v19, v50, v51
    v_cmp_eq_u32 vcc, -1, v19
    v_mfma_f32_16x16x32_bf16 v[52:55], a[0:3], v[20:23], 0
    v_mfma_f32_16x16x32_bf16 v[56:59], a[4:7], v[20:23], 0
    s_cbranch_vccnz L_rt_74
L_R_o1b:
    v_mfma_f32_16x16x32_bf16 v[60:63], a[128:131], v[20:23], 0
    s_waitcnt lgkmcnt(0)
    s_barrier
    v_mfma_f32_16x16x32_bf16 v[64:67], a[132:135], v[20:23], 0
    ds_read_b128 v[36:39], v11 offset:0
    v_mov_b32 v76, -1
    v_mfma_f32_16x16x32_bf16 v[52:55], a[8:11], v[24:27], v[52:55]
    ds_read_b128 v[40:43], v11 offset:1024
    v_mov_b32 v77, -1
    v_mfma_f32_16x16x32_bf16 v[56:59], a[12:15], v[24:27], v[56:59]
    ds_read_b128 v[44:47], v11 offset:2048
    v_mov_b32 v78, -1
    v_mfma_f32_16x16x32_bf16 v[60:63], a[136:139], v[24:27], v[60:63]
    ds_read_b128 v[48:51], v11 offset:3072
    v_mov_b32 v79, -1
    v_mfma_f32_16x16x32_bf16 v[64:67], a[140:143], v[24:27], v[64:67]
L_R_kvf:
    s_min_u32 s86, s86, s87
    s_cmp_lt_u32 s86, s47
    s_cbranch_scc1 L_rt_73
    v_mfma_f32_16x16x32_bf16 v[52:55], a[16:19], v[28:31], v[52:55]
    buffer_load_dwordx4 v0, s[4:7], s43 offen sc1 lds
    v_mfma_f32_16x16x32_bf16 v[56:59], a[20:23], v[28:31], v[56:59]
    v_mfma_f32_16x16x32_bf16 v[60:63], a[144:147], v[28:31], v[60:63]
    v_mfma_f32_16x16x32_bf16 v[64:67], a[148:151], v[28:31], v[64:67]
    buffer_load_dwordx4 v0, s[4:7], s43 offen offset:1024 sc1 lds
    v_mfma_f32_16x16x32_bf16 v[52:55], a[24:27], v[32:35], v[52:55]
    v_mfma_f32_16x16x32_bf16 v[56:59], a[28:31], v[32:35], v[56:59]
    v_mfma_f32_16x16x32_bf16 v[60:63], a[152:155], v[32:35], v[60:63]
    v_mfma_f32_16x16x32_bf16 v[64:67], a[156:159], v[32:35], v[64:67]
    s_waitcnt lgkmcnt(3)
    v_mfma_f32_16x16x32_bf16 v[52:55], a[32:35], v[36:39], v[52:55]
    buffer_load_dwordx4 v[108:111], v0, s[4:7], s44 offen offset:0 sc1
    v_mfma_f32_16x16x32_bf16 v[56:59], a[36:39], v[36:39], v[56:59]
    v_mfma_f32_16x16x32_bf16 v[60:63], a[160:163], v[36:39], v[60:63]
    v_mfma_f32_16x16x32_bf16 v[64:67], a[164:167], v[36:39], v[64:67]
    ds_read_b128 v[36:39], v12 offset:0
    s_waitcnt lgkmcnt(3)
    v_mfma_f32_16x16x32_bf16 v[52:55], a[40:43], v[40:43], v[52:55]
    buffer_load_dwordx4 v[112:115], v0, s[4:7], s44 offen offset:1024 sc1
    v_mfma_f32_16x16x32_bf16 v[56:59], a[44:47], v[40:43], v[56:59]
    v_mfma_f32_16x16x32_bf16 v[60:63], a[168:171], v[40:43], v[60:63]
    v_mfma_f32_16x16x32_bf16 v[64:67], a[172:175], v[40:43], v[64:67]
    ds_read_b128 v[40:43], v12 offset:1024
    s_waitcnt lgkmcnt(3)
    v_mfma_f32_16x16x32_bf16 v[52:55], a[48:51], v[44:47], v[52:55]
    buffer_store_dword v76, v1, s[4:7], s52 offen sc1
    v_mfma_f32_16x16x32_bf16 v[56:59], a[52:55], v[44:47], v[56:59]
    v_mfma_f32_16x16x32_bf16 v[60:63], a[176:179], v[44:47], v[60:63]
    v_mfma_f32_16x16x32_bf16 v[64:67], a[180:183], v[44:47], v[64:67]
    ds_read_b128 v[44:47], v12 offset:2048
    s_waitcnt lgkmcnt(3)
    v_mfma_f32_16x16x32_bf16 v[52:55], a[56:59], v[48:51], v[52:55]
    buffer_store_dword v76, v1, s[4:7], s51 offen
    v_mfma_f32_16x16x32_bf16 v[56:59], a[60:63], v[48:51], v[56:59]
    v_mfma_f32_16x16x32_bf16 v[60:63], a[184:187], v[48:51], v[60:63]
    v_mfma_f32_16x16x32_bf16 v[64:67], a[188:191], v[48:51], v[64:67]
    ds_read_b128 v[48:51], v12 offset:3072
    s_waitcnt lgkmcnt(3)
    v_mfma_f32_16x16x32_bf16 v[52:55], a[64:67], v[36:39], v[52:55]
    buffer_store_dwordx4 v[76:79], v0, s[4:7], s48 offen
    v_mfma_f32_16x16x32_bf16 v[56:59], a[68:71], v[36:39], v[56:59]
    v_mfma_f32_16x16x32_bf16 v[60:63], a[192:195], v[36:39], v[60:63]
    v_mfma_f32_16x16x32_bf16 v[64:67], a[196:199], v[36:39], v[64:67]
    ds_read_b128 v[36:39], v13 offset:0
    s_waitcnt lgkmcnt(3)
    v_mfma_f32_16x16x32_bf16 v[52:55], a[72:75], v[40:43], v[52:55]
    buffer_store_dwordx4 v[76:79], v4, s[4:7], s49 offen
    v_mfma_f32_16x16x32_bf16 v[56:59], a[76:79], v[40:43], v[56:59]
    v_mfma_f32_16x16x32_bf16 v[60:63], a[200:203], v[40:43], v[60:63]
    v_mfma_f32_16x16x32_bf16 v[64:67], a[204:207], v[40:43], v[64:67]
    ds_read_b128 v[40:43], v13 offset:1024
    s_waitcnt lgkmcnt(3)
    v_mfma_f32_16x16x32_bf16 v[52:55], a[80:83], v[44:47], v[52:55]
    buffer_store_dwordx4 v[76:79], v5, s[4:7], s50 offen
    v_mfma_f32_16x16x32_bf16 v[56:59], a[84:87], v[44:47], v[56:59]
    v_mfma_f32_16x16x32_bf16 v[60:63], a[208:211], v[44:47], v[60:63]
    v_mfma_f32_16x16x32_bf16 v[64:67], a[212:215], v[44:47], v[64:67]
    ds_read_b128 v[44:47], v13 offset:2048
    s_waitcnt lgkmcnt(3)
    v_mfma_f32_16x16x32_bf16 v[52:55], a[88:91], v[48:51], v[52:55]
    v_mfma_f32_16x16x32_bf16 v[56:59], a[92:95], v[48:51], v[56:59]
    v_mfma_f32_16x16x32_bf16 v[60:63], a[216:219], v[48:51], v[60:63]
    v_mfma_f32_16x16x32_bf16 v[64:67], a[220:223], v[48:51], v[64:67]
    ds_read_b128 v[48:51], v13 offset:3072
    s_waitcnt lgkmcnt(3)
    v_mfma_f32_16x16x32_bf16 v[52:55], a[96:99], v[36:39], v[52:55]
    v_mfma_f32_16x16x32_bf16 v[56:59], a[100:103], v[36:39], v[56:59]
    v_mfma_f32_16x16x32_bf16 v[60:63], a[224:227], v[36:39], v[60:63]
    v_mfma_f32_16x16x32_bf16 v[64:67], a[228:231], v[36:39], v[64:67]
    s_waitcnt lgkmcnt(2)
    v_mfma_f32_16x16x32_bf16 v[52:55], a[104:107], v[40:43], v[52:55]
    v_mfma_f32_16x16x32_bf16 v[56:59], a[108:111], v[40:43], v[56:59]
    v_mfma_f32_16x16x32_bf16 v[60:63], a[232:235], v[40:43], v[60:63]
    v_mfma_f32_16x16x32_bf16 v[64:67], a[236:239], v[40:43], v[64:67]
    s_waitcnt lgkmcnt(1)
    v_mfma_f32_16x16x32_bf16 v[52:55], a[112:115], v[44:47], v[52:55]
    v_mfma_f32_16x16x32_bf16 v[56:59], a[116:119], v[44:47], v[56:59]
    s_waitcnt lgkmcnt(0)
    v_mfma_f32_16x16x32_bf16 v[52:55], a[120:123], v[48:51], v[52:55]
    v_mfma_f32_16x16x32_bf16 v[56:59], a[124:127], v[48:51], v[56:59]
    v_mfma_f32_16x16x32_bf16 v[60:63], a[240:243], v[44:47], v[60:63]
    v_mfma_f32_16x16x32_bf16 v[64:67], a[244:247], v[44:47], v[64:67]
    v_mfma_f32_16x16x32_bf16 v[60:63], a[248:251], v[48:51], v[60:63]
    v_mfma_f32_16x16x32_bf16 v[64:67], a[252:255], v[48:51], v[64:67]
    v_mfma_f32_16x16x32_bf16 v[68:71], v[36:39], v[224:227], 0
    s_cmp_eq_u32 s36, 1
    s_cbranch_scc1 L_R_o2
    v_cvt_pk_bf16_f32 v116, v52, v53
    v_cvt_pk_bf16_f32 v117, v54, v55
    v_cvt_pk_bf16_f32 v118, v56, v57
    v_cvt_pk_bf16_f32 v119, v58, v59
    buffer_store_dwordx4 v[116:119], v3, s[4:7], s37 offen
    v_mfma_f32_16x16x32_bf16 v[72:75], v[36:39], v[228:231], 0
    v_cvt_pk_bf16_f32 v120, v60, v61
    v_cvt_pk_bf16_f32 v121, v62, v63
    v_cvt_pk_bf16_f32 v122, v64, v65
    v_cvt_pk_bf16_f32 v123, v66, v67
    buffer_store_dwordx4 v[120:123], v2, s[4:7], s37 offen
L_R_o2b:
    ds_read_b128 v[36:39], v11 offset:0
    v_mfma_f32_16x16x32_bf16 v[68:71], v[40:43], v[232:235], v[68:71]
    v_mov_b32_dpp v52, v52 row_ror:8 row_mask:0xf bank_mask:0xf
    v_mov_b32_dpp v53, v53 row_ror:8 row_mask:0xf bank_mask:0xf
    v_mfma_f32_16x16x32_bf16 v[72:75], v[40:43], v[236:239], v[72:75]
    ds_read_b128 v[40:43], v11 offset:1024
    v_mov_b32_dpp v54, v54 row_ror:8 row_mask:0xf bank_mask:0xf
    v_mfma_f32_16x16x32_bf16 v[68:71], v[44:47], v[240:243], v[68:71]
    v_mov_b32_dpp v55, v55 row_ror:8 row_mask:0xf bank_mask:0xf
    v_mov_b32_dpp v56, v56 row_ror:8 row_mask:0xf bank_mask:0xf
    v_mfma_f32_16x16x32_bf16 v[72:75], v[44:47], v[244:247], v[72:75]
    ds_read_b128 v[44:47], v11 offset:2048
    v_mov_b32_dpp v57, v57 row_ror:8 row_mask:0xf bank_mask:0xf
    v_mfma_f32_16x16x32_bf16 v[68:71], v[48:51], v[248:251], v[68:71]
    v_mov_b32_dpp v58, v58 row_ror:8 row_mask:0xf bank_mask:0xf
    v_mov_b32_dpp v59, v59 row_ror:8 row_mask:0xf bank_mask:0xf
    v_mfma_f32_16x16x32_bf16 v[72:75], v[48:51], v[252:255], v[72:75]
    ds_read_b128 v[48:51], v11 offset:3072
    v_cndmask_b32 v60, v52, v60, s[10:11]
    v_mfma_f32_16x16x32_bf16 v[68:71], v[20:23], v[128:131], v[68:71]
    v_cndmask_b32 v61, v53, v61, s[10:11]
    v_cndmask_b32 v62, v54, v62, s[10:11]
    v_mfma_f32_16x16x32_bf16 v[72:75], v[20:23], v[132:135], v[72:75]
    v_cndmask_b32 v63, v55, v63, s[10:11]
    v_cndmask_b32 v64, v56, v64, s[10:11]
    v_mfma_f32_16x16x32_bf16 v[68:71], v[24:27], v[136:139], v[68:71]
    v_cndmask_b32 v65, v57, v65, s[10:11]
    v_cndmask_b32 v66, v58, v66, s[10:11]
    v_mfma_f32_16x16x32_bf16 v[72:75], v[24:27], v[140:143], v[72:75]
    v_cndmask_b32 v67, v59, v67, s[10:11]
    v_mfma_f32_16x16x32_bf16 v[68:71], v[28:31], v[144:147], v[68:71]
    v_mfma_f32_16x16x32_bf16 v[72:75], v[28:31], v[148:151], v[72:75]
    v_mfma_f32_16x16x32_bf16 v[68:71], v[32:35], v[152:155], v[68:71]
    v_mfma_f32_16x16x32_bf16 v[72:75], v[32:35], v[156:159], v[72:75]
    s_waitcnt lgkmcnt(3)
    v_mfma_f32_16x16x32_bf16 v[68:71], v[36:39], v[160:163], v[68:71]
    v_mfma_f32_16x16x32_bf16 v[72:75], v[36:39], v[164:167], v[72:75]
    ds_read_b128 v[36:39], v12 offset:0
    s_waitcnt lgkmcnt(3)
    v_mfma_f32_16x16x32_bf16 v[68:71], v[40:43], v[168:171], v[68:71]
    buffer_load_dwordx4 v[52:55], v0, s[4:7], s39 offen sc1
    v_mov_b32 v127, 0xff800000
    v_mfma_f32_16x16x32_bf16 v[72:75], v[40:43], v[172:175], v[72:75]
    ds_read_b128 v[40:43], v12 offset:1024
    s_waitcnt lgkmcnt(3)
    v_mfma_f32_16x16x32_bf16 v[68:71], v[44:47], v[176:179], v[68:71]
    v_cndmask_b32 v124, v127, 0, s[56:57]
    v_cndmask_b32 v125, v127, 0, s[56:57]
    v_mfma_f32_16x16x32_bf16 v[72:75], v[44:47], v[180:183], v[72:75]
    ds_read_b128 v[44:47], v12 offset:2048
    s_waitcnt lgkmcnt(3)
    v_mfma_f32_16x16x32_bf16 v[68:71], v[48:51], v[184:187], v[68:71]
    v_cndmask_b32 v126, v127, 0, s[56:57]
    v_cndmask_b32 v127, v127, 0, s[56:57]
    v_mfma_f32_16x16x32_bf16 v[72:75], v[48:51], v[188:191], v[72:75]
    ds_read_b128 v[48:51], v12 offset:3072
    s_waitcnt lgkmcnt(3)
    v_mfma_f32_16x16x32_bf16 v[68:71], v[36:39], v[192:195], v[68:71]
    v_mfma_f32_16x16x32_bf16 v[72:75], v[36:39], v[196:199], v[72:75]
    s_waitcnt lgkmcnt(2)
    v_mfma_f32_16x16x32_bf16 v[68:71], v[40:43], v[200:203], v[68:71]
    v_mfma_f32_16x16x32_bf16 v[72:75], v[40:43], v[204:207], v[72:75]
    s_waitcnt lgkmcnt(1)
    v_mfma_f32_16x16x32_bf16 v[68:71], v[44:47], v[208:211], v[68:71]
    v_mfma_f32_16x16x32_bf16 v[72:75], v[44:47], v[212:215], v[72:75]
    s_waitcnt lgkmcnt(0)
    v_mfma_f32_16x16x32_bf16 v[68:71], v[48:51], v[216:219], v[68:71]
    v_mfma_f32_16x16x32_bf16 v[72:75], v[48:51], v[220:223], v[72:75]
    s_waitcnt vmcnt(0)
    ds_read_b128 v[76:79], v10 offset:6144
    ds_read_b128 v[80:83], v10 offset:7168
L_R_x2:
    v_max3_u32 v19, v52, v53, v54
    v_max_u32 v19, v19, v55
    v_cmp_eq_u32 vcc, -1, v19
    v_dot2_f32_bf16 v36, v52, s60, v60
    v_dot2_f32_bf16 v37, v52, s61, v61
    v_dot2_f32_bf16 v38, v53, s60, v62
    v_dot2_f32_bf16 v39, v53, s61, v63
    v_dot2_f32_bf16 v40, v54, s60, v64
    v_dot2_f32_bf16 v41, v54, s61, v65
    v_dot2_f32_bf16 v42, v55, s60, v66
    v_dot2_f32_bf16 v43, v55, s61, v67
    s_cbranch_vccnz L_rt_75
    v_cvt_pk_bf16_f32 v20, v36, v37
    v_cvt_pk_bf16_f32 v21, v38, v39
    v_cvt_pk_bf16_f32 v22, v40, v41
    v_cvt_pk_bf16_f32 v23, v42, v43
    ds_write_b128 v10, v[20:23] offset:4096
    s_cmp_eq_u32 s36, 1
    s_cbranch_scc1 L_R_o3
L_R_o3b:
    v_cvt_pk_bf16_f32 v44, v68, v69
    v_cvt_pk_bf16_f32 v45, v70, v71
    v_cvt_pk_bf16_f32 v46, v72, v73
    v_cvt_pk_bf16_f32 v47, v74, v75
    buffer_store_dwordx4 v[44:47], v4, s[4:7], s38 offen
    s_waitcnt lgkmcnt(0)
    s_barrier
    ds_read_b128 v[24:27], v11 offset:4096
    ds_read_b128 v[84:87], v11 offset:6144
    ds_read_b128 v[88:91], v11 offset:7168
    ds_read_b128 v[28:31], v12 offset:4096
    v_mfma_f32_16x16x32_bf16 v[124:127], v[20:23], v[20:23], v[124:127]
    ds_read_b128 v[92:95], v12 offset:6144
    v_cndmask_b32 v68, 0, v68, s[56:57]
    v_mfma_f32_16x16x32_bf16 v[116:119], v[76:79], v[20:23], 0
    ds_read_b128 v[96:99], v12 offset:7168
    v_cndmask_b32 v69, 0, v69, s[56:57]
    v_mfma_f32_16x16x32_bf16 v[120:123], v[80:83], v[20:23], 0
    ds_read_b128 v[32:35], v13 offset:4096
    s_waitcnt lgkmcnt(6)
    v_mfma_f32_16x16x32_bf16 v[124:127], v[24:27], v[24:27], v[124:127]
    ds_read_b128 v[100:103], v13 offset:6144
    s_waitcnt lgkmcnt(6)
    v_mfma_f32_16x16x32_bf16 v[116:119], v[84:87], v[24:27], v[116:119]
    ds_read_b128 v[104:107], v13 offset:7168
    s_waitcnt lgkmcnt(6)
    v_mfma_f32_16x16x32_bf16 v[120:123], v[88:91], v[24:27], v[120:123]
    s_waitcnt lgkmcnt(5)
    v_cndmask_b32 v70, 0, v70, s[56:57]
    v_cndmask_b32 v71, 0, v71, s[56:57]
    v_mfma_f32_16x16x32_bf16 v[124:127], v[28:31], v[28:31], v[124:127]
    s_waitcnt lgkmcnt(4)
    v_cndmask_b32 v72, 0, v72, s[56:57]
    v_cndmask_b32 v73, 0, v73, s[56:57]
    v_mfma_f32_16x16x32_bf16 v[116:119], v[92:95], v[28:31], v[116:119]
    s_waitcnt lgkmcnt(3)
    v_cndmask_b32 v74, 0, v74, s[56:57]
    v_cndmask_b32 v75, 0, v75, s[56:57]
    v_mfma_f32_16x16x32_bf16 v[120:123], v[96:99], v[28:31], v[120:123]
    s_waitcnt lgkmcnt(2)
    v_mov_b32 v36, 0x3f803f80
    v_mov_b32 v37, 0x3f803f80
    v_mfma_f32_16x16x32_bf16 v[124:127], v[32:35], v[32:35], v[124:127]
    s_waitcnt lgkmcnt(1)
    v_mov_b32 v38, 0x3f803f80
    v_mov_b32 v39, 0x3f803f80
    v_mfma_f32_16x16x32_bf16 v[116:119], v[100:103], v[32:35], v[116:119]
    s_waitcnt lgkmcnt(0)
    v_cvt_pk_bf16_f32 v76, v68, v69
    v_cvt_pk_bf16_f32 v77, v70, v71
    v_mfma_f32_16x16x32_bf16 v[120:123], v[104:107], v[32:35], v[120:123]
    buffer_load_dwordx2 v[78:79], v7, s[4:7], s40 offen sc1
    v_cvt_pk_bf16_f32 v80, v72, v73
    v_cvt_pk_bf16_f32 v81, v74, v75
    buffer_load_dwordx2 v[82:83], v7, s[4:7], s40 offen offset:8 sc1
    s_add_u32 s92, s42, 4096
    s_add_u32 s93, s42, 8192
    s_add_u32 s94, s42, 12288
    v_max3_f32 v64, v116, v117, v118
    v_max3_f32 v65, v119, v120, v121
    v_max3_f32 v64, v64, v122, v123
    v_max3_f32 v65, v65, v124, v125
    v_max3_f32 v66, v64, v126, v127
    v_max_f32 v64, v66, v65
    v_max_f32 v65, v66, v65
    s_nop 1
    v_permlane16_swap_b32 v64, v65
    v_max_f32 v66, v64, v65
    v_max_f32 v67, v64, v65
    s_nop 1
    v_permlane32_swap_b32 v66, v67
    v_max_f32 v64, v66, v67
    v_mul_f32 v64, s62, v64
    v_pk_fma_f32 v[116:117], v[116:117], s[8:9], v[64:65] op_sel_hi:[1,1,0]
    v_pk_fma_f32 v[118:119], v[118:119], s[8:9], v[64:65] op_sel_hi:[1,1,0]
    v_pk_fma_f32 v[120:121], v[120:121], s[8:9], v[64:65] op_sel_hi:[1,1,0]
    v_pk_fma_f32 v[122:123], v[122:123], s[8:9], v[64:65] op_sel_hi:[1,1,0]
    v_pk_fma_f32 v[124:125], v[124:125], s[8:9], v[64:65] op_sel_hi:[1,1,0]
    v_pk_fma_f32 v[126:127], v[126:127], s[8:9], v[64:65] op_sel_hi:[1,1,0]
    v_exp_f32 v124, v124
    v_exp_f32 v125, v125
    v_exp_f32 v126, v126
    v_exp_f32 v127, v127
    v_exp_f32 v116, v116
    v_exp_f32 v117, v117
    v_cvt_pk_bf16_f32 v48, v124, v125
    v_cvt_pk_bf16_f32 v49, v126, v127
    v_cvt_pk_bf16_f32 v50, v124, v125
    v_cvt_pk_bf16_f32 v51, v126, v127
    v_exp_f32 v118, v118
    v_mfma_f32_16x16x16_bf16 v[60:63], v[36:37], v[48:49], 0
    v_exp_f32 v119, v119
    v_exp_f32 v120, v120
    v_exp_f32 v121, v121
    s_waitcnt vmcnt(0)
L_R_x2v:
    v_mfma_f32_16x16x32_bf16 v[52:55], v[76:79], v[48:51], 0
    v_max3_u32 v19, v78, v79, v82
    v_max_u32 v19, v19, v83
    v_mfma_f32_16x16x32_bf16 v[56:59], v[80:83], v[48:51], 0
    v_cmp_eq_u32 vcc, -1, v19
    v_exp_f32 v66, v122
    v_exp_f32 v67, v123
    v_cvt_pk_bf16_f32 v40, v116, v117
    v_cvt_pk_bf16_f32 v41, v118, v119
    v_cvt_pk_bf16_f32 v42, v120, v121
    v_cvt_pk_bf16_f32 v43, v66, v67
    s_cbranch_vccnz L_rt_76
    s_nop 0
    v_mfma_f32_16x16x32_bf16 v[60:63], v[36:39], v[40:43], v[60:63]
    v_mfma_f32_16x16x32_bf16 v[52:55], v[108:111], v[40:43], v[52:55]
    v_mfma_f32_16x16x32_bf16 v[56:59], v[112:115], v[40:43], v[56:59]
    v_mov_b32 v116, -1
    v_mov_b32 v117, -1
    v_mov_b32 v118, -1
    v_mov_b32 v119, -1
    s_nop 1
    v_rcp_f32 v64, v60
    s_nop 0
    v_pk_mul_f32 v[52:53], v[52:53], v[64:65] op_sel_hi:[1,0]
    v_pk_mul_f32 v[54:55], v[54:55], v[64:65] op_sel_hi:[1,0]
    v_pk_mul_f32 v[56:57], v[56:57], v[64:65] op_sel_hi:[1,0]
    v_pk_mul_f32 v[58:59], v[58:59], v[64:65] op_sel_hi:[1,0]
    v_cvt_pk_bf16_f32 v40, v52, v53
    v_cvt_pk_bf16_f32 v41, v54, v55
    v_cvt_pk_bf16_f32 v42, v56, v57
    v_cvt_pk_bf16_f32 v43, v58, v59
    buffer_store_dwordx4 v[40:43], v5, s[4:7], s41 offen
    buffer_store_dwordx4 v[20:23], v6, s[4:7], s45 offen sc1
    v_dot2c_f32_bf16 v68, s60, v78
    v_dot2c_f32_bf16 v69, s61, v78
    v_dot2c_f32_bf16 v70, s60, v79
    v_dot2c_f32_bf16 v71, s61, v79
    v_dot2c_f32_bf16 v72, s60, v82
    v_dot2c_f32_bf16 v73, s61, v82
    v_dot2c_f32_bf16 v74, s60, v83
    v_dot2c_f32_bf16 v75, s61, v83
    v_cvt_pk_bf16_f32 v124, v68, v69
    v_cvt_pk_bf16_f32 v125, v70, v71
    v_cvt_pk_bf16_f32 v126, v72, v73
    v_cvt_pk_bf16_f32 v127, v74, v75
    buffer_store_dwordx4 v[124:127], v7, s[4:7], s45 offen offset:2048 sc1
    s_barrier
    s_cmp_eq_u32 s21, 72
    s_cbranch_scc1 L_R_done
    ds_read_b128 v[20:23], v9 offset:0
    ds_read_b128 v[24:27], v9 offset:1024
    ds_read_b128 v[28:31], v9 offset:8192
    ds_read_b128 v[32:35], v9 offset:9216
    ds_read_b128 v[108:111], v9 offset:16384
    ds_read_b128 v[112:115], v9 offset:17408
    ds_read_b128 v[68:71], v9 offset:24576
    ds_read_b128 v[72:75], v9 offset:25600
    s_cmp_eq_u32 s21, 9
    s_cselect_b32 s95, 1536, 0
    v_xor_b32 v18, s95, v18
    s_sub_u32 s95, s21, 9
    s_waitcnt vmcnt(2)
    s_cmp_ge_u32 s95, 54
    s_cbranch_scc1 L_R_one
    buffer_load_dwordx4 v[76:79], v8, s[4:7], s42 offen offset:0 sc1
    buffer_load_dwordx4 v[80:83], v8, s[4:7], s42 offen offset:1024 sc1
    buffer_load_dwordx4 v[84:87], v8, s[4:7], s42 offen offset:2048 sc1
    buffer_load_dwordx4 v[88:91], v8, s[4:7], s42 offen offset:3072 sc1
    buffer_load_dwordx4 v[92:95], v8, s[4:7], s92 offen offset:0 sc1
    buffer_load_dwordx4 v[96:99], v8, s[4:7], s92 offen offset:1024 sc1
    s_waitcnt vmcnt(5) lgkmcnt(6)
    s_mov_b32 s88, 1
    s_buffer_atomic_add s88, s[4:7], s54
    v_mfma_f32_16x16x32_bf16 v[52:55], v[20:23], v[76:79], 0
    ds_read_b128 v[20:23], v9 offset:32768
    v_max3_u32 v19, v76, v77, v78
    v_mfma_f32_16x16x32_bf16 v[56:59], v[24:27], v[76:79], 0
    ds_read_b128 v[24:27], v9 offset:33792
    v_max_u32 v19, v19, v79
    buffer_load_dwordx4 v[100:103], v8, s[4:7], s92 offen offset:2048 sc1
    s_waitcnt vmcnt(5) lgkmcnt(6)
    v_mfma_f32_16x16x32_bf16 v[52:55], v[28:31], v[80:83], v[52:55]
    ds_read_b128 v[28:31], v9 offset:40960
    v_max3_u32 v19, v19, v80, v81
    v_mfma_f32_16x16x32_bf16 v[56:59], v[32:35], v[80:83], v[56:59]
    ds_read_b128 v[32:35], v9 offset:41984
    v_max3_u32 v19, v19, v82, v83
    buffer_load_dwordx4 v[104:107], v8, s[4:7], s92 offen offset:3072 sc1
    s_waitcnt vmcnt(5) lgkmcnt(6)
    v_mfma_f32_16x16x32_bf16 v[52:55], v[108:111], v[84:87], v[52:55]
    ds_read_b128 v[108:111], v9 offset:49152
    v_max3_u32 v19, v19, v84, v85
    v_mfma_f32_16x16x32_bf16 v[56:59], v[112:115], v[84:87], v[56:59]
    ds_read_b128 v[112:115], v9 offset:50176
    v_max3_u32 v19, v19, v86, v87
    buffer_load_dwordx4 v[36:39], v8, s[4:7], s93 offen offset:0 sc1
    s_waitcnt vmcnt(5) lgkmcnt(6)
    v_max3_u32 v19, v19, v88, v89
    v_max3_u32 v19, v19, v90, v91
    v_cmp_eq_u32 vcc, -1, v19
    v_mfma_f32_16x16x32_bf16 v[52:55], v[68:71], v[88:91], v[52:55]
    ds_read_b128 v[68:71], v9 offset:57344
    v_mfma_f32_16x16x32_bf16 v[56:59], v[72:75], v[88:91], v[56:59]
    ds_read_b128 v[72:75], v9 offset:58368
    buffer_load_dwordx4 v[40:43], v8, s[4:7], s93 offen offset:1024 sc1
    s_cbranch_vccnz L_R_x3sd0
    s_waitcnt vmcnt(5) lgkmcnt(6)
    v_mfma_f32_16x16x32_bf16 v[60:63], v[20:23], v[92:95], v[52:55]
    ds_read_b128 v[20:23], v14 offset:0
    v_max3_u32 v19, v92, v93, v94
    v_mfma_f32_16x16x32_bf16 v[64:67], v[24:27], v[92:95], v[56:59]
    ds_read_b128 v[24:27], v14 offset:1024
    v_max_u32 v19, v19, v95
    buffer_load_dwordx4 v[44:47], v8, s[4:7], s93 offen offset:2048 sc1
    s_waitcnt vmcnt(5) lgkmcnt(6)
    v_mfma_f32_16x16x32_bf16 v[60:63], v[28:31], v[96:99], v[60:63]
    ds_read_b128 v[28:31], v14 offset:8192
    v_max3_u32 v19, v19, v96, v97
    v_mfma_f32_16x16x32_bf16 v[64:67], v[32:35], v[96:99], v[64:67]
    ds_read_b128 v[32:35], v14 offset:9216
    v_max3_u32 v19, v19, v98, v99
    buffer_load_dwordx4 v[48:51], v8, s[4:7], s93 offen offset:3072 sc1
    s_waitcnt vmcnt(5) lgkmcnt(6)
    v_mfma_f32_16x16x32_bf16 v[60:63], v[108:111], v[100:103], v[60:63]
    ds_read_b128 v[108:111], v14 offset:16384
    v_max3_u32 v19, v19, v100, v101
    v_mfma_f32_16x16x32_bf16 v[64:67], v[112:115], v[100:103], v[64:67]
    ds_read_b128 v[112:115], v14 offset:17408
    v_max3_u32 v19, v19, v102, v103
    buffer_load_dwordx4 v[76:79], v8, s[4:7], s94 offen offset:0 sc1
    s_waitcnt vmcnt(5) lgkmcnt(6)
    v_max3_u32 v19, v19, v104, v105
    v_max3_u32 v19, v19, v106, v107
    v_cmp_eq_u32 vcc, -1, v19
    v_mfma_f32_16x16x32_bf16 v[60:63], v[68:71], v[104:107], v[60:63]
    ds_read_b128 v[68:71], v14 offset:24576
    v_mfma_f32_16x16x32_bf16 v[64:67], v[72:75], v[104:107], v[64:67]
    ds_read_b128 v[72:75], v14 offset:25600
    buffer_load_dwordx4 v[80:83], v8, s[4:7], s94 offen offset:1024 sc1
    s_cbranch_vccnz L_R_x3sd1
    s_waitcnt vmcnt(5) lgkmcnt(6)
    v_mfma_f32_16x16x32_bf16 v[52:55], v[20:23], v[36:39], v[60:63]
    ds_read_b128 v[20:23], v14 offset:32768
    v_max3_u32 v19, v36, v37, v38
    v_mfma_f32_16x16x32_bf16 v[56:59], v[24:27], v[36:39], v[64:67]
    ds_read_b128 v[24:27], v14 offset:33792
    v_max_u32 v19, v19, v39
    buffer_load_dwordx4 v[84:87], v8, s[4:7], s94 offen offset:2048 sc1
    s_waitcnt vmcnt(5) lgkmcnt(6)
    v_mfma_f32_16x16x32_bf16 v[52:55], v[28:31], v[40:43], v[52:55]
    ds_read_b128 v[28:31], v14 offset:40960
    v_max3_u32 v19, v19, v40, v41
    v_mfma_f32_16x16x32_bf16 v[56:59], v[32:35], v[40:43], v[56:59]
    ds_read_b128 v[32:35], v14 offset:41984
    v_max3_u32 v19, v19, v42, v43
    buffer_load_dwordx4 v[88:91], v8, s[4:7], s94 offen offset:3072 sc1
    s_waitcnt vmcnt(5) lgkmcnt(6)
    v_mfma_f32_16x16x32_bf16 v[52:55], v[108:111], v[44:47], v[52:55]
    ds_read_b128 v[108:111], v14 offset:49152
    v_max3_u32 v19, v19, v44, v45
    v_mfma_f32_16x16x32_bf16 v[56:59], v[112:115], v[44:47], v[56:59]
    ds_read_b128 v[112:115], v14 offset:50176
    v_max3_u32 v19, v19, v46, v47
    s_waitcnt vmcnt(4) lgkmcnt(6)
    v_max3_u32 v19, v19, v48, v49
    v_max3_u32 v19, v19, v50, v51
    v_cmp_eq_u32 vcc, -1, v19
    v_mfma_f32_16x16x32_bf16 v[52:55], v[68:71], v[48:51], v[52:55]
    ds_read_b128 v[68:71], v14 offset:57344
    v_mfma_f32_16x16x32_bf16 v[56:59], v[72:75], v[48:51], v[56:59]
    ds_read_b128 v[72:75], v14 offset:58368
    s_cbranch_vccnz L_R_x3sd2
    s_waitcnt vmcnt(3) lgkmcnt(6)
    v_mfma_f32_16x16x32_bf16 v[60:63], v[20:23], v[76:79], v[52:55]
    v_max3_u32 v19, v76, v77, v78
    v_mfma_f32_16x16x32_bf16 v[64:67], v[24:27], v[76:79], v[56:59]
    v_max_u32 v19, v19, v79
    s_waitcnt vmcnt(2) lgkmcnt(4)
    v_mfma_f32_16x16x32_bf16 v[60:63], v[28:31], v[80:83], v[60:63]
    v_max3_u32 v19, v19, v80, v81
    v_mfma_f32_16x16x32_bf16 v[64:67], v[32:35], v[80:83], v[64:67]
    v_max3_u32 v19, v19, v82, v83
    s_waitcnt vmcnt(1) lgkmcnt(2)
    v_mfma_f32_16x16x32_bf16 v[60:63], v[108:111], v[84:87], v[60:63]
    v_max3_u32 v19, v19, v84, v85
    v_mfma_f32_16x16x32_bf16 v[64:67], v[112:115], v[84:87], v[64:67]
    v_max3_u32 v19, v19, v86, v87
    s_waitcnt vmcnt(0) lgkmcnt(0)
    v_max3_u32 v19, v19, v88, v89
    v_max3_u32 v19, v19, v90, v91
    v_cmp_eq_u32 vcc, -1, v19
    v_mfma_f32_16x16x32_bf16 v[60:63], v[68:71], v[88:91], v[60:63]
    v_mfma_f32_16x16x32_bf16 v[64:67], v[72:75], v[88:91], v[64:67]
    s_cbranch_vccnz L_R_x3sd3
L_R_x3bd3:
L_R_red:
    s_add_u32 s21, s21, 1
    ds_read_b64 v[110:111], v10 offset:5120
    s_nop 3
    ds_write_b128 v10, v[60:63] offset:6144
    ds_write_b128 v10, v[64:67] offset:7168
    s_waitcnt lgkmcnt(0)
    s_barrier
    ds_read_b64 v[52:53], v16 offset:6144
    ds_read_b64 v[54:55], v16 offset:14336
    ds_read_b64 v[56:57], v16 offset:22528
    ds_read_b64 v[58:59], v16 offset:30720
    s_waitcnt lgkmcnt(2)
    v_pk_add_f32 v[52:53], v[52:53], v[54:55]
    s_waitcnt lgkmcnt(0)
    v_pk_add_f32 v[56:57], v[56:57], v[58:59]
    v_pk_add_f32 v[52:53], v[52:53], v[56:57]
    v_cvt_pk_bf16_f32 v52, v52, v53
    v_cndmask_b32 v52, v52, v17, s[58:59]
    buffer_store_dword v52, v1, s[4:7], s34 offen
    buffer_store_dword v52, v1, s[4:7], s35 offen sc1
    s_branch L_R_step
L_R_o1:
    s_cmp_gt_u32 s21, 63
    s_cselect_b32 s94, 128, 0
    s_sub_u32 s95, s33, s32
    s_add_u32 s32, s32, s94
    v_bfe_u32 v108, v0, 7, 1
    v_mad_u32_u24 v108, v108, s95, v15
    s_waitcnt vmcnt(0)
    s_lshl_b32 s93, s92, 19
    s_add_u32 s37, s26, s93
    s_add_u32 s38, s27, s93
    s_add_u32 s39, s28, s93
    s_add_u32 s40, s29, s93
    s_xor_b32 s93, s93, 0x100000
    s_add_u32 s48, s26, s93
    s_add_u32 s49, s27, s93
    s_add_u32 s92, s21, 1
    s_and_b32 s92, s92, 3
    s_lshl_b32 s93, s92, 16
    s_add_u32 s34, s24, s93
    s_lshl_b32 s93, s92, 17
    s_add_u32 s35, s25, s93
    s_cmp_eq_u32 s21, 8
    s_cselect_b32 s59, -1, 0
    s_mov_b32 s58, 0
    s_mul_i32 s92, s19, 9
    s_sub_u32 s92, s21, s92
    s_add_u32 s55, s92, 1
    s_and_b32 s93, s92, 31
    s_lshl_b32 s93, s93, 5
    s_add_u32 s93, s93, s63
    s_lshl_b32 s94, s93, 13
    s_add_u32 s94, s94, s84
    s_add_u32 s43, s94, 4194304
    s_add_u32 s44, s94, 37748736
    s_and_b32 s94, s92, 31
    s_lshl_b32 s94, s94, 18
    s_add_u32 s45, s94, s96
    s_bfe_u32 s94, s92, 0x20003
    s_lshr_b32 s94, s85, s94
    s_and_b32 s94, s94, 8192
    s_add_u32 s45, s45, s94
    s_cmp_lt_u32 s92, 64
    s_cselect_b32 s43, s43, 268435456
    s_cselect_b32 s44, s44, 268435456
    s_cselect_b32 s54, s89, 268435456
    s_cselect_b32 s47, s55, 0
    buffer_load_dwordx4 v[20:23], v108, s[4:7], s32 offen offset:0 sc1
    buffer_load_dwordx4 v[24:27], v108, s[4:7], s32 offen offset:1024 sc1
    buffer_load_dwordx4 v[28:31], v108, s[4:7], s32 offen offset:2048 sc1
    buffer_load_dwordx4 v[32:35], v108, s[4:7], s32 offen offset:3072 sc1
    s_buffer_load_dwordx2 s[86:87], s[4:7], s97 glc
L_R_o1r:
    s_waitcnt vmcnt(3)
    ds_write_b128 v10, v[20:23] offset:0
    v_max3_u32 v19, v20, v21, v22
    v_max_u32 v19, v19, v23
    s_waitcnt vmcnt(2)
    ds_write_b128 v10, v[24:27] offset:1024
    v_max3_u32 v19, v19, v24, v25
    v_max3_u32 v19, v19, v26, v27
    s_waitcnt vmcnt(1)
    ds_write_b128 v10, v[28:31] offset:2048
    v_max3_u32 v19, v19, v28, v29
    v_max3_u32 v19, v19, v30, v31
    s_waitcnt vmcnt(0)
    ds_write_b128 v10, v[32:35] offset:3072
    v_max3_u32 v19, v19, v32, v33
    v_max3_u32 v19, v19, v34, v35
    v_cmp_eq_u32 vcc, -1, v19
    v_mfma_f32_16x16x32_bf16 v[52:55], a[0:3], v[20:23], 0
    v_mfma_f32_16x16x32_bf16 v[56:59], a[4:7], v[20:23], 0
    s_cbranch_vccnz L_rt_77
    s_branch L_R_o1b
L_R_o2:
    v_add_f32_dpp v52, v52, v52 row_ror:8 row_mask:0xf bank_mask:0xf
    v_add_f32_dpp v53, v53, v53 row_ror:8 row_mask:0xf bank_mask:0xf
    v_add_f32_dpp v54, v54, v54 row_ror:8 row_mask:0xf bank_mask:0xf
    v_add_f32_dpp v55, v55, v55 row_ror:8 row_mask:0xf bank_mask:0xf
    v_add_f32_dpp v56, v56, v56 row_ror:8 row_mask:0xf bank_mask:0xf
    v_add_f32_dpp v57, v57, v57 row_ror:8 row_mask:0xf bank_mask:0xf
    v_add_f32_dpp v58, v58, v58 row_ror:8 row_mask:0xf bank_mask:0xf
    v_add_f32_dpp v59, v59, v59 row_ror:8 row_mask:0xf bank_mask:0xf
    v_cvt_pk_bf16_f32 v116, v52, v53
    v_cvt_pk_bf16_f32 v117, v54, v55
    v_cvt_pk_bf16_f32 v118, v56, v57
    v_cvt_pk_bf16_f32 v119, v58, v59
    buffer_store_dwordx4 v[116:119], v3, s[4:7], s37 offen
    v_mfma_f32_16x16x32_bf16 v[72:75], v[36:39], v[228:231], 0
    v_add_f32_dpp v60, v60, v60 row_ror:8 row_mask:0xf bank_mask:0xf
    v_add_f32_dpp v61, v61, v61 row_ror:8 row_mask:0xf bank_mask:0xf
    v_add_f32_dpp v62, v62, v62 row_ror:8 row_mask:0xf bank_mask:0xf
    v_add_f32_dpp v63, v63, v63 row_ror:8 row_mask:0xf bank_mask:0xf
    v_add_f32_dpp v64, v64, v64 row_ror:8 row_mask:0xf bank_mask:0xf
    v_add_f32_dpp v65, v65, v65 row_ror:8 row_mask:0xf bank_mask:0xf
    v_add_f32_dpp v66, v66, v66 row_ror:8 row_mask:0xf bank_mask:0xf
    v_add_f32_dpp v67, v67, v67 row_ror:8 row_mask:0xf bank_mask:0xf
    v_cvt_pk_bf16_f32 v120, v60, v61
    v_cvt_pk_bf16_f32 v121, v62, v63
    v_cvt_pk_bf16_f32 v122, v64, v65
    v_cvt_pk_bf16_f32 v123, v66, v67
    buffer_store_dwordx4 v[120:123], v2, s[4:7], s37 offen
    s_branch L_R_o2b
L_R_o3:
    v_permlane32_swap_b32 v68, v72
    v_permlane32_swap_b32 v69, v73
    v_permlane32_swap_b32 v70, v74
    v_permlane32_swap_b32 v71, v75
    v_add_f32 v68, v68, v72
    v_add_f32 v69, v69, v73
    v_add_f32 v70, v70, v74
    v_add_f32 v71, v71, v75
    v_mov_b32 v72, v68
    v_mov_b32 v73, v69
    v_mov_b32 v74, v70
    v_mov_b32 v75, v71
    v_permlane32_swap_b32 v68, v72
    v_permlane32_swap_b32 v69, v73
    v_permlane32_swap_b32 v70, v74
    v_permlane32_swap_b32 v71, v75
    s_branch L_R_o3b
L_R_one:
    s_waitcnt vmcnt(0)
    buffer_load_dwordx4 v[76:79], v18, s[4:7], s42 offen offset:0 sc1
    buffer_load_dwordx4 v[80:83], v18, s[4:7], s42 offen offset:2048 sc1
    buffer_load_dwordx4 v[84:87], v18, s[4:7], s92 offen offset:0 sc1
    buffer_load_dwordx4 v[88:91], v18, s[4:7], s92 offen offset:2048 sc1
    s_waitcnt vmcnt(3) lgkmcnt(6)
    s_mov_b32 s88, 1
    s_buffer_atomic_add s88, s[4:7], s54
    v_mfma_f32_16x16x32_bf16 v[36:39], v[20:23], v[76:79], 0
    ds_read_b128 v[20:23], v9 offset:32768
    v_max3_u32 v19, v76, v77, v78
    v_mfma_f32_16x16x32_bf16 v[40:43], v[24:27], v[76:79], 0
    ds_read_b128 v[24:27], v9 offset:33792
    v_max_u32 v19, v19, v79
    buffer_load_dwordx4 v[92:95], v18, s[4:7], s93 offen offset:0 sc1
    s_waitcnt lgkmcnt(6)
    v_mfma_f32_16x16x32_bf16 v[44:47], v[28:31], v[76:79], 0
    ds_read_b128 v[28:31], v9 offset:40960
    v_mfma_f32_16x16x32_bf16 v[48:51], v[32:35], v[76:79], 0
    ds_read_b128 v[32:35], v9 offset:41984
    s_waitcnt vmcnt(3) lgkmcnt(6)
    v_mfma_f32_16x16x32_bf16 v[36:39], v[108:111], v[80:83], v[36:39]
    ds_read_b128 v[108:111], v9 offset:49152
    v_max3_u32 v19, v19, v80, v81
    v_mfma_f32_16x16x32_bf16 v[40:43], v[112:115], v[80:83], v[40:43]
    ds_read_b128 v[112:115], v9 offset:50176
    v_max3_u32 v19, v19, v82, v83
    buffer_load_dwordx4 v[96:99], v18, s[4:7], s93 offen offset:2048 sc1
    s_waitcnt lgkmcnt(6)
    v_mfma_f32_16x16x32_bf16 v[44:47], v[68:71], v[80:83], v[44:47]
    ds_read_b128 v[68:71], v9 offset:57344
    v_cmp_eq_u32 vcc, -1, v19
    v_mfma_f32_16x16x32_bf16 v[48:51], v[72:75], v[80:83], v[48:51]
    ds_read_b128 v[72:75], v9 offset:58368
    s_cbranch_vccnz L_R_x3so0
L_R_x3bo0:
    s_waitcnt vmcnt(3) lgkmcnt(6)
    v_mfma_f32_16x16x32_bf16 v[52:55], v[20:23], v[84:87], v[36:39]
    ds_read_b128 v[20:23], v14 offset:0
    v_max3_u32 v19, v84, v85, v86
    v_mfma_f32_16x16x32_bf16 v[56:59], v[24:27], v[84:87], v[40:43]
    ds_read_b128 v[24:27], v14 offset:1024
    v_max_u32 v19, v19, v87
    buffer_load_dwordx4 v[100:103], v18, s[4:7], s94 offen offset:0 sc1
    s_waitcnt lgkmcnt(6)
    v_mfma_f32_16x16x32_bf16 v[60:63], v[28:31], v[84:87], v[44:47]
    ds_read_b128 v[28:31], v14 offset:8192
    v_mfma_f32_16x16x32_bf16 v[64:67], v[32:35], v[84:87], v[48:51]
    ds_read_b128 v[32:35], v14 offset:9216
    s_waitcnt vmcnt(3) lgkmcnt(6)
    v_mfma_f32_16x16x32_bf16 v[52:55], v[108:111], v[88:91], v[52:55]
    ds_read_b128 v[108:111], v14 offset:16384
    v_max3_u32 v19, v19, v88, v89
    v_mfma_f32_16x16x32_bf16 v[56:59], v[112:115], v[88:91], v[56:59]
    ds_read_b128 v[112:115], v14 offset:17408
    v_max3_u32 v19, v19, v90, v91
    buffer_load_dwordx4 v[104:107], v18, s[4:7], s94 offen offset:2048 sc1
    s_waitcnt lgkmcnt(6)
    v_mfma_f32_16x16x32_bf16 v[60:63], v[68:71], v[88:91], v[60:63]
    ds_read_b128 v[68:71], v14 offset:24576
    v_cmp_eq_u32 vcc, -1, v19
    v_mfma_f32_16x16x32_bf16 v[64:67], v[72:75], v[88:91], v[64:67]
    ds_read_b128 v[72:75], v14 offset:25600
    s_cbranch_vccnz L_R_x3so1
L_R_x3bo1:
    s_waitcnt vmcnt(3) lgkmcnt(6)
    v_mfma_f32_16x16x32_bf16 v[36:39], v[20:23], v[92:95], v[52:55]
    ds_read_b128 v[20:23], v14 offset:32768
    v_max3_u32 v19, v92, v93, v94
    v_mfma_f32_16x16x32_bf16 v[40:43], v[24:27], v[92:95], v[56:59]
    ds_read_b128 v[24:27], v14 offset:33792
    v_max_u32 v19, v19, v95
    s_waitcnt lgkmcnt(6)
    v_mfma_f32_16x16x32_bf16 v[44:47], v[28:31], v[92:95], v[60:63]
    ds_read_b128 v[28:31], v14 offset:40960
    v_mfma_f32_16x16x32_bf16 v[48:51], v[32:35], v[92:95], v[64:67]
    ds_read_b128 v[32:35], v14 offset:41984
    s_waitcnt vmcnt(2) lgkmcnt(6)
    v_mfma_f32_16x16x32_bf16 v[36:39], v[108:111], v[96:99], v[36:39]
    ds_read_b128 v[108:111], v14 offset:49152
    v_max3_u32 v19, v19, v96, v97
    v_mfma_f32_16x16x32_bf16 v[40:43], v[112:115], v[96:99], v[40:43]
    ds_read_b128 v[112:115], v14 offset:50176
    v_max3_u32 v19, v19, v98, v99
    s_waitcnt lgkmcnt(6)
    v_mfma_f32_16x16x32_bf16 v[44:47], v[68:71], v[96:99], v[44:47]
    ds_read_b128 v[68:71], v14 offset:57344
    v_cmp_eq_u32 vcc, -1, v19
    v_mfma_f32_16x16x32_bf16 v[48:51], v[72:75], v[96:99], v[48:51]
    ds_read_b128 v[72:75], v14 offset:58368
    s_cbranch_vccnz L_R_x3so2
L_R_x3bo2:
    s_waitcnt vmcnt(1) lgkmcnt(6)
    v_mfma_f32_16x16x32_bf16 v[52:55], v[20:23], v[100:103], v[36:39]
    v_max3_u32 v19, v100, v101, v102
    v_mfma_f32_16x16x32_bf16 v[56:59], v[24:27], v[100:103], v[40:43]
    v_max_u32 v19, v19, v103
    s_waitcnt lgkmcnt(4)
    v_mfma_f32_16x16x32_bf16 v[60:63], v[28:31], v[100:103], v[44:47]
    v_mfma_f32_16x16x32_bf16 v[64:67], v[32:35], v[100:103], v[48:51]
    s_waitcnt vmcnt(0) lgkmcnt(2)
    v_mfma_f32_16x16x32_bf16 v[52:55], v[108:111], v[104:107], v[52:55]
    v_max3_u32 v19, v19, v104, v105
    v_mfma_f32_16x16x32_bf16 v[56:59], v[112:115], v[104:107], v[56:59]
    v_max3_u32 v19, v19, v106, v107
    s_waitcnt lgkmcnt(0)
    v_mfma_f32_16x16x32_bf16 v[60:63], v[68:71], v[104:107], v[60:63]
    v_cmp_eq_u32 vcc, -1, v19
    v_mfma_f32_16x16x32_bf16 v[64:67], v[72:75], v[104:107], v[64:67]
    s_cbranch_vccnz L_R_x3so3
L_R_x3bo3:
    s_nop 5
    v_add_f32_dpp v60, v60, v52 row_ror:8 row_mask:0xf bank_mask:0xf
    v_add_f32_dpp v61, v61, v53 row_ror:8 row_mask:0xf bank_mask:0xf
    v_add_f32_dpp v62, v62, v54 row_ror:8 row_mask:0xf bank_mask:0xf
    v_add_f32_dpp v63, v63, v55 row_ror:8 row_mask:0xf bank_mask:0xf
    v_add_f32_dpp v64, v64, v56 row_ror:8 row_mask:0xf bank_mask:0xf
    v_add_f32_dpp v65, v65, v57 row_ror:8 row_mask:0xf bank_mask:0xf
    v_add_f32_dpp v66, v66, v58 row_ror:8 row_mask:0xf bank_mask:0xf
    v_add_f32_dpp v67, v67, v59 row_ror:8 row_mask:0xf bank_mask:0xf
    s_branch L_R_red
L_R_x3sd0:
    s_waitcnt vmcnt(5) lgkmcnt(6)
    v_mfma_f32_16x16x32_bf16 v[52:55], v[20:23], v[92:95], 0
    ds_read_b128 v[20:23], v14 offset:0
    v_max3_u32 v19, v92, v93, v94
    v_mfma_f32_16x16x32_bf16 v[56:59], v[24:27], v[92:95], 0
    ds_read_b128 v[24:27], v14 offset:1024
    v_max_u32 v19, v19, v95
    buffer_load_dwordx4 v[44:47], v8, s[4:7], s93 offen offset:2048 sc1
    s_waitcnt vmcnt(5) lgkmcnt(6)
    v_mfma_f32_16x16x32_bf16 v[52:55], v[28:31], v[96:99], v[52:55]
    ds_read_b128 v[28:31], v14 offset:8192
    v_max3_u32 v19, v19, v96, v97
    v_mfma_f32_16x16x32_bf16 v[56:59], v[32:35], v[96:99], v[56:59]
    ds_read_b128 v[32:35], v14 offset:9216
    v_max3_u32 v19, v19, v98, v99
    buffer_load_dwordx4 v[48:51], v8, s[4:7], s93 offen offset:3072 sc1
    s_waitcnt vmcnt(5) lgkmcnt(6)
    v_mfma_f32_16x16x32_bf16 v[52:55], v[108:111], v[100:103], v[52:55]
    ds_read_b128 v[108:111], v14 offset:16384
    v_max3_u32 v19, v19, v100, v101
    v_mfma_f32_16x16x32_bf16 v[56:59], v[112:115], v[100:103], v[56:59]
    ds_read_b128 v[112:115], v14 offset:17408
    v_max3_u32 v19, v19, v102, v103
    buffer_load_dwordx4 v[76:79], v8, s[4:7], s94 offen offset:0 sc1
    s_waitcnt vmcnt(5) lgkmcnt(6)
    v_max3_u32 v19, v19, v104, v105
    v_max3_u32 v19, v19, v106, v107
    v_cmp_eq_u32 vcc, -1, v19
    v_mfma_f32_16x16x32_bf16 v[52:55], v[68:71], v[104:107], v[52:55]
    ds_read_b128 v[68:71], v14 offset:24576
    v_mfma_f32_16x16x32_bf16 v[56:59], v[72:75], v[104:107], v[56:59]
    ds_read_b128 v[72:75], v14 offset:25600
    buffer_load_dwordx4 v[80:83], v8, s[4:7], s94 offen offset:1024 sc1
    s_cbranch_vccnz L_R_x3sd0_1
    s_waitcnt vmcnt(5) lgkmcnt(6)
    v_mfma_f32_16x16x32_bf16 v[60:63], v[20:23], v[36:39], v[52:55]
    ds_read_b128 v[20:23], v14 offset:32768
    v_max3_u32 v19, v36, v37, v38
    v_mfma_f32_16x16x32_bf16 v[64:67], v[24:27], v[36:39], v[56:59]
    ds_read_b128 v[24:27], v14 offset:33792
    v_max_u32 v19, v19, v39
    buffer_load_dwordx4 v[84:87], v8, s[4:7], s94 offen offset:2048 sc1
    s_waitcnt vmcnt(5) lgkmcnt(6)
    v_mfma_f32_16x16x32_bf16 v[60:63], v[28:31], v[40:43], v[60:63]
    ds_read_b128 v[28:31], v14 offset:40960
    v_max3_u32 v19, v19, v40, v41
    v_mfma_f32_16x16x32_bf16 v[64:67], v[32:35], v[40:43], v[64:67]
    ds_read_b128 v[32:35], v14 offset:41984
    v_max3_u32 v19, v19, v42, v43
    buffer_load_dwordx4 v[88:91], v8, s[4:7], s94 offen offset:3072 sc1
    s_waitcnt vmcnt(5) lgkmcnt(6)
    v_mfma_f32_16x16x32_bf16 v[60:63], v[108:111], v[44:47], v[60:63]
    ds_read_b128 v[108:111], v14 offset:49152
    v_max3_u32 v19, v19, v44, v45
    v_mfma_f32_16x16x32_bf16 v[64:67], v[112:115], v[44:47], v[64:67]
    ds_read_b128 v[112:115], v14 offset:50176
    v_max3_u32 v19, v19, v46, v47
    buffer_load_dwordx4 v[92:95], v8, s[4:7], s42 offen offset:0 sc1
    s_waitcnt vmcnt(5) lgkmcnt(6)
    v_max3_u32 v19, v19, v48, v49
    v_max3_u32 v19, v19, v50, v51
    v_cmp_eq_u32 vcc, -1, v19
    v_mfma_f32_16x16x32_bf16 v[60:63], v[68:71], v[48:51], v[60:63]
    ds_read_b128 v[68:71], v14 offset:57344
    v_mfma_f32_16x16x32_bf16 v[64:67], v[72:75], v[48:51], v[64:67]
    ds_read_b128 v[72:75], v14 offset:58368
    buffer_load_dwordx4 v[96:99], v8, s[4:7], s42 offen offset:1024 sc1
    s_cbranch_vccnz L_R_x3sd0_2
L_R_x3bd0_2:
    s_waitcnt vmcnt(5) lgkmcnt(6)
    v_mfma_f32_16x16x32_bf16 v[52:55], v[20:23], v[76:79], v[60:63]
    ds_read_b128 v[20:23], v9 offset:0
    v_max3_u32 v19, v76, v77, v78
    v_mfma_f32_16x16x32_bf16 v[56:59], v[24:27], v[76:79], v[64:67]
    ds_read_b128 v[24:27], v9 offset:1024
    v_max_u32 v19, v19, v79
    buffer_load_dwordx4 v[100:103], v8, s[4:7], s42 offen offset:2048 sc1
    s_waitcnt vmcnt(5) lgkmcnt(6)
    v_mfma_f32_16x16x32_bf16 v[52:55], v[28:31], v[80:83], v[52:55]
    ds_read_b128 v[28:31], v9 offset:8192
    v_max3_u32 v19, v19, v80, v81
    v_mfma_f32_16x16x32_bf16 v[56:59], v[32:35], v[80:83], v[56:59]
    ds_read_b128 v[32:35], v9 offset:9216
    v_max3_u32 v19, v19, v82, v83
    buffer_load_dwordx4 v[104:107], v8, s[4:7], s42 offen offset:3072 sc1
    s_waitcnt vmcnt(5) lgkmcnt(6)
    v_mfma_f32_16x16x32_bf16 v[52:55], v[108:111], v[84:87], v[52:55]
    ds_read_b128 v[108:111], v9 offset:16384
    v_max3_u32 v19, v19, v84, v85
    v_mfma_f32_16x16x32_bf16 v[56:59], v[112:115], v[84:87], v[56:59]
    ds_read_b128 v[112:115], v9 offset:17408
    v_max3_u32 v19, v19, v86, v87
    s_waitcnt vmcnt(4) lgkmcnt(6)
    v_max3_u32 v19, v19, v88, v89
    v_max3_u32 v19, v19, v90, v91
    v_cmp_eq_u32 vcc, -1, v19
    v_mfma_f32_16x16x32_bf16 v[52:55], v[68:71], v[88:91], v[52:55]
    ds_read_b128 v[68:71], v9 offset:24576
    v_mfma_f32_16x16x32_bf16 v[56:59], v[72:75], v[88:91], v[56:59]
    ds_read_b128 v[72:75], v9 offset:25600
    s_cbranch_vccnz L_R_x3sd0_3
L_R_x3bd0_3:
    s_waitcnt vmcnt(3) lgkmcnt(6)
    v_mfma_f32_16x16x32_bf16 v[60:63], v[20:23], v[92:95], v[52:55]
    v_max3_u32 v19, v92, v93, v94
    v_mfma_f32_16x16x32_bf16 v[64:67], v[24:27], v[92:95], v[56:59]
    v_max_u32 v19, v19, v95
    s_waitcnt vmcnt(2) lgkmcnt(4)
    v_mfma_f32_16x16x32_bf16 v[60:63], v[28:31], v[96:99], v[60:63]
    v_max3_u32 v19, v19, v96, v97
    v_mfma_f32_16x16x32_bf16 v[64:67], v[32:35], v[96:99], v[64:67]
    v_max3_u32 v19, v19, v98, v99
    s_waitcnt vmcnt(1) lgkmcnt(2)
    v_mfma_f32_16x16x32_bf16 v[60:63], v[108:111], v[100:103], v[60:63]
    v_max3_u32 v19, v19, v100, v101
    v_mfma_f32_16x16x32_bf16 v[64:67], v[112:115], v[100:103], v[64:67]
    v_max3_u32 v19, v19, v102, v103
    s_waitcnt vmcnt(0) lgkmcnt(0)
    v_max3_u32 v19, v19, v104, v105
    v_max3_u32 v19, v19, v106, v107
    v_cmp_eq_u32 vcc, -1, v19
    v_mfma_f32_16x16x32_bf16 v[60:63], v[68:71], v[104:107], v[60:63]
    v_mfma_f32_16x16x32_bf16 v[64:67], v[72:75], v[104:107], v[64:67]
    s_cbranch_vccnz L_R_x3sd0_4
L_R_x3bd0_4:
    s_branch L_R_red
L_R_x3sd1:
    s_waitcnt vmcnt(5) lgkmcnt(6)
    v_mfma_f32_16x16x32_bf16 v[60:63], v[20:23], v[36:39], v[52:55]
    ds_read_b128 v[20:23], v14 offset:32768
    v_max3_u32 v19, v36, v37, v38
    v_mfma_f32_16x16x32_bf16 v[64:67], v[24:27], v[36:39], v[56:59]
    ds_read_b128 v[24:27], v14 offset:33792
    v_max_u32 v19, v19, v39
    buffer_load_dwordx4 v[84:87], v8, s[4:7], s94 offen offset:2048 sc1
    s_waitcnt vmcnt(5) lgkmcnt(6)
    v_mfma_f32_16x16x32_bf16 v[60:63], v[28:31], v[40:43], v[60:63]
    ds_read_b128 v[28:31], v14 offset:40960
    v_max3_u32 v19, v19, v40, v41
    v_mfma_f32_16x16x32_bf16 v[64:67], v[32:35], v[40:43], v[64:67]
    ds_read_b128 v[32:35], v14 offset:41984
    v_max3_u32 v19, v19, v42, v43
    buffer_load_dwordx4 v[88:91], v8, s[4:7], s94 offen offset:3072 sc1
    s_waitcnt vmcnt(5) lgkmcnt(6)
    v_mfma_f32_16x16x32_bf16 v[60:63], v[108:111], v[44:47], v[60:63]
    ds_read_b128 v[108:111], v14 offset:49152
    v_max3_u32 v19, v19, v44, v45
    v_mfma_f32_16x16x32_bf16 v[64:67], v[112:115], v[44:47], v[64:67]
    ds_read_b128 v[112:115], v14 offset:50176
    v_max3_u32 v19, v19, v46, v47
    buffer_load_dwordx4 v[92:95], v8, s[4:7], s92 offen offset:0 sc1
    s_waitcnt vmcnt(5) lgkmcnt(6)
    v_max3_u32 v19, v19, v48, v49
    v_max3_u32 v19, v19, v50, v51
    v_cmp_eq_u32 vcc, -1, v19
    v_mfma_f32_16x16x32_bf16 v[60:63], v[68:71], v[48:51], v[60:63]
    ds_read_b128 v[68:71], v14 offset:57344
    v_mfma_f32_16x16x32_bf16 v[64:67], v[72:75], v[48:51], v[64:67]
    ds_read_b128 v[72:75], v14 offset:58368
    buffer_load_dwordx4 v[96:99], v8, s[4:7], s92 offen offset:1024 sc1
    s_cbranch_vccnz L_R_x3sd1_2
L_R_x3bd1_2:
    s_waitcnt vmcnt(5) lgkmcnt(6)
    v_mfma_f32_16x16x32_bf16 v[52:55], v[20:23], v[76:79], v[60:63]
    ds_read_b128 v[20:23], v9 offset:32768
    v_max3_u32 v19, v76, v77, v78
    v_mfma_f32_16x16x32_bf16 v[56:59], v[24:27], v[76:79], v[64:67]
    ds_read_b128 v[24:27], v9 offset:33792
    v_max_u32 v19, v19, v79
    buffer_load_dwordx4 v[100:103], v8, s[4:7], s92 offen offset:2048 sc1
    s_waitcnt vmcnt(5) lgkmcnt(6)
    v_mfma_f32_16x16x32_bf16 v[52:55], v[28:31], v[80:83], v[52:55]
    ds_read_b128 v[28:31], v9 offset:40960
    v_max3_u32 v19, v19, v80, v81
    v_mfma_f32_16x16x32_bf16 v[56:59], v[32:35], v[80:83], v[56:59]
    ds_read_b128 v[32:35], v9 offset:41984
    v_max3_u32 v19, v19, v82, v83
    buffer_load_dwordx4 v[104:107], v8, s[4:7], s92 offen offset:3072 sc1
    s_waitcnt vmcnt(5) lgkmcnt(6)
    v_mfma_f32_16x16x32_bf16 v[52:55], v[108:111], v[84:87], v[52:55]
    ds_read_b128 v[108:111], v9 offset:49152
    v_max3_u32 v19, v19, v84, v85
    v_mfma_f32_16x16x32_bf16 v[56:59], v[112:115], v[84:87], v[56:59]
    ds_read_b128 v[112:115], v9 offset:50176
    v_max3_u32 v19, v19, v86, v87
    s_waitcnt vmcnt(4) lgkmcnt(6)
    v_max3_u32 v19, v19, v88, v89
    v_max3_u32 v19, v19, v90, v91
    v_cmp_eq_u32 vcc, -1, v19
    v_mfma_f32_16x16x32_bf16 v[52:55], v[68:71], v[88:91], v[52:55]
    ds_read_b128 v[68:71], v9 offset:57344
    v_mfma_f32_16x16x32_bf16 v[56:59], v[72:75], v[88:91], v[56:59]
    ds_read_b128 v[72:75], v9 offset:58368
    s_cbranch_vccnz L_R_x3sd1_3
L_R_x3bd1_3:
    s_waitcnt vmcnt(3) lgkmcnt(6)
    v_mfma_f32_16x16x32_bf16 v[60:63], v[20:23], v[92:95], v[52:55]
    v_max3_u32 v19, v92, v93, v94
    v_mfma_f32_16x16x32_bf16 v[64:67], v[24:27], v[92:95], v[56:59]
    v_max_u32 v19, v19, v95
    s_waitcnt vmcnt(2) lgkmcnt(4)
    v_mfma_f32_16x16x32_bf16 v[60:63], v[28:31], v[96:99], v[60:63]
    v_max3_u32 v19, v19, v96, v97
    v_mfma_f32_16x16x32_bf16 v[64:67], v[32:35], v[96:99], v[64:67]
    v_max3_u32 v19, v19, v98, v99
    s_waitcnt vmcnt(1) lgkmcnt(2)
    v_mfma_f32_16x16x32_bf16 v[60:63], v[108:111], v[100:103], v[60:63]
    v_max3_u32 v19, v19, v100, v101
    v_mfma_f32_16x16x32_bf16 v[64:67], v[112:115], v[100:103], v[64:67]
    v_max3_u32 v19, v19, v102, v103
    s_waitcnt vmcnt(0) lgkmcnt(0)
    v_max3_u32 v19, v19, v104, v105
    v_max3_u32 v19, v19, v106, v107
    v_cmp_eq_u32 vcc, -1, v19
    v_mfma_f32_16x16x32_bf16 v[60:63], v[68:71], v[104:107], v[60:63]
    v_mfma_f32_16x16x32_bf16 v[64:67], v[72:75], v[104:107], v[64:67]
    s_cbranch_vccnz L_R_x3sd1_4
L_R_x3bd1_4:
    s_branch L_R_red
L_R_x3sd2:
    buffer_load_dwordx4 v[92:95], v8, s[4:7], s93 offen offset:0 sc1
    buffer_load_dwordx4 v[96:99], v8, s[4:7], s93 offen offset:1024 sc1
    s_waitcnt vmcnt(5) lgkmcnt(6)
    v_mfma_f32_16x16x32_bf16 v[52:55], v[20:23], v[76:79], v[60:63]
    ds_read_b128 v[20:23], v14 offset:0
    v_max3_u32 v19, v76, v77, v78
    v_mfma_f32_16x16x32_bf16 v[56:59], v[24:27], v[76:79], v[64:67]
    ds_read_b128 v[24:27], v14 offset:1024
    v_max_u32 v19, v19, v79
    buffer_load_dwordx4 v[100:103], v8, s[4:7], s93 offen offset:2048 sc1
    s_waitcnt vmcnt(5) lgkmcnt(6)
    v_mfma_f32_16x16x32_bf16 v[52:55], v[28:31], v[80:83], v[52:55]
    ds_read_b128 v[28:31], v14 offset:8192
    v_max3_u32 v19, v19, v80, v81
    v_mfma_f32_16x16x32_bf16 v[56:59], v[32:35], v[80:83], v[56:59]
    ds_read_b128 v[32:35], v14 offset:9216
    v_max3_u32 v19, v19, v82, v83
    buffer_load_dwordx4 v[104:107], v8, s[4:7], s93 offen offset:3072 sc1
    s_waitcnt vmcnt(5) lgkmcnt(6)
    v_mfma_f32_16x16x32_bf16 v[52:55], v[108:111], v[84:87], v[52:55]
    ds_read_b128 v[108:111], v14 offset:16384
    v_max3_u32 v19, v19, v84, v85
    v_mfma_f32_16x16x32_bf16 v[56:59], v[112:115], v[84:87], v[56:59]
    ds_read_b128 v[112:115], v14 offset:17408
    v_max3_u32 v19, v19, v86, v87
    s_waitcnt vmcnt(4) lgkmcnt(6)
    v_max3_u32 v19, v19, v88, v89
    v_max3_u32 v19, v19, v90, v91
    v_cmp_eq_u32 vcc, -1, v19
    v_mfma_f32_16x16x32_bf16 v[52:55], v[68:71], v[88:91], v[52:55]
    ds_read_b128 v[68:71], v14 offset:24576
    v_mfma_f32_16x16x32_bf16 v[56:59], v[72:75], v[88:91], v[56:59]
    ds_read_b128 v[72:75], v14 offset:25600
    s_cbranch_vccnz L_R_x3sd2_3
L_R_x3bd2_3:
    s_waitcnt vmcnt(3) lgkmcnt(6)
    v_mfma_f32_16x16x32_bf16 v[60:63], v[20:23], v[92:95], v[52:55]
    v_max3_u32 v19, v92, v93, v94
    v_mfma_f32_16x16x32_bf16 v[64:67], v[24:27], v[92:95], v[56:59]
    v_max_u32 v19, v19, v95
    s_waitcnt vmcnt(2) lgkmcnt(4)
    v_mfma_f32_16x16x32_bf16 v[60:63], v[28:31], v[96:99], v[60:63]
    v_max3_u32 v19, v19, v96, v97
    v_mfma_f32_16x16x32_bf16 v[64:67], v[32:35], v[96:99], v[64:67]
    v_max3_u32 v19, v19, v98, v99
    s_waitcnt vmcnt(1) lgkmcnt(2)
    v_mfma_f32_16x16x32_bf16 v[60:63], v[108:111], v[100:103], v[60:63]
    v_max3_u32 v19, v19, v100, v101
    v_mfma_f32_16x16x32_bf16 v[64:67], v[112:115], v[100:103], v[64:67]
    v_max3_u32 v19, v19, v102, v103
    s_waitcnt vmcnt(0) lgkmcnt(0)
    v_max3_u32 v19, v19, v104, v105
    v_max3_u32 v19, v19, v106, v107
    v_cmp_eq_u32 vcc, -1, v19
    v_mfma_f32_16x16x32_bf16 v[60:63], v[68:71], v[104:107], v[60:63]
    v_mfma_f32_16x16x32_bf16 v[64:67], v[72:75], v[104:107], v[64:67]
    s_cbranch_vccnz L_R_x3sd2_4
L_R_x3bd2_4:
    s_branch L_R_red
L_R_x3sd0_1:
    s_waitcnt vmcnt(5) lgkmcnt(6)
    v_mfma_f32_16x16x32_bf16 v[52:55], v[20:23], v[36:39], 0
    ds_read_b128 v[20:23], v14 offset:32768
    v_max3_u32 v19, v36, v37, v38
    v_mfma_f32_16x16x32_bf16 v[56:59], v[24:27], v[36:39], 0
    ds_read_b128 v[24:27], v14 offset:33792
    v_max_u32 v19, v19, v39
    buffer_load_dwordx4 v[84:87], v8, s[4:7], s94 offen offset:2048 sc1
    s_waitcnt vmcnt(5) lgkmcnt(6)
    v_mfma_f32_16x16x32_bf16 v[52:55], v[28:31], v[40:43], v[52:55]
    ds_read_b128 v[28:31], v14 offset:40960
    v_max3_u32 v19, v19, v40, v41
    v_mfma_f32_16x16x32_bf16 v[56:59], v[32:35], v[40:43], v[56:59]
    ds_read_b128 v[32:35], v14 offset:41984
    v_max3_u32 v19, v19, v42, v43
    buffer_load_dwordx4 v[88:91], v8, s[4:7], s94 offen offset:3072 sc1
    s_waitcnt vmcnt(5) lgkmcnt(6)
    v_mfma_f32_16x16x32_bf16 v[52:55], v[108:111], v[44:47], v[52:55]
    ds_read_b128 v[108:111], v14 offset:49152
    v_max3_u32 v19, v19, v44, v45
    v_mfma_f32_16x16x32_bf16 v[56:59], v[112:115], v[44:47], v[56:59]
    ds_read_b128 v[112:115], v14 offset:50176
    v_max3_u32 v19, v19, v46, v47
    buffer_load_dwordx4 v[92:95], v8, s[4:7], s42 offen offset:0 sc1
    s_waitcnt vmcnt(5) lgkmcnt(6)
    v_max3_u32 v19, v19, v48, v49
    v_max3_u32 v19, v19, v50, v51
    v_cmp_eq_u32 vcc, -1, v19
    v_mfma_f32_16x16x32_bf16 v[52:55], v[68:71], v[48:51], v[52:55]
    ds_read_b128 v[68:71], v14 offset:57344
    v_mfma_f32_16x16x32_bf16 v[56:59], v[72:75], v[48:51], v[56:59]
    ds_read_b128 v[72:75], v14 offset:58368
    buffer_load_dwordx4 v[96:99], v8, s[4:7], s42 offen offset:1024 sc1
    s_cbranch_vccnz L_R_x3sd0_1_2
L_R_x3bd0_1_2:
    s_waitcnt vmcnt(5) lgkmcnt(6)
    v_mfma_f32_16x16x32_bf16 v[60:63], v[20:23], v[76:79], v[52:55]
    ds_read_b128 v[20:23], v9 offset:0
    v_max3_u32 v19, v76, v77, v78
    v_mfma_f32_16x16x32_bf16 v[64:67], v[24:27], v[76:79], v[56:59]
    ds_read_b128 v[24:27], v9 offset:1024
    v_max_u32 v19, v19, v79
    buffer_load_dwordx4 v[100:103], v8, s[4:7], s42 offen offset:2048 sc1
    s_waitcnt vmcnt(5) lgkmcnt(6)
    v_mfma_f32_16x16x32_bf16 v[60:63], v[28:31], v[80:83], v[60:63]
    ds_read_b128 v[28:31], v9 offset:8192
    v_max3_u32 v19, v19, v80, v81
    v_mfma_f32_16x16x32_bf16 v[64:67], v[32:35], v[80:83], v[64:67]
    ds_read_b128 v[32:35], v9 offset:9216
    v_max3_u32 v19, v19, v82, v83
    buffer_load_dwordx4 v[104:107], v8, s[4:7], s42 offen offset:3072 sc1
    s_waitcnt vmcnt(5) lgkmcnt(6)
    v_mfma_f32_16x16x32_bf16 v[60:63], v[108:111], v[84:87], v[60:63]
    ds_read_b128 v[108:111], v9 offset:16384
    v_max3_u32 v19, v19, v84, v85
    v_mfma_f32_16x16x32_bf16 v[64:67], v[112:115], v[84:87], v[64:67]
    ds_read_b128 v[112:115], v9 offset:17408
    v_max3_u32 v19, v19, v86, v87
    buffer_load_dwordx4 v[36:39], v8, s[4:7], s92 offen offset:0 sc1
    s_waitcnt vmcnt(5) lgkmcnt(6)
    v_max3_u32 v19, v19, v88, v89
    v_max3_u32 v19, v19, v90, v91
    v_cmp_eq_u32 vcc, -1, v19
    v_mfma_f32_16x16x32_bf16 v[60:63], v[68:71], v[88:91], v[60:63]
    ds_read_b128 v[68:71], v9 offset:24576
    v_mfma_f32_16x16x32_bf16 v[64:67], v[72:75], v[88:91], v[64:67]
    ds_read_b128 v[72:75], v9 offset:25600
    buffer_load_dwordx4 v[40:43], v8, s[4:7], s92 offen offset:1024 sc1
    s_cbranch_vccnz L_R_x3sd0_1_3
L_R_x3bd0_1_3:
    s_waitcnt vmcnt(5) lgkmcnt(6)
    v_mfma_f32_16x16x32_bf16 v[52:55], v[20:23], v[92:95], v[60:63]
    ds_read_b128 v[20:23], v9 offset:32768
    v_max3_u32 v19, v92, v93, v94
    v_mfma_f32_16x16x32_bf16 v[56:59], v[24:27], v[92:95], v[64:67]
    ds_read_b128 v[24:27], v9 offset:33792
    v_max_u32 v19, v19, v95
    buffer_load_dwordx4 v[44:47], v8, s[4:7], s92 offen offset:2048 sc1
    s_waitcnt vmcnt(5) lgkmcnt(6)
    v_mfma_f32_16x16x32_bf16 v[52:55], v[28:31], v[96:99], v[52:55]
    ds_read_b128 v[28:31], v9 offset:40960
    v_max3_u32 v19, v19, v96, v97
    v_mfma_f32_16x16x32_bf16 v[56:59], v[32:35], v[96:99], v[56:59]
    ds_read_b128 v[32:35], v9 offset:41984
    v_max3_u32 v19, v19, v98, v99
    buffer_load_dwordx4 v[48:51], v8, s[4:7], s92 offen offset:3072 sc1
    s_waitcnt vmcnt(5) lgkmcnt(6)
    v_mfma_f32_16x16x32_bf16 v[52:55], v[108:111], v[100:103], v[52:55]
    ds_read_b128 v[108:111], v9 offset:49152
    v_max3_u32 v19, v19, v100, v101
    v_mfma_f32_16x16x32_bf16 v[56:59], v[112:115], v[100:103], v[56:59]
    ds_read_b128 v[112:115], v9 offset:50176
    v_max3_u32 v19, v19, v102, v103
    s_waitcnt vmcnt(4) lgkmcnt(6)
    v_max3_u32 v19, v19, v104, v105
    v_max3_u32 v19, v19, v106, v107
    v_cmp_eq_u32 vcc, -1, v19
    v_mfma_f32_16x16x32_bf16 v[52:55], v[68:71], v[104:107], v[52:55]
    ds_read_b128 v[68:71], v9 offset:57344
    v_mfma_f32_16x16x32_bf16 v[56:59], v[72:75], v[104:107], v[56:59]
    ds_read_b128 v[72:75], v9 offset:58368
    s_cbranch_vccnz L_R_x3sd0_1_4
L_R_x3bd0_1_4:
    s_waitcnt vmcnt(3) lgkmcnt(6)
    v_mfma_f32_16x16x32_bf16 v[60:63], v[20:23], v[36:39], v[52:55]
    v_max3_u32 v19, v36, v37, v38
    v_mfma_f32_16x16x32_bf16 v[64:67], v[24:27], v[36:39], v[56:59]
    v_max_u32 v19, v19, v39
    s_waitcnt vmcnt(2) lgkmcnt(4)
    v_mfma_f32_16x16x32_bf16 v[60:63], v[28:31], v[40:43], v[60:63]
    v_max3_u32 v19, v19, v40, v41
    v_mfma_f32_16x16x32_bf16 v[64:67], v[32:35], v[40:43], v[64:67]
    v_max3_u32 v19, v19, v42, v43
    s_waitcnt vmcnt(1) lgkmcnt(2)
    v_mfma_f32_16x16x32_bf16 v[60:63], v[108:111], v[44:47], v[60:63]
    v_max3_u32 v19, v19, v44, v45
    v_mfma_f32_16x16x32_bf16 v[64:67], v[112:115], v[44:47], v[64:67]
    v_max3_u32 v19, v19, v46, v47
    s_waitcnt vmcnt(0) lgkmcnt(0)
    v_max3_u32 v19, v19, v48, v49
    v_max3_u32 v19, v19, v50, v51
    v_cmp_eq_u32 vcc, -1, v19
    v_mfma_f32_16x16x32_bf16 v[60:63], v[68:71], v[48:51], v[60:63]
    v_mfma_f32_16x16x32_bf16 v[64:67], v[72:75], v[48:51], v[64:67]
    s_cbranch_vccnz L_R_x3sd0_1_5
L_R_x3bd0_1_5:
    s_branch L_R_red
L_R_x3sd3:
    buffer_load_dwordx4 v[76:79], v8, s[4:7], s94 offen offset:0 sc1
    buffer_load_dwordx4 v[80:83], v8, s[4:7], s94 offen offset:1024 sc1
    buffer_load_dwordx4 v[84:87], v8, s[4:7], s94 offen offset:2048 sc1
    buffer_load_dwordx4 v[88:91], v8, s[4:7], s94 offen offset:3072 sc1
    ds_read_b128 v[20:23], v14 offset:32768
    ds_read_b128 v[24:27], v14 offset:33792
    ds_read_b128 v[28:31], v14 offset:40960
    ds_read_b128 v[32:35], v14 offset:41984
    ds_read_b128 v[108:111], v14 offset:49152
    ds_read_b128 v[112:115], v14 offset:50176
    ds_read_b128 v[68:71], v14 offset:57344
    ds_read_b128 v[72:75], v14 offset:58368
    s_branch L_R_x3wd3
L_R_x3rd3:
    buffer_load_dwordx4 v[76:79], v8, s[4:7], s94 offen offset:0 sc1
    buffer_load_dwordx4 v[80:83], v8, s[4:7], s94 offen offset:1024 sc1
    buffer_load_dwordx4 v[84:87], v8, s[4:7], s94 offen offset:2048 sc1
    buffer_load_dwordx4 v[88:91], v8, s[4:7], s94 offen offset:3072 sc1
L_R_x3wd3:
    s_add_u32 s3, s3, 1
    s_cmp_lt_u32 s3, 40000
    s_cbranch_scc0 L_R_x3abort
    s_waitcnt vmcnt(0)
    v_max3_u32 v19, v76, v77, v78
    v_max_u32 v19, v19, v79
    v_max3_u32 v19, v19, v80, v81
    v_max3_u32 v19, v19, v82, v83
    v_max3_u32 v19, v19, v84, v85
    v_max3_u32 v19, v19, v86, v87
    v_max3_u32 v19, v19, v88, v89
    v_max3_u32 v19, v19, v90, v91
    v_cmp_eq_u32 vcc, -1, v19
    s_cbranch_vccnz L_R_x3rd3
    s_waitcnt lgkmcnt(0)
    v_mfma_f32_16x16x32_bf16 v[60:63], v[20:23], v[76:79], v[52:55]
    v_mfma_f32_16x16x32_bf16 v[64:67], v[24:27], v[76:79], v[56:59]
    v_mfma_f32_16x16x32_bf16 v[60:63], v[28:31], v[80:83], v[60:63]
    v_mfma_f32_16x16x32_bf16 v[64:67], v[32:35], v[80:83], v[64:67]
    v_mfma_f32_16x16x32_bf16 v[60:63], v[108:111], v[84:87], v[60:63]
    v_mfma_f32_16x16x32_bf16 v[64:67], v[112:115], v[84:87], v[64:67]
    v_mfma_f32_16x16x32_bf16 v[60:63], v[68:71], v[88:91], v[60:63]
    v_mfma_f32_16x16x32_bf16 v[64:67], v[72:75], v[88:91], v[64:67]
    s_branch L_R_x3bd3
L_R_x3so0:
    buffer_load_dwordx4 v[76:79], v18, s[4:7], s42 offen offset:0 sc1
    buffer_load_dwordx4 v[80:83], v18, s[4:7], s42 offen offset:2048 sc1
    buffer_load_dwordx4 v[84:87], v18, s[4:7], s92 offen offset:0 sc1
    buffer_load_dwordx4 v[88:91], v18, s[4:7], s92 offen offset:2048 sc1
    buffer_load_dwordx4 v[92:95], v18, s[4:7], s93 offen offset:0 sc1
    buffer_load_dwordx4 v[96:99], v18, s[4:7], s93 offen offset:2048 sc1
    ds_read_b128 v[20:23], v9 offset:0
    ds_read_b128 v[24:27], v9 offset:1024
    ds_read_b128 v[28:31], v9 offset:8192
    ds_read_b128 v[32:35], v9 offset:9216
    ds_read_b128 v[108:111], v9 offset:16384
    ds_read_b128 v[112:115], v9 offset:17408
    ds_read_b128 v[68:71], v9 offset:24576
    ds_read_b128 v[72:75], v9 offset:25600
    s_branch L_R_x3wo0
L_R_x3ro0:
    buffer_load_dwordx4 v[76:79], v18, s[4:7], s42 offen offset:0 sc1
    buffer_load_dwordx4 v[80:83], v18, s[4:7], s42 offen offset:2048 sc1
    buffer_load_dwordx4 v[84:87], v18, s[4:7], s92 offen offset:0 sc1
    buffer_load_dwordx4 v[88:91], v18, s[4:7], s92 offen offset:2048 sc1
    buffer_load_dwordx4 v[92:95], v18, s[4:7], s93 offen offset:0 sc1
    buffer_load_dwordx4 v[96:99], v18, s[4:7], s93 offen offset:2048 sc1
L_R_x3wo0:
    s_add_u32 s3, s3, 1
    s_cmp_lt_u32 s3, 40000
    s_cbranch_scc0 L_R_x3abort
    s_waitcnt vmcnt(4)
    v_max3_u32 v19, v76, v77, v78
    v_max_u32 v19, v19, v79
    v_max3_u32 v19, v19, v80, v81
    v_max3_u32 v19, v19, v82, v83
    v_cmp_eq_u32 vcc, -1, v19
    s_cbranch_vccnz L_R_x3ro0
    s_waitcnt lgkmcnt(0)
    v_mfma_f32_16x16x32_bf16 v[36:39], v[20:23], v[76:79], 0
    ds_read_b128 v[20:23], v9 offset:32768
    v_mfma_f32_16x16x32_bf16 v[40:43], v[24:27], v[76:79], 0
    ds_read_b128 v[24:27], v9 offset:33792
    v_mfma_f32_16x16x32_bf16 v[44:47], v[28:31], v[76:79], 0
    ds_read_b128 v[28:31], v9 offset:40960
    v_mfma_f32_16x16x32_bf16 v[48:51], v[32:35], v[76:79], 0
    ds_read_b128 v[32:35], v9 offset:41984
    v_mfma_f32_16x16x32_bf16 v[36:39], v[108:111], v[80:83], v[36:39]
    ds_read_b128 v[108:111], v9 offset:49152
    v_mfma_f32_16x16x32_bf16 v[40:43], v[112:115], v[80:83], v[40:43]
    ds_read_b128 v[112:115], v9 offset:50176
    v_mfma_f32_16x16x32_bf16 v[44:47], v[68:71], v[80:83], v[44:47]
    ds_read_b128 v[68:71], v9 offset:57344
    v_mfma_f32_16x16x32_bf16 v[48:51], v[72:75], v[80:83], v[48:51]
    ds_read_b128 v[72:75], v9 offset:58368
    s_branch L_R_x3bo0
L_R_x3so1:
    buffer_load_dwordx4 v[84:87], v18, s[4:7], s92 offen offset:0 sc1
    buffer_load_dwordx4 v[88:91], v18, s[4:7], s92 offen offset:2048 sc1
    buffer_load_dwordx4 v[92:95], v18, s[4:7], s93 offen offset:0 sc1
    buffer_load_dwordx4 v[96:99], v18, s[4:7], s93 offen offset:2048 sc1
    buffer_load_dwordx4 v[100:103], v18, s[4:7], s94 offen offset:0 sc1
    buffer_load_dwordx4 v[104:107], v18, s[4:7], s94 offen offset:2048 sc1
    ds_read_b128 v[20:23], v9 offset:32768
    ds_read_b128 v[24:27], v9 offset:33792
    ds_read_b128 v[28:31], v9 offset:40960
    ds_read_b128 v[32:35], v9 offset:41984
    ds_read_b128 v[108:111], v9 offset:49152
    ds_read_b128 v[112:115], v9 offset:50176
    ds_read_b128 v[68:71], v9 offset:57344
    ds_read_b128 v[72:75], v9 offset:58368
    s_branch L_R_x3wo1
L_R_x3ro1:
    buffer_load_dwordx4 v[84:87], v18, s[4:7], s92 offen offset:0 sc1
    buffer_load_dwordx4 v[88:91], v18, s[4:7], s92 offen offset:2048 sc1
    buffer_load_dwordx4 v[92:95], v18, s[4:7], s93 offen offset:0 sc1
    buffer_load_dwordx4 v[96:99], v18, s[4:7], s93 offen offset:2048 sc1
    buffer_load_dwordx4 v[100:103], v18, s[4:7], s94 offen offset:0 sc1
    buffer_load_dwordx4 v[104:107], v18, s[4:7], s94 offen offset:2048 sc1
L_R_x3wo1:
    s_add_u32 s3, s3, 1
    s_cmp_lt_u32 s3, 40000
    s_cbranch_scc0 L_R_x3abort
    s_waitcnt vmcnt(4)
    v_max3_u32 v19, v84, v85, v86
    v_max_u32 v19, v19, v87
    v_max3_u32 v19, v19, v88, v89
    v_max3_u32 v19, v19, v90, v91
    v_cmp_eq_u32 vcc, -1, v19
    s_cbranch_vccnz L_R_x3ro1
    s_waitcnt lgkmcnt(0)
    v_mfma_f32_16x16x32_bf16 v[52:55], v[20:23], v[84:87], v[36:39]
    ds_read_b128 v[20:23], v14 offset:0
    v_mfma_f32_16x16x32_bf16 v[56:59], v[24:27], v[84:87], v[40:43]
    ds_read_b128 v[24:27], v14 offset:1024
    v_mfma_f32_16x16x32_bf16 v[60:63], v[28:31], v[84:87], v[44:47]
    ds_read_b128 v[28:31], v14 offset:8192
    v_mfma_f32_16x16x32_bf16 v[64:67], v[32:35], v[84:87], v[48:51]
    ds_read_b128 v[32:35], v14 offset:9216
    v_mfma_f32_16x16x32_bf16 v[52:55], v[108:111], v[88:91], v[52:55]
    ds_read_b128 v[108:111], v14 offset:16384
    v_mfma_f32_16x16x32_bf16 v[56:59], v[112:115], v[88:91], v[56:59]
    ds_read_b128 v[112:115], v14 offset:17408
    v_mfma_f32_16x16x32_bf16 v[60:63], v[68:71], v[88:91], v[60:63]
    ds_read_b128 v[68:71], v14 offset:24576
    v_mfma_f32_16x16x32_bf16 v[64:67], v[72:75], v[88:91], v[64:67]
    ds_read_b128 v[72:75], v14 offset:25600
    s_branch L_R_x3bo1
L_R_x3so2:
    buffer_load_dwordx4 v[92:95], v18, s[4:7], s93 offen offset:0 sc1
    buffer_load_dwordx4 v[96:99], v18, s[4:7], s93 offen offset:2048 sc1
    buffer_load_dwordx4 v[100:103], v18, s[4:7], s94 offen offset:0 sc1
    buffer_load_dwordx4 v[104:107], v18, s[4:7], s94 offen offset:2048 sc1
    ds_read_b128 v[20:23], v14 offset:0
    ds_read_b128 v[24:27], v14 offset:1024
    ds_read_b128 v[28:31], v14 offset:8192
    ds_read_b128 v[32:35], v14 offset:9216
    ds_read_b128 v[108:111], v14 offset:16384
    ds_read_b128 v[112:115], v14 offset:17408
    ds_read_b128 v[68:71], v14 offset:24576
    ds_read_b128 v[72:75], v14 offset:25600
    s_branch L_R_x3wo2
L_R_x3ro2:
    buffer_load_dwordx4 v[92:95], v18, s[4:7], s93 offen offset:0 sc1
    buffer_load_dwordx4 v[96:99], v18, s[4:7], s93 offen offset:2048 sc1
    buffer_load_dwordx4 v[100:103], v18, s[4:7], s94 offen offset:0 sc1
    buffer_load_dwordx4 v[104:107], v18, s[4:7], s94 offen offset:2048 sc1
L_R_x3wo2:
    s_add_u32 s3, s3, 1
    s_cmp_lt_u32 s3, 40000
    s_cbranch_scc0 L_R_x3abort
    s_waitcnt vmcnt(2)
    v_max3_u32 v19, v92, v93, v94
    v_max_u32 v19, v19, v95
    v_max3_u32 v19, v19, v96, v97
    v_max3_u32 v19, v19, v98, v99
    v_cmp_eq_u32 vcc, -1, v19
    s_cbranch_vccnz L_R_x3ro2
    s_waitcnt lgkmcnt(0)
    v_mfma_f32_16x16x32_bf16 v[36:39], v[20:23], v[92:95], v[52:55]
    ds_read_b128 v[20:23], v14 offset:32768
    v_mfma_f32_16x16x32_bf16 v[40:43], v[24:27], v[92:95], v[56:59]
    ds_read_b128 v[24:27], v14 offset:33792
    v_mfma_f32_16x16x32_bf16 v[44:47], v[28:31], v[92:95], v[60:63]
    ds_read_b128 v[28:31], v14 offset:40960
    v_mfma_f32_16x16x32_bf16 v[48:51], v[32:35], v[92:95], v[64:67]
    ds_read_b128 v[32:35], v14 offset:41984
    v_mfma_f32_16x16x32_bf16 v[36:39], v[108:111], v[96:99], v[36:39]
    ds_read_b128 v[108:111], v14 offset:49152
    v_mfma_f32_16x16x32_bf16 v[40:43], v[112:115], v[96:99], v[40:43]
    ds_read_b128 v[112:115], v14 offset:50176
    v_mfma_f32_16x16x32_bf16 v[44:47], v[68:71], v[96:99], v[44:47]
    ds_read_b128 v[68:71], v14 offset:57344
    v_mfma_f32_16x16x32_bf16 v[48:51], v[72:75], v[96:99], v[48:51]
    ds_read_b128 v[72:75], v14 offset:58368
    s_branch L_R_x3bo2
L_R_x3so3:
    buffer_load_dwordx4 v[100:103], v18, s[4:7], s94 offen offset:0 sc1
    buffer_load_dwordx4 v[104:107], v18, s[4:7], s94 offen offset:2048 sc1
    ds_read_b128 v[20:23], v14 offset:32768
    ds_read_b128 v[24:27], v14 offset:33792
    ds_read_b128 v[28:31], v14 offset:40960
    ds_read_b128 v[32:35], v14 offset:41984
    ds_read_b128 v[108:111], v14 offset:49152
    ds_read_b128 v[112:115], v14 offset:50176
    ds_read_b128 v[68:71], v14 offset:57344
    ds_read_b128 v[72:75], v14 offset:58368
    s_branch L_R_x3wo3
L_R_x3ro3:
    buffer_load_dwordx4 v[100:103], v18, s[4:7], s94 offen offset:0 sc1
    buffer_load_dwordx4 v[104:107], v18, s[4:7], s94 offen offset:2048 sc1
L_R_x3wo3:
    s_add_u32 s3, s3, 1
    s_cmp_lt_u32 s3, 40000
    s_cbranch_scc0 L_R_x3abort
    s_waitcnt vmcnt(0)
    v_max3_u32 v19, v100, v101, v102
    v_max_u32 v19, v19, v103
    v_max3_u32 v19, v19, v104, v105
    v_max3_u32 v19, v19, v106, v107
    v_cmp_eq_u32 vcc, -1, v19
    s_cbranch_vccnz L_R_x3ro3
    s_waitcnt lgkmcnt(0)
    v_mfma_f32_16x16x32_bf16 v[52:55], v[20:23], v[100:103], v[36:39]
    v_mfma_f32_16x16x32_bf16 v[56:59], v[24:27], v[100:103], v[40:43]
    v_mfma_f32_16x16x32_bf16 v[60:63], v[28:31], v[100:103], v[44:47]
    v_mfma_f32_16x16x32_bf16 v[64:67], v[32:35], v[100:103], v[48:51]
    v_mfma_f32_16x16x32_bf16 v[52:55], v[108:111], v[104:107], v[52:55]
    v_mfma_f32_16x16x32_bf16 v[56:59], v[112:115], v[104:107], v[56:59]
    v_mfma_f32_16x16x32_bf16 v[60:63], v[68:71], v[104:107], v[60:63]
    v_mfma_f32_16x16x32_bf16 v[64:67], v[72:75], v[104:107], v[64:67]
    s_branch L_R_x3bo3
L_R_x3sd0_2:
    buffer_load_dwordx4 v[36:39], v8, s[4:7], s93 offen offset:0 sc1
    buffer_load_dwordx4 v[40:43], v8, s[4:7], s93 offen offset:1024 sc1
    buffer_load_dwordx4 v[44:47], v8, s[4:7], s93 offen offset:2048 sc1
    buffer_load_dwordx4 v[48:51], v8, s[4:7], s93 offen offset:3072 sc1
    buffer_load_dwordx4 v[76:79], v8, s[4:7], s94 offen offset:0 sc1
    buffer_load_dwordx4 v[80:83], v8, s[4:7], s94 offen offset:1024 sc1
    buffer_load_dwordx4 v[84:87], v8, s[4:7], s94 offen offset:2048 sc1
    buffer_load_dwordx4 v[88:91], v8, s[4:7], s94 offen offset:3072 sc1
    buffer_load_dwordx4 v[92:95], v8, s[4:7], s42 offen offset:0 sc1
    buffer_load_dwordx4 v[96:99], v8, s[4:7], s42 offen offset:1024 sc1
    ds_read_b128 v[20:23], v14 offset:0
    ds_read_b128 v[24:27], v14 offset:1024
    ds_read_b128 v[28:31], v14 offset:8192
    ds_read_b128 v[32:35], v14 offset:9216
    ds_read_b128 v[108:111], v14 offset:16384
    ds_read_b128 v[112:115], v14 offset:17408
    ds_read_b128 v[68:71], v14 offset:24576
    ds_read_b128 v[72:75], v14 offset:25600
    s_branch L_R_x3wd0_2
L_R_x3rd0_2:
    buffer_load_dwordx4 v[36:39], v8, s[4:7], s93 offen offset:0 sc1
    buffer_load_dwordx4 v[40:43], v8, s[4:7], s93 offen offset:1024 sc1
    buffer_load_dwordx4 v[44:47], v8, s[4:7], s93 offen offset:2048 sc1
    buffer_load_dwordx4 v[48:51], v8, s[4:7], s93 offen offset:3072 sc1
    buffer_load_dwordx4 v[76:79], v8, s[4:7], s94 offen offset:0 sc1
    buffer_load_dwordx4 v[80:83], v8, s[4:7], s94 offen offset:1024 sc1
    buffer_load_dwordx4 v[84:87], v8, s[4:7], s94 offen offset:2048 sc1
    buffer_load_dwordx4 v[88:91], v8, s[4:7], s94 offen offset:3072 sc1
    buffer_load_dwordx4 v[92:95], v8, s[4:7], s42 offen offset:0 sc1
    buffer_load_dwordx4 v[96:99], v8, s[4:7], s42 offen offset:1024 sc1
L_R_x3wd0_2:
    s_add_u32 s3, s3, 1
    s_cmp_lt_u32 s3, 40000
    s_cbranch_scc0 L_R_x3abort
    s_waitcnt vmcnt(6)
    v_max3_u32 v19, v36, v37, v38
    v_max_u32 v19, v19, v39
    v_max3_u32 v19, v19, v40, v41
    v_max3_u32 v19, v19, v42, v43
    v_max3_u32 v19, v19, v44, v45
    v_max3_u32 v19, v19, v46, v47
    v_max3_u32 v19, v19, v48, v49
    v_max3_u32 v19, v19, v50, v51
    v_cmp_eq_u32 vcc, -1, v19
    s_cbranch_vccnz L_R_x3rd0_2
    s_waitcnt lgkmcnt(0)
    v_mfma_f32_16x16x32_bf16 v[60:63], v[20:23], v[36:39], v[52:55]
    ds_read_b128 v[20:23], v14 offset:32768
    v_mfma_f32_16x16x32_bf16 v[64:67], v[24:27], v[36:39], v[56:59]
    ds_read_b128 v[24:27], v14 offset:33792
    v_mfma_f32_16x16x32_bf16 v[60:63], v[28:31], v[40:43], v[60:63]
    ds_read_b128 v[28:31], v14 offset:40960
    v_mfma_f32_16x16x32_bf16 v[64:67], v[32:35], v[40:43], v[64:67]
    ds_read_b128 v[32:35], v14 offset:41984
    v_mfma_f32_16x16x32_bf16 v[60:63], v[108:111], v[44:47], v[60:63]
    ds_read_b128 v[108:111], v14 offset:49152
    v_mfma_f32_16x16x32_bf16 v[64:67], v[112:115], v[44:47], v[64:67]
    ds_read_b128 v[112:115], v14 offset:50176
    v_mfma_f32_16x16x32_bf16 v[60:63], v[68:71], v[48:51], v[60:63]
    ds_read_b128 v[68:71], v14 offset:57344
    v_mfma_f32_16x16x32_bf16 v[64:67], v[72:75], v[48:51], v[64:67]
    ds_read_b128 v[72:75], v14 offset:58368
    s_branch L_R_x3bd0_2
L_R_x3sd0_3:
    buffer_load_dwordx4 v[76:79], v8, s[4:7], s94 offen offset:0 sc1
    buffer_load_dwordx4 v[80:83], v8, s[4:7], s94 offen offset:1024 sc1
    buffer_load_dwordx4 v[84:87], v8, s[4:7], s94 offen offset:2048 sc1
    buffer_load_dwordx4 v[88:91], v8, s[4:7], s94 offen offset:3072 sc1
    buffer_load_dwordx4 v[92:95], v8, s[4:7], s42 offen offset:0 sc1
    buffer_load_dwordx4 v[96:99], v8, s[4:7], s42 offen offset:1024 sc1
    buffer_load_dwordx4 v[100:103], v8, s[4:7], s42 offen offset:2048 sc1
    buffer_load_dwordx4 v[104:107], v8, s[4:7], s42 offen offset:3072 sc1
    ds_read_b128 v[20:23], v14 offset:32768
    ds_read_b128 v[24:27], v14 offset:33792
    ds_read_b128 v[28:31], v14 offset:40960
    ds_read_b128 v[32:35], v14 offset:41984
    ds_read_b128 v[108:111], v14 offset:49152
    ds_read_b128 v[112:115], v14 offset:50176
    ds_read_b128 v[68:71], v14 offset:57344
    ds_read_b128 v[72:75], v14 offset:58368
    s_branch L_R_x3wd0_3
L_R_x3rd0_3:
    buffer_load_dwordx4 v[76:79], v8, s[4:7], s94 offen offset:0 sc1
    buffer_load_dwordx4 v[80:83], v8, s[4:7], s94 offen offset:1024 sc1
    buffer_load_dwordx4 v[84:87], v8, s[4:7], s94 offen offset:2048 sc1
    buffer_load_dwordx4 v[88:91], v8, s[4:7], s94 offen offset:3072 sc1
    buffer_load_dwordx4 v[92:95], v8, s[4:7], s42 offen offset:0 sc1
    buffer_load_dwordx4 v[96:99], v8, s[4:7], s42 offen offset:1024 sc1
    buffer_load_dwordx4 v[100:103], v8, s[4:7], s42 offen offset:2048 sc1
    buffer_load_dwordx4 v[104:107], v8, s[4:7], s42 offen offset:3072 sc1
L_R_x3wd0_3:
    s_add_u32 s3, s3, 1
    s_cmp_lt_u32 s3, 40000
    s_cbranch_scc0 L_R_x3abort
    s_waitcnt vmcnt(4)
    v_max3_u32 v19, v76, v77, v78
    v_max_u32 v19, v19, v79
    v_max3_u32 v19, v19, v80, v81
    v_max3_u32 v19, v19, v82, v83
    v_max3_u32 v19, v19, v84, v85
    v_max3_u32 v19, v19, v86, v87
    v_max3_u32 v19, v19, v88, v89
    v_max3_u32 v19, v19, v90, v91
    v_cmp_eq_u32 vcc, -1, v19
    s_cbranch_vccnz L_R_x3rd0_3
    s_waitcnt lgkmcnt(0)
    v_mfma_f32_16x16x32_bf16 v[52:55], v[20:23], v[76:79], v[60:63]
    ds_read_b128 v[20:23], v9 offset:0
    v_mfma_f32_16x16x32_bf16 v[56:59], v[24:27], v[76:79], v[64:67]
    ds_read_b128 v[24:27], v9 offset:1024
    v_mfma_f32_16x16x32_bf16 v[52:55], v[28:31], v[80:83], v[52:55]
    ds_read_b128 v[28:31], v9 offset:8192
    v_mfma_f32_16x16x32_bf16 v[56:59], v[32:35], v[80:83], v[56:59]
    ds_read_b128 v[32:35], v9 offset:9216
    v_mfma_f32_16x16x32_bf16 v[52:55], v[108:111], v[84:87], v[52:55]
    ds_read_b128 v[108:111], v9 offset:16384
    v_mfma_f32_16x16x32_bf16 v[56:59], v[112:115], v[84:87], v[56:59]
    ds_read_b128 v[112:115], v9 offset:17408
    v_mfma_f32_16x16x32_bf16 v[52:55], v[68:71], v[88:91], v[52:55]
    ds_read_b128 v[68:71], v9 offset:24576
    v_mfma_f32_16x16x32_bf16 v[56:59], v[72:75], v[88:91], v[56:59]
    ds_read_b128 v[72:75], v9 offset:25600
    s_branch L_R_x3bd0_3
L_R_x3sd0_4:
    buffer_load_dwordx4 v[92:95], v8, s[4:7], s42 offen offset:0 sc1
    buffer_load_dwordx4 v[96:99], v8, s[4:7], s42 offen offset:1024 sc1
    buffer_load_dwordx4 v[100:103], v8, s[4:7], s42 offen offset:2048 sc1
    buffer_load_dwordx4 v[104:107], v8, s[4:7], s42 offen offset:3072 sc1
    ds_read_b128 v[20:23], v9 offset:0
    ds_read_b128 v[24:27], v9 offset:1024
    ds_read_b128 v[28:31], v9 offset:8192
    ds_read_b128 v[32:35], v9 offset:9216
    ds_read_b128 v[108:111], v9 offset:16384
    ds_read_b128 v[112:115], v9 offset:17408
    ds_read_b128 v[68:71], v9 offset:24576
    ds_read_b128 v[72:75], v9 offset:25600
    s_branch L_R_x3wd0_4
L_R_x3rd0_4:
    buffer_load_dwordx4 v[92:95], v8, s[4:7], s42 offen offset:0 sc1
    buffer_load_dwordx4 v[96:99], v8, s[4:7], s42 offen offset:1024 sc1
    buffer_load_dwordx4 v[100:103], v8, s[4:7], s42 offen offset:2048 sc1
    buffer_load_dwordx4 v[104:107], v8, s[4:7], s42 offen offset:3072 sc1
L_R_x3wd0_4:
    s_add_u32 s3, s3, 1
    s_cmp_lt_u32 s3, 40000
    s_cbranch_scc0 L_R_x3abort
    s_waitcnt vmcnt(0)
    v_max3_u32 v19, v92, v93, v94
    v_max_u32 v19, v19, v95
    v_max3_u32 v19, v19, v96, v97
    v_max3_u32 v19, v19, v98, v99
    v_max3_u32 v19, v19, v100, v101
    v_max3_u32 v19, v19, v102, v103
    v_max3_u32 v19, v19, v104, v105
    v_max3_u32 v19, v19, v106, v107
    v_cmp_eq_u32 vcc, -1, v19
    s_cbranch_vccnz L_R_x3rd0_4
    s_waitcnt lgkmcnt(0)
    v_mfma_f32_16x16x32_bf16 v[60:63], v[20:23], v[92:95], v[52:55]
    v_mfma_f32_16x16x32_bf16 v[64:67], v[24:27], v[92:95], v[56:59]
    v_mfma_f32_16x16x32_bf16 v[60:63], v[28:31], v[96:99], v[60:63]
    v_mfma_f32_16x16x32_bf16 v[64:67], v[32:35], v[96:99], v[64:67]
    v_mfma_f32_16x16x32_bf16 v[60:63], v[108:111], v[100:103], v[60:63]
    v_mfma_f32_16x16x32_bf16 v[64:67], v[112:115], v[100:103], v[64:67]
    v_mfma_f32_16x16x32_bf16 v[60:63], v[68:71], v[104:107], v[60:63]
    v_mfma_f32_16x16x32_bf16 v[64:67], v[72:75], v[104:107], v[64:67]
    s_branch L_R_x3bd0_4
L_R_x3sd1_2:
    buffer_load_dwordx4 v[36:39], v8, s[4:7], s93 offen offset:0 sc1
    buffer_load_dwordx4 v[40:43], v8, s[4:7], s93 offen offset:1024 sc1
    buffer_load_dwordx4 v[44:47], v8, s[4:7], s93 offen offset:2048 sc1
    buffer_load_dwordx4 v[48:51], v8, s[4:7], s93 offen offset:3072 sc1
    buffer_load_dwordx4 v[76:79], v8, s[4:7], s94 offen offset:0 sc1
    buffer_load_dwordx4 v[80:83], v8, s[4:7], s94 offen offset:1024 sc1
    buffer_load_dwordx4 v[84:87], v8, s[4:7], s94 offen offset:2048 sc1
    buffer_load_dwordx4 v[88:91], v8, s[4:7], s94 offen offset:3072 sc1
    buffer_load_dwordx4 v[92:95], v8, s[4:7], s92 offen offset:0 sc1
    buffer_load_dwordx4 v[96:99], v8, s[4:7], s92 offen offset:1024 sc1
    ds_read_b128 v[20:23], v14 offset:0
    ds_read_b128 v[24:27], v14 offset:1024
    ds_read_b128 v[28:31], v14 offset:8192
    ds_read_b128 v[32:35], v14 offset:9216
    ds_read_b128 v[108:111], v14 offset:16384
    ds_read_b128 v[112:115], v14 offset:17408
    ds_read_b128 v[68:71], v14 offset:24576
    ds_read_b128 v[72:75], v14 offset:25600
    s_branch L_R_x3wd1_2
L_R_x3rd1_2:
    buffer_load_dwordx4 v[36:39], v8, s[4:7], s93 offen offset:0 sc1
    buffer_load_dwordx4 v[40:43], v8, s[4:7], s93 offen offset:1024 sc1
    buffer_load_dwordx4 v[44:47], v8, s[4:7], s93 offen offset:2048 sc1
    buffer_load_dwordx4 v[48:51], v8, s[4:7], s93 offen offset:3072 sc1
    buffer_load_dwordx4 v[76:79], v8, s[4:7], s94 offen offset:0 sc1
    buffer_load_dwordx4 v[80:83], v8, s[4:7], s94 offen offset:1024 sc1
    buffer_load_dwordx4 v[84:87], v8, s[4:7], s94 offen offset:2048 sc1
    buffer_load_dwordx4 v[88:91], v8, s[4:7], s94 offen offset:3072 sc1
    buffer_load_dwordx4 v[92:95], v8, s[4:7], s92 offen offset:0 sc1
    buffer_load_dwordx4 v[96:99], v8, s[4:7], s92 offen offset:1024 sc1
L_R_x3wd1_2:
    s_add_u32 s3, s3, 1
    s_cmp_lt_u32 s3, 40000
    s_cbranch_scc0 L_R_x3abort
    s_waitcnt vmcnt(6)
    v_max3_u32 v19, v36, v37, v38
    v_max_u32 v19, v19, v39
    v_max3_u32 v19, v19, v40, v41
    v_max3_u32 v19, v19, v42, v43
    v_max3_u32 v19, v19, v44, v45
    v_max3_u32 v19, v19, v46, v47
    v_max3_u32 v19, v19, v48, v49
    v_max3_u32 v19, v19, v50, v51
    v_cmp_eq_u32 vcc, -1, v19
    s_cbranch_vccnz L_R_x3rd1_2
    s_waitcnt lgkmcnt(0)
    v_mfma_f32_16x16x32_bf16 v[60:63], v[20:23], v[36:39], v[52:55]
    ds_read_b128 v[20:23], v14 offset:32768
    v_mfma_f32_16x16x32_bf16 v[64:67], v[24:27], v[36:39], v[56:59]
    ds_read_b128 v[24:27], v14 offset:33792
    v_mfma_f32_16x16x32_bf16 v[60:63], v[28:31], v[40:43], v[60:63]
    ds_read_b128 v[28:31], v14 offset:40960
    v_mfma_f32_16x16x32_bf16 v[64:67], v[32:35], v[40:43], v[64:67]
    ds_read_b128 v[32:35], v14 offset:41984
    v_mfma_f32_16x16x32_bf16 v[60:63], v[108:111], v[44:47], v[60:63]
    ds_read_b128 v[108:111], v14 offset:49152
    v_mfma_f32_16x16x32_bf16 v[64:67], v[112:115], v[44:47], v[64:67]
    ds_read_b128 v[112:115], v14 offset:50176
    v_mfma_f32_16x16x32_bf16 v[60:63], v[68:71], v[48:51], v[60:63]
    ds_read_b128 v[68:71], v14 offset:57344
    v_mfma_f32_16x16x32_bf16 v[64:67], v[72:75], v[48:51], v[64:67]
    ds_read_b128 v[72:75], v14 offset:58368
    s_branch L_R_x3bd1_2
L_R_x3sd1_3:
    buffer_load_dwordx4 v[76:79], v8, s[4:7], s94 offen offset:0 sc1
    buffer_load_dwordx4 v[80:83], v8, s[4:7], s94 offen offset:1024 sc1
    buffer_load_dwordx4 v[84:87], v8, s[4:7], s94 offen offset:2048 sc1
    buffer_load_dwordx4 v[88:91], v8, s[4:7], s94 offen offset:3072 sc1
    buffer_load_dwordx4 v[92:95], v8, s[4:7], s92 offen offset:0 sc1
    buffer_load_dwordx4 v[96:99], v8, s[4:7], s92 offen offset:1024 sc1
    buffer_load_dwordx4 v[100:103], v8, s[4:7], s92 offen offset:2048 sc1
    buffer_load_dwordx4 v[104:107], v8, s[4:7], s92 offen offset:3072 sc1
    ds_read_b128 v[20:23], v14 offset:32768
    ds_read_b128 v[24:27], v14 offset:33792
    ds_read_b128 v[28:31], v14 offset:40960
    ds_read_b128 v[32:35], v14 offset:41984
    ds_read_b128 v[108:111], v14 offset:49152
    ds_read_b128 v[112:115], v14 offset:50176
    ds_read_b128 v[68:71], v14 offset:57344
    ds_read_b128 v[72:75], v14 offset:58368
    s_branch L_R_x3wd1_3
L_R_x3rd1_3:
    buffer_load_dwordx4 v[76:79], v8, s[4:7], s94 offen offset:0 sc1
    buffer_load_dwordx4 v[80:83], v8, s[4:7], s94 offen offset:1024 sc1
    buffer_load_dwordx4 v[84:87], v8, s[4:7], s94 offen offset:2048 sc1
    buffer_load_dwordx4 v[88:91], v8, s[4:7], s94 offen offset:3072 sc1
    buffer_load_dwordx4 v[92:95], v8, s[4:7], s92 offen offset:0 sc1
    buffer_load_dwordx4 v[96:99], v8, s[4:7], s92 offen offset:1024 sc1
    buffer_load_dwordx4 v[100:103], v8, s[4:7], s92 offen offset:2048 sc1
    buffer_load_dwordx4 v[104:107], v8, s[4:7], s92 offen offset:3072 sc1
L_R_x3wd1_3:
    s_add_u32 s3, s3, 1
    s_cmp_lt_u32 s3, 40000
    s_cbranch_scc0 L_R_x3abort
    s_waitcnt vmcnt(4)
    v_max3_u32 v19, v76, v77, v78
    v_max_u32 v19, v19, v79
    v_max3_u32 v19, v19, v80, v81
    v_max3_u32 v19, v19, v82, v83
    v_max3_u32 v19, v19, v84, v85
    v_max3_u32 v19, v19, v86, v87
    v_max3_u32 v19, v19, v88, v89
    v_max3_u32 v19, v19, v90, v91
    v_cmp_eq_u32 vcc, -1, v19
    s_cbranch_vccnz L_R_x3rd1_3
    s_waitcnt lgkmcnt(0)
    v_mfma_f32_16x16x32_bf16 v[52:55], v[20:23], v[76:79], v[60:63]
    ds_read_b128 v[20:23], v9 offset:32768
    v_mfma_f32_16x16x32_bf16 v[56:59], v[24:27], v[76:79], v[64:67]
    ds_read_b128 v[24:27], v9 offset:33792
    v_mfma_f32_16x16x32_bf16 v[52:55], v[28:31], v[80:83], v[52:55]
    ds_read_b128 v[28:31], v9 offset:40960
    v_mfma_f32_16x16x32_bf16 v[56:59], v[32:35], v[80:83], v[56:59]
    ds_read_b128 v[32:35], v9 offset:41984
    v_mfma_f32_16x16x32_bf16 v[52:55], v[108:111], v[84:87], v[52:55]
    ds_read_b128 v[108:111], v9 offset:49152
    v_mfma_f32_16x16x32_bf16 v[56:59], v[112:115], v[84:87], v[56:59]
    ds_read_b128 v[112:115], v9 offset:50176
    v_mfma_f32_16x16x32_bf16 v[52:55], v[68:71], v[88:91], v[52:55]
    ds_read_b128 v[68:71], v9 offset:57344
    v_mfma_f32_16x16x32_bf16 v[56:59], v[72:75], v[88:91], v[56:59]
    ds_read_b128 v[72:75], v9 offset:58368
    s_branch L_R_x3bd1_3
L_R_x3sd1_4:
    buffer_load_dwordx4 v[92:95], v8, s[4:7], s92 offen offset:0 sc1
    buffer_load_dwordx4 v[96:99], v8, s[4:7], s92 offen offset:1024 sc1
    buffer_load_dwordx4 v[100:103], v8, s[4:7], s92 offen offset:2048 sc1
    buffer_load_dwordx4 v[104:107], v8, s[4:7], s92 offen offset:3072 sc1
    ds_read_b128 v[20:23], v9 offset:32768
    ds_read_b128 v[24:27], v9 offset:33792
    ds_read_b128 v[28:31], v9 offset:40960
    ds_read_b128 v[32:35], v9 offset:41984
    ds_read_b128 v[108:111], v9 offset:49152
    ds_read_b128 v[112:115], v9 offset:50176
    ds_read_b128 v[68:71], v9 offset:57344
    ds_read_b128 v[72:75], v9 offset:58368
    s_branch L_R_x3wd1_4
L_R_x3rd1_4:
    buffer_load_dwordx4 v[92:95], v8, s[4:7], s92 offen offset:0 sc1
    buffer_load_dwordx4 v[96:99], v8, s[4:7], s92 offen offset:1024 sc1
    buffer_load_dwordx4 v[100:103], v8, s[4:7], s92 offen offset:2048 sc1
    buffer_load_dwordx4 v[104:107], v8, s[4:7], s92 offen offset:3072 sc1
L_R_x3wd1_4:
    s_add_u32 s3, s3, 1
    s_cmp_lt_u32 s3, 40000
    s_cbranch_scc0 L_R_x3abort
    s_waitcnt vmcnt(0)
    v_max3_u32 v19, v92, v93, v94
    v_max_u32 v19, v19, v95
    v_max3_u32 v19, v19, v96, v97
    v_max3_u32 v19, v19, v98, v99
    v_max3_u32 v19, v19, v100, v101
    v_max3_u32 v19, v19, v102, v103
    v_max3_u32 v19, v19, v104, v105
    v_max3_u32 v19, v19, v106, v107
    v_cmp_eq_u32 vcc, -1, v19
    s_cbranch_vccnz L_R_x3rd1_4
    s_waitcnt lgkmcnt(0)
    v_mfma_f32_16x16x32_bf16 v[60:63], v[20:23], v[92:95], v[52:55]
    v_mfma_f32_16x16x32_bf16 v[64:67], v[24:27], v[92:95], v[56:59]
    v_mfma_f32_16x16x32_bf16 v[60:63], v[28:31], v[96:99], v[60:63]
    v_mfma_f32_16x16x32_bf16 v[64:67], v[32:35], v[96:99], v[64:67]
    v_mfma_f32_16x16x32_bf16 v[60:63], v[108:111], v[100:103], v[60:63]
    v_mfma_f32_16x16x32_bf16 v[64:67], v[112:115], v[100:103], v[64:67]
    v_mfma_f32_16x16x32_bf16 v[60:63], v[68:71], v[104:107], v[60:63]
    v_mfma_f32_16x16x32_bf16 v[64:67], v[72:75], v[104:107], v[64:67]
    s_branch L_R_x3bd1_4
L_R_x3sd2_3:
    buffer_load_dwordx4 v[76:79], v8, s[4:7], s94 offen offset:0 sc1
    buffer_load_dwordx4 v[80:83], v8, s[4:7], s94 offen offset:1024 sc1
    buffer_load_dwordx4 v[84:87], v8, s[4:7], s94 offen offset:2048 sc1
    buffer_load_dwordx4 v[88:91], v8, s[4:7], s94 offen offset:3072 sc1
    buffer_load_dwordx4 v[92:95], v8, s[4:7], s93 offen offset:0 sc1
    buffer_load_dwordx4 v[96:99], v8, s[4:7], s93 offen offset:1024 sc1
    buffer_load_dwordx4 v[100:103], v8, s[4:7], s93 offen offset:2048 sc1
    buffer_load_dwordx4 v[104:107], v8, s[4:7], s93 offen offset:3072 sc1
    ds_read_b128 v[20:23], v14 offset:32768
    ds_read_b128 v[24:27], v14 offset:33792
    ds_read_b128 v[28:31], v14 offset:40960
    ds_read_b128 v[32:35], v14 offset:41984
    ds_read_b128 v[108:111], v14 offset:49152
    ds_read_b128 v[112:115], v14 offset:50176
    ds_read_b128 v[68:71], v14 offset:57344
    ds_read_b128 v[72:75], v14 offset:58368
    s_branch L_R_x3wd2_3
L_R_x3rd2_3:
    buffer_load_dwordx4 v[76:79], v8, s[4:7], s94 offen offset:0 sc1
    buffer_load_dwordx4 v[80:83], v8, s[4:7], s94 offen offset:1024 sc1
    buffer_load_dwordx4 v[84:87], v8, s[4:7], s94 offen offset:2048 sc1
    buffer_load_dwordx4 v[88:91], v8, s[4:7], s94 offen offset:3072 sc1
    buffer_load_dwordx4 v[92:95], v8, s[4:7], s93 offen offset:0 sc1
    buffer_load_dwordx4 v[96:99], v8, s[4:7], s93 offen offset:1024 sc1
    buffer_load_dwordx4 v[100:103], v8, s[4:7], s93 offen offset:2048 sc1
    buffer_load_dwordx4 v[104:107], v8, s[4:7], s93 offen offset:3072 sc1
L_R_x3wd2_3:
    s_add_u32 s3, s3, 1
    s_cmp_lt_u32 s3, 40000
    s_cbranch_scc0 L_R_x3abort
    s_waitcnt vmcnt(4)
    v_max3_u32 v19, v76, v77, v78
    v_max_u32 v19, v19, v79
    v_max3_u32 v19, v19, v80, v81
    v_max3_u32 v19, v19, v82, v83
    v_max3_u32 v19, v19, v84, v85
    v_max3_u32 v19, v19, v86, v87
    v_max3_u32 v19, v19, v88, v89
    v_max3_u32 v19, v19, v90, v91
    v_cmp_eq_u32 vcc, -1, v19
    s_cbranch_vccnz L_R_x3rd2_3
    s_waitcnt lgkmcnt(0)
    v_mfma_f32_16x16x32_bf16 v[52:55], v[20:23], v[76:79], v[60:63]
    ds_read_b128 v[20:23], v14 offset:0
    v_mfma_f32_16x16x32_bf16 v[56:59], v[24:27], v[76:79], v[64:67]
    ds_read_b128 v[24:27], v14 offset:1024
    v_mfma_f32_16x16x32_bf16 v[52:55], v[28:31], v[80:83], v[52:55]
    ds_read_b128 v[28:31], v14 offset:8192
    v_mfma_f32_16x16x32_bf16 v[56:59], v[32:35], v[80:83], v[56:59]
    ds_read_b128 v[32:35], v14 offset:9216
    v_mfma_f32_16x16x32_bf16 v[52:55], v[108:111], v[84:87], v[52:55]
    ds_read_b128 v[108:111], v14 offset:16384
    v_mfma_f32_16x16x32_bf16 v[56:59], v[112:115], v[84:87], v[56:59]
    ds_read_b128 v[112:115], v14 offset:17408
    v_mfma_f32_16x16x32_bf16 v[52:55], v[68:71], v[88:91], v[52:55]
    ds_read_b128 v[68:71], v14 offset:24576
    v_mfma_f32_16x16x32_bf16 v[56:59], v[72:75], v[88:91], v[56:59]
    ds_read_b128 v[72:75], v14 offset:25600
    s_branch L_R_x3bd2_3
L_R_x3sd2_4:
    buffer_load_dwordx4 v[92:95], v8, s[4:7], s93 offen offset:0 sc1
    buffer_load_dwordx4 v[96:99], v8, s[4:7], s93 offen offset:1024 sc1
    buffer_load_dwordx4 v[100:103], v8, s[4:7], s93 offen offset:2048 sc1
    buffer_load_dwordx4 v[104:107], v8, s[4:7], s93 offen offset:3072 sc1
    ds_read_b128 v[20:23], v14 offset:0
    ds_read_b128 v[24:27], v14 offset:1024
    ds_read_b128 v[28:31], v14 offset:8192
    ds_read_b128 v[32:35], v14 offset:9216
    ds_read_b128 v[108:111], v14 offset:16384
    ds_read_b128 v[112:115], v14 offset:17408
    ds_read_b128 v[68:71], v14 offset:24576
    ds_read_b128 v[72:75], v14 offset:25600
    s_branch L_R_x3wd2_4
L_R_x3rd2_4:
    buffer_load_dwordx4 v[92:95], v8, s[4:7], s93 offen offset:0 sc1
    buffer_load_dwordx4 v[96:99], v8, s[4:7], s93 offen offset:1024 sc1
    buffer_load_dwordx4 v[100:103], v8, s[4:7], s93 offen offset:2048 sc1
    buffer_load_dwordx4 v[104:107], v8, s[4:7], s93 offen offset:3072 sc1
L_R_x3wd2_4:
    s_add_u32 s3, s3, 1
    s_cmp_lt_u32 s3, 40000
    s_cbranch_scc0 L_R_x3abort
    s_waitcnt vmcnt(0)
    v_max3_u32 v19, v92, v93, v94
    v_max_u32 v19, v19, v95
    v_max3_u32 v19, v19, v96, v97
    v_max3_u32 v19, v19, v98, v99
    v_max3_u32 v19, v19, v100, v101
    v_max3_u32 v19, v19, v102, v103
    v_max3_u32 v19, v19, v104, v105
    v_max3_u32 v19, v19, v106, v107
    v_cmp_eq_u32 vcc, -1, v19
    s_cbranch_vccnz L_R_x3rd2_4
    s_waitcnt lgkmcnt(0)
    v_mfma_f32_16x16x32_bf16 v[60:63], v[20:23], v[92:95], v[52:55]
    v_mfma_f32_16x16x32_bf16 v[64:67], v[24:27], v[92:95], v[56:59]
    v_mfma_f32_16x16x32_bf16 v[60:63], v[28:31], v[96:99], v[60:63]
    v_mfma_f32_16x16x32_bf16 v[64:67], v[32:35], v[96:99], v[64:67]
    v_mfma_f32_16x16x32_bf16 v[60:63], v[108:111], v[100:103], v[60:63]
    v_mfma_f32_16x16x32_bf16 v[64:67], v[112:115], v[100:103], v[64:67]
    v_mfma_f32_16x16x32_bf16 v[60:63], v[68:71], v[104:107], v[60:63]
    v_mfma_f32_16x16x32_bf16 v[64:67], v[72:75], v[104:107], v[64:67]
    s_branch L_R_x3bd2_4
L_R_x3sd0_1_2:
    buffer_load_dwordx4 v[36:39], v8, s[4:7], s93 offen offset:0 sc1
    buffer_load_dwordx4 v[40:43], v8, s[4:7], s93 offen offset:1024 sc1
    buffer_load_dwordx4 v[44:47], v8, s[4:7], s93 offen offset:2048 sc1
    buffer_load_dwordx4 v[48:51], v8, s[4:7], s93 offen offset:3072 sc1
    buffer_load_dwordx4 v[76:79], v8, s[4:7], s94 offen offset:0 sc1
    buffer_load_dwordx4 v[80:83], v8, s[4:7], s94 offen offset:1024 sc1
    buffer_load_dwordx4 v[84:87], v8, s[4:7], s94 offen offset:2048 sc1
    buffer_load_dwordx4 v[88:91], v8, s[4:7], s94 offen offset:3072 sc1
    buffer_load_dwordx4 v[92:95], v8, s[4:7], s42 offen offset:0 sc1
    buffer_load_dwordx4 v[96:99], v8, s[4:7], s42 offen offset:1024 sc1
    ds_read_b128 v[20:23], v14 offset:0
    ds_read_b128 v[24:27], v14 offset:1024
    ds_read_b128 v[28:31], v14 offset:8192
    ds_read_b128 v[32:35], v14 offset:9216
    ds_read_b128 v[108:111], v14 offset:16384
    ds_read_b128 v[112:115], v14 offset:17408
    ds_read_b128 v[68:71], v14 offset:24576
    ds_read_b128 v[72:75], v14 offset:25600
    s_branch L_R_x3wd0_1_2
L_R_x3rd0_1_2:
    buffer_load_dwordx4 v[36:39], v8, s[4:7], s93 offen offset:0 sc1
    buffer_load_dwordx4 v[40:43], v8, s[4:7], s93 offen offset:1024 sc1
    buffer_load_dwordx4 v[44:47], v8, s[4:7], s93 offen offset:2048 sc1
    buffer_load_dwordx4 v[48:51], v8, s[4:7], s93 offen offset:3072 sc1
    buffer_load_dwordx4 v[76:79], v8, s[4:7], s94 offen offset:0 sc1
    buffer_load_dwordx4 v[80:83], v8, s[4:7], s94 offen offset:1024 sc1
    buffer_load_dwordx4 v[84:87], v8, s[4:7], s94 offen offset:2048 sc1
    buffer_load_dwordx4 v[88:91], v8, s[4:7], s94 offen offset:3072 sc1
    buffer_load_dwordx4 v[92:95], v8, s[4:7], s42 offen offset:0 sc1
    buffer_load_dwordx4 v[96:99], v8, s[4:7], s42 offen offset:1024 sc1
L_R_x3wd0_1_2:
    s_add_u32 s3, s3, 1
    s_cmp_lt_u32 s3, 40000
    s_cbranch_scc0 L_R_x3abort
    s_waitcnt vmcnt(6)
    v_max3_u32 v19, v36, v37, v38
    v_max_u32 v19, v19, v39
    v_max3_u32 v19, v19, v40, v41
    v_max3_u32 v19, v19, v42, v43
    v_max3_u32 v19, v19, v44, v45
    v_max3_u32 v19, v19, v46, v47
    v_max3_u32 v19, v19, v48, v49
    v_max3_u32 v19, v19, v50, v51
    v_cmp_eq_u32 vcc, -1, v19
    s_cbranch_vccnz L_R_x3rd0_1_2
    s_waitcnt lgkmcnt(0)
    v_mfma_f32_16x16x32_bf16 v[52:55], v[20:23], v[36:39], 0
    ds_read_b128 v[20:23], v14 offset:32768
    v_mfma_f32_16x16x32_bf16 v[56:59], v[24:27], v[36:39], 0
    ds_read_b128 v[24:27], v14 offset:33792
    v_mfma_f32_16x16x32_bf16 v[52:55], v[28:31], v[40:43], v[52:55]
    ds_read_b128 v[28:31], v14 offset:40960
    v_mfma_f32_16x16x32_bf16 v[56:59], v[32:35], v[40:43], v[56:59]
    ds_read_b128 v[32:35], v14 offset:41984
    v_mfma_f32_16x16x32_bf16 v[52:55], v[108:111], v[44:47], v[52:55]
    ds_read_b128 v[108:111], v14 offset:49152
    v_mfma_f32_16x16x32_bf16 v[56:59], v[112:115], v[44:47], v[56:59]
    ds_read_b128 v[112:115], v14 offset:50176
    v_mfma_f32_16x16x32_bf16 v[52:55], v[68:71], v[48:51], v[52:55]
    ds_read_b128 v[68:71], v14 offset:57344
    v_mfma_f32_16x16x32_bf16 v[56:59], v[72:75], v[48:51], v[56:59]
    ds_read_b128 v[72:75], v14 offset:58368
    s_branch L_R_x3bd0_1_2
L_R_x3sd0_1_3:
    buffer_load_dwordx4 v[76:79], v8, s[4:7], s94 offen offset:0 sc1
    buffer_load_dwordx4 v[80:83], v8, s[4:7], s94 offen offset:1024 sc1
    buffer_load_dwordx4 v[84:87], v8, s[4:7], s94 offen offset:2048 sc1
    buffer_load_dwordx4 v[88:91], v8, s[4:7], s94 offen offset:3072 sc1
    buffer_load_dwordx4 v[92:95], v8, s[4:7], s42 offen offset:0 sc1
    buffer_load_dwordx4 v[96:99], v8, s[4:7], s42 offen offset:1024 sc1
    buffer_load_dwordx4 v[100:103], v8, s[4:7], s42 offen offset:2048 sc1
    buffer_load_dwordx4 v[104:107], v8, s[4:7], s42 offen offset:3072 sc1
    buffer_load_dwordx4 v[36:39], v8, s[4:7], s92 offen offset:0 sc1
    buffer_load_dwordx4 v[40:43], v8, s[4:7], s92 offen offset:1024 sc1
    ds_read_b128 v[20:23], v14 offset:32768
    ds_read_b128 v[24:27], v14 offset:33792
    ds_read_b128 v[28:31], v14 offset:40960
    ds_read_b128 v[32:35], v14 offset:41984
    ds_read_b128 v[108:111], v14 offset:49152
    ds_read_b128 v[112:115], v14 offset:50176
    ds_read_b128 v[68:71], v14 offset:57344
    ds_read_b128 v[72:75], v14 offset:58368
    s_branch L_R_x3wd0_1_3
L_R_x3rd0_1_3:
    buffer_load_dwordx4 v[76:79], v8, s[4:7], s94 offen offset:0 sc1
    buffer_load_dwordx4 v[80:83], v8, s[4:7], s94 offen offset:1024 sc1
    buffer_load_dwordx4 v[84:87], v8, s[4:7], s94 offen offset:2048 sc1
    buffer_load_dwordx4 v[88:91], v8, s[4:7], s94 offen offset:3072 sc1
    buffer_load_dwordx4 v[92:95], v8, s[4:7], s42 offen offset:0 sc1
    buffer_load_dwordx4 v[96:99], v8, s[4:7], s42 offen offset:1024 sc1
    buffer_load_dwordx4 v[100:103], v8, s[4:7], s42 offen offset:2048 sc1
    buffer_load_dwordx4 v[104:107], v8, s[4:7], s42 offen offset:3072 sc1
    buffer_load_dwordx4 v[36:39], v8, s[4:7], s92 offen offset:0 sc1
    buffer_load_dwordx4 v[40:43], v8, s[4:7], s92 offen offset:1024 sc1
L_R_x3wd0_1_3:
    s_add_u32 s3, s3, 1
    s_cmp_lt_u32 s3, 40000
    s_cbranch_scc0 L_R_x3abort
    s_waitcnt vmcnt(6)
    v_max3_u32 v19, v76, v77, v78
    v_max_u32 v19, v19, v79
    v_max3_u32 v19, v19, v80, v81
    v_max3_u32 v19, v19, v82, v83
    v_max3_u32 v19, v19, v84, v85
    v_max3_u32 v19, v19, v86, v87
    v_max3_u32 v19, v19, v88, v89
    v_max3_u32 v19, v19, v90, v91
    v_cmp_eq_u32 vcc, -1, v19
    s_cbranch_vccnz L_R_x3rd0_1_3
    s_waitcnt lgkmcnt(0)
    v_mfma_f32_16x16x32_bf16 v[60:63], v[20:23], v[76:79], v[52:55]
    ds_read_b128 v[20:23], v9 offset:0
    v_mfma_f32_16x16x32_bf16 v[64:67], v[24:27], v[76:79], v[56:59]
    ds_read_b128 v[24:27], v9 offset:1024
    v_mfma_f32_16x16x32_bf16 v[60:63], v[28:31], v[80:83], v[60:63]
    ds_read_b128 v[28:31], v9 offset:8192
    v_mfma_f32_16x16x32_bf16 v[64:67], v[32:35], v[80:83], v[64:67]
    ds_read_b128 v[32:35], v9 offset:9216
    v_mfma_f32_16x16x32_bf16 v[60:63], v[108:111], v[84:87], v[60:63]
    ds_read_b128 v[108:111], v9 offset:16384
    v_mfma_f32_16x16x32_bf16 v[64:67], v[112:115], v[84:87], v[64:67]
    ds_read_b128 v[112:115], v9 offset:17408
    v_mfma_f32_16x16x32_bf16 v[60:63], v[68:71], v[88:91], v[60:63]
    ds_read_b128 v[68:71], v9 offset:24576
    v_mfma_f32_16x16x32_bf16 v[64:67], v[72:75], v[88:91], v[64:67]
    ds_read_b128 v[72:75], v9 offset:25600
    s_branch L_R_x3bd0_1_3
L_R_x3sd0_1_4:
    buffer_load_dwordx4 v[92:95], v8, s[4:7], s42 offen offset:0 sc1
    buffer_load_dwordx4 v[96:99], v8, s[4:7], s42 offen offset:1024 sc1
    buffer_load_dwordx4 v[100:103], v8, s[4:7], s42 offen offset:2048 sc1
    buffer_load_dwordx4 v[104:107], v8, s[4:7], s42 offen offset:3072 sc1
    buffer_load_dwordx4 v[36:39], v8, s[4:7], s92 offen offset:0 sc1
    buffer_load_dwordx4 v[40:43], v8, s[4:7], s92 offen offset:1024 sc1
    buffer_load_dwordx4 v[44:47], v8, s[4:7], s92 offen offset:2048 sc1
    buffer_load_dwordx4 v[48:51], v8, s[4:7], s92 offen offset:3072 sc1
    ds_read_b128 v[20:23], v9 offset:0
    ds_read_b128 v[24:27], v9 offset:1024
    ds_read_b128 v[28:31], v9 offset:8192
    ds_read_b128 v[32:35], v9 offset:9216
    ds_read_b128 v[108:111], v9 offset:16384
    ds_read_b128 v[112:115], v9 offset:17408
    ds_read_b128 v[68:71], v9 offset:24576
    ds_read_b128 v[72:75], v9 offset:25600
    s_branch L_R_x3wd0_1_4
L_R_x3rd0_1_4:
    buffer_load_dwordx4 v[92:95], v8, s[4:7], s42 offen offset:0 sc1
    buffer_load_dwordx4 v[96:99], v8, s[4:7], s42 offen offset:1024 sc1
    buffer_load_dwordx4 v[100:103], v8, s[4:7], s42 offen offset:2048 sc1
    buffer_load_dwordx4 v[104:107], v8, s[4:7], s42 offen offset:3072 sc1
    buffer_load_dwordx4 v[36:39], v8, s[4:7], s92 offen offset:0 sc1
    buffer_load_dwordx4 v[40:43], v8, s[4:7], s92 offen offset:1024 sc1
    buffer_load_dwordx4 v[44:47], v8, s[4:7], s92 offen offset:2048 sc1
    buffer_load_dwordx4 v[48:51], v8, s[4:7], s92 offen offset:3072 sc1
L_R_x3wd0_1_4:
    s_add_u32 s3, s3, 1
    s_cmp_lt_u32 s3, 40000
    s_cbranch_scc0 L_R_x3abort
    s_waitcnt vmcnt(4)
    v_max3_u32 v19, v92, v93, v94
    v_max_u32 v19, v19, v95
    v_max3_u32 v19, v19, v96, v97
    v_max3_u32 v19, v19, v98, v99
    v_max3_u32 v19, v19, v100, v101
    v_max3_u32 v19, v19, v102, v103
    v_max3_u32 v19, v19, v104, v105
    v_max3_u32 v19, v19, v106, v107
    v_cmp_eq_u32 vcc, -1, v19
    s_cbranch_vccnz L_R_x3rd0_1_4
    s_waitcnt lgkmcnt(0)
    v_mfma_f32_16x16x32_bf16 v[52:55], v[20:23], v[92:95], v[60:63]
    ds_read_b128 v[20:23], v9 offset:32768
    v_mfma_f32_16x16x32_bf16 v[56:59], v[24:27], v[92:95], v[64:67]
    ds_read_b128 v[24:27], v9 offset:33792
    v_mfma_f32_16x16x32_bf16 v[52:55], v[28:31], v[96:99], v[52:55]
    ds_read_b128 v[28:31], v9 offset:40960
    v_mfma_f32_16x16x32_bf16 v[56:59], v[32:35], v[96:99], v[56:59]
    ds_read_b128 v[32:35], v9 offset:41984
    v_mfma_f32_16x16x32_bf16 v[52:55], v[108:111], v[100:103], v[52:55]
    ds_read_b128 v[108:111], v9 offset:49152
    v_mfma_f32_16x16x32_bf16 v[56:59], v[112:115], v[100:103], v[56:59]
    ds_read_b128 v[112:115], v9 offset:50176
    v_mfma_f32_16x16x32_bf16 v[52:55], v[68:71], v[104:107], v[52:55]
    ds_read_b128 v[68:71], v9 offset:57344
    v_mfma_f32_16x16x32_bf16 v[56:59], v[72:75], v[104:107], v[56:59]
    ds_read_b128 v[72:75], v9 offset:58368
    s_branch L_R_x3bd0_1_4
L_R_x3sd0_1_5:
    buffer_load_dwordx4 v[36:39], v8, s[4:7], s92 offen offset:0 sc1
    buffer_load_dwordx4 v[40:43], v8, s[4:7], s92 offen offset:1024 sc1
    buffer_load_dwordx4 v[44:47], v8, s[4:7], s92 offen offset:2048 sc1
    buffer_load_dwordx4 v[48:51], v8, s[4:7], s92 offen offset:3072 sc1
    ds_read_b128 v[20:23], v9 offset:32768
    ds_read_b128 v[24:27], v9 offset:33792
    ds_read_b128 v[28:31], v9 offset:40960
    ds_read_b128 v[32:35], v9 offset:41984
    ds_read_b128 v[108:111], v9 offset:49152
    ds_read_b128 v[112:115], v9 offset:50176
    ds_read_b128 v[68:71], v9 offset:57344
    ds_read_b128 v[72:75], v9 offset:58368
    s_branch L_R_x3wd0_1_5
L_R_x3rd0_1_5:
    buffer_load_dwordx4 v[36:39], v8, s[4:7], s92 offen offset:0 sc1
    buffer_load_dwordx4 v[40:43], v8, s[4:7], s92 offen offset:1024 sc1
    buffer_load_dwordx4 v[44:47], v8, s[4:7], s92 offen offset:2048 sc1
    buffer_load_dwordx4 v[48:51], v8, s[4:7], s92 offen offset:3072 sc1
L_R_x3wd0_1_5:
    s_add_u32 s3, s3, 1
    s_cmp_lt_u32 s3, 40000
    s_cbranch_scc0 L_R_x3abort
    s_waitcnt vmcnt(0)
    v_max3_u32 v19, v36, v37, v38
    v_max_u32 v19, v19, v39
    v_max3_u32 v19, v19, v40, v41
    v_max3_u32 v19, v19, v42, v43
    v_max3_u32 v19, v19, v44, v45
    v_max3_u32 v19, v19, v46, v47
    v_max3_u32 v19, v19, v48, v49
    v_max3_u32 v19, v19, v50, v51
    v_cmp_eq_u32 vcc, -1, v19
    s_cbranch_vccnz L_R_x3rd0_1_5
    s_waitcnt lgkmcnt(0)
    v_mfma_f32_16x16x32_bf16 v[60:63], v[20:23], v[36:39], v[52:55]
    v_mfma_f32_16x16x32_bf16 v[64:67], v[24:27], v[36:39], v[56:59]
    v_mfma_f32_16x16x32_bf16 v[60:63], v[28:31], v[40:43], v[60:63]
    v_mfma_f32_16x16x32_bf16 v[64:67], v[32:35], v[40:43], v[64:67]
    v_mfma_f32_16x16x32_bf16 v[60:63], v[108:111], v[44:47], v[60:63]
    v_mfma_f32_16x16x32_bf16 v[64:67], v[112:115], v[44:47], v[64:67]
    v_mfma_f32_16x16x32_bf16 v[60:63], v[68:71], v[48:51], v[60:63]
    v_mfma_f32_16x16x32_bf16 v[64:67], v[72:75], v[48:51], v[64:67]
    s_branch L_R_x3bd0_1_5
L_R_x3abort:
    s_mov_b32 s3, 7
    s_branch L_abort
L_rt_72:
    buffer_load_dwordx4 v[20:23], v0, s[4:7], s32 offen offset:0 sc1
    buffer_load_dwordx4 v[24:27], v0, s[4:7], s32 offen offset:1024 sc1
    buffer_load_dwordx4 v[28:31], v0, s[4:7], s32 offen offset:2048 sc1
    buffer_load_dwordx4 v[32:35], v0, s[4:7], s32 offen offset:3072 sc1
    s_waitcnt vmcnt(0)
    s_add_u32 s3, s3, 1
    s_cmp_lt_u32 s3, 40000
    s_cbranch_scc1 L_R_x1l
    s_mov_b32 s3, 2
    s_branch L_abort
L_rt_73:
    s_buffer_load_dwordx2 s[86:87], s[4:7], s97 glc
    s_waitcnt lgkmcnt(0)
    s_add_u32 s3, s3, 1
    s_cmp_lt_u32 s3, 40000
    s_cbranch_scc1 L_R_kvf
    s_mov_b32 s3, 3
    s_branch L_abort
L_rt_74:
    buffer_load_dwordx4 v[36:39], v0, s[4:7], s33 offen offset:0 sc1
    buffer_load_dwordx4 v[40:43], v0, s[4:7], s33 offen offset:1024 sc1
    buffer_load_dwordx4 v[44:47], v0, s[4:7], s33 offen offset:2048 sc1
    buffer_load_dwordx4 v[48:51], v0, s[4:7], s33 offen offset:3072 sc1
    s_waitcnt vmcnt(0)
    s_add_u32 s3, s3, 1
    s_cmp_lt_u32 s3, 40000
    s_cbranch_scc1 L_R_x1r
    s_mov_b32 s3, 4
    s_branch L_abort
L_rt_75:
    buffer_load_dwordx4 v[52:55], v0, s[4:7], s39 offen sc1
    s_waitcnt vmcnt(0)
    s_add_u32 s3, s3, 1
    s_cmp_lt_u32 s3, 40000
    s_cbranch_scc1 L_R_x2
    s_mov_b32 s3, 5
    s_branch L_abort
L_rt_76:
    buffer_load_dwordx2 v[78:79], v7, s[4:7], s40 offen sc1
    buffer_load_dwordx2 v[82:83], v7, s[4:7], s40 offen offset:8 sc1
    s_waitcnt vmcnt(0)
    s_add_u32 s3, s3, 1
    s_cmp_lt_u32 s3, 40000
    s_cbranch_scc1 L_R_x2v
    s_mov_b32 s3, 6
    s_branch L_abort
L_rt_77:
    buffer_load_dwordx4 v[20:23], v108, s[4:7], s32 offen offset:0 sc1
    buffer_load_dwordx4 v[24:27], v108, s[4:7], s32 offen offset:1024 sc1
    buffer_load_dwordx4 v[28:31], v108, s[4:7], s32 offen offset:2048 sc1
    buffer_load_dwordx4 v[32:35], v108, s[4:7], s32 offen offset:3072 sc1
    s_add_u32 s3, s3, 1
    s_cmp_lt_u32 s3, 40000
    s_cbranch_scc1 L_R_o1r
    s_mov_b32 s3, 8
    s_branch L_abort
L_R_done:
    s_waitcnt vmcnt(0)
    s_mov_b32 s88, 1
    s_buffer_atomic_add s88, s[4:7], s54
    s_waitcnt lgkmcnt(0)
    v_mov_b32 v117, 0
    s_endpgm
L_code_end:
.section .rodata,"a"
.p2align 6
.amdhsa_kernel interleave_layers__memory_aug_recurrent_mem_tr__glu_gated_geglu__prompt_kernel
.amdhsa_next_free_vgpr 512
.amdhsa_next_free_sgpr 102
.amdhsa_accum_offset 256
.amdhsa_group_segment_fixed_size 0
.amdhsa_kernarg_size 112
.amdhsa_user_sgpr_count 2
.amdhsa_user_sgpr_kernarg_segment_ptr 1
.amdhsa_system_sgpr_workgroup_id_x 1
.amdhsa_float_denorm_mode_32 3
.end_amdhsa_kernel
```
